```python
import torch

def _softmax(x, axis=-1):
    return torch.softmax(x, dim=axis)

def _gelu(x):
    return torch.nn.functional.gelu(x, approximate='tanh')

def _silu(x):
    return torch.nn.functional.silu(x)

def _sigmoid(x):
    return torch.sigmoid(x)

def _layernorm(x, axis=-1, eps=1e-05):
    m = x.mean(dim=axis, keepdim=True)
    v = x.var(dim=axis, keepdim=True, unbiased=False)
    return (x - m) / torch.sqrt(v + eps)

def _scatter_add(tgt, idx, src, axis=0):
    return tgt.clone().index_add_(axis, idx, src)

def _segment_sum(src, seg, n):
    out = torch.zeros((n,) + src.shape[1:], dtype=src.dtype)
    return out.index_add_(0, seg, src)

def _pad(x, pw):
    flat = tuple((v for pair in reversed(pw) for v in pair))
    return torch.nn.functional.pad(x, flat)
kernel_name = 'sequential_preLN__memory_aug_recurrent_mem_tr__dense_activation_relu__prompt'

def setup_inputs():

    _w = lambda a: (lambda t: t.to(torch.bfloat16) if t.is_floating_point() else t)(torch.as_tensor(a))

    def _A_setup():
        B, S, Dm = (1, 2048, 640)
        H, Dh = (32, 128)
        M, seg = (8, 32)
        seg = min(seg, S)
        S = S // seg * seg
        return {'x': _w((lambda *s: torch.randn(*s, dtype=torch.bfloat16) * 0.05)(B, S, Dm)), 'mem0': _w((lambda *s: torch.randn(*s, dtype=torch.bfloat16) * 0.2)(B, M, Dm)), 'Wq': _w((lambda *s: torch.randn(*s, dtype=torch.bfloat16) * 1.6)(Dm, H, Dh) * Dm ** (-0.5)), 'Wk': _w((lambda *s: torch.randn(*s, dtype=torch.bfloat16) * 1.6)(Dm, H, Dh) * Dm ** (-0.5)), 'Wv': _w((lambda *s: torch.randn(*s, dtype=torch.bfloat16) * 0.2)(Dm, H, Dh) * Dm ** (-0.5)), 'Wo': _w((lambda *s: torch.randn(*s, dtype=torch.bfloat16) * 0.2)(H, Dh, Dm) * (H * Dh) ** (-0.5)), 'seg_len': seg}
    _A_in = _A_setup()

    def _B_setup():
        B, S, D, Dff = (1, 2048, 640, 1728)
        return {'x': _w((lambda *s: torch.randn(*s, dtype=torch.bfloat16) * 0.05)(B, S, D)), 'w1': _w((lambda *s: torch.randn(*s, dtype=torch.bfloat16) * 0.05)(D, Dff)), 'w2': _w((lambda *s: torch.randn(*s, dtype=torch.bfloat16) * 0.05)(Dff, D))}
    _B_in = _B_setup()
    return {'A_x': _A_in['x'], 'A_mem0': _A_in['mem0'], 'A_Wq': _A_in['Wq'], 'A_Wk': _A_in['Wk'], 'A_Wv': _A_in['Wv'], 'A_Wo': _A_in['Wo'], 'A_seg_len': _A_in['seg_len'], 'B_x': _B_in['x'], 'B_w1': _B_in['w1'], 'B_w2': _B_in['w2']}

def reference(A_x, A_mem0, A_Wq, A_Wk, A_Wv, A_Wo, A_seg_len, B_x, B_w1, B_w2):

    def _A_ref(x, mem0, Wq, Wk, Wv, Wo, seg_len):
        B, S, Dm = x.shape
        H, Dh = (Wq.shape[1], Wq.shape[2])
        M = mem0.shape[1]
        scale = Dh ** (-0.5)
        n_seg = S // seg_len
        L = M + seg_len
        idx = torch.arange(L)
        mask = (idx[:, None] < M) | (idx[:, None] >= idx[None, :])
        mem = mem0
        outs = []
        for s in range(n_seg):
            xs = x[:, s * seg_len:(s + 1) * seg_len, :].clone()
            h = torch.concatenate([mem, xs], axis=1)
            q = torch.einsum('btd,dhe->bhte', h, Wq)
            k = torch.einsum('btd,dhe->bhte', h, Wk)
            v = torch.einsum('btd,dhe->bhte', h, Wv)
            scores = torch.einsum('bhqe,bhke->bhqk', q, k) * scale
            scores = torch.where(mask[None, None], scores, -1000000000.0)
            p = _softmax(scores, axis=-1)
            o = torch.einsum('bhqk,bhke->bhqe', p, v)
            o = torch.einsum('bhte,hed->btd', o, Wo)
            mem = o[:, :M, :].clone()
            outs.append(o[:, M:, :])
        return torch.concatenate(outs, axis=1)

    def _B_ref(x, w1, w2):
        h = torch.einsum('bsd,df->bsf', x, w1)
        zero = torch.zeros_like(h)
        h = torch.maximum(h, zero)
        return torch.einsum('bsf,fd->bsd', h, w2)
    x = A_x
    h = x + _A_ref(_layernorm(x, axis=-1), A_mem0, A_Wq, A_Wk, A_Wv, A_Wo, A_seg_len)
    h2 = h + _B_ref(_layernorm(h, axis=-1), B_w1, B_w2)
    return h2
```

```asm
; @launch kernel=prep_kernel grid=(161,1,1) block=(256,1,1) lds=0
; @launch kernel=rec_kernel grid=(256,1,1) block=(256,1,1) lds=163840
.amdgcn_target "amdgcn-amd-amdhsa--gfx950"
.text
.globl prep_kernel
.p2align 8
.type prep_kernel,@function
prep_kernel:
    s_cmp_ge_u32 s2, 161
    s_cbranch_scc1 PD_1
    s_load_dwordx2 s[4:5], s[0:1], 0
    s_load_dwordx2 s[6:7], s[0:1], 96
    s_waitcnt lgkmcnt(0)
    s_cmp_ge_u32 s2, 128
    s_cbranch_scc1 PC_2
    s_add_u32 s8, s4, 0x0
    s_addc_u32 s9, s5, 0
    s_and_b32 s9, s9, 0xffff
    s_mov_b32 s10, 0x280000
    s_mov_b32 s11, 0x20000
    s_add_u32 s12, s6, 0x0
    s_addc_u32 s13, s7, 0
    s_and_b32 s13, s13, 0xffff
    s_mov_b32 s14, 0x280000
    s_mov_b32 s15, 0x20000
    s_mul_i32 s16, s2, 20480
    v_lshrrev_b32 v1, 4, v0
    v_mul_u32_u24 v1, 1280, v1
    v_and_b32 v2, 15, v0
    v_lshl_add_u32 v1, v2, 4, v1
    buffer_load_dwordx4 v[48:51], v1, s[8:11], s16 offen offset:0
    buffer_load_dwordx4 v[52:55], v1, s[8:11], s16 offen offset:256
    buffer_load_dwordx4 v[56:59], v1, s[8:11], s16 offen offset:512
    buffer_load_dwordx4 v[60:63], v1, s[8:11], s16 offen offset:768
    buffer_load_dwordx4 v[64:67], v1, s[8:11], s16 offen offset:1024
    v_and_b32 v3, 15, v0
    v_lshrrev_b32 v2, 2, v3
    v_lshlrev_b32 v2, 10, v2
    v_and_b32 v3, 3, v3
    v_lshl_add_u32 v2, v3, 8, v2
    v_lshrrev_b32 v3, 4, v0
    v_lshl_add_u32 v2, v3, 4, v2
    s_waitcnt vmcnt(4)
    v_lshlrev_b32 v8, 16, v48
    v_and_b32 v9, 0xffff0000, v48
    v_lshlrev_b32 v10, 16, v49
    v_and_b32 v11, 0xffff0000, v49
    v_lshlrev_b32 v12, 16, v50
    v_and_b32 v13, 0xffff0000, v50
    v_lshlrev_b32 v14, 16, v51
    v_and_b32 v15, 0xffff0000, v51
    s_waitcnt vmcnt(3)
    v_lshlrev_b32 v16, 16, v52
    v_and_b32 v17, 0xffff0000, v52
    v_lshlrev_b32 v18, 16, v53
    v_and_b32 v19, 0xffff0000, v53
    v_lshlrev_b32 v20, 16, v54
    v_and_b32 v21, 0xffff0000, v54
    v_lshlrev_b32 v22, 16, v55
    v_and_b32 v23, 0xffff0000, v55
    s_waitcnt vmcnt(2)
    v_lshlrev_b32 v24, 16, v56
    v_and_b32 v25, 0xffff0000, v56
    v_lshlrev_b32 v26, 16, v57
    v_and_b32 v27, 0xffff0000, v57
    v_lshlrev_b32 v28, 16, v58
    v_and_b32 v29, 0xffff0000, v58
    v_lshlrev_b32 v30, 16, v59
    v_and_b32 v31, 0xffff0000, v59
    s_waitcnt vmcnt(1)
    v_lshlrev_b32 v32, 16, v60
    v_and_b32 v33, 0xffff0000, v60
    v_lshlrev_b32 v34, 16, v61
    v_and_b32 v35, 0xffff0000, v61
    v_lshlrev_b32 v36, 16, v62
    v_and_b32 v37, 0xffff0000, v62
    v_lshlrev_b32 v38, 16, v63
    v_and_b32 v39, 0xffff0000, v63
    s_waitcnt vmcnt(0)
    v_lshlrev_b32 v40, 16, v64
    v_and_b32 v41, 0xffff0000, v64
    v_lshlrev_b32 v42, 16, v65
    v_and_b32 v43, 0xffff0000, v65
    v_lshlrev_b32 v44, 16, v66
    v_and_b32 v45, 0xffff0000, v66
    v_lshlrev_b32 v46, 16, v67
    v_and_b32 v47, 0xffff0000, v67
    v_add_f32 v4, v8, v9
    v_add_f32 v6, v10, v11
    v_add_f32 v4, v4, v12
    v_add_f32 v6, v6, v13
    v_add_f32 v4, v4, v14
    v_add_f32 v6, v6, v15
    v_add_f32 v4, v4, v16
    v_add_f32 v6, v6, v17
    v_add_f32 v4, v4, v18
    v_add_f32 v6, v6, v19
    v_add_f32 v4, v4, v20
    v_add_f32 v6, v6, v21
    v_add_f32 v4, v4, v22
    v_add_f32 v6, v6, v23
    v_add_f32 v4, v4, v24
    v_add_f32 v6, v6, v25
    v_add_f32 v4, v4, v26
    v_add_f32 v6, v6, v27
    v_add_f32 v4, v4, v28
    v_add_f32 v6, v6, v29
    v_add_f32 v4, v4, v30
    v_add_f32 v6, v6, v31
    v_add_f32 v4, v4, v32
    v_add_f32 v6, v6, v33
    v_add_f32 v4, v4, v34
    v_add_f32 v6, v6, v35
    v_add_f32 v4, v4, v36
    v_add_f32 v6, v6, v37
    v_add_f32 v4, v4, v38
    v_add_f32 v6, v6, v39
    v_add_f32 v4, v4, v40
    v_add_f32 v6, v6, v41
    v_add_f32 v4, v4, v42
    v_add_f32 v6, v6, v43
    v_add_f32 v4, v4, v44
    v_add_f32 v6, v6, v45
    v_add_f32 v4, v4, v46
    v_add_f32 v6, v6, v47
    v_add_f32 v4, v4, v6
    s_nop 1
    v_add_f32_dpp v4, v4, v4 row_ror:8 row_mask:0xf bank_mask:0xf
    s_nop 1
    v_add_f32_dpp v4, v4, v4 row_ror:4 row_mask:0xf bank_mask:0xf
    s_nop 1
    v_add_f32_dpp v4, v4, v4 row_ror:2 row_mask:0xf bank_mask:0xf
    s_nop 1
    v_add_f32_dpp v4, v4, v4 row_ror:1 row_mask:0xf bank_mask:0xf
    v_mul_f32 v4, 0x3acccccd, v4
    v_mov_b32 v6, 0
    v_mov_b32 v5, 0
    v_sub_f32 v7, v8, v4
    v_fmac_f32 v6, v7, v7
    v_sub_f32 v7, v9, v4
    v_fmac_f32 v5, v7, v7
    v_sub_f32 v7, v10, v4
    v_fmac_f32 v6, v7, v7
    v_sub_f32 v7, v11, v4
    v_fmac_f32 v5, v7, v7
    v_sub_f32 v7, v12, v4
    v_fmac_f32 v6, v7, v7
    v_sub_f32 v7, v13, v4
    v_fmac_f32 v5, v7, v7
    v_sub_f32 v7, v14, v4
    v_fmac_f32 v6, v7, v7
    v_sub_f32 v7, v15, v4
    v_fmac_f32 v5, v7, v7
    v_sub_f32 v7, v16, v4
    v_fmac_f32 v6, v7, v7
    v_sub_f32 v7, v17, v4
    v_fmac_f32 v5, v7, v7
    v_sub_f32 v7, v18, v4
    v_fmac_f32 v6, v7, v7
    v_sub_f32 v7, v19, v4
    v_fmac_f32 v5, v7, v7
    v_sub_f32 v7, v20, v4
    v_fmac_f32 v6, v7, v7
    v_sub_f32 v7, v21, v4
    v_fmac_f32 v5, v7, v7
    v_sub_f32 v7, v22, v4
    v_fmac_f32 v6, v7, v7
    v_sub_f32 v7, v23, v4
    v_fmac_f32 v5, v7, v7
    v_sub_f32 v7, v24, v4
    v_fmac_f32 v6, v7, v7
    v_sub_f32 v7, v25, v4
    v_fmac_f32 v5, v7, v7
    v_sub_f32 v7, v26, v4
    v_fmac_f32 v6, v7, v7
    v_sub_f32 v7, v27, v4
    v_fmac_f32 v5, v7, v7
    v_sub_f32 v7, v28, v4
    v_fmac_f32 v6, v7, v7
    v_sub_f32 v7, v29, v4
    v_fmac_f32 v5, v7, v7
    v_sub_f32 v7, v30, v4
    v_fmac_f32 v6, v7, v7
    v_sub_f32 v7, v31, v4
    v_fmac_f32 v5, v7, v7
    v_sub_f32 v7, v32, v4
    v_fmac_f32 v6, v7, v7
    v_sub_f32 v7, v33, v4
    v_fmac_f32 v5, v7, v7
    v_sub_f32 v7, v34, v4
    v_fmac_f32 v6, v7, v7
    v_sub_f32 v7, v35, v4
    v_fmac_f32 v5, v7, v7
    v_sub_f32 v7, v36, v4
    v_fmac_f32 v6, v7, v7
    v_sub_f32 v7, v37, v4
    v_fmac_f32 v5, v7, v7
    v_sub_f32 v7, v38, v4
    v_fmac_f32 v6, v7, v7
    v_sub_f32 v7, v39, v4
    v_fmac_f32 v5, v7, v7
    v_sub_f32 v7, v40, v4
    v_fmac_f32 v6, v7, v7
    v_sub_f32 v7, v41, v4
    v_fmac_f32 v5, v7, v7
    v_sub_f32 v7, v42, v4
    v_fmac_f32 v6, v7, v7
    v_sub_f32 v7, v43, v4
    v_fmac_f32 v5, v7, v7
    v_sub_f32 v7, v44, v4
    v_fmac_f32 v6, v7, v7
    v_sub_f32 v7, v45, v4
    v_fmac_f32 v5, v7, v7
    v_sub_f32 v7, v46, v4
    v_fmac_f32 v6, v7, v7
    v_sub_f32 v7, v47, v4
    v_fmac_f32 v5, v7, v7
    v_add_f32 v6, v6, v5
    s_nop 1
    v_add_f32_dpp v6, v6, v6 row_ror:8 row_mask:0xf bank_mask:0xf
    s_nop 1
    v_add_f32_dpp v6, v6, v6 row_ror:4 row_mask:0xf bank_mask:0xf
    s_nop 1
    v_add_f32_dpp v6, v6, v6 row_ror:2 row_mask:0xf bank_mask:0xf
    s_nop 1
    v_add_f32_dpp v6, v6, v6 row_ror:1 row_mask:0xf bank_mask:0xf
    v_mul_f32 v6, 0x3acccccd, v6
    v_cvt_pk_bf16_f32 v6, v6, v6
    v_and_b32 v6, 0xffff0000, v6
    v_add_f32 v6, 0x3727c5ac, v6
    v_cvt_pk_bf16_f32 v6, v6, v6
    v_and_b32 v6, 0xffff0000, v6
    v_sqrt_f32 v6, v6
    s_nop 0
    v_cvt_pk_bf16_f32 v6, v6, v6
    v_and_b32 v6, 0xffff0000, v6
    v_rcp_f32 v6, v6
    v_cvt_pk_bf16_f32 v4, v4, v4
    v_and_b32 v4, 0xffff0000, v4
    v_sub_f32 v8, v8, v4
    v_sub_f32 v9, v9, v4
    v_cvt_pk_bf16_f32 v48, v8, v9
    v_lshlrev_b32 v8, 16, v48
    v_and_b32 v9, 0xffff0000, v48
    v_mul_f32 v8, v8, v6
    v_mul_f32 v9, v9, v6
    v_cvt_pk_bf16_f32 v48, v8, v9
    v_sub_f32 v10, v10, v4
    v_sub_f32 v11, v11, v4
    v_cvt_pk_bf16_f32 v49, v10, v11
    v_lshlrev_b32 v10, 16, v49
    v_and_b32 v11, 0xffff0000, v49
    v_mul_f32 v10, v10, v6
    v_mul_f32 v11, v11, v6
    v_cvt_pk_bf16_f32 v49, v10, v11
    v_sub_f32 v12, v12, v4
    v_sub_f32 v13, v13, v4
    v_cvt_pk_bf16_f32 v50, v12, v13
    v_lshlrev_b32 v12, 16, v50
    v_and_b32 v13, 0xffff0000, v50
    v_mul_f32 v12, v12, v6
    v_mul_f32 v13, v13, v6
    v_cvt_pk_bf16_f32 v50, v12, v13
    v_sub_f32 v14, v14, v4
    v_sub_f32 v15, v15, v4
    v_cvt_pk_bf16_f32 v51, v14, v15
    v_lshlrev_b32 v14, 16, v51
    v_and_b32 v15, 0xffff0000, v51
    v_mul_f32 v14, v14, v6
    v_mul_f32 v15, v15, v6
    v_cvt_pk_bf16_f32 v51, v14, v15
    v_add_u32 v7, 0, v2
    buffer_store_dwordx4 v[48:51], v7, s[12:15], s16 offen
    v_sub_f32 v16, v16, v4
    v_sub_f32 v17, v17, v4
    v_cvt_pk_bf16_f32 v52, v16, v17
    v_lshlrev_b32 v16, 16, v52
    v_and_b32 v17, 0xffff0000, v52
    v_mul_f32 v16, v16, v6
    v_mul_f32 v17, v17, v6
    v_cvt_pk_bf16_f32 v52, v16, v17
    v_sub_f32 v18, v18, v4
    v_sub_f32 v19, v19, v4
    v_cvt_pk_bf16_f32 v53, v18, v19
    v_lshlrev_b32 v18, 16, v53
    v_and_b32 v19, 0xffff0000, v53
    v_mul_f32 v18, v18, v6
    v_mul_f32 v19, v19, v6
    v_cvt_pk_bf16_f32 v53, v18, v19
    v_sub_f32 v20, v20, v4
    v_sub_f32 v21, v21, v4
    v_cvt_pk_bf16_f32 v54, v20, v21
    v_lshlrev_b32 v20, 16, v54
    v_and_b32 v21, 0xffff0000, v54
    v_mul_f32 v20, v20, v6
    v_mul_f32 v21, v21, v6
    v_cvt_pk_bf16_f32 v54, v20, v21
    v_sub_f32 v22, v22, v4
    v_sub_f32 v23, v23, v4
    v_cvt_pk_bf16_f32 v55, v22, v23
    v_lshlrev_b32 v22, 16, v55
    v_and_b32 v23, 0xffff0000, v55
    v_mul_f32 v22, v22, v6
    v_mul_f32 v23, v23, v6
    v_cvt_pk_bf16_f32 v55, v22, v23
    v_add_u32 v7, 4096, v2
    buffer_store_dwordx4 v[52:55], v7, s[12:15], s16 offen
    v_sub_f32 v24, v24, v4
    v_sub_f32 v25, v25, v4
    v_cvt_pk_bf16_f32 v56, v24, v25
    v_lshlrev_b32 v24, 16, v56
    v_and_b32 v25, 0xffff0000, v56
    v_mul_f32 v24, v24, v6
    v_mul_f32 v25, v25, v6
    v_cvt_pk_bf16_f32 v56, v24, v25
    v_sub_f32 v26, v26, v4
    v_sub_f32 v27, v27, v4
    v_cvt_pk_bf16_f32 v57, v26, v27
    v_lshlrev_b32 v26, 16, v57
    v_and_b32 v27, 0xffff0000, v57
    v_mul_f32 v26, v26, v6
    v_mul_f32 v27, v27, v6
    v_cvt_pk_bf16_f32 v57, v26, v27
    v_sub_f32 v28, v28, v4
    v_sub_f32 v29, v29, v4
    v_cvt_pk_bf16_f32 v58, v28, v29
    v_lshlrev_b32 v28, 16, v58
    v_and_b32 v29, 0xffff0000, v58
    v_mul_f32 v28, v28, v6
    v_mul_f32 v29, v29, v6
    v_cvt_pk_bf16_f32 v58, v28, v29
    v_sub_f32 v30, v30, v4
    v_sub_f32 v31, v31, v4
    v_cvt_pk_bf16_f32 v59, v30, v31
    v_lshlrev_b32 v30, 16, v59
    v_and_b32 v31, 0xffff0000, v59
    v_mul_f32 v30, v30, v6
    v_mul_f32 v31, v31, v6
    v_cvt_pk_bf16_f32 v59, v30, v31
    v_add_u32 v7, 8192, v2
    buffer_store_dwordx4 v[56:59], v7, s[12:15], s16 offen
    v_sub_f32 v32, v32, v4
    v_sub_f32 v33, v33, v4
    v_cvt_pk_bf16_f32 v60, v32, v33
    v_lshlrev_b32 v32, 16, v60
    v_and_b32 v33, 0xffff0000, v60
    v_mul_f32 v32, v32, v6
    v_mul_f32 v33, v33, v6
    v_cvt_pk_bf16_f32 v60, v32, v33
    v_sub_f32 v34, v34, v4
    v_sub_f32 v35, v35, v4
    v_cvt_pk_bf16_f32 v61, v34, v35
    v_lshlrev_b32 v34, 16, v61
    v_and_b32 v35, 0xffff0000, v61
    v_mul_f32 v34, v34, v6
    v_mul_f32 v35, v35, v6
    v_cvt_pk_bf16_f32 v61, v34, v35
    v_sub_f32 v36, v36, v4
    v_sub_f32 v37, v37, v4
    v_cvt_pk_bf16_f32 v62, v36, v37
    v_lshlrev_b32 v36, 16, v62
    v_and_b32 v37, 0xffff0000, v62
    v_mul_f32 v36, v36, v6
    v_mul_f32 v37, v37, v6
    v_cvt_pk_bf16_f32 v62, v36, v37
    v_sub_f32 v38, v38, v4
    v_sub_f32 v39, v39, v4
    v_cvt_pk_bf16_f32 v63, v38, v39
    v_lshlrev_b32 v38, 16, v63
    v_and_b32 v39, 0xffff0000, v63
    v_mul_f32 v38, v38, v6
    v_mul_f32 v39, v39, v6
    v_cvt_pk_bf16_f32 v63, v38, v39
    v_add_u32 v7, 12288, v2
    buffer_store_dwordx4 v[60:63], v7, s[12:15], s16 offen
    v_sub_f32 v40, v40, v4
    v_sub_f32 v41, v41, v4
    v_cvt_pk_bf16_f32 v64, v40, v41
    v_lshlrev_b32 v40, 16, v64
    v_and_b32 v41, 0xffff0000, v64
    v_mul_f32 v40, v40, v6
    v_mul_f32 v41, v41, v6
    v_cvt_pk_bf16_f32 v64, v40, v41
    v_sub_f32 v42, v42, v4
    v_sub_f32 v43, v43, v4
    v_cvt_pk_bf16_f32 v65, v42, v43
    v_lshlrev_b32 v42, 16, v65
    v_and_b32 v43, 0xffff0000, v65
    v_mul_f32 v42, v42, v6
    v_mul_f32 v43, v43, v6
    v_cvt_pk_bf16_f32 v65, v42, v43
    v_sub_f32 v44, v44, v4
    v_sub_f32 v45, v45, v4
    v_cvt_pk_bf16_f32 v66, v44, v45
    v_lshlrev_b32 v44, 16, v66
    v_and_b32 v45, 0xffff0000, v66
    v_mul_f32 v44, v44, v6
    v_mul_f32 v45, v45, v6
    v_cvt_pk_bf16_f32 v66, v44, v45
    v_sub_f32 v46, v46, v4
    v_sub_f32 v47, v47, v4
    v_cvt_pk_bf16_f32 v67, v46, v47
    v_lshlrev_b32 v46, 16, v67
    v_and_b32 v47, 0xffff0000, v67
    v_mul_f32 v46, v46, v6
    v_mul_f32 v47, v47, v6
    v_cvt_pk_bf16_f32 v67, v46, v47
    v_add_u32 v7, 16384, v2
    buffer_store_dwordx4 v[64:67], v7, s[12:15], s16 offen
    s_endpgm
PC_2:
    s_add_u32 s8, s6, 0x8000000
    s_addc_u32 s9, s7, 0
    s_and_b32 s9, s9, 0xffff
    s_mov_b32 s10, 0x400000
    s_mov_b32 s11, 0x20000
    s_cmp_eq_u32 s2, 160
    s_cbranch_scc1 PM_3
    s_sub_u32 s16, s2, 128
    s_lshl_b32 s16, s16, 16
    s_add_u32 s16, s16, 20480
    v_mov_b32 v4, -1
    s_cmp_lt_u32 s2, 158
    s_cbranch_scc1 PC_4
    s_sub_u32 s16, s2, 158
    s_lshl_b32 s16, s16, 16
    s_add_u32 s16, s16, 0x300000
    v_mov_b32 v4, 0
PC_4:
    v_mov_b32 v5, v4
    v_mov_b32 v6, v4
    v_mov_b32 v7, v4
    v_lshlrev_b32 v1, 4, v0
    buffer_store_dwordx4 v[4:7], v1, s[8:11], s16 offen
    v_add_u32 v1, 0x1000, v1
    buffer_store_dwordx4 v[4:7], v1, s[8:11], s16 offen
    v_add_u32 v1, 0x1000, v1
    buffer_store_dwordx4 v[4:7], v1, s[8:11], s16 offen
    v_add_u32 v1, 0x1000, v1
    buffer_store_dwordx4 v[4:7], v1, s[8:11], s16 offen
    v_add_u32 v1, 0x1000, v1
    buffer_store_dwordx4 v[4:7], v1, s[8:11], s16 offen
    v_add_u32 v1, 0x1000, v1
    buffer_store_dwordx4 v[4:7], v1, s[8:11], s16 offen
    v_add_u32 v1, 0x1000, v1
    buffer_store_dwordx4 v[4:7], v1, s[8:11], s16 offen
    v_add_u32 v1, 0x1000, v1
    buffer_store_dwordx4 v[4:7], v1, s[8:11], s16 offen
    v_add_u32 v1, 0x1000, v1
    buffer_store_dwordx4 v[4:7], v1, s[8:11], s16 offen
    v_add_u32 v1, 0x1000, v1
    buffer_store_dwordx4 v[4:7], v1, s[8:11], s16 offen
    v_add_u32 v1, 0x1000, v1
    buffer_store_dwordx4 v[4:7], v1, s[8:11], s16 offen
    v_add_u32 v1, 0x1000, v1
    buffer_store_dwordx4 v[4:7], v1, s[8:11], s16 offen
    v_add_u32 v1, 0x1000, v1
    buffer_store_dwordx4 v[4:7], v1, s[8:11], s16 offen
    v_add_u32 v1, 0x1000, v1
    buffer_store_dwordx4 v[4:7], v1, s[8:11], s16 offen
    v_add_u32 v1, 0x1000, v1
    buffer_store_dwordx4 v[4:7], v1, s[8:11], s16 offen
    v_add_u32 v1, 0x1000, v1
    buffer_store_dwordx4 v[4:7], v1, s[8:11], s16 offen
    v_add_u32 v1, 0x1000, v1
    s_endpgm
PM_3:
    s_load_dwordx2 s[4:5], s[0:1], 8
    s_waitcnt lgkmcnt(0)
    s_add_u32 s12, s4, 0x0
    s_addc_u32 s13, s5, 0
    s_and_b32 s13, s13, 0xffff
    s_mov_b32 s14, 0x2800
    s_mov_b32 s15, 0x20000
    v_and_b32 v1, 7, v0
    v_mul_u32_u24 v1, 1280, v1
    v_bfe_u32 v2, v0, 3, 1
    v_lshl_add_u32 v1, v2, 4, v1
    v_bfe_u32 v2, v0, 4, 2
    v_lshl_add_u32 v1, v2, 5, v1
    v_lshrrev_b32 v2, 7, v0
    v_mul_u32_u24 v2, 640, v2
    v_add_u32 v1, v1, v2
    v_lshrrev_b32 v2, 6, v0
    v_mul_u32_u24 v2, 5120, v2
    v_and_b32 v3, 63, v0
    v_lshl_add_u32 v2, v3, 4, v2
    s_mov_b32 s16, 0x0
    buffer_load_dwordx4 v[8:11], v1, s[12:15], 0 offen offset:0
    buffer_load_dwordx4 v[12:15], v1, s[12:15], 0 offen offset:128
    buffer_load_dwordx4 v[16:19], v1, s[12:15], 0 offen offset:256
    buffer_load_dwordx4 v[20:23], v1, s[12:15], 0 offen offset:384
    buffer_load_dwordx4 v[24:27], v1, s[12:15], 0 offen offset:512
    s_waitcnt vmcnt(0)
    buffer_store_dwordx4 v[8:11], v2, s[8:11], s16 offen
    v_add_u32 v2, 1024, v2
    buffer_store_dwordx4 v[12:15], v2, s[8:11], s16 offen
    v_add_u32 v2, 1024, v2
    buffer_store_dwordx4 v[16:19], v2, s[8:11], s16 offen
    v_add_u32 v2, 1024, v2
    buffer_store_dwordx4 v[20:23], v2, s[8:11], s16 offen
    v_add_u32 v2, 1024, v2
    buffer_store_dwordx4 v[24:27], v2, s[8:11], s16 offen
    v_add_u32 v2, 1024, v2
PD_1:
    s_endpgm
.globl rec_kernel
.p2align 8
.type rec_kernel,@function
rec_kernel:
    s_load_dwordx2 s[4:5], s[0:1], 96
    v_lshrrev_b32 v1, 6, v0
    s_getreg_b32 s26, hwreg(HW_REG_XCC_ID)
    v_readfirstlane_b32 s27, v1
    s_and_b32 s26, s26, 7
    s_waitcnt lgkmcnt(0)
    s_add_u32 s8, s4, 0x8000000
    s_addc_u32 s9, s5, 0
    s_and_b32 s9, s9, 0xffff
    s_mov_b32 s10, 0x400000
    s_mov_b32 s11, 0x20000
    s_cmp_lg_u32 s27, 0
    s_cbranch_scc1 RR_6
    s_mov_b64 exec, 1
    s_lshl_b32 s56, s26, 7
    s_add_u32 s56, s56, 3145728
    s_mov_b32 s57, 3145728
    v_mov_b32 v2, 1
    v_mov_b32 v3, 0
    buffer_atomic_add v2, v3, s[8:11], s56 offen sc0
    s_waitcnt vmcnt(0)
    v_readfirstlane_b32 s25, v2
    s_cmp_lg_u32 s25, 31
    s_cbranch_scc1 RR_7
    s_cmp_ge_u32 s26, 2
    s_cbranch_scc1 RR_7
    v_mov_b32 v2, 1
    buffer_atomic_add v2, v3, s[8:11], s57 offen offset:1152 sc0
    s_waitcnt vmcnt(0)
    v_readfirstlane_b32 s58, v2
    s_cmp_lg_u32 s58, 1
    s_cbranch_scc1 RR_7
    v_mov_b32 v4, 1
    v_mov_b32 v5, 0
    buffer_atomic_cmpswap v[4:5], v3, s[8:11], s57 offen offset:1024
RR_7:
    s_mov_b32 s73, 0
RR_8:
    buffer_load_dword v2, v3, s[8:11], s57 offen offset:1024 sc1
    s_waitcnt vmcnt(0)
    v_readfirstlane_b32 s58, v2
    s_cmp_lg_u32 s58, 0
    s_cbranch_scc1 RR_9
    s_add_u32 s73, s73, 1
    s_cmp_lt_u32 s73, 2000
    s_cbranch_scc1 RR_8
    v_mov_b32 v4, 2
    v_mov_b32 v5, 0
    buffer_atomic_cmpswap v[4:5], v3, s[8:11], s57 offen offset:1024 sc0
    s_waitcnt vmcnt(0)
    v_readfirstlane_b32 s58, v4
    s_cmp_eq_u32 s58, 0
    s_cselect_b32 s58, 2, s58
RR_9:
    s_cmp_eq_u32 s58, 1
    s_cbranch_scc1 RR_10
    v_mov_b32 v2, 1
    buffer_atomic_add v2, v3, s[8:11], s57 offen offset:1280 sc0
    s_waitcnt vmcnt(0)
    v_readfirstlane_b32 s59, v2
    s_cmp_ge_u32 s59, 64
    s_cbranch_scc1 RR_11
    s_or_b32 s59, s59, 0x100
    s_branch RR_12
RR_10:
    s_cmp_ge_u32 s26, 2
    s_cbranch_scc1 RR_11
    s_cmp_ge_u32 s25, 32
    s_cbranch_scc1 RR_11
    s_lshl_b32 s59, s26, 5
    s_or_b32 s59, s59, s25
    s_branch RR_12
RR_11:
    s_mov_b32 s59, 0x1000
RR_12:
    v_mov_b32 v2, s59
    v_mov_b32 v3, 12288
    ds_write_b32 v3, v2
    s_waitcnt lgkmcnt(0)
    s_mov_b64 exec, -1
RR_6:
    s_barrier
    v_mov_b32 v3, 12288
    ds_read_b32 v2, v3
    s_waitcnt lgkmcnt(0)
    v_readfirstlane_b32 s59, v2
    s_cmp_ge_u32 s59, 0x1000
    s_cbranch_scc1 RW_13
    s_and_b32 s25, s59, 31
    s_bfe_u32 s26, s59, 0x10005
    s_lshr_b32 s28, s59, 8
    s_load_dwordx4 s[40:43], s[0:1], 16
    s_load_dwordx4 s[44:47], s[0:1], 32
    s_waitcnt lgkmcnt(0)
    s_mov_b32 s48, s46
    s_and_b32 s49, s47, 0xffff
    s_mov_b32 s50, 5242880
    s_mov_b32 s51, 0x20000
    s_and_b32 s45, s45, 0xffff
    s_mov_b32 s46, 5242880
    s_mov_b32 s47, 0x20000
    s_cmp_ge_u32 s27, 2
    s_cselect_b32 s40, s42, s40
    s_cselect_b32 s41, s43, s41
    s_and_b32 s41, s41, 0xffff
    s_mov_b32 s42, 5242880
    s_mov_b32 s43, 0x20000
    s_add_u32 s12, s4, 0x1400000
    s_addc_u32 s13, s5, 0
    s_and_b32 s13, s13, 0xffff
    s_mov_b32 s14, 0x1000000
    s_mov_b32 s15, 0x20000
    s_add_u32 s16, s4, 0x2400000
    s_addc_u32 s17, s5, 0
    s_and_b32 s17, s17, 0xffff
    s_mov_b32 s18, 0x1000000
    s_mov_b32 s19, 0x20000
    s_lshl_b32 s56, s26, 23
    s_add_u32 s6, s4, s56
    s_addc_u32 s7, s5, 0
    s_add_u32 s20, s6, 0x4400000
    s_addc_u32 s21, s7, 0
    s_and_b32 s21, s21, 0xffff
    s_mov_b32 s22, 0x800000
    s_mov_b32 s23, 0x20000
    v_and_b32 v2, 63, v0
    v_lshlrev_b32 v2, 4, v2
    s_mul_i32 s56, s27, 36864
    s_add_u32 s56, s56, 16384
    v_add_u32 v2, s56, v2
    s_mov_b32 s52, 0x05040100
    s_mov_b32 s53, 0x07060302
    v_and_b32 v7, 63, v0
    v_lshrrev_b32 v4, 5, v7
    v_lshlrev_b32 v3, 17, v4
    v_mul_u32_u24 v6, 20480, v4
    v_bfe_u32 v4, v7, 4, 1
    v_lshl_add_u32 v3, v4, 15, v3
    v_mul_u32_u24 v4, 10240, v4
    v_add_u32 v6, v6, v4
    v_and_b32 v4, 15, v7
    v_lshl_add_u32 v3, v4, 3, v3
    v_lshl_add_u32 v6, v4, 1, v6
    s_lshl_b32 s54, s25, 8
    s_and_b32 s56, s27, 1
    s_lshl_b32 s57, s56, 7
    s_lshl_b32 s56, s56, 2
    s_add_u32 s55, s54, s56
    s_add_u32 s54, s54, s57
    s_lshr_b32 s56, s27, 1
    s_lshl_b32 s56, s56, 7
    s_add_u32 s55, s55, s56
    s_mul_i32 s58, s26, 2621440
    s_sub_u32 s59, 2621440, s58
    s_mul_i32 s60, s25, 163840
    s_mul_i32 s56, s26, 640
    s_add_u32 s60, s60, s56
    s_mul_i32 s56, s27, 160
    s_add_u32 s60, s60, s56
    s_xor_b32 s61, s27, 0
    s_lshl_b32 s61, s61, 19
    s_add_u32 s61, s61, s58
    s_add_u32 s61, s61, s54
    s_add_u32 s56, s61, 0
    buffer_load_dwordx2 v[8:9], v3, s[40:43], s56 offen
    s_add_u32 s56, s61, 8192
    buffer_load_dwordx2 v[10:11], v3, s[40:43], s56 offen
    s_add_u32 s56, s61, 65536
    buffer_load_dwordx2 v[12:13], v3, s[40:43], s56 offen
    s_add_u32 s56, s61, 73728
    buffer_load_dwordx2 v[14:15], v3, s[40:43], s56 offen
    s_add_u32 s56, s61, 16384
    buffer_load_dwordx2 v[16:17], v3, s[40:43], s56 offen
    s_add_u32 s56, s61, 24576
    buffer_load_dwordx2 v[18:19], v3, s[40:43], s56 offen
    s_add_u32 s56, s61, 81920
    buffer_load_dwordx2 v[20:21], v3, s[40:43], s56 offen
    s_add_u32 s56, s61, 90112
    buffer_load_dwordx2 v[22:23], v3, s[40:43], s56 offen
    s_add_u32 s56, s61, 262144
    buffer_load_dwordx2 v[24:25], v3, s[40:43], s56 offen
    s_add_u32 s56, s61, 270336
    buffer_load_dwordx2 v[26:27], v3, s[40:43], s56 offen
    s_add_u32 s56, s61, 327680
    buffer_load_dwordx2 v[28:29], v3, s[40:43], s56 offen
    s_add_u32 s56, s61, 335872
    buffer_load_dwordx2 v[30:31], v3, s[40:43], s56 offen
    s_add_u32 s56, s61, 278528
    buffer_load_dwordx2 v[32:33], v3, s[40:43], s56 offen
    s_add_u32 s56, s61, 286720
    buffer_load_dwordx2 v[34:35], v3, s[40:43], s56 offen
    s_add_u32 s56, s61, 344064
    buffer_load_dwordx2 v[36:37], v3, s[40:43], s56 offen
    s_add_u32 s56, s61, 352256
    buffer_load_dwordx2 v[38:39], v3, s[40:43], s56 offen
    s_xor_b32 s61, s27, 1
    s_lshl_b32 s61, s61, 19
    s_add_u32 s61, s61, s58
    s_add_u32 s61, s61, s54
    s_add_u32 s56, s61, 0
    buffer_load_dwordx2 v[40:41], v3, s[40:43], s56 offen
    s_add_u32 s56, s61, 8192
    buffer_load_dwordx2 v[42:43], v3, s[40:43], s56 offen
    s_add_u32 s56, s61, 65536
    buffer_load_dwordx2 v[44:45], v3, s[40:43], s56 offen
    s_add_u32 s56, s61, 73728
    buffer_load_dwordx2 v[46:47], v3, s[40:43], s56 offen
    s_add_u32 s56, s61, 16384
    buffer_load_dwordx2 v[48:49], v3, s[40:43], s56 offen
    s_add_u32 s56, s61, 24576
    buffer_load_dwordx2 v[50:51], v3, s[40:43], s56 offen
    s_add_u32 s56, s61, 81920
    buffer_load_dwordx2 v[52:53], v3, s[40:43], s56 offen
    s_add_u32 s56, s61, 90112
    buffer_load_dwordx2 v[54:55], v3, s[40:43], s56 offen
    s_add_u32 s56, s61, 262144
    buffer_load_dwordx2 v[56:57], v3, s[40:43], s56 offen
    s_add_u32 s56, s61, 270336
    buffer_load_dwordx2 v[58:59], v3, s[40:43], s56 offen
    s_add_u32 s56, s61, 327680
    buffer_load_dwordx2 v[60:61], v3, s[40:43], s56 offen
    s_add_u32 s56, s61, 335872
    buffer_load_dwordx2 v[62:63], v3, s[40:43], s56 offen
    s_add_u32 s56, s61, 278528
    buffer_load_dwordx2 v[64:65], v3, s[40:43], s56 offen
    s_add_u32 s56, s61, 286720
    buffer_load_dwordx2 v[66:67], v3, s[40:43], s56 offen
    s_add_u32 s56, s61, 344064
    buffer_load_dwordx2 v[68:69], v3, s[40:43], s56 offen
    s_add_u32 s56, s61, 352256
    buffer_load_dwordx2 v[70:71], v3, s[40:43], s56 offen
    s_waitcnt vmcnt(16)
    v_perm_b32 v88, v10, v8, s52
    v_perm_b32 v89, v14, v12, s52
    v_perm_b32 v90, v18, v16, s52
    v_perm_b32 v91, v22, v20, s52
    v_perm_b32 v92, v26, v24, s52
    v_perm_b32 v93, v30, v28, s52
    v_perm_b32 v94, v34, v32, s52
    v_perm_b32 v95, v38, v36, s52
    ds_write_b128 v2, v[88:91] offset:0
    ds_write_b128 v2, v[92:95] offset:1024
    s_nop 1
    v_perm_b32 v88, v10, v8, s53
    v_perm_b32 v89, v14, v12, s53
    v_perm_b32 v90, v18, v16, s53
    v_perm_b32 v91, v22, v20, s53
    v_perm_b32 v92, v26, v24, s53
    v_perm_b32 v93, v30, v28, s53
    v_perm_b32 v94, v34, v32, s53
    v_perm_b32 v95, v38, v36, s53
    ds_write_b128 v2, v[88:91] offset:2048
    ds_write_b128 v2, v[92:95] offset:3072
    s_nop 1
    v_perm_b32 v96, v11, v9, s52
    v_perm_b32 v97, v15, v13, s52
    v_perm_b32 v98, v19, v17, s52
    v_perm_b32 v99, v23, v21, s52
    v_perm_b32 v100, v27, v25, s52
    v_perm_b32 v101, v31, v29, s52
    v_perm_b32 v102, v35, v33, s52
    v_perm_b32 v103, v39, v37, s52
    v_perm_b32 v104, v11, v9, s53
    v_perm_b32 v105, v15, v13, s53
    v_perm_b32 v106, v19, v17, s53
    v_perm_b32 v107, v23, v21, s53
    v_perm_b32 v108, v27, v25, s53
    v_perm_b32 v109, v31, v29, s53
    v_perm_b32 v110, v35, v33, s53
    v_perm_b32 v111, v39, v37, s53
    s_xor_b32 s61, s27, 2
    s_lshl_b32 s61, s61, 19
    s_add_u32 s61, s61, s58
    s_add_u32 s61, s61, s54
    s_add_u32 s56, s61, 0
    buffer_load_dwordx2 v[8:9], v3, s[40:43], s56 offen
    s_add_u32 s56, s61, 8192
    buffer_load_dwordx2 v[10:11], v3, s[40:43], s56 offen
    s_add_u32 s56, s61, 65536
    buffer_load_dwordx2 v[12:13], v3, s[40:43], s56 offen
    s_add_u32 s56, s61, 73728
    buffer_load_dwordx2 v[14:15], v3, s[40:43], s56 offen
    s_add_u32 s56, s61, 16384
    buffer_load_dwordx2 v[16:17], v3, s[40:43], s56 offen
    s_add_u32 s56, s61, 24576
    buffer_load_dwordx2 v[18:19], v3, s[40:43], s56 offen
    s_add_u32 s56, s61, 81920
    buffer_load_dwordx2 v[20:21], v3, s[40:43], s56 offen
    s_add_u32 s56, s61, 90112
    buffer_load_dwordx2 v[22:23], v3, s[40:43], s56 offen
    s_add_u32 s56, s61, 262144
    buffer_load_dwordx2 v[24:25], v3, s[40:43], s56 offen
    s_add_u32 s56, s61, 270336
    buffer_load_dwordx2 v[26:27], v3, s[40:43], s56 offen
    s_add_u32 s56, s61, 327680
    buffer_load_dwordx2 v[28:29], v3, s[40:43], s56 offen
    s_add_u32 s56, s61, 335872
    buffer_load_dwordx2 v[30:31], v3, s[40:43], s56 offen
    s_add_u32 s56, s61, 278528
    buffer_load_dwordx2 v[32:33], v3, s[40:43], s56 offen
    s_add_u32 s56, s61, 286720
    buffer_load_dwordx2 v[34:35], v3, s[40:43], s56 offen
    s_add_u32 s56, s61, 344064
    buffer_load_dwordx2 v[36:37], v3, s[40:43], s56 offen
    s_add_u32 s56, s61, 352256
    buffer_load_dwordx2 v[38:39], v3, s[40:43], s56 offen
    s_waitcnt vmcnt(16)
    v_perm_b32 v160, v42, v40, s52
    v_perm_b32 v161, v46, v44, s52
    v_perm_b32 v162, v50, v48, s52
    v_perm_b32 v163, v54, v52, s52
    v_perm_b32 v164, v58, v56, s52
    v_perm_b32 v165, v62, v60, s52
    v_perm_b32 v166, v66, v64, s52
    v_perm_b32 v167, v70, v68, s52
    v_perm_b32 v168, v42, v40, s53
    v_perm_b32 v169, v46, v44, s53
    v_perm_b32 v170, v50, v48, s53
    v_perm_b32 v171, v54, v52, s53
    v_perm_b32 v172, v58, v56, s53
    v_perm_b32 v173, v62, v60, s53
    v_perm_b32 v174, v66, v64, s53
    v_perm_b32 v175, v70, v68, s53
    v_perm_b32 v176, v43, v41, s52
    v_perm_b32 v177, v47, v45, s52
    v_perm_b32 v178, v51, v49, s52
    v_perm_b32 v179, v55, v53, s52
    v_perm_b32 v180, v59, v57, s52
    v_perm_b32 v181, v63, v61, s52
    v_perm_b32 v182, v67, v65, s52
    v_perm_b32 v183, v71, v69, s52
    v_perm_b32 v184, v43, v41, s53
    v_perm_b32 v185, v47, v45, s53
    v_perm_b32 v186, v51, v49, s53
    v_perm_b32 v187, v55, v53, s53
    v_perm_b32 v188, v59, v57, s53
    v_perm_b32 v189, v63, v61, s53
    v_perm_b32 v190, v67, v65, s53
    v_perm_b32 v191, v71, v69, s53
    s_xor_b32 s61, s27, 3
    s_lshl_b32 s61, s61, 19
    s_add_u32 s61, s61, s58
    s_add_u32 s61, s61, s54
    s_add_u32 s56, s61, 0
    buffer_load_dwordx2 v[40:41], v3, s[40:43], s56 offen
    s_add_u32 s56, s61, 8192
    buffer_load_dwordx2 v[42:43], v3, s[40:43], s56 offen
    s_add_u32 s56, s61, 65536
    buffer_load_dwordx2 v[44:45], v3, s[40:43], s56 offen
    s_add_u32 s56, s61, 73728
    buffer_load_dwordx2 v[46:47], v3, s[40:43], s56 offen
    s_add_u32 s56, s61, 16384
    buffer_load_dwordx2 v[48:49], v3, s[40:43], s56 offen
    s_add_u32 s56, s61, 24576
    buffer_load_dwordx2 v[50:51], v3, s[40:43], s56 offen
    s_add_u32 s56, s61, 81920
    buffer_load_dwordx2 v[52:53], v3, s[40:43], s56 offen
    s_add_u32 s56, s61, 90112
    buffer_load_dwordx2 v[54:55], v3, s[40:43], s56 offen
    s_add_u32 s56, s61, 262144
    buffer_load_dwordx2 v[56:57], v3, s[40:43], s56 offen
    s_add_u32 s56, s61, 270336
    buffer_load_dwordx2 v[58:59], v3, s[40:43], s56 offen
    s_add_u32 s56, s61, 327680
    buffer_load_dwordx2 v[60:61], v3, s[40:43], s56 offen
    s_add_u32 s56, s61, 335872
    buffer_load_dwordx2 v[62:63], v3, s[40:43], s56 offen
    s_add_u32 s56, s61, 278528
    buffer_load_dwordx2 v[64:65], v3, s[40:43], s56 offen
    s_add_u32 s56, s61, 286720
    buffer_load_dwordx2 v[66:67], v3, s[40:43], s56 offen
    s_add_u32 s56, s61, 344064
    buffer_load_dwordx2 v[68:69], v3, s[40:43], s56 offen
    s_add_u32 s56, s61, 352256
    buffer_load_dwordx2 v[70:71], v3, s[40:43], s56 offen
    s_waitcnt vmcnt(16)
    v_perm_b32 v192, v10, v8, s52
    v_perm_b32 v193, v14, v12, s52
    v_perm_b32 v194, v18, v16, s52
    v_perm_b32 v195, v22, v20, s52
    v_perm_b32 v196, v26, v24, s52
    v_perm_b32 v197, v30, v28, s52
    v_perm_b32 v198, v34, v32, s52
    v_perm_b32 v199, v38, v36, s52
    v_perm_b32 v200, v10, v8, s53
    v_perm_b32 v201, v14, v12, s53
    v_perm_b32 v202, v18, v16, s53
    v_perm_b32 v203, v22, v20, s53
    v_perm_b32 v204, v26, v24, s53
    v_perm_b32 v205, v30, v28, s53
    v_perm_b32 v206, v34, v32, s53
    v_perm_b32 v207, v38, v36, s53
    v_perm_b32 v208, v11, v9, s52
    v_perm_b32 v209, v15, v13, s52
    v_perm_b32 v210, v19, v17, s52
    v_perm_b32 v211, v23, v21, s52
    v_perm_b32 v212, v27, v25, s52
    v_perm_b32 v213, v31, v29, s52
    v_perm_b32 v214, v35, v33, s52
    v_perm_b32 v215, v39, v37, s52
    v_perm_b32 v216, v11, v9, s53
    v_perm_b32 v217, v15, v13, s53
    v_perm_b32 v218, v19, v17, s53
    v_perm_b32 v219, v23, v21, s53
    v_perm_b32 v220, v27, v25, s53
    v_perm_b32 v221, v31, v29, s53
    v_perm_b32 v222, v35, v33, s53
    v_perm_b32 v223, v39, v37, s53
    s_mov_b32 s61, 2097152
    s_add_u32 s61, s61, s58
    s_add_u32 s61, s61, s54
    s_add_u32 s56, s61, 0
    buffer_load_dwordx2 v[8:9], v3, s[40:43], s56 offen
    s_add_u32 s56, s61, 8192
    buffer_load_dwordx2 v[10:11], v3, s[40:43], s56 offen
    s_add_u32 s56, s61, 65536
    buffer_load_dwordx2 v[12:13], v3, s[40:43], s56 offen
    s_add_u32 s56, s61, 73728
    buffer_load_dwordx2 v[14:15], v3, s[40:43], s56 offen
    s_add_u32 s56, s61, 16384
    buffer_load_dwordx2 v[16:17], v3, s[40:43], s56 offen
    s_add_u32 s56, s61, 24576
    buffer_load_dwordx2 v[18:19], v3, s[40:43], s56 offen
    s_add_u32 s56, s61, 81920
    buffer_load_dwordx2 v[20:21], v3, s[40:43], s56 offen
    s_add_u32 s56, s61, 90112
    buffer_load_dwordx2 v[22:23], v3, s[40:43], s56 offen
    s_add_u32 s56, s61, 262144
    buffer_load_dwordx2 v[24:25], v3, s[40:43], s56 offen
    s_add_u32 s56, s61, 270336
    buffer_load_dwordx2 v[26:27], v3, s[40:43], s56 offen
    s_add_u32 s56, s61, 327680
    buffer_load_dwordx2 v[28:29], v3, s[40:43], s56 offen
    s_add_u32 s56, s61, 335872
    buffer_load_dwordx2 v[30:31], v3, s[40:43], s56 offen
    s_add_u32 s56, s61, 278528
    buffer_load_dwordx2 v[32:33], v3, s[40:43], s56 offen
    s_add_u32 s56, s61, 286720
    buffer_load_dwordx2 v[34:35], v3, s[40:43], s56 offen
    s_add_u32 s56, s61, 344064
    buffer_load_dwordx2 v[36:37], v3, s[40:43], s56 offen
    s_add_u32 s56, s61, 352256
    buffer_load_dwordx2 v[38:39], v3, s[40:43], s56 offen
    s_waitcnt vmcnt(16)
    v_perm_b32 v88, v42, v40, s52
    v_perm_b32 v89, v46, v44, s52
    v_perm_b32 v90, v50, v48, s52
    v_perm_b32 v91, v54, v52, s52
    v_perm_b32 v92, v58, v56, s52
    v_perm_b32 v93, v62, v60, s52
    v_perm_b32 v94, v66, v64, s52
    v_perm_b32 v95, v70, v68, s52
    ds_write_b128 v2, v[88:91] offset:8192
    ds_write_b128 v2, v[92:95] offset:9216
    s_nop 1
    v_perm_b32 v88, v42, v40, s53
    v_perm_b32 v89, v46, v44, s53
    v_perm_b32 v90, v50, v48, s53
    v_perm_b32 v91, v54, v52, s53
    v_perm_b32 v92, v58, v56, s53
    v_perm_b32 v93, v62, v60, s53
    v_perm_b32 v94, v66, v64, s53
    v_perm_b32 v95, v70, v68, s53
    ds_write_b128 v2, v[88:91] offset:10240
    ds_write_b128 v2, v[92:95] offset:11264
    s_nop 1
    v_perm_b32 v224, v43, v41, s52
    v_perm_b32 v225, v47, v45, s52
    v_perm_b32 v226, v51, v49, s52
    v_perm_b32 v227, v55, v53, s52
    v_perm_b32 v228, v59, v57, s52
    v_perm_b32 v229, v63, v61, s52
    v_perm_b32 v230, v67, v65, s52
    v_perm_b32 v231, v71, v69, s52
    v_perm_b32 v232, v43, v41, s53
    v_perm_b32 v233, v47, v45, s53
    v_perm_b32 v234, v51, v49, s53
    v_perm_b32 v235, v55, v53, s53
    v_perm_b32 v236, v59, v57, s53
    v_perm_b32 v237, v63, v61, s53
    v_perm_b32 v238, v67, v65, s53
    v_perm_b32 v239, v71, v69, s53
    s_xor_b32 s61, s27, 0
    s_lshl_b32 s61, s61, 19
    s_add_u32 s61, s61, s59
    s_add_u32 s61, s61, s54
    s_add_u32 s56, s61, 0
    buffer_load_dwordx2 v[40:41], v3, s[40:43], s56 offen
    s_add_u32 s56, s61, 8192
    buffer_load_dwordx2 v[42:43], v3, s[40:43], s56 offen
    s_add_u32 s56, s61, 65536
    buffer_load_dwordx2 v[44:45], v3, s[40:43], s56 offen
    s_add_u32 s56, s61, 73728
    buffer_load_dwordx2 v[46:47], v3, s[40:43], s56 offen
    s_add_u32 s56, s61, 16384
    buffer_load_dwordx2 v[48:49], v3, s[40:43], s56 offen
    s_add_u32 s56, s61, 24576
    buffer_load_dwordx2 v[50:51], v3, s[40:43], s56 offen
    s_add_u32 s56, s61, 81920
    buffer_load_dwordx2 v[52:53], v3, s[40:43], s56 offen
    s_add_u32 s56, s61, 90112
    buffer_load_dwordx2 v[54:55], v3, s[40:43], s56 offen
    s_add_u32 s56, s61, 262144
    buffer_load_dwordx2 v[56:57], v3, s[40:43], s56 offen
    s_add_u32 s56, s61, 270336
    buffer_load_dwordx2 v[58:59], v3, s[40:43], s56 offen
    s_add_u32 s56, s61, 327680
    buffer_load_dwordx2 v[60:61], v3, s[40:43], s56 offen
    s_add_u32 s56, s61, 335872
    buffer_load_dwordx2 v[62:63], v3, s[40:43], s56 offen
    s_add_u32 s56, s61, 278528
    buffer_load_dwordx2 v[64:65], v3, s[40:43], s56 offen
    s_add_u32 s56, s61, 286720
    buffer_load_dwordx2 v[66:67], v3, s[40:43], s56 offen
    s_add_u32 s56, s61, 344064
    buffer_load_dwordx2 v[68:69], v3, s[40:43], s56 offen
    s_add_u32 s56, s61, 352256
    buffer_load_dwordx2 v[70:71], v3, s[40:43], s56 offen
    s_waitcnt vmcnt(16)
    v_perm_b32 v128, v10, v8, s52
    v_perm_b32 v129, v14, v12, s52
    v_perm_b32 v130, v18, v16, s52
    v_perm_b32 v131, v22, v20, s52
    v_perm_b32 v132, v26, v24, s52
    v_perm_b32 v133, v30, v28, s52
    v_perm_b32 v134, v34, v32, s52
    v_perm_b32 v135, v38, v36, s52
    v_perm_b32 v136, v10, v8, s53
    v_perm_b32 v137, v14, v12, s53
    v_perm_b32 v138, v18, v16, s53
    v_perm_b32 v139, v22, v20, s53
    v_perm_b32 v140, v26, v24, s53
    v_perm_b32 v141, v30, v28, s53
    v_perm_b32 v142, v34, v32, s53
    v_perm_b32 v143, v38, v36, s53
    v_perm_b32 v144, v11, v9, s52
    v_perm_b32 v145, v15, v13, s52
    v_perm_b32 v146, v19, v17, s52
    v_perm_b32 v147, v23, v21, s52
    v_perm_b32 v148, v27, v25, s52
    v_perm_b32 v149, v31, v29, s52
    v_perm_b32 v150, v35, v33, s52
    v_perm_b32 v151, v39, v37, s52
    v_perm_b32 v152, v11, v9, s53
    v_perm_b32 v153, v15, v13, s53
    v_perm_b32 v154, v19, v17, s53
    v_perm_b32 v155, v23, v21, s53
    v_perm_b32 v156, v27, v25, s53
    v_perm_b32 v157, v31, v29, s53
    v_perm_b32 v158, v35, v33, s53
    v_perm_b32 v159, v39, v37, s53
    s_xor_b32 s61, s27, 1
    s_lshl_b32 s61, s61, 19
    s_add_u32 s61, s61, s59
    s_add_u32 s61, s61, s54
    s_add_u32 s56, s61, 0
    buffer_load_dwordx2 v[8:9], v3, s[40:43], s56 offen
    s_add_u32 s56, s61, 8192
    buffer_load_dwordx2 v[10:11], v3, s[40:43], s56 offen
    s_add_u32 s56, s61, 65536
    buffer_load_dwordx2 v[12:13], v3, s[40:43], s56 offen
    s_add_u32 s56, s61, 73728
    buffer_load_dwordx2 v[14:15], v3, s[40:43], s56 offen
    s_add_u32 s56, s61, 16384
    buffer_load_dwordx2 v[16:17], v3, s[40:43], s56 offen
    s_add_u32 s56, s61, 24576
    buffer_load_dwordx2 v[18:19], v3, s[40:43], s56 offen
    s_add_u32 s56, s61, 81920
    buffer_load_dwordx2 v[20:21], v3, s[40:43], s56 offen
    s_add_u32 s56, s61, 90112
    buffer_load_dwordx2 v[22:23], v3, s[40:43], s56 offen
    s_add_u32 s56, s61, 262144
    buffer_load_dwordx2 v[24:25], v3, s[40:43], s56 offen
    s_add_u32 s56, s61, 270336
    buffer_load_dwordx2 v[26:27], v3, s[40:43], s56 offen
    s_add_u32 s56, s61, 327680
    buffer_load_dwordx2 v[28:29], v3, s[40:43], s56 offen
    s_add_u32 s56, s61, 335872
    buffer_load_dwordx2 v[30:31], v3, s[40:43], s56 offen
    s_add_u32 s56, s61, 278528
    buffer_load_dwordx2 v[32:33], v3, s[40:43], s56 offen
    s_add_u32 s56, s61, 286720
    buffer_load_dwordx2 v[34:35], v3, s[40:43], s56 offen
    s_add_u32 s56, s61, 344064
    buffer_load_dwordx2 v[36:37], v3, s[40:43], s56 offen
    s_add_u32 s56, s61, 352256
    buffer_load_dwordx2 v[38:39], v3, s[40:43], s56 offen
    s_waitcnt vmcnt(16)
    v_perm_b32 v88, v42, v40, s52
    v_perm_b32 v89, v46, v44, s52
    v_perm_b32 v90, v50, v48, s52
    v_perm_b32 v91, v54, v52, s52
    v_perm_b32 v92, v58, v56, s52
    v_perm_b32 v93, v62, v60, s52
    v_perm_b32 v94, v66, v64, s52
    v_perm_b32 v95, v70, v68, s52
    ds_write_b128 v2, v[88:91] offset:12288
    ds_write_b128 v2, v[92:95] offset:13312
    s_nop 1
    v_perm_b32 v88, v42, v40, s53
    v_perm_b32 v89, v46, v44, s53
    v_perm_b32 v90, v50, v48, s53
    v_perm_b32 v91, v54, v52, s53
    v_perm_b32 v92, v58, v56, s53
    v_perm_b32 v93, v62, v60, s53
    v_perm_b32 v94, v66, v64, s53
    v_perm_b32 v95, v70, v68, s53
    ds_write_b128 v2, v[88:91] offset:14336
    ds_write_b128 v2, v[92:95] offset:15360
    s_nop 1
    v_perm_b32 v4, v43, v41, s52
    v_accvgpr_write_b32 a32, v4
    v_perm_b32 v5, v47, v45, s52
    v_accvgpr_write_b32 a33, v5
    v_perm_b32 v4, v51, v49, s52
    v_accvgpr_write_b32 a34, v4
    v_perm_b32 v5, v55, v53, s52
    v_accvgpr_write_b32 a35, v5
    v_perm_b32 v4, v59, v57, s52
    v_accvgpr_write_b32 a36, v4
    v_perm_b32 v5, v63, v61, s52
    v_accvgpr_write_b32 a37, v5
    v_perm_b32 v4, v67, v65, s52
    v_accvgpr_write_b32 a38, v4
    v_perm_b32 v5, v71, v69, s52
    v_accvgpr_write_b32 a39, v5
    v_perm_b32 v88, v43, v41, s53
    v_perm_b32 v89, v47, v45, s53
    v_perm_b32 v90, v51, v49, s53
    v_perm_b32 v91, v55, v53, s53
    v_perm_b32 v92, v59, v57, s53
    v_perm_b32 v93, v63, v61, s53
    v_perm_b32 v94, v67, v65, s53
    v_perm_b32 v95, v71, v69, s53
    ds_write_b128 v2, v[88:91] offset:16384
    ds_write_b128 v2, v[92:95] offset:17408
    s_nop 1
    s_xor_b32 s61, s27, 2
    s_lshl_b32 s61, s61, 19
    s_add_u32 s61, s61, s59
    s_add_u32 s61, s61, s54
    s_add_u32 s56, s61, 0
    buffer_load_dwordx2 v[40:41], v3, s[40:43], s56 offen
    s_add_u32 s56, s61, 8192
    buffer_load_dwordx2 v[42:43], v3, s[40:43], s56 offen
    s_add_u32 s56, s61, 65536
    buffer_load_dwordx2 v[44:45], v3, s[40:43], s56 offen
    s_add_u32 s56, s61, 73728
    buffer_load_dwordx2 v[46:47], v3, s[40:43], s56 offen
    s_add_u32 s56, s61, 16384
    buffer_load_dwordx2 v[48:49], v3, s[40:43], s56 offen
    s_add_u32 s56, s61, 24576
    buffer_load_dwordx2 v[50:51], v3, s[40:43], s56 offen
    s_add_u32 s56, s61, 81920
    buffer_load_dwordx2 v[52:53], v3, s[40:43], s56 offen
    s_add_u32 s56, s61, 90112
    buffer_load_dwordx2 v[54:55], v3, s[40:43], s56 offen
    s_add_u32 s56, s61, 262144
    buffer_load_dwordx2 v[56:57], v3, s[40:43], s56 offen
    s_add_u32 s56, s61, 270336
    buffer_load_dwordx2 v[58:59], v3, s[40:43], s56 offen
    s_add_u32 s56, s61, 327680
    buffer_load_dwordx2 v[60:61], v3, s[40:43], s56 offen
    s_add_u32 s56, s61, 335872
    buffer_load_dwordx2 v[62:63], v3, s[40:43], s56 offen
    s_add_u32 s56, s61, 278528
    buffer_load_dwordx2 v[64:65], v3, s[40:43], s56 offen
    s_add_u32 s56, s61, 286720
    buffer_load_dwordx2 v[66:67], v3, s[40:43], s56 offen
    s_add_u32 s56, s61, 344064
    buffer_load_dwordx2 v[68:69], v3, s[40:43], s56 offen
    s_add_u32 s56, s61, 352256
    buffer_load_dwordx2 v[70:71], v3, s[40:43], s56 offen
    s_waitcnt vmcnt(16)
    v_perm_b32 v88, v10, v8, s52
    v_perm_b32 v89, v14, v12, s52
    v_perm_b32 v90, v18, v16, s52
    v_perm_b32 v91, v22, v20, s52
    v_perm_b32 v92, v26, v24, s52
    v_perm_b32 v93, v30, v28, s52
    v_perm_b32 v94, v34, v32, s52
    v_perm_b32 v95, v38, v36, s52
    ds_write_b128 v2, v[88:91] offset:20480
    ds_write_b128 v2, v[92:95] offset:21504
    s_nop 1
    v_perm_b32 v88, v10, v8, s53
    v_perm_b32 v89, v14, v12, s53
    v_perm_b32 v90, v18, v16, s53
    v_perm_b32 v91, v22, v20, s53
    v_perm_b32 v92, v26, v24, s53
    v_perm_b32 v93, v30, v28, s53
    v_perm_b32 v94, v34, v32, s53
    v_perm_b32 v95, v38, v36, s53
    ds_write_b128 v2, v[88:91] offset:22528
    ds_write_b128 v2, v[92:95] offset:23552
    s_nop 1
    v_perm_b32 v4, v11, v9, s52
    v_accvgpr_write_b32 a104, v4
    v_perm_b32 v5, v15, v13, s52
    v_accvgpr_write_b32 a105, v5
    v_perm_b32 v4, v19, v17, s52
    v_accvgpr_write_b32 a106, v4
    v_perm_b32 v5, v23, v21, s52
    v_accvgpr_write_b32 a107, v5
    v_perm_b32 v4, v27, v25, s52
    v_accvgpr_write_b32 a108, v4
    v_perm_b32 v5, v31, v29, s52
    v_accvgpr_write_b32 a109, v5
    v_perm_b32 v4, v35, v33, s52
    v_accvgpr_write_b32 a110, v4
    v_perm_b32 v5, v39, v37, s52
    v_accvgpr_write_b32 a111, v5
    v_perm_b32 v4, v11, v9, s53
    v_accvgpr_write_b32 a112, v4
    v_perm_b32 v5, v15, v13, s53
    v_accvgpr_write_b32 a113, v5
    v_perm_b32 v4, v19, v17, s53
    v_accvgpr_write_b32 a114, v4
    v_perm_b32 v5, v23, v21, s53
    v_accvgpr_write_b32 a115, v5
    v_perm_b32 v4, v27, v25, s53
    v_accvgpr_write_b32 a116, v4
    v_perm_b32 v5, v31, v29, s53
    v_accvgpr_write_b32 a117, v5
    v_perm_b32 v4, v35, v33, s53
    v_accvgpr_write_b32 a118, v4
    v_perm_b32 v5, v39, v37, s53
    v_accvgpr_write_b32 a119, v5
    s_xor_b32 s61, s27, 3
    s_lshl_b32 s61, s61, 19
    s_add_u32 s61, s61, s59
    s_add_u32 s61, s61, s54
    s_add_u32 s56, s61, 0
    buffer_load_dwordx2 v[8:9], v3, s[40:43], s56 offen
    s_add_u32 s56, s61, 8192
    buffer_load_dwordx2 v[10:11], v3, s[40:43], s56 offen
    s_add_u32 s56, s61, 65536
    buffer_load_dwordx2 v[12:13], v3, s[40:43], s56 offen
    s_add_u32 s56, s61, 73728
    buffer_load_dwordx2 v[14:15], v3, s[40:43], s56 offen
    s_add_u32 s56, s61, 16384
    buffer_load_dwordx2 v[16:17], v3, s[40:43], s56 offen
    s_add_u32 s56, s61, 24576
    buffer_load_dwordx2 v[18:19], v3, s[40:43], s56 offen
    s_add_u32 s56, s61, 81920
    buffer_load_dwordx2 v[20:21], v3, s[40:43], s56 offen
    s_add_u32 s56, s61, 90112
    buffer_load_dwordx2 v[22:23], v3, s[40:43], s56 offen
    s_add_u32 s56, s61, 262144
    buffer_load_dwordx2 v[24:25], v3, s[40:43], s56 offen
    s_add_u32 s56, s61, 270336
    buffer_load_dwordx2 v[26:27], v3, s[40:43], s56 offen
    s_add_u32 s56, s61, 327680
    buffer_load_dwordx2 v[28:29], v3, s[40:43], s56 offen
    s_add_u32 s56, s61, 335872
    buffer_load_dwordx2 v[30:31], v3, s[40:43], s56 offen
    s_add_u32 s56, s61, 278528
    buffer_load_dwordx2 v[32:33], v3, s[40:43], s56 offen
    s_add_u32 s56, s61, 286720
    buffer_load_dwordx2 v[34:35], v3, s[40:43], s56 offen
    s_add_u32 s56, s61, 344064
    buffer_load_dwordx2 v[36:37], v3, s[40:43], s56 offen
    s_add_u32 s56, s61, 352256
    buffer_load_dwordx2 v[38:39], v3, s[40:43], s56 offen
    s_waitcnt vmcnt(16)
    v_perm_b32 v4, v42, v40, s52
    v_accvgpr_write_b32 a80, v4
    v_perm_b32 v5, v46, v44, s52
    v_accvgpr_write_b32 a81, v5
    v_perm_b32 v4, v50, v48, s52
    v_accvgpr_write_b32 a82, v4
    v_perm_b32 v5, v54, v52, s52
    v_accvgpr_write_b32 a83, v5
    v_perm_b32 v4, v58, v56, s52
    v_accvgpr_write_b32 a84, v4
    v_perm_b32 v5, v62, v60, s52
    v_accvgpr_write_b32 a85, v5
    v_perm_b32 v4, v66, v64, s52
    v_accvgpr_write_b32 a86, v4
    v_perm_b32 v5, v70, v68, s52
    v_accvgpr_write_b32 a87, v5
    v_perm_b32 v88, v42, v40, s53
    v_perm_b32 v89, v46, v44, s53
    v_perm_b32 v90, v50, v48, s53
    v_perm_b32 v91, v54, v52, s53
    v_perm_b32 v92, v58, v56, s53
    v_perm_b32 v93, v62, v60, s53
    v_perm_b32 v94, v66, v64, s53
    v_perm_b32 v95, v70, v68, s53
    ds_write_b128 v2, v[88:91] offset:24576
    ds_write_b128 v2, v[92:95] offset:25600
    s_nop 1
    v_perm_b32 v4, v43, v41, s52
    v_accvgpr_write_b32 a120, v4
    v_perm_b32 v5, v47, v45, s52
    v_accvgpr_write_b32 a121, v5
    v_perm_b32 v4, v51, v49, s52
    v_accvgpr_write_b32 a122, v4
    v_perm_b32 v5, v55, v53, s52
    v_accvgpr_write_b32 a123, v5
    v_perm_b32 v4, v59, v57, s52
    v_accvgpr_write_b32 a124, v4
    v_perm_b32 v5, v63, v61, s52
    v_accvgpr_write_b32 a125, v5
    v_perm_b32 v4, v67, v65, s52
    v_accvgpr_write_b32 a126, v4
    v_perm_b32 v5, v71, v69, s52
    v_accvgpr_write_b32 a127, v5
    v_perm_b32 v4, v43, v41, s53
    v_accvgpr_write_b32 a128, v4
    v_perm_b32 v5, v47, v45, s53
    v_accvgpr_write_b32 a129, v5
    v_perm_b32 v4, v51, v49, s53
    v_accvgpr_write_b32 a130, v4
    v_perm_b32 v5, v55, v53, s53
    v_accvgpr_write_b32 a131, v5
    v_perm_b32 v4, v59, v57, s53
    v_accvgpr_write_b32 a132, v4
    v_perm_b32 v5, v63, v61, s53
    v_accvgpr_write_b32 a133, v5
    v_perm_b32 v4, v67, v65, s53
    v_accvgpr_write_b32 a134, v4
    v_perm_b32 v5, v71, v69, s53
    v_accvgpr_write_b32 a135, v5
    s_mov_b32 s61, 2097152
    s_add_u32 s61, s61, s59
    s_add_u32 s61, s61, s54
    s_add_u32 s56, s61, 0
    buffer_load_dwordx2 v[40:41], v3, s[40:43], s56 offen
    s_add_u32 s56, s61, 8192
    buffer_load_dwordx2 v[42:43], v3, s[40:43], s56 offen
    s_add_u32 s56, s61, 65536
    buffer_load_dwordx2 v[44:45], v3, s[40:43], s56 offen
    s_add_u32 s56, s61, 73728
    buffer_load_dwordx2 v[46:47], v3, s[40:43], s56 offen
    s_add_u32 s56, s61, 16384
    buffer_load_dwordx2 v[48:49], v3, s[40:43], s56 offen
    s_add_u32 s56, s61, 24576
    buffer_load_dwordx2 v[50:51], v3, s[40:43], s56 offen
    s_add_u32 s56, s61, 81920
    buffer_load_dwordx2 v[52:53], v3, s[40:43], s56 offen
    s_add_u32 s56, s61, 90112
    buffer_load_dwordx2 v[54:55], v3, s[40:43], s56 offen
    s_add_u32 s56, s61, 262144
    buffer_load_dwordx2 v[56:57], v3, s[40:43], s56 offen
    s_add_u32 s56, s61, 270336
    buffer_load_dwordx2 v[58:59], v3, s[40:43], s56 offen
    s_add_u32 s56, s61, 327680
    buffer_load_dwordx2 v[60:61], v3, s[40:43], s56 offen
    s_add_u32 s56, s61, 335872
    buffer_load_dwordx2 v[62:63], v3, s[40:43], s56 offen
    s_add_u32 s56, s61, 278528
    buffer_load_dwordx2 v[64:65], v3, s[40:43], s56 offen
    s_add_u32 s56, s61, 286720
    buffer_load_dwordx2 v[66:67], v3, s[40:43], s56 offen
    s_add_u32 s56, s61, 344064
    buffer_load_dwordx2 v[68:69], v3, s[40:43], s56 offen
    s_add_u32 s56, s61, 352256
    buffer_load_dwordx2 v[70:71], v3, s[40:43], s56 offen
    s_waitcnt vmcnt(16)
    v_perm_b32 v4, v10, v8, s52
    v_accvgpr_write_b32 a88, v4
    v_perm_b32 v5, v14, v12, s52
    v_accvgpr_write_b32 a89, v5
    v_perm_b32 v4, v18, v16, s52
    v_accvgpr_write_b32 a90, v4
    v_perm_b32 v5, v22, v20, s52
    v_accvgpr_write_b32 a91, v5
    v_perm_b32 v4, v26, v24, s52
    v_accvgpr_write_b32 a92, v4
    v_perm_b32 v5, v30, v28, s52
    v_accvgpr_write_b32 a93, v5
    v_perm_b32 v4, v34, v32, s52
    v_accvgpr_write_b32 a94, v4
    v_perm_b32 v5, v38, v36, s52
    v_accvgpr_write_b32 a95, v5
    v_perm_b32 v4, v10, v8, s53
    v_accvgpr_write_b32 a96, v4
    v_perm_b32 v5, v14, v12, s53
    v_accvgpr_write_b32 a97, v5
    v_perm_b32 v4, v18, v16, s53
    v_accvgpr_write_b32 a98, v4
    v_perm_b32 v5, v22, v20, s53
    v_accvgpr_write_b32 a99, v5
    v_perm_b32 v4, v26, v24, s53
    v_accvgpr_write_b32 a100, v4
    v_perm_b32 v5, v30, v28, s53
    v_accvgpr_write_b32 a101, v5
    v_perm_b32 v4, v34, v32, s53
    v_accvgpr_write_b32 a102, v4
    v_perm_b32 v5, v38, v36, s53
    v_accvgpr_write_b32 a103, v5
    v_perm_b32 v4, v11, v9, s52
    v_accvgpr_write_b32 a136, v4
    v_perm_b32 v5, v15, v13, s52
    v_accvgpr_write_b32 a137, v5
    v_perm_b32 v4, v19, v17, s52
    v_accvgpr_write_b32 a138, v4
    v_perm_b32 v5, v23, v21, s52
    v_accvgpr_write_b32 a139, v5
    v_perm_b32 v4, v27, v25, s52
    v_accvgpr_write_b32 a140, v4
    v_perm_b32 v5, v31, v29, s52
    v_accvgpr_write_b32 a141, v5
    v_perm_b32 v4, v35, v33, s52
    v_accvgpr_write_b32 a142, v4
    v_perm_b32 v5, v39, v37, s52
    v_accvgpr_write_b32 a143, v5
    v_perm_b32 v4, v11, v9, s53
    v_accvgpr_write_b32 a144, v4
    v_perm_b32 v5, v15, v13, s53
    v_accvgpr_write_b32 a145, v5
    v_perm_b32 v4, v19, v17, s53
    v_accvgpr_write_b32 a146, v4
    v_perm_b32 v5, v23, v21, s53
    v_accvgpr_write_b32 a147, v5
    v_perm_b32 v4, v27, v25, s53
    v_accvgpr_write_b32 a148, v4
    v_perm_b32 v5, v31, v29, s53
    v_accvgpr_write_b32 a149, v5
    v_perm_b32 v4, v35, v33, s53
    v_accvgpr_write_b32 a150, v4
    v_perm_b32 v5, v39, v37, s53
    v_accvgpr_write_b32 a151, v5
    s_xor_b32 s61, s27, 0
    s_lshl_b32 s61, s61, 19
    s_add_u32 s61, s61, s58
    s_add_u32 s61, s61, s55
    s_add_u32 s56, s61, 0
    buffer_load_dword v8, v3, s[44:47], s56 offen
    s_add_u32 s56, s61, 8192
    buffer_load_dword v9, v3, s[44:47], s56 offen
    s_add_u32 s56, s61, 65536
    buffer_load_dword v10, v3, s[44:47], s56 offen
    s_add_u32 s56, s61, 73728
    buffer_load_dword v11, v3, s[44:47], s56 offen
    s_add_u32 s56, s61, 16384
    buffer_load_dword v12, v3, s[44:47], s56 offen
    s_add_u32 s56, s61, 24576
    buffer_load_dword v13, v3, s[44:47], s56 offen
    s_add_u32 s56, s61, 81920
    buffer_load_dword v14, v3, s[44:47], s56 offen
    s_add_u32 s56, s61, 90112
    buffer_load_dword v15, v3, s[44:47], s56 offen
    s_add_u32 s56, s61, 262144
    buffer_load_dword v16, v3, s[44:47], s56 offen
    s_add_u32 s56, s61, 270336
    buffer_load_dword v17, v3, s[44:47], s56 offen
    s_add_u32 s56, s61, 327680
    buffer_load_dword v18, v3, s[44:47], s56 offen
    s_add_u32 s56, s61, 335872
    buffer_load_dword v19, v3, s[44:47], s56 offen
    s_add_u32 s56, s61, 278528
    buffer_load_dword v20, v3, s[44:47], s56 offen
    s_add_u32 s56, s61, 286720
    buffer_load_dword v21, v3, s[44:47], s56 offen
    s_add_u32 s56, s61, 344064
    buffer_load_dword v22, v3, s[44:47], s56 offen
    s_add_u32 s56, s61, 352256
    buffer_load_dword v23, v3, s[44:47], s56 offen
    s_xor_b32 s61, s27, 1
    s_lshl_b32 s61, s61, 19
    s_add_u32 s61, s61, s58
    s_add_u32 s61, s61, s55
    s_add_u32 s56, s61, 0
    buffer_load_dword v24, v3, s[44:47], s56 offen
    s_add_u32 s56, s61, 8192
    buffer_load_dword v25, v3, s[44:47], s56 offen
    s_add_u32 s56, s61, 65536
    buffer_load_dword v26, v3, s[44:47], s56 offen
    s_add_u32 s56, s61, 73728
    buffer_load_dword v27, v3, s[44:47], s56 offen
    s_add_u32 s56, s61, 16384
    buffer_load_dword v28, v3, s[44:47], s56 offen
    s_add_u32 s56, s61, 24576
    buffer_load_dword v29, v3, s[44:47], s56 offen
    s_add_u32 s56, s61, 81920
    buffer_load_dword v30, v3, s[44:47], s56 offen
    s_add_u32 s56, s61, 90112
    buffer_load_dword v31, v3, s[44:47], s56 offen
    s_add_u32 s56, s61, 262144
    buffer_load_dword v32, v3, s[44:47], s56 offen
    s_add_u32 s56, s61, 270336
    buffer_load_dword v33, v3, s[44:47], s56 offen
    s_add_u32 s56, s61, 327680
    buffer_load_dword v34, v3, s[44:47], s56 offen
    s_add_u32 s56, s61, 335872
    buffer_load_dword v35, v3, s[44:47], s56 offen
    s_add_u32 s56, s61, 278528
    buffer_load_dword v36, v3, s[44:47], s56 offen
    s_add_u32 s56, s61, 286720
    buffer_load_dword v37, v3, s[44:47], s56 offen
    s_add_u32 s56, s61, 344064
    buffer_load_dword v38, v3, s[44:47], s56 offen
    s_add_u32 s56, s61, 352256
    buffer_load_dword v39, v3, s[44:47], s56 offen
    s_waitcnt vmcnt(32)
    v_perm_b32 v4, v42, v40, s52
    v_accvgpr_write_b32 a40, v4
    v_perm_b32 v5, v46, v44, s52
    v_accvgpr_write_b32 a41, v5
    v_perm_b32 v4, v50, v48, s52
    v_accvgpr_write_b32 a42, v4
    v_perm_b32 v5, v54, v52, s52
    v_accvgpr_write_b32 a43, v5
    v_perm_b32 v4, v58, v56, s52
    v_accvgpr_write_b32 a44, v4
    v_perm_b32 v5, v62, v60, s52
    v_accvgpr_write_b32 a45, v5
    v_perm_b32 v4, v66, v64, s52
    v_accvgpr_write_b32 a46, v4
    v_perm_b32 v5, v70, v68, s52
    v_accvgpr_write_b32 a47, v5
    v_perm_b32 v4, v42, v40, s53
    v_accvgpr_write_b32 a48, v4
    v_perm_b32 v5, v46, v44, s53
    v_accvgpr_write_b32 a49, v5
    v_perm_b32 v4, v50, v48, s53
    v_accvgpr_write_b32 a50, v4
    v_perm_b32 v5, v54, v52, s53
    v_accvgpr_write_b32 a51, v5
    v_perm_b32 v4, v58, v56, s53
    v_accvgpr_write_b32 a52, v4
    v_perm_b32 v5, v62, v60, s53
    v_accvgpr_write_b32 a53, v5
    v_perm_b32 v4, v66, v64, s53
    v_accvgpr_write_b32 a54, v4
    v_perm_b32 v5, v70, v68, s53
    v_accvgpr_write_b32 a55, v5
    v_perm_b32 v4, v43, v41, s52
    v_accvgpr_write_b32 a56, v4
    v_perm_b32 v5, v47, v45, s52
    v_accvgpr_write_b32 a57, v5
    v_perm_b32 v4, v51, v49, s52
    v_accvgpr_write_b32 a58, v4
    v_perm_b32 v5, v55, v53, s52
    v_accvgpr_write_b32 a59, v5
    v_perm_b32 v4, v59, v57, s52
    v_accvgpr_write_b32 a60, v4
    v_perm_b32 v5, v63, v61, s52
    v_accvgpr_write_b32 a61, v5
    v_perm_b32 v4, v67, v65, s52
    v_accvgpr_write_b32 a62, v4
    v_perm_b32 v5, v71, v69, s52
    v_accvgpr_write_b32 a63, v5
    v_perm_b32 v88, v43, v41, s53
    v_perm_b32 v89, v47, v45, s53
    v_perm_b32 v90, v51, v49, s53
    v_perm_b32 v91, v55, v53, s53
    v_perm_b32 v92, v59, v57, s53
    v_perm_b32 v93, v63, v61, s53
    v_perm_b32 v94, v67, v65, s53
    v_perm_b32 v95, v71, v69, s53
    ds_write_b128 v2, v[88:91] offset:18432
    ds_write_b128 v2, v[92:95] offset:19456
    s_nop 1
    s_xor_b32 s61, s27, 2
    s_lshl_b32 s61, s61, 19
    s_add_u32 s61, s61, s58
    s_add_u32 s61, s61, s55
    s_add_u32 s56, s61, 0
    buffer_load_dword v40, v3, s[44:47], s56 offen
    s_add_u32 s56, s61, 8192
    buffer_load_dword v41, v3, s[44:47], s56 offen
    s_add_u32 s56, s61, 65536
    buffer_load_dword v42, v3, s[44:47], s56 offen
    s_add_u32 s56, s61, 73728
    buffer_load_dword v43, v3, s[44:47], s56 offen
    s_add_u32 s56, s61, 16384
    buffer_load_dword v44, v3, s[44:47], s56 offen
    s_add_u32 s56, s61, 24576
    buffer_load_dword v45, v3, s[44:47], s56 offen
    s_add_u32 s56, s61, 81920
    buffer_load_dword v46, v3, s[44:47], s56 offen
    s_add_u32 s56, s61, 90112
    buffer_load_dword v47, v3, s[44:47], s56 offen
    s_add_u32 s56, s61, 262144
    buffer_load_dword v48, v3, s[44:47], s56 offen
    s_add_u32 s56, s61, 270336
    buffer_load_dword v49, v3, s[44:47], s56 offen
    s_add_u32 s56, s61, 327680
    buffer_load_dword v50, v3, s[44:47], s56 offen
    s_add_u32 s56, s61, 335872
    buffer_load_dword v51, v3, s[44:47], s56 offen
    s_add_u32 s56, s61, 278528
    buffer_load_dword v52, v3, s[44:47], s56 offen
    s_add_u32 s56, s61, 286720
    buffer_load_dword v53, v3, s[44:47], s56 offen
    s_add_u32 s56, s61, 344064
    buffer_load_dword v54, v3, s[44:47], s56 offen
    s_add_u32 s56, s61, 352256
    buffer_load_dword v55, v3, s[44:47], s56 offen
    s_xor_b32 s61, s27, 3
    s_lshl_b32 s61, s61, 19
    s_add_u32 s61, s61, s58
    s_add_u32 s61, s61, s55
    s_add_u32 s56, s61, 0
    buffer_load_dword v56, v3, s[44:47], s56 offen
    s_add_u32 s56, s61, 8192
    buffer_load_dword v57, v3, s[44:47], s56 offen
    s_add_u32 s56, s61, 65536
    buffer_load_dword v58, v3, s[44:47], s56 offen
    s_add_u32 s56, s61, 73728
    buffer_load_dword v59, v3, s[44:47], s56 offen
    s_add_u32 s56, s61, 16384
    buffer_load_dword v60, v3, s[44:47], s56 offen
    s_add_u32 s56, s61, 24576
    buffer_load_dword v61, v3, s[44:47], s56 offen
    s_add_u32 s56, s61, 81920
    buffer_load_dword v62, v3, s[44:47], s56 offen
    s_add_u32 s56, s61, 90112
    buffer_load_dword v63, v3, s[44:47], s56 offen
    s_add_u32 s56, s61, 262144
    buffer_load_dword v64, v3, s[44:47], s56 offen
    s_add_u32 s56, s61, 270336
    buffer_load_dword v65, v3, s[44:47], s56 offen
    s_add_u32 s56, s61, 327680
    buffer_load_dword v66, v3, s[44:47], s56 offen
    s_add_u32 s56, s61, 335872
    buffer_load_dword v67, v3, s[44:47], s56 offen
    s_add_u32 s56, s61, 278528
    buffer_load_dword v68, v3, s[44:47], s56 offen
    s_add_u32 s56, s61, 286720
    buffer_load_dword v69, v3, s[44:47], s56 offen
    s_add_u32 s56, s61, 344064
    buffer_load_dword v70, v3, s[44:47], s56 offen
    s_add_u32 s56, s61, 352256
    buffer_load_dword v71, v3, s[44:47], s56 offen
    s_waitcnt vmcnt(32)
    v_perm_b32 v112, v9, v8, s52
    v_perm_b32 v113, v11, v10, s52
    v_perm_b32 v114, v13, v12, s52
    v_perm_b32 v115, v15, v14, s52
    v_perm_b32 v116, v17, v16, s52
    v_perm_b32 v117, v19, v18, s52
    v_perm_b32 v118, v21, v20, s52
    v_perm_b32 v119, v23, v22, s52
    v_perm_b32 v120, v9, v8, s53
    v_perm_b32 v121, v11, v10, s53
    v_perm_b32 v122, v13, v12, s53
    v_perm_b32 v123, v15, v14, s53
    v_perm_b32 v124, v17, v16, s53
    v_perm_b32 v125, v19, v18, s53
    v_perm_b32 v126, v21, v20, s53
    v_perm_b32 v127, v23, v22, s53
    v_perm_b32 v240, v25, v24, s52
    v_perm_b32 v241, v27, v26, s52
    v_perm_b32 v242, v29, v28, s52
    v_perm_b32 v243, v31, v30, s52
    v_perm_b32 v244, v33, v32, s52
    v_perm_b32 v245, v35, v34, s52
    v_perm_b32 v246, v37, v36, s52
    v_perm_b32 v247, v39, v38, s52
    v_perm_b32 v248, v25, v24, s53
    v_perm_b32 v249, v27, v26, s53
    v_perm_b32 v250, v29, v28, s53
    v_perm_b32 v251, v31, v30, s53
    v_perm_b32 v252, v33, v32, s53
    v_perm_b32 v253, v35, v34, s53
    v_perm_b32 v254, v37, v36, s53
    v_perm_b32 v255, v39, v38, s53
    s_mov_b32 s61, 2097152
    s_add_u32 s61, s61, s58
    s_add_u32 s61, s61, s55
    s_add_u32 s56, s61, 0
    buffer_load_dword v8, v3, s[44:47], s56 offen
    s_add_u32 s56, s61, 8192
    buffer_load_dword v9, v3, s[44:47], s56 offen
    s_add_u32 s56, s61, 65536
    buffer_load_dword v10, v3, s[44:47], s56 offen
    s_add_u32 s56, s61, 73728
    buffer_load_dword v11, v3, s[44:47], s56 offen
    s_add_u32 s56, s61, 16384
    buffer_load_dword v12, v3, s[44:47], s56 offen
    s_add_u32 s56, s61, 24576
    buffer_load_dword v13, v3, s[44:47], s56 offen
    s_add_u32 s56, s61, 81920
    buffer_load_dword v14, v3, s[44:47], s56 offen
    s_add_u32 s56, s61, 90112
    buffer_load_dword v15, v3, s[44:47], s56 offen
    s_add_u32 s56, s61, 262144
    buffer_load_dword v16, v3, s[44:47], s56 offen
    s_add_u32 s56, s61, 270336
    buffer_load_dword v17, v3, s[44:47], s56 offen
    s_add_u32 s56, s61, 327680
    buffer_load_dword v18, v3, s[44:47], s56 offen
    s_add_u32 s56, s61, 335872
    buffer_load_dword v19, v3, s[44:47], s56 offen
    s_add_u32 s56, s61, 278528
    buffer_load_dword v20, v3, s[44:47], s56 offen
    s_add_u32 s56, s61, 286720
    buffer_load_dword v21, v3, s[44:47], s56 offen
    s_add_u32 s56, s61, 344064
    buffer_load_dword v22, v3, s[44:47], s56 offen
    s_add_u32 s56, s61, 352256
    buffer_load_dword v23, v3, s[44:47], s56 offen
    s_xor_b32 s61, s27, 0
    s_lshl_b32 s61, s61, 19
    s_add_u32 s61, s61, s59
    s_add_u32 s61, s61, s55
    s_add_u32 s56, s61, 0
    buffer_load_dword v24, v3, s[44:47], s56 offen
    s_add_u32 s56, s61, 8192
    buffer_load_dword v25, v3, s[44:47], s56 offen
    s_add_u32 s56, s61, 65536
    buffer_load_dword v26, v3, s[44:47], s56 offen
    s_add_u32 s56, s61, 73728
    buffer_load_dword v27, v3, s[44:47], s56 offen
    s_add_u32 s56, s61, 16384
    buffer_load_dword v28, v3, s[44:47], s56 offen
    s_add_u32 s56, s61, 24576
    buffer_load_dword v29, v3, s[44:47], s56 offen
    s_add_u32 s56, s61, 81920
    buffer_load_dword v30, v3, s[44:47], s56 offen
    s_add_u32 s56, s61, 90112
    buffer_load_dword v31, v3, s[44:47], s56 offen
    s_add_u32 s56, s61, 262144
    buffer_load_dword v32, v3, s[44:47], s56 offen
    s_add_u32 s56, s61, 270336
    buffer_load_dword v33, v3, s[44:47], s56 offen
    s_add_u32 s56, s61, 327680
    buffer_load_dword v34, v3, s[44:47], s56 offen
    s_add_u32 s56, s61, 335872
    buffer_load_dword v35, v3, s[44:47], s56 offen
    s_add_u32 s56, s61, 278528
    buffer_load_dword v36, v3, s[44:47], s56 offen
    s_add_u32 s56, s61, 286720
    buffer_load_dword v37, v3, s[44:47], s56 offen
    s_add_u32 s56, s61, 344064
    buffer_load_dword v38, v3, s[44:47], s56 offen
    s_add_u32 s56, s61, 352256
    buffer_load_dword v39, v3, s[44:47], s56 offen
    s_waitcnt vmcnt(32)
    v_perm_b32 v4, v41, v40, s52
    v_accvgpr_write_b32 a0, v4
    v_perm_b32 v5, v43, v42, s52
    v_accvgpr_write_b32 a1, v5
    v_perm_b32 v4, v45, v44, s52
    v_accvgpr_write_b32 a2, v4
    v_perm_b32 v5, v47, v46, s52
    v_accvgpr_write_b32 a3, v5
    v_perm_b32 v4, v49, v48, s52
    v_accvgpr_write_b32 a4, v4
    v_perm_b32 v5, v51, v50, s52
    v_accvgpr_write_b32 a5, v5
    v_perm_b32 v4, v53, v52, s52
    v_accvgpr_write_b32 a6, v4
    v_perm_b32 v5, v55, v54, s52
    v_accvgpr_write_b32 a7, v5
    v_perm_b32 v4, v41, v40, s53
    v_accvgpr_write_b32 a8, v4
    v_perm_b32 v5, v43, v42, s53
    v_accvgpr_write_b32 a9, v5
    v_perm_b32 v4, v45, v44, s53
    v_accvgpr_write_b32 a10, v4
    v_perm_b32 v5, v47, v46, s53
    v_accvgpr_write_b32 a11, v5
    v_perm_b32 v4, v49, v48, s53
    v_accvgpr_write_b32 a12, v4
    v_perm_b32 v5, v51, v50, s53
    v_accvgpr_write_b32 a13, v5
    v_perm_b32 v4, v53, v52, s53
    v_accvgpr_write_b32 a14, v4
    v_perm_b32 v5, v55, v54, s53
    v_accvgpr_write_b32 a15, v5
    v_perm_b32 v4, v57, v56, s52
    v_accvgpr_write_b32 a16, v4
    v_perm_b32 v5, v59, v58, s52
    v_accvgpr_write_b32 a17, v5
    v_perm_b32 v4, v61, v60, s52
    v_accvgpr_write_b32 a18, v4
    v_perm_b32 v5, v63, v62, s52
    v_accvgpr_write_b32 a19, v5
    v_perm_b32 v4, v65, v64, s52
    v_accvgpr_write_b32 a20, v4
    v_perm_b32 v5, v67, v66, s52
    v_accvgpr_write_b32 a21, v5
    v_perm_b32 v4, v69, v68, s52
    v_accvgpr_write_b32 a22, v4
    v_perm_b32 v5, v71, v70, s52
    v_accvgpr_write_b32 a23, v5
    v_perm_b32 v4, v57, v56, s53
    v_accvgpr_write_b32 a24, v4
    v_perm_b32 v5, v59, v58, s53
    v_accvgpr_write_b32 a25, v5
    v_perm_b32 v4, v61, v60, s53
    v_accvgpr_write_b32 a26, v4
    v_perm_b32 v5, v63, v62, s53
    v_accvgpr_write_b32 a27, v5
    v_perm_b32 v4, v65, v64, s53
    v_accvgpr_write_b32 a28, v4
    v_perm_b32 v5, v67, v66, s53
    v_accvgpr_write_b32 a29, v5
    v_perm_b32 v4, v69, v68, s53
    v_accvgpr_write_b32 a30, v4
    v_perm_b32 v5, v71, v70, s53
    v_accvgpr_write_b32 a31, v5
    s_xor_b32 s61, s27, 1
    s_lshl_b32 s61, s61, 19
    s_add_u32 s61, s61, s59
    s_add_u32 s61, s61, s55
    s_add_u32 s56, s61, 0
    buffer_load_dword v40, v3, s[44:47], s56 offen
    s_add_u32 s56, s61, 8192
    buffer_load_dword v41, v3, s[44:47], s56 offen
    s_add_u32 s56, s61, 65536
    buffer_load_dword v42, v3, s[44:47], s56 offen
    s_add_u32 s56, s61, 73728
    buffer_load_dword v43, v3, s[44:47], s56 offen
    s_add_u32 s56, s61, 16384
    buffer_load_dword v44, v3, s[44:47], s56 offen
    s_add_u32 s56, s61, 24576
    buffer_load_dword v45, v3, s[44:47], s56 offen
    s_add_u32 s56, s61, 81920
    buffer_load_dword v46, v3, s[44:47], s56 offen
    s_add_u32 s56, s61, 90112
    buffer_load_dword v47, v3, s[44:47], s56 offen
    s_add_u32 s56, s61, 262144
    buffer_load_dword v48, v3, s[44:47], s56 offen
    s_add_u32 s56, s61, 270336
    buffer_load_dword v49, v3, s[44:47], s56 offen
    s_add_u32 s56, s61, 327680
    buffer_load_dword v50, v3, s[44:47], s56 offen
    s_add_u32 s56, s61, 335872
    buffer_load_dword v51, v3, s[44:47], s56 offen
    s_add_u32 s56, s61, 278528
    buffer_load_dword v52, v3, s[44:47], s56 offen
    s_add_u32 s56, s61, 286720
    buffer_load_dword v53, v3, s[44:47], s56 offen
    s_add_u32 s56, s61, 344064
    buffer_load_dword v54, v3, s[44:47], s56 offen
    s_add_u32 s56, s61, 352256
    buffer_load_dword v55, v3, s[44:47], s56 offen
    s_xor_b32 s61, s27, 2
    s_lshl_b32 s61, s61, 19
    s_add_u32 s61, s61, s59
    s_add_u32 s61, s61, s55
    s_add_u32 s56, s61, 0
    buffer_load_dword v56, v3, s[44:47], s56 offen
    s_add_u32 s56, s61, 8192
    buffer_load_dword v57, v3, s[44:47], s56 offen
    s_add_u32 s56, s61, 65536
    buffer_load_dword v58, v3, s[44:47], s56 offen
    s_add_u32 s56, s61, 73728
    buffer_load_dword v59, v3, s[44:47], s56 offen
    s_add_u32 s56, s61, 16384
    buffer_load_dword v60, v3, s[44:47], s56 offen
    s_add_u32 s56, s61, 24576
    buffer_load_dword v61, v3, s[44:47], s56 offen
    s_add_u32 s56, s61, 81920
    buffer_load_dword v62, v3, s[44:47], s56 offen
    s_add_u32 s56, s61, 90112
    buffer_load_dword v63, v3, s[44:47], s56 offen
    s_add_u32 s56, s61, 262144
    buffer_load_dword v64, v3, s[44:47], s56 offen
    s_add_u32 s56, s61, 270336
    buffer_load_dword v65, v3, s[44:47], s56 offen
    s_add_u32 s56, s61, 327680
    buffer_load_dword v66, v3, s[44:47], s56 offen
    s_add_u32 s56, s61, 335872
    buffer_load_dword v67, v3, s[44:47], s56 offen
    s_add_u32 s56, s61, 278528
    buffer_load_dword v68, v3, s[44:47], s56 offen
    s_add_u32 s56, s61, 286720
    buffer_load_dword v69, v3, s[44:47], s56 offen
    s_add_u32 s56, s61, 344064
    buffer_load_dword v70, v3, s[44:47], s56 offen
    s_add_u32 s56, s61, 352256
    buffer_load_dword v71, v3, s[44:47], s56 offen
    s_waitcnt vmcnt(32)
    v_perm_b32 v88, v9, v8, s52
    v_perm_b32 v89, v11, v10, s52
    v_perm_b32 v90, v13, v12, s52
    v_perm_b32 v91, v15, v14, s52
    v_perm_b32 v92, v17, v16, s52
    v_perm_b32 v93, v19, v18, s52
    v_perm_b32 v94, v21, v20, s52
    v_perm_b32 v95, v23, v22, s52
    ds_write_b128 v2, v[88:91] offset:4096
    ds_write_b128 v2, v[92:95] offset:5120
    s_nop 1
    v_perm_b32 v88, v9, v8, s53
    v_perm_b32 v89, v11, v10, s53
    v_perm_b32 v90, v13, v12, s53
    v_perm_b32 v91, v15, v14, s53
    v_perm_b32 v92, v17, v16, s53
    v_perm_b32 v93, v19, v18, s53
    v_perm_b32 v94, v21, v20, s53
    v_perm_b32 v95, v23, v22, s53
    ds_write_b128 v2, v[88:91] offset:6144
    ds_write_b128 v2, v[92:95] offset:7168
    s_nop 1
    v_perm_b32 v4, v25, v24, s52
    v_accvgpr_write_b32 a152, v4
    v_perm_b32 v5, v27, v26, s52
    v_accvgpr_write_b32 a153, v5
    v_perm_b32 v4, v29, v28, s52
    v_accvgpr_write_b32 a154, v4
    v_perm_b32 v5, v31, v30, s52
    v_accvgpr_write_b32 a155, v5
    v_perm_b32 v4, v33, v32, s52
    v_accvgpr_write_b32 a156, v4
    v_perm_b32 v5, v35, v34, s52
    v_accvgpr_write_b32 a157, v5
    v_perm_b32 v4, v37, v36, s52
    v_accvgpr_write_b32 a158, v4
    v_perm_b32 v5, v39, v38, s52
    v_accvgpr_write_b32 a159, v5
    v_perm_b32 v4, v25, v24, s53
    v_accvgpr_write_b32 a160, v4
    v_perm_b32 v5, v27, v26, s53
    v_accvgpr_write_b32 a161, v5
    v_perm_b32 v4, v29, v28, s53
    v_accvgpr_write_b32 a162, v4
    v_perm_b32 v5, v31, v30, s53
    v_accvgpr_write_b32 a163, v5
    v_perm_b32 v4, v33, v32, s53
    v_accvgpr_write_b32 a164, v4
    v_perm_b32 v5, v35, v34, s53
    v_accvgpr_write_b32 a165, v5
    v_perm_b32 v4, v37, v36, s53
    v_accvgpr_write_b32 a166, v4
    v_perm_b32 v5, v39, v38, s53
    v_accvgpr_write_b32 a167, v5
    s_xor_b32 s61, s27, 3
    s_lshl_b32 s61, s61, 19
    s_add_u32 s61, s61, s59
    s_add_u32 s61, s61, s55
    s_add_u32 s56, s61, 0
    buffer_load_dword v8, v3, s[44:47], s56 offen
    s_add_u32 s56, s61, 8192
    buffer_load_dword v9, v3, s[44:47], s56 offen
    s_add_u32 s56, s61, 65536
    buffer_load_dword v10, v3, s[44:47], s56 offen
    s_add_u32 s56, s61, 73728
    buffer_load_dword v11, v3, s[44:47], s56 offen
    s_add_u32 s56, s61, 16384
    buffer_load_dword v12, v3, s[44:47], s56 offen
    s_add_u32 s56, s61, 24576
    buffer_load_dword v13, v3, s[44:47], s56 offen
    s_add_u32 s56, s61, 81920
    buffer_load_dword v14, v3, s[44:47], s56 offen
    s_add_u32 s56, s61, 90112
    buffer_load_dword v15, v3, s[44:47], s56 offen
    s_add_u32 s56, s61, 262144
    buffer_load_dword v16, v3, s[44:47], s56 offen
    s_add_u32 s56, s61, 270336
    buffer_load_dword v17, v3, s[44:47], s56 offen
    s_add_u32 s56, s61, 327680
    buffer_load_dword v18, v3, s[44:47], s56 offen
    s_add_u32 s56, s61, 335872
    buffer_load_dword v19, v3, s[44:47], s56 offen
    s_add_u32 s56, s61, 278528
    buffer_load_dword v20, v3, s[44:47], s56 offen
    s_add_u32 s56, s61, 286720
    buffer_load_dword v21, v3, s[44:47], s56 offen
    s_add_u32 s56, s61, 344064
    buffer_load_dword v22, v3, s[44:47], s56 offen
    s_add_u32 s56, s61, 352256
    buffer_load_dword v23, v3, s[44:47], s56 offen
    s_mov_b32 s61, 2097152
    s_add_u32 s61, s61, s59
    s_add_u32 s61, s61, s55
    s_add_u32 s56, s61, 0
    buffer_load_dword v24, v3, s[44:47], s56 offen
    s_add_u32 s56, s61, 8192
    buffer_load_dword v25, v3, s[44:47], s56 offen
    s_add_u32 s56, s61, 65536
    buffer_load_dword v26, v3, s[44:47], s56 offen
    s_add_u32 s56, s61, 73728
    buffer_load_dword v27, v3, s[44:47], s56 offen
    s_add_u32 s56, s61, 16384
    buffer_load_dword v28, v3, s[44:47], s56 offen
    s_add_u32 s56, s61, 24576
    buffer_load_dword v29, v3, s[44:47], s56 offen
    s_add_u32 s56, s61, 81920
    buffer_load_dword v30, v3, s[44:47], s56 offen
    s_add_u32 s56, s61, 90112
    buffer_load_dword v31, v3, s[44:47], s56 offen
    s_add_u32 s56, s61, 262144
    buffer_load_dword v32, v3, s[44:47], s56 offen
    s_add_u32 s56, s61, 270336
    buffer_load_dword v33, v3, s[44:47], s56 offen
    s_add_u32 s56, s61, 327680
    buffer_load_dword v34, v3, s[44:47], s56 offen
    s_add_u32 s56, s61, 335872
    buffer_load_dword v35, v3, s[44:47], s56 offen
    s_add_u32 s56, s61, 278528
    buffer_load_dword v36, v3, s[44:47], s56 offen
    s_add_u32 s56, s61, 286720
    buffer_load_dword v37, v3, s[44:47], s56 offen
    s_add_u32 s56, s61, 344064
    buffer_load_dword v38, v3, s[44:47], s56 offen
    s_add_u32 s56, s61, 352256
    buffer_load_dword v39, v3, s[44:47], s56 offen
    s_waitcnt vmcnt(32)
    v_perm_b32 v4, v41, v40, s52
    v_accvgpr_write_b32 a168, v4
    v_perm_b32 v5, v43, v42, s52
    v_accvgpr_write_b32 a169, v5
    v_perm_b32 v4, v45, v44, s52
    v_accvgpr_write_b32 a170, v4
    v_perm_b32 v5, v47, v46, s52
    v_accvgpr_write_b32 a171, v5
    v_perm_b32 v4, v49, v48, s52
    v_accvgpr_write_b32 a172, v4
    v_perm_b32 v5, v51, v50, s52
    v_accvgpr_write_b32 a173, v5
    v_perm_b32 v4, v53, v52, s52
    v_accvgpr_write_b32 a174, v4
    v_perm_b32 v5, v55, v54, s52
    v_accvgpr_write_b32 a175, v5
    v_perm_b32 v4, v41, v40, s53
    v_accvgpr_write_b32 a176, v4
    v_perm_b32 v5, v43, v42, s53
    v_accvgpr_write_b32 a177, v5
    v_perm_b32 v4, v45, v44, s53
    v_accvgpr_write_b32 a178, v4
    v_perm_b32 v5, v47, v46, s53
    v_accvgpr_write_b32 a179, v5
    v_perm_b32 v4, v49, v48, s53
    v_accvgpr_write_b32 a180, v4
    v_perm_b32 v5, v51, v50, s53
    v_accvgpr_write_b32 a181, v5
    v_perm_b32 v4, v53, v52, s53
    v_accvgpr_write_b32 a182, v4
    v_perm_b32 v5, v55, v54, s53
    v_accvgpr_write_b32 a183, v5
    v_perm_b32 v4, v57, v56, s52
    v_accvgpr_write_b32 a184, v4
    v_perm_b32 v5, v59, v58, s52
    v_accvgpr_write_b32 a185, v5
    v_perm_b32 v4, v61, v60, s52
    v_accvgpr_write_b32 a186, v4
    v_perm_b32 v5, v63, v62, s52
    v_accvgpr_write_b32 a187, v5
    v_perm_b32 v4, v65, v64, s52
    v_accvgpr_write_b32 a188, v4
    v_perm_b32 v5, v67, v66, s52
    v_accvgpr_write_b32 a189, v5
    v_perm_b32 v4, v69, v68, s52
    v_accvgpr_write_b32 a190, v4
    v_perm_b32 v5, v71, v70, s52
    v_accvgpr_write_b32 a191, v5
    v_perm_b32 v4, v57, v56, s53
    v_accvgpr_write_b32 a192, v4
    v_perm_b32 v5, v59, v58, s53
    v_accvgpr_write_b32 a193, v5
    v_perm_b32 v4, v61, v60, s53
    v_accvgpr_write_b32 a194, v4
    v_perm_b32 v5, v63, v62, s53
    v_accvgpr_write_b32 a195, v5
    v_perm_b32 v4, v65, v64, s53
    v_accvgpr_write_b32 a196, v4
    v_perm_b32 v5, v67, v66, s53
    v_accvgpr_write_b32 a197, v5
    v_perm_b32 v4, v69, v68, s53
    v_accvgpr_write_b32 a198, v4
    v_perm_b32 v5, v71, v70, s53
    v_accvgpr_write_b32 a199, v5
    s_add_u32 s56, s60, 0
    buffer_load_ushort v40, v6, s[48:51], s56 offen
    buffer_load_ushort v41, v6, s[48:51], s56 offen offset:1280
    s_add_u32 s56, s60, 2560
    buffer_load_ushort v42, v6, s[48:51], s56 offen
    buffer_load_ushort v43, v6, s[48:51], s56 offen offset:1280
    s_add_u32 s56, s60, 5120
    buffer_load_ushort v44, v6, s[48:51], s56 offen
    buffer_load_ushort v45, v6, s[48:51], s56 offen offset:1280
    s_add_u32 s56, s60, 7680
    buffer_load_ushort v46, v6, s[48:51], s56 offen
    buffer_load_ushort v47, v6, s[48:51], s56 offen offset:1280
    s_add_u32 s56, s60, 40960
    buffer_load_ushort v48, v6, s[48:51], s56 offen
    buffer_load_ushort v49, v6, s[48:51], s56 offen offset:1280
    s_add_u32 s56, s60, 43520
    buffer_load_ushort v50, v6, s[48:51], s56 offen
    buffer_load_ushort v51, v6, s[48:51], s56 offen offset:1280
    s_add_u32 s56, s60, 46080
    buffer_load_ushort v52, v6, s[48:51], s56 offen
    buffer_load_ushort v53, v6, s[48:51], s56 offen offset:1280
    s_add_u32 s56, s60, 48640
    buffer_load_ushort v54, v6, s[48:51], s56 offen
    buffer_load_ushort v55, v6, s[48:51], s56 offen offset:1280
    s_add_u32 s56, s60, 81920
    buffer_load_ushort v56, v6, s[48:51], s56 offen
    buffer_load_ushort v57, v6, s[48:51], s56 offen offset:1280
    s_add_u32 s56, s60, 84480
    buffer_load_ushort v58, v6, s[48:51], s56 offen
    buffer_load_ushort v59, v6, s[48:51], s56 offen offset:1280
    s_add_u32 s56, s60, 87040
    buffer_load_ushort v60, v6, s[48:51], s56 offen
    buffer_load_ushort v61, v6, s[48:51], s56 offen offset:1280
    s_add_u32 s56, s60, 89600
    buffer_load_ushort v62, v6, s[48:51], s56 offen
    buffer_load_ushort v63, v6, s[48:51], s56 offen offset:1280
    s_add_u32 s56, s60, 122880
    buffer_load_ushort v64, v6, s[48:51], s56 offen
    buffer_load_ushort v65, v6, s[48:51], s56 offen offset:1280
    s_add_u32 s56, s60, 125440
    buffer_load_ushort v66, v6, s[48:51], s56 offen
    buffer_load_ushort v67, v6, s[48:51], s56 offen offset:1280
    s_add_u32 s56, s60, 128000
    buffer_load_ushort v68, v6, s[48:51], s56 offen
    buffer_load_ushort v69, v6, s[48:51], s56 offen offset:1280
    s_add_u32 s56, s60, 130560
    buffer_load_ushort v70, v6, s[48:51], s56 offen
    buffer_load_ushort v71, v6, s[48:51], s56 offen offset:1280
    s_waitcnt vmcnt(32)
    v_perm_b32 v4, v9, v8, s52
    v_accvgpr_write_b32 a200, v4
    v_perm_b32 v5, v11, v10, s52
    v_accvgpr_write_b32 a201, v5
    v_perm_b32 v4, v13, v12, s52
    v_accvgpr_write_b32 a202, v4
    v_perm_b32 v5, v15, v14, s52
    v_accvgpr_write_b32 a203, v5
    v_perm_b32 v4, v17, v16, s52
    v_accvgpr_write_b32 a204, v4
    v_perm_b32 v5, v19, v18, s52
    v_accvgpr_write_b32 a205, v5
    v_perm_b32 v4, v21, v20, s52
    v_accvgpr_write_b32 a206, v4
    v_perm_b32 v5, v23, v22, s52
    v_accvgpr_write_b32 a207, v5
    v_perm_b32 v4, v9, v8, s53
    v_accvgpr_write_b32 a208, v4
    v_perm_b32 v5, v11, v10, s53
    v_accvgpr_write_b32 a209, v5
    v_perm_b32 v4, v13, v12, s53
    v_accvgpr_write_b32 a210, v4
    v_perm_b32 v5, v15, v14, s53
    v_accvgpr_write_b32 a211, v5
    v_perm_b32 v4, v17, v16, s53
    v_accvgpr_write_b32 a212, v4
    v_perm_b32 v5, v19, v18, s53
    v_accvgpr_write_b32 a213, v5
    v_perm_b32 v4, v21, v20, s53
    v_accvgpr_write_b32 a214, v4
    v_perm_b32 v5, v23, v22, s53
    v_accvgpr_write_b32 a215, v5
    v_perm_b32 v4, v25, v24, s52
    v_accvgpr_write_b32 a64, v4
    v_perm_b32 v5, v27, v26, s52
    v_accvgpr_write_b32 a65, v5
    v_perm_b32 v4, v29, v28, s52
    v_accvgpr_write_b32 a66, v4
    v_perm_b32 v5, v31, v30, s52
    v_accvgpr_write_b32 a67, v5
    v_perm_b32 v4, v33, v32, s52
    v_accvgpr_write_b32 a68, v4
    v_perm_b32 v5, v35, v34, s52
    v_accvgpr_write_b32 a69, v5
    v_perm_b32 v4, v37, v36, s52
    v_accvgpr_write_b32 a70, v4
    v_perm_b32 v5, v39, v38, s52
    v_accvgpr_write_b32 a71, v5
    v_perm_b32 v4, v25, v24, s53
    v_accvgpr_write_b32 a72, v4
    v_perm_b32 v5, v27, v26, s53
    v_accvgpr_write_b32 a73, v5
    v_perm_b32 v4, v29, v28, s53
    v_accvgpr_write_b32 a74, v4
    v_perm_b32 v5, v31, v30, s53
    v_accvgpr_write_b32 a75, v5
    v_perm_b32 v4, v33, v32, s53
    v_accvgpr_write_b32 a76, v4
    v_perm_b32 v5, v35, v34, s53
    v_accvgpr_write_b32 a77, v5
    v_perm_b32 v4, v37, v36, s53
    v_accvgpr_write_b32 a78, v4
    v_perm_b32 v5, v39, v38, s53
    v_accvgpr_write_b32 a79, v5
    s_add_u32 s56, s60, 32
    buffer_load_ushort v8, v6, s[48:51], s56 offen
    buffer_load_ushort v9, v6, s[48:51], s56 offen offset:1280
    s_add_u32 s56, s60, 2592
    buffer_load_ushort v10, v6, s[48:51], s56 offen
    buffer_load_ushort v11, v6, s[48:51], s56 offen offset:1280
    s_add_u32 s56, s60, 5152
    buffer_load_ushort v12, v6, s[48:51], s56 offen
    buffer_load_ushort v13, v6, s[48:51], s56 offen offset:1280
    s_add_u32 s56, s60, 7712
    buffer_load_ushort v14, v6, s[48:51], s56 offen
    buffer_load_ushort v15, v6, s[48:51], s56 offen offset:1280
    s_add_u32 s56, s60, 40992
    buffer_load_ushort v16, v6, s[48:51], s56 offen
    buffer_load_ushort v17, v6, s[48:51], s56 offen offset:1280
    s_add_u32 s56, s60, 43552
    buffer_load_ushort v18, v6, s[48:51], s56 offen
    buffer_load_ushort v19, v6, s[48:51], s56 offen offset:1280
    s_add_u32 s56, s60, 46112
    buffer_load_ushort v20, v6, s[48:51], s56 offen
    buffer_load_ushort v21, v6, s[48:51], s56 offen offset:1280
    s_add_u32 s56, s60, 48672
    buffer_load_ushort v22, v6, s[48:51], s56 offen
    buffer_load_ushort v23, v6, s[48:51], s56 offen offset:1280
    s_add_u32 s56, s60, 81952
    buffer_load_ushort v24, v6, s[48:51], s56 offen
    buffer_load_ushort v25, v6, s[48:51], s56 offen offset:1280
    s_add_u32 s56, s60, 84512
    buffer_load_ushort v26, v6, s[48:51], s56 offen
    buffer_load_ushort v27, v6, s[48:51], s56 offen offset:1280
    s_add_u32 s56, s60, 87072
    buffer_load_ushort v28, v6, s[48:51], s56 offen
    buffer_load_ushort v29, v6, s[48:51], s56 offen offset:1280
    s_add_u32 s56, s60, 89632
    buffer_load_ushort v30, v6, s[48:51], s56 offen
    buffer_load_ushort v31, v6, s[48:51], s56 offen offset:1280
    s_add_u32 s56, s60, 122912
    buffer_load_ushort v32, v6, s[48:51], s56 offen
    buffer_load_ushort v33, v6, s[48:51], s56 offen offset:1280
    s_add_u32 s56, s60, 125472
    buffer_load_ushort v34, v6, s[48:51], s56 offen
    buffer_load_ushort v35, v6, s[48:51], s56 offen offset:1280
    s_add_u32 s56, s60, 128032
    buffer_load_ushort v36, v6, s[48:51], s56 offen
    buffer_load_ushort v37, v6, s[48:51], s56 offen offset:1280
    s_add_u32 s56, s60, 130592
    buffer_load_ushort v38, v6, s[48:51], s56 offen
    buffer_load_ushort v39, v6, s[48:51], s56 offen offset:1280
    s_waitcnt vmcnt(32)
    v_lshl_or_b32 v4, v41, 16, v40
    v_accvgpr_write_b32 a232, v4
    v_lshl_or_b32 v5, v43, 16, v42
    v_accvgpr_write_b32 a233, v5
    v_lshl_or_b32 v4, v45, 16, v44
    v_accvgpr_write_b32 a234, v4
    v_lshl_or_b32 v5, v47, 16, v46
    v_accvgpr_write_b32 a235, v5
    v_lshl_or_b32 v4, v49, 16, v48
    v_accvgpr_write_b32 a236, v4
    v_lshl_or_b32 v5, v51, 16, v50
    v_accvgpr_write_b32 a237, v5
    v_lshl_or_b32 v4, v53, 16, v52
    v_accvgpr_write_b32 a238, v4
    v_lshl_or_b32 v5, v55, 16, v54
    v_accvgpr_write_b32 a239, v5
    v_lshl_or_b32 v4, v57, 16, v56
    v_accvgpr_write_b32 a248, v4
    v_lshl_or_b32 v5, v59, 16, v58
    v_accvgpr_write_b32 a249, v5
    v_lshl_or_b32 v4, v61, 16, v60
    v_accvgpr_write_b32 a250, v4
    v_lshl_or_b32 v5, v63, 16, v62
    v_accvgpr_write_b32 a251, v5
    v_lshl_or_b32 v4, v65, 16, v64
    v_accvgpr_write_b32 a252, v4
    v_lshl_or_b32 v5, v67, 16, v66
    v_accvgpr_write_b32 a253, v5
    v_lshl_or_b32 v4, v69, 16, v68
    v_accvgpr_write_b32 a254, v4
    v_lshl_or_b32 v5, v71, 16, v70
    v_accvgpr_write_b32 a255, v5
    s_add_u32 s56, s60, 64
    buffer_load_ushort v40, v6, s[48:51], s56 offen
    buffer_load_ushort v41, v6, s[48:51], s56 offen offset:1280
    s_add_u32 s56, s60, 2624
    buffer_load_ushort v42, v6, s[48:51], s56 offen
    buffer_load_ushort v43, v6, s[48:51], s56 offen offset:1280
    s_add_u32 s56, s60, 5184
    buffer_load_ushort v44, v6, s[48:51], s56 offen
    buffer_load_ushort v45, v6, s[48:51], s56 offen offset:1280
    s_add_u32 s56, s60, 7744
    buffer_load_ushort v46, v6, s[48:51], s56 offen
    buffer_load_ushort v47, v6, s[48:51], s56 offen offset:1280
    s_add_u32 s56, s60, 41024
    buffer_load_ushort v48, v6, s[48:51], s56 offen
    buffer_load_ushort v49, v6, s[48:51], s56 offen offset:1280
    s_add_u32 s56, s60, 43584
    buffer_load_ushort v50, v6, s[48:51], s56 offen
    buffer_load_ushort v51, v6, s[48:51], s56 offen offset:1280
    s_add_u32 s56, s60, 46144
    buffer_load_ushort v52, v6, s[48:51], s56 offen
    buffer_load_ushort v53, v6, s[48:51], s56 offen offset:1280
    s_add_u32 s56, s60, 48704
    buffer_load_ushort v54, v6, s[48:51], s56 offen
    buffer_load_ushort v55, v6, s[48:51], s56 offen offset:1280
    s_add_u32 s56, s60, 81984
    buffer_load_ushort v56, v6, s[48:51], s56 offen
    buffer_load_ushort v57, v6, s[48:51], s56 offen offset:1280
    s_add_u32 s56, s60, 84544
    buffer_load_ushort v58, v6, s[48:51], s56 offen
    buffer_load_ushort v59, v6, s[48:51], s56 offen offset:1280
    s_add_u32 s56, s60, 87104
    buffer_load_ushort v60, v6, s[48:51], s56 offen
    buffer_load_ushort v61, v6, s[48:51], s56 offen offset:1280
    s_add_u32 s56, s60, 89664
    buffer_load_ushort v62, v6, s[48:51], s56 offen
    buffer_load_ushort v63, v6, s[48:51], s56 offen offset:1280
    s_add_u32 s56, s60, 122944
    buffer_load_ushort v64, v6, s[48:51], s56 offen
    buffer_load_ushort v65, v6, s[48:51], s56 offen offset:1280
    s_add_u32 s56, s60, 125504
    buffer_load_ushort v66, v6, s[48:51], s56 offen
    buffer_load_ushort v67, v6, s[48:51], s56 offen offset:1280
    s_add_u32 s56, s60, 128064
    buffer_load_ushort v68, v6, s[48:51], s56 offen
    buffer_load_ushort v69, v6, s[48:51], s56 offen offset:1280
    s_add_u32 s56, s60, 130624
    buffer_load_ushort v70, v6, s[48:51], s56 offen
    buffer_load_ushort v71, v6, s[48:51], s56 offen offset:1280
    s_waitcnt vmcnt(32)
    v_lshl_or_b32 v4, v9, 16, v8
    v_accvgpr_write_b32 a240, v4
    v_lshl_or_b32 v5, v11, 16, v10
    v_accvgpr_write_b32 a241, v5
    v_lshl_or_b32 v4, v13, 16, v12
    v_accvgpr_write_b32 a242, v4
    v_lshl_or_b32 v5, v15, 16, v14
    v_accvgpr_write_b32 a243, v5
    v_lshl_or_b32 v4, v17, 16, v16
    v_accvgpr_write_b32 a244, v4
    v_lshl_or_b32 v5, v19, 16, v18
    v_accvgpr_write_b32 a245, v5
    v_lshl_or_b32 v4, v21, 16, v20
    v_accvgpr_write_b32 a246, v4
    v_lshl_or_b32 v5, v23, 16, v22
    v_accvgpr_write_b32 a247, v5
    v_lshl_or_b32 v88, v25, 16, v24
    v_lshl_or_b32 v89, v27, 16, v26
    v_lshl_or_b32 v90, v29, 16, v28
    v_lshl_or_b32 v91, v31, 16, v30
    v_lshl_or_b32 v92, v33, 16, v32
    v_lshl_or_b32 v93, v35, 16, v34
    v_lshl_or_b32 v94, v37, 16, v36
    v_lshl_or_b32 v95, v39, 16, v38
    ds_write_b128 v2, v[88:91] offset:26624
    ds_write_b128 v2, v[92:95] offset:27648
    s_nop 1
    s_add_u32 s56, s60, 96
    buffer_load_ushort v8, v6, s[48:51], s56 offen
    buffer_load_ushort v9, v6, s[48:51], s56 offen offset:1280
    s_add_u32 s56, s60, 2656
    buffer_load_ushort v10, v6, s[48:51], s56 offen
    buffer_load_ushort v11, v6, s[48:51], s56 offen offset:1280
    s_add_u32 s56, s60, 5216
    buffer_load_ushort v12, v6, s[48:51], s56 offen
    buffer_load_ushort v13, v6, s[48:51], s56 offen offset:1280
    s_add_u32 s56, s60, 7776
    buffer_load_ushort v14, v6, s[48:51], s56 offen
    buffer_load_ushort v15, v6, s[48:51], s56 offen offset:1280
    s_add_u32 s56, s60, 41056
    buffer_load_ushort v16, v6, s[48:51], s56 offen
    buffer_load_ushort v17, v6, s[48:51], s56 offen offset:1280
    s_add_u32 s56, s60, 43616
    buffer_load_ushort v18, v6, s[48:51], s56 offen
    buffer_load_ushort v19, v6, s[48:51], s56 offen offset:1280
    s_add_u32 s56, s60, 46176
    buffer_load_ushort v20, v6, s[48:51], s56 offen
    buffer_load_ushort v21, v6, s[48:51], s56 offen offset:1280
    s_add_u32 s56, s60, 48736
    buffer_load_ushort v22, v6, s[48:51], s56 offen
    buffer_load_ushort v23, v6, s[48:51], s56 offen offset:1280
    s_add_u32 s56, s60, 82016
    buffer_load_ushort v24, v6, s[48:51], s56 offen
    buffer_load_ushort v25, v6, s[48:51], s56 offen offset:1280
    s_add_u32 s56, s60, 84576
    buffer_load_ushort v26, v6, s[48:51], s56 offen
    buffer_load_ushort v27, v6, s[48:51], s56 offen offset:1280
    s_add_u32 s56, s60, 87136
    buffer_load_ushort v28, v6, s[48:51], s56 offen
    buffer_load_ushort v29, v6, s[48:51], s56 offen offset:1280
    s_add_u32 s56, s60, 89696
    buffer_load_ushort v30, v6, s[48:51], s56 offen
    buffer_load_ushort v31, v6, s[48:51], s56 offen offset:1280
    s_add_u32 s56, s60, 122976
    buffer_load_ushort v32, v6, s[48:51], s56 offen
    buffer_load_ushort v33, v6, s[48:51], s56 offen offset:1280
    s_add_u32 s56, s60, 125536
    buffer_load_ushort v34, v6, s[48:51], s56 offen
    buffer_load_ushort v35, v6, s[48:51], s56 offen offset:1280
    s_add_u32 s56, s60, 128096
    buffer_load_ushort v36, v6, s[48:51], s56 offen
    buffer_load_ushort v37, v6, s[48:51], s56 offen offset:1280
    s_add_u32 s56, s60, 130656
    buffer_load_ushort v38, v6, s[48:51], s56 offen
    buffer_load_ushort v39, v6, s[48:51], s56 offen offset:1280
    s_waitcnt vmcnt(32)
    v_lshl_or_b32 v88, v41, 16, v40
    v_lshl_or_b32 v89, v43, 16, v42
    v_lshl_or_b32 v90, v45, 16, v44
    v_lshl_or_b32 v91, v47, 16, v46
    v_lshl_or_b32 v92, v49, 16, v48
    v_lshl_or_b32 v93, v51, 16, v50
    v_lshl_or_b32 v94, v53, 16, v52
    v_lshl_or_b32 v95, v55, 16, v54
    ds_write_b128 v2, v[88:91] offset:28672
    ds_write_b128 v2, v[92:95] offset:29696
    s_nop 1
    v_lshl_or_b32 v88, v57, 16, v56
    v_lshl_or_b32 v89, v59, 16, v58
    v_lshl_or_b32 v90, v61, 16, v60
    v_lshl_or_b32 v91, v63, 16, v62
    v_lshl_or_b32 v92, v65, 16, v64
    v_lshl_or_b32 v93, v67, 16, v66
    v_lshl_or_b32 v94, v69, 16, v68
    v_lshl_or_b32 v95, v71, 16, v70
    ds_write_b128 v2, v[88:91] offset:32768
    ds_write_b128 v2, v[92:95] offset:33792
    s_nop 1
    s_add_u32 s56, s60, 128
    buffer_load_ushort v40, v6, s[48:51], s56 offen
    buffer_load_ushort v41, v6, s[48:51], s56 offen offset:1280
    s_add_u32 s56, s60, 2688
    buffer_load_ushort v42, v6, s[48:51], s56 offen
    buffer_load_ushort v43, v6, s[48:51], s56 offen offset:1280
    s_add_u32 s56, s60, 5248
    buffer_load_ushort v44, v6, s[48:51], s56 offen
    buffer_load_ushort v45, v6, s[48:51], s56 offen offset:1280
    s_add_u32 s56, s60, 7808
    buffer_load_ushort v46, v6, s[48:51], s56 offen
    buffer_load_ushort v47, v6, s[48:51], s56 offen offset:1280
    s_add_u32 s56, s60, 41088
    buffer_load_ushort v48, v6, s[48:51], s56 offen
    buffer_load_ushort v49, v6, s[48:51], s56 offen offset:1280
    s_add_u32 s56, s60, 43648
    buffer_load_ushort v50, v6, s[48:51], s56 offen
    buffer_load_ushort v51, v6, s[48:51], s56 offen offset:1280
    s_add_u32 s56, s60, 46208
    buffer_load_ushort v52, v6, s[48:51], s56 offen
    buffer_load_ushort v53, v6, s[48:51], s56 offen offset:1280
    s_add_u32 s56, s60, 48768
    buffer_load_ushort v54, v6, s[48:51], s56 offen
    buffer_load_ushort v55, v6, s[48:51], s56 offen offset:1280
    s_add_u32 s56, s60, 82048
    buffer_load_ushort v56, v6, s[48:51], s56 offen
    buffer_load_ushort v57, v6, s[48:51], s56 offen offset:1280
    s_add_u32 s56, s60, 84608
    buffer_load_ushort v58, v6, s[48:51], s56 offen
    buffer_load_ushort v59, v6, s[48:51], s56 offen offset:1280
    s_add_u32 s56, s60, 87168
    buffer_load_ushort v60, v6, s[48:51], s56 offen
    buffer_load_ushort v61, v6, s[48:51], s56 offen offset:1280
    s_add_u32 s56, s60, 89728
    buffer_load_ushort v62, v6, s[48:51], s56 offen
    buffer_load_ushort v63, v6, s[48:51], s56 offen offset:1280
    s_add_u32 s56, s60, 123008
    buffer_load_ushort v64, v6, s[48:51], s56 offen
    buffer_load_ushort v65, v6, s[48:51], s56 offen offset:1280
    s_add_u32 s56, s60, 125568
    buffer_load_ushort v66, v6, s[48:51], s56 offen
    buffer_load_ushort v67, v6, s[48:51], s56 offen offset:1280
    s_add_u32 s56, s60, 128128
    buffer_load_ushort v68, v6, s[48:51], s56 offen
    buffer_load_ushort v69, v6, s[48:51], s56 offen offset:1280
    s_add_u32 s56, s60, 130688
    buffer_load_ushort v70, v6, s[48:51], s56 offen
    buffer_load_ushort v71, v6, s[48:51], s56 offen offset:1280
    s_waitcnt vmcnt(32)
    v_lshl_or_b32 v88, v9, 16, v8
    v_lshl_or_b32 v89, v11, 16, v10
    v_lshl_or_b32 v90, v13, 16, v12
    v_lshl_or_b32 v91, v15, 16, v14
    v_lshl_or_b32 v92, v17, 16, v16
    v_lshl_or_b32 v93, v19, 16, v18
    v_lshl_or_b32 v94, v21, 16, v20
    v_lshl_or_b32 v95, v23, 16, v22
    ds_write_b128 v2, v[88:91] offset:30720
    ds_write_b128 v2, v[92:95] offset:31744
    s_nop 1
    v_lshl_or_b32 v88, v25, 16, v24
    v_lshl_or_b32 v89, v27, 16, v26
    v_lshl_or_b32 v90, v29, 16, v28
    v_lshl_or_b32 v91, v31, 16, v30
    v_lshl_or_b32 v92, v33, 16, v32
    v_lshl_or_b32 v93, v35, 16, v34
    v_lshl_or_b32 v94, v37, 16, v36
    v_lshl_or_b32 v95, v39, 16, v38
    ds_write_b128 v2, v[88:91] offset:34816
    ds_write_b128 v2, v[92:95] offset:35840
    s_nop 1
    s_waitcnt vmcnt(0)
    v_lshl_or_b32 v4, v41, 16, v40
    v_accvgpr_write_b32 a216, v4
    v_lshl_or_b32 v5, v43, 16, v42
    v_accvgpr_write_b32 a217, v5
    v_lshl_or_b32 v4, v45, 16, v44
    v_accvgpr_write_b32 a218, v4
    v_lshl_or_b32 v5, v47, 16, v46
    v_accvgpr_write_b32 a219, v5
    v_lshl_or_b32 v4, v49, 16, v48
    v_accvgpr_write_b32 a220, v4
    v_lshl_or_b32 v5, v51, 16, v50
    v_accvgpr_write_b32 a221, v5
    v_lshl_or_b32 v4, v53, 16, v52
    v_accvgpr_write_b32 a222, v4
    v_lshl_or_b32 v5, v55, 16, v54
    v_accvgpr_write_b32 a223, v5
    v_lshl_or_b32 v4, v57, 16, v56
    v_accvgpr_write_b32 a224, v4
    v_lshl_or_b32 v5, v59, 16, v58
    v_accvgpr_write_b32 a225, v5
    v_lshl_or_b32 v4, v61, 16, v60
    v_accvgpr_write_b32 a226, v4
    v_lshl_or_b32 v5, v63, 16, v62
    v_accvgpr_write_b32 a227, v5
    v_lshl_or_b32 v4, v65, 16, v64
    v_accvgpr_write_b32 a228, v4
    v_lshl_or_b32 v5, v67, 16, v66
    v_accvgpr_write_b32 a229, v5
    v_lshl_or_b32 v4, v69, 16, v68
    v_accvgpr_write_b32 a230, v4
    v_lshl_or_b32 v5, v71, 16, v70
    v_accvgpr_write_b32 a231, v5
    s_barrier
    v_and_b32 v7, 63, v0
    v_lshlrev_b32 v0, 4, v7
    v_mov_b32 v1, 0x4444
    v_mov_b32 v8, 0xeeee
    v_and_b32 v9, 8, v7
    v_cmp_ne_u32 vcc, 0, v9
    s_nop 1
    v_cndmask_b32 v1, v1, v8, vcc
    v_bfe_u32 v8, v7, 1, 1
    v_mul_u32_u24 v3, 512, v8
    v_bfe_u32 v8, v7, 2, 2
    v_lshl_add_u32 v3, v8, 7, v3
    v_bfe_u32 v8, v7, 4, 1
    v_lshl_add_u32 v3, v8, 6, v3
    v_lshrrev_b32 v8, 5, v7
    v_lshl_add_u32 v3, v8, 4, v3
    v_and_b32 v8, 1, v7
    v_lshl_add_u32 v3, v8, 3, v3
    s_mul_i32 s56, s27, 1024
    s_add_u32 s56, s56, 8192
    v_add_u32 v3, s56, v3
    v_lshrrev_b32 v8, 4, v7
    v_and_b32 v9, 7, v7
    v_lshlrev_b32 v9, 4, v9
    v_lshl_add_u32 v4, v8, 7, v9
    v_lshl_add_u32 v5, v8, 8, v9
    s_lshr_b32 s56, s27, 1
    s_lshl_b32 s56, s56, 10
    s_and_b32 s57, s27, 1
    s_lshl_b32 s57, s57, 7
    s_add_u32 s56, s56, s57
    s_add_u32 s56, s56, 12288
    v_add_u32 v5, s56, v5
    v_lshrrev_b32 v8, 3, v7
    v_lshl_add_u32 v6, v8, 12, v9
    s_mov_b32 s24, 0
    s_mul_i32 s56, s26, 10240
    s_add_u32 s29, s56, 0
    s_sub_u32 s38, 15360, s56
    s_lshl_b32 s39, s27, 5
    s_add_u32 s39, s39, s25
    s_lshr_b32 s56, s25, 3
    s_mul_i32 s42, s56, 1280
    s_bfe_u32 s56, s25, 0x10002
    s_lshl_b32 s56, s56, 8
    s_add_u32 s42, s42, s56
    s_and_b32 s57, s25, 1
    s_lshl_b32 s57, s57, 7
    s_add_u32 s42, s42, s57
    s_bfe_u32 s56, s25, 0x10001
    s_lshl_b32 s56, s56, 6
    s_add_u32 s42, s42, s56
    s_lshr_b32 s56, s25, 1
    s_mul_i32 s43, s56, 1280
    s_add_u32 s43, s43, s57
    s_add_u32 s43, s43, 1024
    s_cmp_eq_u32 s27, 0
    s_cselect_b32 s62, s42, s43
    s_cselect_b32 s61, 3, 0
    s_add_u32 s62, s62, s29
    s_cmp_ge_u32 s39, 40
    s_cselect_b32 s62, 0x40000000, s62
    s_mov_b32 s35, 0x40000000
    s_mov_b32 s48, 0x30003
    s_mov_b32 s49, 0x30003
    s_mov_b32 s50, 0xc000c
    s_mov_b32 s51, 0xc000c
    s_mov_b32 s52, 0x300030
    s_mov_b32 s53, 0x300030
    s_mov_b32 s54, 0xc000c0
    s_mov_b32 s55, 0xc000c0
    s_mov_b32 s73, 0
    s_mov_b32 s46, 0
    s_mov_b32 s47, 2
    s_mul_i32 s56, s26, 163840
    s_add_u32 s56, s56, 1310720
    s_lshl_b32 s75, s27, 9
    s_add_u32 s75, s75, 10240
    s_lshl_b32 s57, s25, 7
    s_add_u32 s74, s56, s57
    s_lshl_b32 s57, s27, 15
    s_add_u32 s63, s74, s57
    s_lshl_b32 s57, s27, 13
    s_add_u32 s74, s74, s57
    s_add_u32 s74, s74, 131072
    s_lshl_b32 s57, s39, 12
    s_add_u32 s64, s56, s57
    s_lshl_b32 s65, s25, 12
    s_lshl_b32 s57, s27, 10
    s_add_u32 s65, s65, s57
    s_lshl_b32 s66, s65, 1
    s_mov_b32 s67, s65
    s_mov_b32 s76, 0x3e0293ee
    s_mov_b32 s68, s65
    s_lshl_b32 s56, s25, 13
    s_lshl_b32 s57, s27, 24
    s_add_u32 s56, s56, s57
    s_add_u32 s56, s56, 0x1440000
    s_add_u32 s57, s29, 0x8005000
    s_cmp_lt_u32 s27, 2
    s_cselect_b32 s44, s56, s57
    s_mov_b32 s45, 20480
    s_cselect_b32 s45, 262144, s45
    s_add_u32 s40, s4, 0x0
    s_addc_u32 s41, s5, 0
    s_and_b32 s41, s41, 0xffff
    s_mov_b32 s42, 0x8400000
    s_mov_b32 s43, 0x20000
    s_lshr_b32 s3, s25, 2
    s_lshl_b32 s3, s3, 6
    s_add_u32 s3, s3, 3211264
    s_cmp_eq_u32 s27, 3
    s_cselect_b32 s4, 1, 0
    s_mov_b32 s5, 0
    s_waitcnt lgkmcnt(0)
    ds_read_b128 v[16:19], v2 offset:0
    ds_read_b128 v[20:23], v2 offset:1024
    ds_read_b128 v[24:27], v2 offset:2048
    ds_read_b128 v[28:31], v2 offset:3072
    v_mov_b32 v32, 0
    v_mov_b32 v33, 0
    v_mov_b32 v34, 0
    v_mov_b32 v35, 0
    v_mov_b32 v36, 0
    v_mov_b32 v37, 0
    v_mov_b32 v38, 0
    v_mov_b32 v39, 0
    v_mov_b32 v40, 0
    v_mov_b32 v41, 0
    v_mov_b32 v42, 0
    v_mov_b32 v43, 0
    v_mov_b32 v44, 0
    v_mov_b32 v45, 0
    v_mov_b32 v46, 0
    v_mov_b32 v47, 0
    v_mov_b32 v48, 0
    v_mov_b32 v49, 0
    v_mov_b32 v50, 0
    v_mov_b32 v51, 0
    v_mov_b32 v52, 0
    v_mov_b32 v53, 0
    v_mov_b32 v54, 0
    v_mov_b32 v55, 0
    s_lshl_b32 s56, s27, 10
    s_add_u32 s36, s29, s56
    s_add_u32 s37, s38, s56
    s_add_u32 s56, s56, 12288
    v_add_u32 v7, s56, v0
    s_mov_b32 s30, s36
    s_mov_b32 s32, s37
    s_add_u32 s33, s38, 4096
    s_lshl_b32 s56, s27, 8
    s_add_u32 s71, s29, s56
    s_add_u32 s71, s71, 4096
    s_mov_b32 s31, s71
    s_add_u32 s29, s56, 8192
    v_mov_b32 v72, 0
    s_add_u32 s72, s38, 4096
    s_lshl_b32 s56, s28, 1
    s_add_u32 s56, s56, s26
    s_cmp_eq_u32 s56, 1
    s_cbranch_scc1 RV_15
    s_cmp_eq_u32 s56, 2
    s_cbranch_scc1 RV_16
    s_cmp_eq_u32 s56, 3
    s_cbranch_scc1 RV_17
RV_14:
RK_20:
    s_waitcnt vmcnt(0)
    v_lshlrev_b32 v60, 3, v0
    s_mov_b32 s56, 3149824
    buffer_load_dword v60, v60, s[8:11], s56 offen sc1
    s_add_u32 s73, s73, 1
    s_cmp_gt_u32 s73, 131072
    s_cbranch_scc1 RD_5
    s_waitcnt vmcnt(0)
    v_cmp_ne_u32 vcc, 32, v60
    s_nop 3
    s_ff1_i32_b64 s46, vcc
    s_cmp_gt_u32 s47, s46
    s_cbranch_scc1 RK_20
    s_lshl_b32 m0, s27, 10
    s_add_u32 s69, s65, 131072
    s_add_u32 s66, s65, s68
    buffer_load_dwordx4 v0, s[12:15], s65 offen sc1 lds
    s_add_u32 m0, m0, 4096
    buffer_load_dwordx4 v[8:11], v0, s[16:19], s66 offen sc1
    buffer_load_dwordx4 v0, s[12:15], s69 offen sc1 lds
    buffer_load_dwordx4 v[12:15], v0, s[16:19], s66 offen offset:1024 sc1
RL_18:
    s_cmp_gt_u32 s47, s46
    s_cbranch_scc1 RK_21
RK_22:
    s_barrier
    s_mov_b32 s25, s35
    s_and_b32 s56, s24, 1
    s_mul_i32 s56, s56, 327680
    s_add_u32 s57, s63, s56
    s_add_u32 s59, s74, s56
    s_add_u32 s60, s64, s56
    s_bfe_u32 s77, s24, 0x10001
    s_add_u32 s56, s24, 1
    s_mul_i32 s70, s56, 20480
    s_add_u32 s34, s62, s70
    s_add_u32 s35, s34, 5120
    s_add_u32 s65, s65, 262144
    s_lshl_b32 m0, s27, 10
    s_add_u32 s69, s65, 131072
    s_add_u32 s66, s65, s68
    s_nop 15
    buffer_load_dwordx4 v[56:59], v0, s[8:11], s30 offen sc1
    s_mov_b64 exec, 0xffff
    buffer_load_dwordx4 v[72:75], v0, s[8:11], s31 offen sc1
    s_mov_b64 exec, -1
    s_mov_b64 exec, 0xff
    buffer_store_dwordx4 v[92:95], v34, s[8:11], s25 offen sc1
    s_mov_b64 exec, -1
    v_mov_b32 v32, 0
    v_mov_b32 v33, 0
    v_mov_b32 v34, 0
    v_add_u32 v95, s29, v0
    s_waitcnt vmcnt(1) lgkmcnt(0)
RG_23:
    v_max_u32 v60, v56, v72
    v_cmp_eq_u32 vcc, -1, v60
    s_cbranch_vccnz RG_24
    ds_write_b128 v7, v[56:59]
    s_mov_b64 exec, 0xffff
    ds_write_b128 v95, v[72:75]
    s_mov_b64 exec, -1
    v_smfmac_f32_16x16x64_bf16 v[32:35], v[56:59], v[16:23], v1
    ds_read_b128 v[16:19], v2 offset:4096
    ds_read_b128 v[20:23], v2 offset:5120
    v_xor_b32 v60, 1024, v7
    v_xor_b32 v64, 2048, v7
    v_smfmac_f32_16x16x64_bf16 v[36:39], v[56:59], v[24:31], v1
    ds_read_b128 v[24:27], v2 offset:6144
    ds_read_b128 v[28:31], v2 offset:7168
    v_xor_b32 v68, 3072, v7
    s_waitcnt lgkmcnt(4)
    s_barrier
    ds_read_b128 v[72:75], v0 offset:8192
    ds_read_b128 v[60:63], v60
    ds_read_b128 v[64:67], v64
    ds_read_b128 v[68:71], v68
    v_smfmac_f32_16x16x64_bf16 v[40:43], v[56:59], v[96:103], v1
    buffer_load_dwordx4 v[76:79], v0, s[8:11], s32 offen sc1
    v_smfmac_f32_16x16x64_bf16 v[44:47], v[56:59], v[104:111], v1
    buffer_load_dwordx4 v[92:95], v0, s[8:11], s33 offen sc1
    v_smfmac_f32_16x16x64_bf16 v[48:51], v[56:59], v[112:119], v1
    v_smfmac_f32_16x16x64_bf16 v[52:55], v[56:59], v[120:127], v1
    s_waitcnt lgkmcnt(3)
    v_smfmac_f32_16x16x64_bf16 v[32:35], v[72:75], v[128:135], v1
    v_smfmac_f32_16x16x64_bf16 v[36:39], v[72:75], v[136:143], v1
    v_smfmac_f32_16x16x64_bf16 v[40:43], v[72:75], v[144:151], v1
    v_smfmac_f32_16x16x64_bf16 v[44:47], v[72:75], v[152:159], v1
    v_smfmac_f32_16x16x64_bf16 v[48:51], v[72:75], v[16:23], v1
    ds_read_b128 v[16:19], v2 offset:8192
    ds_read_b128 v[20:23], v2 offset:9216
    v_smfmac_f32_16x16x64_bf16 v[52:55], v[72:75], v[24:31], v1
    ds_read_b128 v[24:27], v2 offset:10240
    ds_read_b128 v[28:31], v2 offset:11264
    s_waitcnt lgkmcnt(6)
    v_smfmac_f32_16x16x64_bf16 v[32:35], v[60:63], v[160:167], v1
    v_smfmac_f32_16x16x64_bf16 v[36:39], v[60:63], v[168:175], v1
    v_smfmac_f32_16x16x64_bf16 v[40:43], v[60:63], v[176:183], v1
    v_smfmac_f32_16x16x64_bf16 v[44:47], v[60:63], v[184:191], v1
    s_waitcnt lgkmcnt(5)
    v_smfmac_f32_16x16x64_bf16 v[32:35], v[64:67], v[192:199], v1
    v_smfmac_f32_16x16x64_bf16 v[36:39], v[64:67], v[200:207], v1
    v_smfmac_f32_16x16x64_bf16 v[40:43], v[64:67], v[208:215], v1
    v_smfmac_f32_16x16x64_bf16 v[44:47], v[64:67], v[216:223], v1
    s_waitcnt lgkmcnt(4)
    s_waitcnt lgkmcnt(2)
    v_smfmac_f32_16x16x64_bf16 v[32:35], v[68:71], v[16:23], v1
    ds_read_b128 v[16:19], v2 offset:12288
    ds_read_b128 v[20:23], v2 offset:13312
    s_waitcnt lgkmcnt(2)
    v_smfmac_f32_16x16x64_bf16 v[36:39], v[68:71], v[24:31], v1
    ds_read_b128 v[24:27], v2 offset:14336
    ds_read_b128 v[28:31], v2 offset:15360
    s_barrier
    v_smfmac_f32_16x16x64_bf16 v[40:43], v[68:71], v[224:231], v1
    v_smfmac_f32_16x16x64_bf16 v[44:47], v[68:71], v[232:239], v1
    v_smfmac_f32_16x16x64_bf16 v[48:51], v[60:63], v[240:247], v1
    v_smfmac_f32_16x16x64_bf16 v[52:55], v[60:63], v[248:255], v1
    ds_read_b128 v[56:59], v2 offset:16384
    ds_read_b128 v[60:63], v2 offset:17408
    v_smfmac_f32_16x16x64_bf16 v[48:51], v[64:67], a[0:7], v1
    v_smfmac_f32_16x16x64_bf16 v[52:55], v[64:67], a[8:15], v1
    v_smfmac_f32_16x16x64_bf16 v[48:51], v[68:71], a[16:23], v1
    v_smfmac_f32_16x16x64_bf16 v[52:55], v[68:71], a[24:31], v1
    ds_read_b128 v[64:67], v2 offset:18432
    ds_read_b128 v[68:71], v2 offset:19456
    s_waitcnt vmcnt(0)
RG_25:
    v_max_u32 v72, v76, v92
    v_cmp_eq_u32 vcc, -1, v72
    s_cbranch_vccnz RG_26
    ds_write_b128 v7, v[76:79]
    s_waitcnt lgkmcnt(7)
    v_smfmac_f32_16x16x64_bf16 v[32:35], v[76:79], v[16:23], v1
    ds_read_b128 v[16:19], v2 offset:20480
    ds_read_b128 v[20:23], v2 offset:21504
    v_xor_b32 v80, 1024, v7
    v_xor_b32 v84, 2048, v7
    s_waitcnt lgkmcnt(7)
    v_smfmac_f32_16x16x64_bf16 v[36:39], v[76:79], v[24:31], v1
    ds_read_b128 v[24:27], v2 offset:22528
    ds_read_b128 v[28:31], v2 offset:23552
    v_xor_b32 v88, 3072, v7
    s_waitcnt lgkmcnt(4)
    s_barrier
    ds_read_b128 v[80:83], v80
    ds_read_b128 v[84:87], v84
    ds_read_b128 v[88:91], v88
    v_smfmac_f32_16x16x64_bf16 v[40:43], v[76:79], a[32:39], v1
    v_smfmac_f32_16x16x64_bf16 v[44:47], v[76:79], v[56:63], v1
    ds_read_b128 v[56:59], v2 offset:24576
    ds_read_b128 v[60:63], v2 offset:25600
    v_smfmac_f32_16x16x64_bf16 v[32:35], v[92:95], a[40:47], v1
    v_smfmac_f32_16x16x64_bf16 v[36:39], v[92:95], a[48:55], v1
    v_smfmac_f32_16x16x64_bf16 v[40:43], v[92:95], a[56:63], v1
    v_smfmac_f32_16x16x64_bf16 v[44:47], v[92:95], v[64:71], v1
    v_smfmac_f32_16x16x64_bf16 v[48:51], v[92:95], a[64:71], v1
    ds_read_b128 v[64:67], v0 offset:6144
    ds_read_b128 v[68:71], v0 offset:7168
    v_smfmac_f32_16x16x64_bf16 v[52:55], v[92:95], a[72:79], v1
    s_waitcnt lgkmcnt(6)
    v_smfmac_f32_16x16x64_bf16 v[32:35], v[80:83], v[16:23], v1
    v_lshlrev_b32 v94, 3, v0
    buffer_load_dword v94, v94, s[40:43], s44 offen sc1
    v_smfmac_f32_16x16x64_bf16 v[36:39], v[80:83], v[24:31], v1
    ds_read_b128 v[16:19], v0 offset:0
    ds_read_b128 v[20:23], v0 offset:1024
    ds_read_b128 v[24:27], v0 offset:2048
    ds_read_b128 v[28:31], v0 offset:3072
    s_waitcnt lgkmcnt(9)
    v_smfmac_f32_16x16x64_bf16 v[32:35], v[84:87], a[80:87], v1
    s_waitcnt lgkmcnt(6)
    v_smfmac_f32_16x16x64_bf16 v[36:39], v[84:87], v[56:63], v1
    v_smfmac_f32_16x16x64_bf16 v[32:35], v[88:91], a[88:95], v1
    ds_read_b128 v[56:59], v0 offset:4096
    ds_read_b128 v[60:63], v0 offset:5120
    v_smfmac_f32_16x16x64_bf16 v[36:39], v[88:91], a[96:103], v1
    v_smfmac_f32_16x16x64_bf16 v[40:43], v[80:83], a[104:111], v1
    s_mov_b64 exec, s[4:5]
    buffer_atomic_add v1, off, s[8:11], s3 sc1
    s_mov_b64 exec, -1
    v_smfmac_f32_16x16x64_bf16 v[44:47], v[80:83], a[112:119], v1
    v_smfmac_f32_16x16x64_bf16 v[40:43], v[84:87], a[120:127], v1
    v_permlane32_swap_b32 v32, v33
    v_permlane32_swap_b32 v34, v35
    v_smfmac_f32_16x16x64_bf16 v[44:47], v[84:87], a[128:135], v1
    v_permlane32_swap_b32 v36, v37
    v_permlane32_swap_b32 v38, v39
    v_smfmac_f32_16x16x64_bf16 v[40:43], v[88:91], a[136:143], v1
    v_add_f32 v32, v32, v33
    v_add_f32 v34, v34, v35
    v_smfmac_f32_16x16x64_bf16 v[44:47], v[88:91], a[144:151], v1
    v_add_f32 v36, v36, v37
    v_add_f32 v38, v38, v39
    v_smfmac_f32_16x16x64_bf16 v[48:51], v[76:79], a[152:159], v1
    v_cvt_pk_bf16_f32 v72, v32, v36
    v_cvt_pk_bf16_f32 v74, v34, v38
    v_smfmac_f32_16x16x64_bf16 v[52:55], v[76:79], a[160:167], v1
    v_smfmac_f32_16x16x64_bf16 v[48:51], v[80:83], a[168:175], v1
    v_permlane32_swap_b32 v40, v41
    v_permlane32_swap_b32 v42, v43
    v_permlane32_swap_b32 v44, v45
    v_permlane32_swap_b32 v46, v47
    v_smfmac_f32_16x16x64_bf16 v[52:55], v[80:83], a[176:183], v1
    v_add_f32 v40, v40, v41
    v_add_f32 v42, v42, v43
    v_add_f32 v44, v44, v45
    v_add_f32 v46, v46, v47
    v_smfmac_f32_16x16x64_bf16 v[48:51], v[84:87], a[184:191], v1
    v_cvt_pk_bf16_f32 v73, v40, v44
    v_cvt_pk_bf16_f32 v75, v42, v46
    ds_write_b64 v3, v[72:73]
    ds_write_b64 v3, v[74:75] offset:32
    v_smfmac_f32_16x16x64_bf16 v[52:55], v[84:87], a[192:199], v1
    s_waitcnt lgkmcnt(0)
    s_barrier
    ds_read_b128 v[32:35], v4 offset:8192
    ds_read_b128 v[36:39], v4 offset:8704
    ds_read_b128 v[40:43], v4 offset:9216
    ds_read_b128 v[44:47], v4 offset:9728
    v_smfmac_f32_16x16x64_bf16 v[48:51], v[88:91], a[200:207], v1
    ds_read_b128 v[76:79], v4 offset:10240
    ds_read_b128 v[80:83], v4 offset:10752
    ds_read_b128 v[84:87], v4 offset:11264
    v_smfmac_f32_16x16x64_bf16 v[52:55], v[88:91], a[208:215], v1
    ds_read_b128 v[88:91], v4 offset:11776
    s_cmp_eq_u32 s24, 63
    s_cbranch_scc1 RF_19
    s_waitcnt lgkmcnt(7)
    v_mfma_f32_16x16x32_bf16 v[16:19], v[16:19], v[32:35], 0
    v_mfma_f32_16x16x32_bf16 v[56:59], v[56:59], v[32:35], 0
    s_waitcnt lgkmcnt(6)
    v_mfma_f32_16x16x32_bf16 v[16:19], v[20:23], v[36:39], v[16:19]
    v_mfma_f32_16x16x32_bf16 v[56:59], v[60:63], v[36:39], v[56:59]
    buffer_load_dwordx4 v0, s[12:15], s65 offen sc1 lds
    s_add_u32 m0, m0, 4096
    s_waitcnt lgkmcnt(5)
    v_mfma_f32_16x16x32_bf16 v[16:19], v[24:27], v[40:43], v[16:19]
    v_mfma_f32_16x16x32_bf16 v[56:59], v[64:67], v[40:43], v[56:59]
    v_cvt_pk_bf16_f32 v72, v48, v49
    v_cvt_pk_bf16_f32 v73, v50, v51
    s_waitcnt lgkmcnt(4)
    v_mfma_f32_16x16x32_bf16 v[16:19], v[28:31], v[44:47], v[16:19]
    v_mfma_f32_16x16x32_bf16 v[56:59], v[68:71], v[44:47], v[56:59]
    v_cvt_pk_bf16_f32 v74, v52, v53
    v_cvt_pk_bf16_f32 v75, v54, v55
    s_waitcnt lgkmcnt(0)
    v_mfma_f32_16x16x32_bf16 v[76:79], v[76:79], v[32:35], 0
    v_mov_b32 v26, 0x3f003f00
    v_mov_b32 v27, 0x3f003f00
    v_add_u32 v48, s75, v4
    ds_read_b128 v[48:51], v48
    v_mfma_f32_16x16x32_bf16 v[76:79], v[80:83], v[36:39], v[76:79]
    v_mov_b32 v28, 0x3f803f80
    v_mov_b32 v29, 0x3f803f80
    v_mfma_f32_16x16x32_bf16 v[76:79], v[84:87], v[40:43], v[76:79]
    v_max3_f32 v92, v16, v17, v18
    v_max3_f32 v93, v56, v57, v58
    v_mfma_f32_16x16x32_bf16 v[76:79], v[88:91], v[44:47], v[76:79]
    v_max3_f32 v92, v92, v19, v59
    v_mov_b32 v30, 0x3f803f80
    v_mov_b32 v31, 0x3f803f80
    ds_read_b128 v[64:67], v2 offset:28672
    ds_read_b128 v[68:71], v2 offset:29696
    ds_read_b128 v[84:87], v2 offset:26624
    ds_read_b128 v[88:91], v2 offset:27648
    s_nop 0
    v_max3_f32 v93, v93, v76, v77
    v_max3_f32 v92, v92, v78, v79
    v_max_f32 v92, v92, v93
    v_mov_b32 v93, v92
    s_waitcnt lgkmcnt(4)
    buffer_store_dwordx4 v[48:51], v0, s[20:23], s67 offen sc1
    v_permlane32_swap_b32 v92, v93
    v_max_f32 v92, v92, v93
    v_mov_b32 v93, v92
    s_nop 1
    v_permlane16_swap_b32 v92, v93
    v_max_f32 v92, v92, v93
    v_mul_f32 v92, s76, v92
    v_fma_f32 v16, v16, s76, -v92
    v_fma_f32 v17, v17, s76, -v92
    v_fma_f32 v18, v18, s76, -v92
    v_fma_f32 v19, v19, s76, -v92
    v_exp_f32 v16, v16
    v_exp_f32 v17, v17
    v_exp_f32 v18, v18
    v_exp_f32 v19, v19
    v_cvt_pk_bf16_f32 v20, v16, v17
    v_cvt_pk_bf16_f32 v21, v18, v19
    v_fma_f32 v56, v56, s76, -v92
    v_fma_f32 v57, v57, s76, -v92
    v_fma_f32 v58, v58, s76, -v92
    v_fma_f32 v59, v59, s76, -v92
    v_exp_f32 v56, v56
    v_exp_f32 v57, v57
    v_exp_f32 v58, v58
    v_exp_f32 v59, v59
    v_cvt_pk_bf16_f32 v22, v56, v57
    v_cvt_pk_bf16_f32 v23, v58, v59
    v_fma_f32 v76, v76, s76, -v92
    v_fma_f32 v77, v77, s76, -v92
    v_fma_f32 v78, v78, s76, -v92
    v_fma_f32 v79, v79, s76, -v92
    v_mfma_f32_16x16x32_bf16 v[60:63], v[28:31], v[20:23], 0
    v_exp_f32 v76, v76
    v_mfma_f32_16x16x32_bf16 v[48:51], v[8:11], v[20:23], 0
    v_exp_f32 v77, v77
    v_mfma_f32_16x16x32_bf16 v[52:55], v[12:15], v[20:23], 0
    v_exp_f32 v78, v78
    v_exp_f32 v79, v79
    v_cvt_pk_bf16_f32 v24, v76, v77
    v_cvt_pk_bf16_f32 v25, v78, v79
    s_nop 1
    v_mfma_f32_16x16x16_bf16 v[60:63], v[26:27], v[24:25], v[60:63]
    buffer_load_dwordx4 v0, s[12:15], s69 offen sc1 lds
    v_mfma_f32_16x16x16_bf16 v[48:51], v[72:73], v[24:25], v[48:51]
    v_mfma_f32_16x16x16_bf16 v[52:55], v[74:75], v[24:25], v[52:55]
    v_mov_b32 v32, 0
    v_mov_b32 v33, 0
    v_mov_b32 v34, 0
    v_mov_b32 v35, 0
    v_mov_b32 v36, 0
    v_mov_b32 v37, 0
    v_rcp_f32 v92, v60
    v_mov_b32 v38, 0
    v_mul_f32 v48, v48, v92
    v_mul_f32 v49, v49, v92
    v_mul_f32 v50, v50, v92
    v_mul_f32 v51, v51, v92
    v_mul_f32 v52, v52, v92
    v_cvt_pk_bf16_f32 v76, v48, v52
    v_mul_f32 v53, v53, v92
    v_cvt_pk_bf16_f32 v77, v49, v53
    v_mul_f32 v54, v54, v92
    v_cvt_pk_bf16_f32 v78, v50, v54
    v_mul_f32 v55, v55, v92
    v_cvt_pk_bf16_f32 v79, v51, v55
    ds_write_b128 v5, v[76:79]
    v_mov_b32 v80, 0
    v_mov_b32 v81, 0
    v_mov_b32 v82, 0
    v_mov_b32 v83, 0
    v_mov_b32 v39, 0
    v_mov_b32 v40, 0
    v_mov_b32 v41, 0
    v_mov_b32 v42, 0
    v_mov_b32 v43, 0
    v_mov_b32 v44, 0
    v_mov_b32 v45, 0
    v_mov_b32 v46, 0
    v_mov_b32 v47, 0
    s_waitcnt lgkmcnt(0)
    s_barrier
    ds_read_b128 v[48:51], v0 offset:12288
    ds_read_b128 v[52:55], v0 offset:13312
    ds_read_b128 v[16:19], v2 offset:30720
    ds_read_b128 v[20:23], v2 offset:31744
    ds_read_b128 v[24:27], v2 offset:32768
    ds_read_b128 v[28:31], v2 offset:33792
    ds_read_b128 v[56:59], v2 offset:34816
    ds_read_b128 v[60:63], v2 offset:35840
    buffer_load_dwordx4 v[8:11], v0, s[16:19], s66 offen sc1
    s_waitcnt lgkmcnt(7)
    v_smfmac_f32_16x16x64_bf16 v[80:83], v[48:51], a[216:223], v1
    s_waitcnt lgkmcnt(6)
    v_smfmac_f32_16x16x64_bf16 v[80:83], v[52:55], a[224:231], v1
    v_smfmac_f32_16x16x64_bf16 v[32:35], v[48:51], a[232:239], v1
    buffer_load_dwordx4 v[12:15], v0, s[16:19], s66 offen offset:1024 sc1
    v_smfmac_f32_16x16x64_bf16 v[36:39], v[48:51], a[240:247], v1
    v_permlane32_swap_b32 v80, v82
    v_permlane32_swap_b32 v81, v83
    v_smfmac_f32_16x16x64_bf16 v[32:35], v[52:55], a[248:255], v1
    v_pk_add_f32 v[80:81], v[80:81], v[82:83]
    v_cvt_pk_bf16_f32 v82, v80, v81
    v_smfmac_f32_16x16x64_bf16 v[36:39], v[52:55], v[84:91], v1
    v_cvt_pk_bf16_f32 v81, v80, v81
    s_nop 1
    v_smfmac_f32_16x16x64_bf16 v[40:43], v[48:51], v[64:71], v1
    v_permlane32_swap_b32 v82, v81
    v_mov_b32 v80, v82
    s_waitcnt lgkmcnt(4)
    v_smfmac_f32_16x16x64_bf16 v[44:47], v[48:51], v[16:23], v1
    v_mov_b32 v83, v81
    s_nop 1
    s_waitcnt lgkmcnt(2)
    v_smfmac_f32_16x16x64_bf16 v[40:43], v[52:55], v[24:31], v1
    v_permlane16_swap_b32 v80, v82
    v_permlane16_swap_b32 v81, v83
    s_waitcnt lgkmcnt(0)
    v_smfmac_f32_16x16x64_bf16 v[44:47], v[52:55], v[56:63], v1
    v_and_or_b32 v80, v80, -2, s77
    v_permlane32_swap_b32 v32, v36
    v_permlane32_swap_b32 v33, v37
    v_permlane32_swap_b32 v34, v38
    v_permlane32_swap_b32 v35, v39
    v_pk_add_f32 v[32:33], v[32:33], v[36:37]
    v_pk_add_f32 v[34:35], v[34:35], v[38:39]
    v_cvt_pk_bf16_f32 v32, v32, v33
    v_cvt_pk_bf16_f32 v33, v34, v35
    v_permlane32_swap_b32 v40, v44
    v_permlane32_swap_b32 v41, v45
    v_permlane32_swap_b32 v42, v46
    v_permlane32_swap_b32 v43, v47
    v_pk_add_f32 v[40:41], v[40:41], v[44:45]
    v_pk_add_f32 v[42:43], v[42:43], v[46:47]
    v_and_or_b32 v32, v32, -2, s77
    v_cvt_pk_bf16_f32 v34, v40, v41
    v_cvt_pk_bf16_f32 v35, v42, v43
    buffer_store_dwordx4 v[32:35], v6, s[8:11], s57 offen
    s_mov_b64 exec, 0xffff
    buffer_store_dwordx4 v[80:83], v6, s[8:11], s59 offen
    s_mov_b64 exec, -1
    s_cmp_ge_u32 s39, 40
    s_cbranch_scc1 RN_27
    ds_read_b128 v[16:19], v2 offset:0
    ds_read_b128 v[20:23], v2 offset:1024
    ds_read_b128 v[24:27], v2 offset:2048
    ds_read_b128 v[28:31], v2 offset:3072
    buffer_load_dwordx4 v[56:59], v0, s[8:11], s60 offen offset:0 sc1
    buffer_load_dwordx4 v[60:63], v0, s[8:11], s60 offen offset:1024 sc1
    buffer_load_dwordx4 v[64:67], v0, s[8:11], s60 offen offset:2048 sc1
    buffer_load_dwordx4 v[68:71], v0, s[8:11], s60 offen offset:3072 sc1
    v_mov_b32 v32, 0
    v_mov_b32 v33, 0
    v_mov_b32 v34, 0
    v_mov_b32 v35, 0
    v_mov_b32 v36, 0
    v_mov_b32 v37, 0
    v_mov_b32 v38, 0
    v_mov_b32 v39, 0
    v_mov_b32 v40, 0
    v_mov_b32 v41, 0
    v_mov_b32 v42, 0
    v_mov_b32 v43, 0
    v_mov_b32 v44, 0
    v_mov_b32 v45, 0
    v_mov_b32 v46, 0
    v_mov_b32 v47, 0
    v_mov_b32 v48, 0
    v_mov_b32 v49, 0
    v_mov_b32 v50, 0
    v_mov_b32 v51, 0
    v_mov_b32 v52, 0
    v_mov_b32 v53, 0
    v_mov_b32 v54, 0
    v_mov_b32 v55, 0
    s_add_u32 s30, s36, s70
    s_add_u32 s31, s71, s70
    s_add_u32 s32, s37, s70
    s_add_u32 s33, s72, s70
    s_add_u32 s24, s24, 1
    s_add_u32 s67, s67, 131072
    s_add_u32 s44, s44, s45
    s_add_u32 s47, s47, 1
    s_add_u32 s3, s3, 512
    s_mov_b32 s73, 0
    v_mov_b32 v32, 0x3f80
    v_lshlrev_b32 v32, v0, v32
    v_cndmask_b32 v72, 0, v32, s[48:49]
    v_cndmask_b32 v73, 0, v32, s[50:51]
    v_cndmask_b32 v74, 0, v32, s[52:53]
    v_cndmask_b32 v75, 0, v32, s[54:55]
    v_and_b32 v33, 0x40, v0
    v_and_b32 v34, 0x30, v0
    v_lshl_add_u32 v34, v33, s61, v34
RP_28:
    buffer_load_dwordx4 v[76:79], v0, s[8:11], s60 offen offset:0 sc1
    buffer_load_dwordx4 v[80:83], v0, s[8:11], s60 offen offset:1024 sc1
    buffer_load_dwordx4 v[84:87], v0, s[8:11], s60 offen offset:2048 sc1
    buffer_load_dwordx4 v[88:91], v0, s[8:11], s60 offen offset:3072 sc1
    s_waitcnt vmcnt(4)
    v_mfma_f32_16x16x32_bf16 v[92:95], v[56:59], v[72:75], 0
    v_bitop3_b32 v32, v56, v60, s77 bitop3:0x7e
    v_bitop3_b32 v33, v64, v68, s77 bitop3:0x7e
    v_mfma_f32_16x16x32_bf16 v[92:95], v[60:63], v[72:75], v[92:95]
    v_bitop3_b32 v32, v32, 1, v33 bitop3:0xc8
    v_cmp_ne_u32 vcc, 0, v32
    v_mfma_f32_16x16x32_bf16 v[92:95], v[64:67], v[72:75], v[92:95]
    v_mfma_f32_16x16x32_bf16 v[92:95], v[68:71], v[72:75], v[92:95]
    s_cbranch_vccz RP_29
    buffer_load_dwordx4 v[56:59], v0, s[8:11], s60 offen offset:0 sc1
    buffer_load_dwordx4 v[60:63], v0, s[8:11], s60 offen offset:1024 sc1
    buffer_load_dwordx4 v[64:67], v0, s[8:11], s60 offen offset:2048 sc1
    buffer_load_dwordx4 v[68:71], v0, s[8:11], s60 offen offset:3072 sc1
    s_add_u32 s73, s73, 1
    s_cmp_gt_u32 s73, 131072
    s_cbranch_scc1 RD_5
    s_waitcnt vmcnt(4)
    v_mfma_f32_16x16x32_bf16 v[92:95], v[76:79], v[72:75], 0
    v_bitop3_b32 v32, v76, v80, s77 bitop3:0x7e
    v_bitop3_b32 v33, v84, v88, s77 bitop3:0x7e
    v_mfma_f32_16x16x32_bf16 v[92:95], v[80:83], v[72:75], v[92:95]
    v_bitop3_b32 v32, v32, 1, v33 bitop3:0xc8
    v_cmp_ne_u32 vcc, 0, v32
    v_mfma_f32_16x16x32_bf16 v[92:95], v[84:87], v[72:75], v[92:95]
    v_mfma_f32_16x16x32_bf16 v[92:95], v[88:91], v[72:75], v[92:95]
    s_cbranch_vccnz RP_28
RP_29:
    s_nop 6
    v_permlane32_swap_b32 v92, v94
    v_permlane32_swap_b32 v93, v95
    v_pk_add_f32 v[92:93], v[92:93], v[94:95]
    v_cvt_pk_bf16_f32 v94, v92, v93
    v_cvt_pk_bf16_f32 v93, v92, v93
    s_nop 1
    v_permlane32_swap_b32 v94, v93
    v_mov_b32 v92, v94
    v_mov_b32 v95, v93
    s_nop 1
    v_permlane16_swap_b32 v92, v94
    v_permlane16_swap_b32 v93, v95
    s_mov_b64 exec, 0xff
    buffer_store_dwordx4 v[92:95], v34, s[8:11], s34 offen
    s_mov_b64 exec, -1
    s_branch RL_18
RG_26:
    buffer_load_dwordx4 v[76:79], v0, s[8:11], s32 offen sc1
    buffer_load_dwordx4 v[92:95], v0, s[8:11], s33 offen sc1
    s_add_u32 s73, s73, 1
    s_cmp_gt_u32 s73, 131072
    s_cbranch_scc1 RD_5
    s_waitcnt vmcnt(0)
    s_branch RG_25
RK_21:
    s_waitcnt vmcnt(0)
    v_lshlrev_b32 v60, 3, v0
    s_mov_b32 s56, 3149824
    buffer_load_dword v60, v60, s[8:11], s56 offen sc1
    s_add_u32 s73, s73, 1
    s_cmp_gt_u32 s73, 131072
    s_cbranch_scc1 RD_5
    s_waitcnt vmcnt(0)
    v_cmp_ne_u32 vcc, 32, v60
    s_nop 3
    s_ff1_i32_b64 s46, vcc
    s_cmp_gt_u32 s47, s46
    s_cbranch_scc1 RK_21
    s_branch RK_22
RG_24:
    buffer_load_dwordx4 v[56:59], v0, s[8:11], s30 offen sc1
    s_mov_b64 exec, 0xffff
    buffer_load_dwordx4 v[72:75], v0, s[8:11], s31 offen sc1
    s_mov_b64 exec, -1
    s_add_u32 s73, s73, 1
    s_cmp_gt_u32 s73, 131072
    s_cbranch_scc1 RD_5
    s_waitcnt vmcnt(0)
    s_branch RG_23
RN_27:
    ds_read_b128 v[16:19], v2 offset:0
    ds_read_b128 v[20:23], v2 offset:1024
    ds_read_b128 v[24:27], v2 offset:2048
    ds_read_b128 v[28:31], v2 offset:3072
    v_mov_b32 v32, 0
    v_mov_b32 v33, 0
    v_mov_b32 v34, 0
    v_mov_b32 v35, 0
    v_mov_b32 v36, 0
    v_mov_b32 v37, 0
    v_mov_b32 v38, 0
    v_mov_b32 v39, 0
    v_mov_b32 v40, 0
    v_mov_b32 v41, 0
    v_mov_b32 v42, 0
    v_mov_b32 v43, 0
    v_mov_b32 v44, 0
    v_mov_b32 v45, 0
    v_mov_b32 v46, 0
    v_mov_b32 v47, 0
    v_mov_b32 v48, 0
    v_mov_b32 v49, 0
    v_mov_b32 v50, 0
    v_mov_b32 v51, 0
    v_mov_b32 v52, 0
    v_mov_b32 v53, 0
    v_mov_b32 v54, 0
    v_mov_b32 v55, 0
    s_add_u32 s30, s36, s70
    s_add_u32 s31, s71, s70
    s_add_u32 s32, s37, s70
    s_add_u32 s33, s72, s70
    s_add_u32 s24, s24, 1
    s_add_u32 s67, s67, 131072
    s_add_u32 s44, s44, s45
    s_add_u32 s47, s47, 1
    s_add_u32 s3, s3, 512
    s_mov_b32 s73, 0
    s_branch RL_18
RF_19:
    v_add_u32 v72, s75, v4
    ds_read_b128 v[72:75], v72
    s_waitcnt lgkmcnt(0)
    buffer_store_dwordx4 v[72:75], v0, s[20:23], s67 offen sc1
    s_waitcnt vmcnt(0) lgkmcnt(0)
    s_barrier
    s_add_u32 s3, s3, 512
    s_mov_b64 exec, s[4:5]
    buffer_atomic_add v1, off, s[8:11], s3 sc1
    s_mov_b64 exec, -1
    s_branch RD_5
RV_15:
RK_32:
    s_waitcnt vmcnt(0)
    v_lshlrev_b32 v60, 3, v0
    s_mov_b32 s56, 3149824
    buffer_load_dword v60, v60, s[8:11], s56 offen sc1
    s_add_u32 s73, s73, 1
    s_cmp_gt_u32 s73, 131072
    s_cbranch_scc1 RD_5
    s_waitcnt vmcnt(0)
    v_cmp_ne_u32 vcc, 32, v60
    s_nop 3
    s_ff1_i32_b64 s46, vcc
    s_cmp_gt_u32 s47, s46
    s_cbranch_scc1 RK_32
    s_lshl_b32 m0, s27, 10
    s_add_u32 s69, s65, 131072
    s_add_u32 s66, s65, s68
    buffer_load_dwordx4 v0, s[12:15], s65 offen sc1 lds
    s_add_u32 m0, m0, 4096
    buffer_load_dwordx4 v[8:11], v0, s[16:19], s66 offen sc1
    buffer_load_dwordx4 v0, s[12:15], s69 offen sc1 lds
    buffer_load_dwordx4 v[12:15], v0, s[16:19], s66 offen offset:1024 sc1
RL_30:
    s_cmp_gt_u32 s47, s46
    s_cbranch_scc1 RK_33
RK_34:
    s_barrier
    s_mov_b32 s25, s35
    s_and_b32 s56, s24, 1
    s_mul_i32 s56, s56, 327680
    s_add_u32 s57, s63, s56
    s_add_u32 s59, s74, s56
    s_add_u32 s60, s64, s56
    s_bfe_u32 s77, s24, 0x10001
    s_add_u32 s56, s24, 1
    s_mul_i32 s70, s56, 20480
    s_add_u32 s34, s62, s70
    s_add_u32 s35, s34, 5120
    s_add_u32 s65, s65, 262144
    s_lshl_b32 m0, s27, 10
    s_add_u32 s69, s65, 131072
    s_add_u32 s66, s65, s68
    s_nop 15
    buffer_load_dwordx4 v[56:59], v0, s[8:11], s30 offen sc1
    s_mov_b64 exec, 0xffff
    buffer_load_dwordx4 v[72:75], v0, s[8:11], s31 offen sc1
    s_mov_b64 exec, -1
    s_mov_b64 exec, 0xff
    buffer_store_dwordx4 v[92:95], v34, s[8:11], s25 offen sc1
    s_mov_b64 exec, -1
    v_mov_b32 v32, 0
    v_mov_b32 v33, 0
    v_mov_b32 v34, 0
    v_add_u32 v95, s29, v0
    s_waitcnt vmcnt(1) lgkmcnt(0)
RG_35:
    v_max_u32 v60, v56, v72
    v_cmp_eq_u32 vcc, -1, v60
    s_cbranch_vccnz RG_36
    ds_write_b128 v7, v[56:59]
    s_mov_b64 exec, 0xffff
    ds_write_b128 v95, v[72:75]
    s_mov_b64 exec, -1
    v_smfmac_f32_16x16x64_bf16 v[32:35], v[56:59], v[16:23], v1
    ds_read_b128 v[16:19], v2 offset:4096
    ds_read_b128 v[20:23], v2 offset:5120
    v_xor_b32 v60, 1024, v7
    v_xor_b32 v64, 2048, v7
    v_smfmac_f32_16x16x64_bf16 v[36:39], v[56:59], v[24:31], v1
    ds_read_b128 v[24:27], v2 offset:6144
    ds_read_b128 v[28:31], v2 offset:7168
    v_xor_b32 v68, 3072, v7
    s_waitcnt lgkmcnt(4)
    s_barrier
    ds_read_b128 v[72:75], v0 offset:8192
    ds_read_b128 v[60:63], v60
    ds_read_b128 v[64:67], v64
    ds_read_b128 v[68:71], v68
    v_smfmac_f32_16x16x64_bf16 v[40:43], v[56:59], v[96:103], v1
    buffer_load_dwordx4 v[76:79], v0, s[8:11], s32 offen sc1
    v_smfmac_f32_16x16x64_bf16 v[44:47], v[56:59], v[104:111], v1
    buffer_load_dwordx4 v[92:95], v0, s[8:11], s33 offen sc1
    v_smfmac_f32_16x16x64_bf16 v[48:51], v[56:59], v[112:119], v1
    v_smfmac_f32_16x16x64_bf16 v[52:55], v[56:59], v[120:127], v1
    s_waitcnt lgkmcnt(3)
    v_smfmac_f32_16x16x64_bf16 v[32:35], v[72:75], v[128:135], v1
    v_smfmac_f32_16x16x64_bf16 v[36:39], v[72:75], v[136:143], v1
    v_smfmac_f32_16x16x64_bf16 v[40:43], v[72:75], v[144:151], v1
    v_smfmac_f32_16x16x64_bf16 v[44:47], v[72:75], v[152:159], v1
    v_smfmac_f32_16x16x64_bf16 v[48:51], v[72:75], v[16:23], v1
    ds_read_b128 v[16:19], v2 offset:8192
    ds_read_b128 v[20:23], v2 offset:9216
    v_smfmac_f32_16x16x64_bf16 v[52:55], v[72:75], v[24:31], v1
    ds_read_b128 v[24:27], v2 offset:10240
    ds_read_b128 v[28:31], v2 offset:11264
    s_waitcnt lgkmcnt(6)
    v_smfmac_f32_16x16x64_bf16 v[32:35], v[60:63], v[160:167], v1
    v_smfmac_f32_16x16x64_bf16 v[36:39], v[60:63], v[168:175], v1
    v_smfmac_f32_16x16x64_bf16 v[40:43], v[60:63], v[176:183], v1
    v_smfmac_f32_16x16x64_bf16 v[44:47], v[60:63], v[184:191], v1
    s_waitcnt lgkmcnt(5)
    v_smfmac_f32_16x16x64_bf16 v[32:35], v[64:67], v[192:199], v1
    v_smfmac_f32_16x16x64_bf16 v[36:39], v[64:67], v[200:207], v1
    v_smfmac_f32_16x16x64_bf16 v[40:43], v[64:67], v[208:215], v1
    v_smfmac_f32_16x16x64_bf16 v[44:47], v[64:67], v[216:223], v1
    s_waitcnt lgkmcnt(4)
    s_waitcnt lgkmcnt(2)
    v_smfmac_f32_16x16x64_bf16 v[32:35], v[68:71], v[16:23], v1
    ds_read_b128 v[16:19], v2 offset:12288
    ds_read_b128 v[20:23], v2 offset:13312
    s_waitcnt lgkmcnt(2)
    v_smfmac_f32_16x16x64_bf16 v[36:39], v[68:71], v[24:31], v1
    ds_read_b128 v[24:27], v2 offset:14336
    ds_read_b128 v[28:31], v2 offset:15360
    s_barrier
    v_smfmac_f32_16x16x64_bf16 v[40:43], v[68:71], v[224:231], v1
    v_smfmac_f32_16x16x64_bf16 v[44:47], v[68:71], v[232:239], v1
    v_smfmac_f32_16x16x64_bf16 v[48:51], v[60:63], v[240:247], v1
    v_smfmac_f32_16x16x64_bf16 v[52:55], v[60:63], v[248:255], v1
    ds_read_b128 v[56:59], v2 offset:16384
    ds_read_b128 v[60:63], v2 offset:17408
    v_smfmac_f32_16x16x64_bf16 v[48:51], v[64:67], a[0:7], v1
    v_smfmac_f32_16x16x64_bf16 v[52:55], v[64:67], a[8:15], v1
    v_smfmac_f32_16x16x64_bf16 v[48:51], v[68:71], a[16:23], v1
    v_smfmac_f32_16x16x64_bf16 v[52:55], v[68:71], a[24:31], v1
    ds_read_b128 v[64:67], v2 offset:18432
    ds_read_b128 v[68:71], v2 offset:19456
    s_waitcnt vmcnt(0)
RG_37:
    v_max_u32 v72, v76, v92
    v_cmp_eq_u32 vcc, -1, v72
    s_cbranch_vccnz RG_38
    ds_write_b128 v7, v[76:79]
    s_waitcnt lgkmcnt(7)
    v_smfmac_f32_16x16x64_bf16 v[32:35], v[76:79], v[16:23], v1
    ds_read_b128 v[16:19], v2 offset:20480
    ds_read_b128 v[20:23], v2 offset:21504
    v_xor_b32 v80, 1024, v7
    v_xor_b32 v84, 2048, v7
    s_waitcnt lgkmcnt(7)
    v_smfmac_f32_16x16x64_bf16 v[36:39], v[76:79], v[24:31], v1
    ds_read_b128 v[24:27], v2 offset:22528
    ds_read_b128 v[28:31], v2 offset:23552
    v_xor_b32 v88, 3072, v7
    s_waitcnt lgkmcnt(4)
    s_barrier
    ds_read_b128 v[80:83], v80
    ds_read_b128 v[84:87], v84
    ds_read_b128 v[88:91], v88
    v_smfmac_f32_16x16x64_bf16 v[40:43], v[76:79], a[32:39], v1
    v_smfmac_f32_16x16x64_bf16 v[44:47], v[76:79], v[56:63], v1
    ds_read_b128 v[56:59], v2 offset:24576
    ds_read_b128 v[60:63], v2 offset:25600
    v_smfmac_f32_16x16x64_bf16 v[32:35], v[92:95], a[40:47], v1
    v_smfmac_f32_16x16x64_bf16 v[36:39], v[92:95], a[48:55], v1
    v_smfmac_f32_16x16x64_bf16 v[40:43], v[92:95], a[56:63], v1
    v_smfmac_f32_16x16x64_bf16 v[44:47], v[92:95], v[64:71], v1
    v_smfmac_f32_16x16x64_bf16 v[48:51], v[92:95], a[64:71], v1
    ds_read_b128 v[64:67], v0 offset:6144
    ds_read_b128 v[68:71], v0 offset:7168
    v_smfmac_f32_16x16x64_bf16 v[52:55], v[92:95], a[72:79], v1
    s_waitcnt lgkmcnt(6)
    v_smfmac_f32_16x16x64_bf16 v[32:35], v[80:83], v[16:23], v1
    v_lshlrev_b32 v94, 3, v0
    buffer_load_dword v94, v94, s[40:43], s44 offen sc1
    v_smfmac_f32_16x16x64_bf16 v[36:39], v[80:83], v[24:31], v1
    ds_read_b128 v[16:19], v0 offset:0
    ds_read_b128 v[20:23], v0 offset:1024
    ds_read_b128 v[24:27], v0 offset:2048
    ds_read_b128 v[28:31], v0 offset:3072
    s_waitcnt lgkmcnt(9)
    v_smfmac_f32_16x16x64_bf16 v[32:35], v[84:87], a[80:87], v1
    s_waitcnt lgkmcnt(6)
    v_smfmac_f32_16x16x64_bf16 v[36:39], v[84:87], v[56:63], v1
    v_smfmac_f32_16x16x64_bf16 v[32:35], v[88:91], a[88:95], v1
    ds_read_b128 v[56:59], v0 offset:4096
    ds_read_b128 v[60:63], v0 offset:5120
    v_smfmac_f32_16x16x64_bf16 v[36:39], v[88:91], a[96:103], v1
    v_smfmac_f32_16x16x64_bf16 v[40:43], v[80:83], a[104:111], v1
    s_mov_b64 exec, s[4:5]
    buffer_atomic_add v1, off, s[8:11], s3 sc1
    s_mov_b64 exec, -1
    v_smfmac_f32_16x16x64_bf16 v[44:47], v[80:83], a[112:119], v1
    v_smfmac_f32_16x16x64_bf16 v[40:43], v[84:87], a[120:127], v1
    v_permlane32_swap_b32 v32, v33
    v_permlane32_swap_b32 v34, v35
    v_smfmac_f32_16x16x64_bf16 v[44:47], v[84:87], a[128:135], v1
    v_permlane32_swap_b32 v36, v37
    v_permlane32_swap_b32 v38, v39
    v_smfmac_f32_16x16x64_bf16 v[40:43], v[88:91], a[136:143], v1
    v_add_f32 v32, v32, v33
    v_add_f32 v34, v34, v35
    v_smfmac_f32_16x16x64_bf16 v[44:47], v[88:91], a[144:151], v1
    v_add_f32 v36, v36, v37
    v_add_f32 v38, v38, v39
    v_smfmac_f32_16x16x64_bf16 v[48:51], v[76:79], a[152:159], v1
    v_cvt_pk_bf16_f32 v72, v32, v36
    v_cvt_pk_bf16_f32 v74, v34, v38
    v_smfmac_f32_16x16x64_bf16 v[52:55], v[76:79], a[160:167], v1
    v_smfmac_f32_16x16x64_bf16 v[48:51], v[80:83], a[168:175], v1
    v_permlane32_swap_b32 v40, v41
    v_permlane32_swap_b32 v42, v43
    v_permlane32_swap_b32 v44, v45
    v_permlane32_swap_b32 v46, v47
    v_smfmac_f32_16x16x64_bf16 v[52:55], v[80:83], a[176:183], v1
    v_add_f32 v40, v40, v41
    v_add_f32 v42, v42, v43
    v_add_f32 v44, v44, v45
    v_add_f32 v46, v46, v47
    v_smfmac_f32_16x16x64_bf16 v[48:51], v[84:87], a[184:191], v1
    v_cvt_pk_bf16_f32 v73, v40, v44
    v_cvt_pk_bf16_f32 v75, v42, v46
    ds_write_b64 v3, v[72:73]
    ds_write_b64 v3, v[74:75] offset:32
    v_smfmac_f32_16x16x64_bf16 v[52:55], v[84:87], a[192:199], v1
    s_waitcnt lgkmcnt(0)
    s_barrier
    ds_read_b128 v[32:35], v4 offset:8192
    ds_read_b128 v[36:39], v4 offset:8704
    ds_read_b128 v[40:43], v4 offset:9216
    ds_read_b128 v[44:47], v4 offset:9728
    v_smfmac_f32_16x16x64_bf16 v[48:51], v[88:91], a[200:207], v1
    ds_read_b128 v[76:79], v4 offset:10240
    ds_read_b128 v[80:83], v4 offset:10752
    ds_read_b128 v[84:87], v4 offset:11264
    v_smfmac_f32_16x16x64_bf16 v[52:55], v[88:91], a[208:215], v1
    ds_read_b128 v[88:91], v4 offset:11776
    s_cmp_eq_u32 s24, 63
    s_cbranch_scc1 RF_31
    s_waitcnt lgkmcnt(7)
    v_mfma_f32_16x16x32_bf16 v[16:19], v[16:19], v[32:35], 0
    v_mfma_f32_16x16x32_bf16 v[56:59], v[56:59], v[32:35], 0
    s_waitcnt lgkmcnt(6)
    v_mfma_f32_16x16x32_bf16 v[16:19], v[20:23], v[36:39], v[16:19]
    v_mfma_f32_16x16x32_bf16 v[56:59], v[60:63], v[36:39], v[56:59]
    buffer_load_dwordx4 v0, s[12:15], s65 offen sc1 lds
    s_add_u32 m0, m0, 4096
    s_waitcnt lgkmcnt(5)
    v_mfma_f32_16x16x32_bf16 v[16:19], v[24:27], v[40:43], v[16:19]
    v_mfma_f32_16x16x32_bf16 v[56:59], v[64:67], v[40:43], v[56:59]
    v_cvt_pk_bf16_f32 v72, v48, v49
    v_cvt_pk_bf16_f32 v73, v50, v51
    s_waitcnt lgkmcnt(4)
    v_mfma_f32_16x16x32_bf16 v[16:19], v[28:31], v[44:47], v[16:19]
    v_mfma_f32_16x16x32_bf16 v[56:59], v[68:71], v[44:47], v[56:59]
    v_cvt_pk_bf16_f32 v74, v52, v53
    v_cvt_pk_bf16_f32 v75, v54, v55
    s_waitcnt lgkmcnt(0)
    v_mfma_f32_16x16x32_bf16 v[76:79], v[76:79], v[32:35], 0
    v_mov_b32 v26, 0x3f003f00
    v_mov_b32 v27, 0x3f003f00
    v_mfma_f32_16x16x32_bf16 v[76:79], v[80:83], v[36:39], v[76:79]
    v_mov_b32 v28, 0x3f803f80
    v_mov_b32 v29, 0x3f803f80
    v_mfma_f32_16x16x32_bf16 v[76:79], v[84:87], v[40:43], v[76:79]
    v_max3_f32 v92, v16, v17, v18
    v_max3_f32 v93, v56, v57, v58
    v_mfma_f32_16x16x32_bf16 v[76:79], v[88:91], v[44:47], v[76:79]
    v_max3_f32 v92, v92, v19, v59
    v_mov_b32 v30, 0x3f803f80
    v_mov_b32 v31, 0x3f803f80
    ds_read_b128 v[64:67], v2 offset:28672
    ds_read_b128 v[68:71], v2 offset:29696
    ds_read_b128 v[84:87], v2 offset:26624
    ds_read_b128 v[88:91], v2 offset:27648
    s_nop 0
    v_max3_f32 v93, v93, v76, v77
    v_max3_f32 v92, v92, v78, v79
    v_max_f32 v92, v92, v93
    v_mov_b32 v93, v92
    s_waitcnt lgkmcnt(4)
    buffer_store_dwordx4 v[72:75], v0, s[20:23], s67 offen sc1
    v_permlane32_swap_b32 v92, v93
    v_max_f32 v92, v92, v93
    v_mov_b32 v93, v92
    s_nop 1
    v_permlane16_swap_b32 v92, v93
    v_max_f32 v92, v92, v93
    v_mul_f32 v92, s76, v92
    v_fma_f32 v16, v16, s76, -v92
    v_fma_f32 v17, v17, s76, -v92
    v_fma_f32 v18, v18, s76, -v92
    v_fma_f32 v19, v19, s76, -v92
    v_exp_f32 v16, v16
    v_exp_f32 v17, v17
    v_exp_f32 v18, v18
    v_exp_f32 v19, v19
    v_cvt_pk_bf16_f32 v20, v16, v17
    v_cvt_pk_bf16_f32 v21, v18, v19
    v_fma_f32 v56, v56, s76, -v92
    v_fma_f32 v57, v57, s76, -v92
    v_fma_f32 v58, v58, s76, -v92
    v_fma_f32 v59, v59, s76, -v92
    v_exp_f32 v56, v56
    v_exp_f32 v57, v57
    v_exp_f32 v58, v58
    v_exp_f32 v59, v59
    v_cvt_pk_bf16_f32 v22, v56, v57
    v_cvt_pk_bf16_f32 v23, v58, v59
    v_fma_f32 v76, v76, s76, -v92
    v_fma_f32 v77, v77, s76, -v92
    v_fma_f32 v78, v78, s76, -v92
    v_fma_f32 v79, v79, s76, -v92
    v_mfma_f32_16x16x32_bf16 v[60:63], v[28:31], v[20:23], 0
    v_exp_f32 v76, v76
    v_mfma_f32_16x16x32_bf16 v[48:51], v[8:11], v[20:23], 0
    v_exp_f32 v77, v77
    v_mfma_f32_16x16x32_bf16 v[52:55], v[12:15], v[20:23], 0
    v_exp_f32 v78, v78
    v_exp_f32 v79, v79
    v_cvt_pk_bf16_f32 v24, v76, v77
    v_cvt_pk_bf16_f32 v25, v78, v79
    s_nop 1
    v_mfma_f32_16x16x16_bf16 v[60:63], v[26:27], v[24:25], v[60:63]
    buffer_load_dwordx4 v0, s[12:15], s69 offen sc1 lds
    v_mfma_f32_16x16x16_bf16 v[48:51], v[72:73], v[24:25], v[48:51]
    v_mfma_f32_16x16x16_bf16 v[52:55], v[74:75], v[24:25], v[52:55]
    v_mov_b32 v32, 0
    v_mov_b32 v33, 0
    v_mov_b32 v34, 0
    v_mov_b32 v35, 0
    v_mov_b32 v36, 0
    v_mov_b32 v37, 0
    v_rcp_f32 v92, v60
    v_mov_b32 v38, 0
    v_mul_f32 v48, v48, v92
    v_mul_f32 v49, v49, v92
    v_mul_f32 v50, v50, v92
    v_mul_f32 v51, v51, v92
    v_mul_f32 v52, v52, v92
    v_cvt_pk_bf16_f32 v76, v48, v52
    v_mul_f32 v53, v53, v92
    v_cvt_pk_bf16_f32 v77, v49, v53
    v_mul_f32 v54, v54, v92
    v_cvt_pk_bf16_f32 v78, v50, v54
    v_mul_f32 v55, v55, v92
    v_cvt_pk_bf16_f32 v79, v51, v55
    ds_write_b128 v5, v[76:79]
    v_mov_b32 v80, 0
    v_mov_b32 v81, 0
    v_mov_b32 v82, 0
    v_mov_b32 v83, 0
    v_mov_b32 v39, 0
    v_mov_b32 v40, 0
    v_mov_b32 v41, 0
    v_mov_b32 v42, 0
    v_mov_b32 v43, 0
    v_mov_b32 v44, 0
    v_mov_b32 v45, 0
    v_mov_b32 v46, 0
    v_mov_b32 v47, 0
    s_waitcnt lgkmcnt(0)
    s_barrier
    ds_read_b128 v[48:51], v0 offset:12288
    ds_read_b128 v[52:55], v0 offset:13312
    ds_read_b128 v[16:19], v2 offset:30720
    ds_read_b128 v[20:23], v2 offset:31744
    ds_read_b128 v[24:27], v2 offset:32768
    ds_read_b128 v[28:31], v2 offset:33792
    ds_read_b128 v[56:59], v2 offset:34816
    ds_read_b128 v[60:63], v2 offset:35840
    buffer_load_dwordx4 v[8:11], v0, s[16:19], s66 offen sc1
    s_waitcnt lgkmcnt(7)
    v_smfmac_f32_16x16x64_bf16 v[80:83], v[48:51], a[216:223], v1
    s_waitcnt lgkmcnt(6)
    v_smfmac_f32_16x16x64_bf16 v[80:83], v[52:55], a[224:231], v1
    v_smfmac_f32_16x16x64_bf16 v[32:35], v[48:51], a[232:239], v1
    buffer_load_dwordx4 v[12:15], v0, s[16:19], s66 offen offset:1024 sc1
    v_smfmac_f32_16x16x64_bf16 v[36:39], v[48:51], a[240:247], v1
    v_permlane32_swap_b32 v80, v82
    v_permlane32_swap_b32 v81, v83
    v_smfmac_f32_16x16x64_bf16 v[32:35], v[52:55], a[248:255], v1
    v_pk_add_f32 v[80:81], v[80:81], v[82:83]
    v_cvt_pk_bf16_f32 v82, v80, v81
    v_smfmac_f32_16x16x64_bf16 v[36:39], v[52:55], v[84:91], v1
    v_cvt_pk_bf16_f32 v81, v80, v81
    s_nop 1
    v_smfmac_f32_16x16x64_bf16 v[40:43], v[48:51], v[64:71], v1
    v_permlane32_swap_b32 v82, v81
    v_mov_b32 v80, v82
    s_waitcnt lgkmcnt(4)
    v_smfmac_f32_16x16x64_bf16 v[44:47], v[48:51], v[16:23], v1
    v_mov_b32 v83, v81
    s_nop 1
    s_waitcnt lgkmcnt(2)
    v_smfmac_f32_16x16x64_bf16 v[40:43], v[52:55], v[24:31], v1
    v_permlane16_swap_b32 v80, v82
    v_permlane16_swap_b32 v81, v83
    s_waitcnt lgkmcnt(0)
    v_smfmac_f32_16x16x64_bf16 v[44:47], v[52:55], v[56:63], v1
    v_and_or_b32 v80, v80, -2, s77
    v_permlane32_swap_b32 v32, v36
    v_permlane32_swap_b32 v33, v37
    v_permlane32_swap_b32 v34, v38
    v_permlane32_swap_b32 v35, v39
    v_pk_add_f32 v[32:33], v[32:33], v[36:37]
    v_pk_add_f32 v[34:35], v[34:35], v[38:39]
    v_cvt_pk_bf16_f32 v32, v32, v33
    v_cvt_pk_bf16_f32 v33, v34, v35
    v_permlane32_swap_b32 v40, v44
    v_permlane32_swap_b32 v41, v45
    v_permlane32_swap_b32 v42, v46
    v_permlane32_swap_b32 v43, v47
    v_pk_add_f32 v[40:41], v[40:41], v[44:45]
    v_pk_add_f32 v[42:43], v[42:43], v[46:47]
    v_and_or_b32 v32, v32, -2, s77
    v_cvt_pk_bf16_f32 v34, v40, v41
    v_cvt_pk_bf16_f32 v35, v42, v43
    buffer_store_dwordx4 v[32:35], v6, s[8:11], s57 offen
    s_mov_b64 exec, 0xffff
    buffer_store_dwordx4 v[80:83], v6, s[8:11], s59 offen
    s_mov_b64 exec, -1
    s_cmp_ge_u32 s39, 40
    s_cbranch_scc1 RN_39
    ds_read_b128 v[16:19], v2 offset:0
    ds_read_b128 v[20:23], v2 offset:1024
    ds_read_b128 v[24:27], v2 offset:2048
    ds_read_b128 v[28:31], v2 offset:3072
    buffer_load_dwordx4 v[56:59], v0, s[8:11], s60 offen offset:0 sc1
    buffer_load_dwordx4 v[60:63], v0, s[8:11], s60 offen offset:1024 sc1
    buffer_load_dwordx4 v[64:67], v0, s[8:11], s60 offen offset:2048 sc1
    buffer_load_dwordx4 v[68:71], v0, s[8:11], s60 offen offset:3072 sc1
    v_mov_b32 v32, 0
    v_mov_b32 v33, 0
    v_mov_b32 v34, 0
    v_mov_b32 v35, 0
    v_mov_b32 v36, 0
    v_mov_b32 v37, 0
    v_mov_b32 v38, 0
    v_mov_b32 v39, 0
    v_mov_b32 v40, 0
    v_mov_b32 v41, 0
    v_mov_b32 v42, 0
    v_mov_b32 v43, 0
    v_mov_b32 v44, 0
    v_mov_b32 v45, 0
    v_mov_b32 v46, 0
    v_mov_b32 v47, 0
    v_mov_b32 v48, 0
    v_mov_b32 v49, 0
    v_mov_b32 v50, 0
    v_mov_b32 v51, 0
    v_mov_b32 v52, 0
    v_mov_b32 v53, 0
    v_mov_b32 v54, 0
    v_mov_b32 v55, 0
    s_add_u32 s30, s36, s70
    s_add_u32 s31, s71, s70
    s_add_u32 s32, s37, s70
    s_add_u32 s33, s72, s70
    s_add_u32 s24, s24, 1
    s_add_u32 s67, s67, 131072
    s_add_u32 s44, s44, s45
    s_add_u32 s47, s47, 1
    s_add_u32 s3, s3, 512
    s_mov_b32 s73, 0
    v_mov_b32 v32, 0x3f80
    v_lshlrev_b32 v32, v0, v32
    v_cndmask_b32 v72, 0, v32, s[48:49]
    v_cndmask_b32 v73, 0, v32, s[50:51]
    v_cndmask_b32 v74, 0, v32, s[52:53]
    v_cndmask_b32 v75, 0, v32, s[54:55]
    v_and_b32 v33, 0x40, v0
    v_and_b32 v34, 0x30, v0
    v_lshl_add_u32 v34, v33, s61, v34
RP_40:
    buffer_load_dwordx4 v[76:79], v0, s[8:11], s60 offen offset:0 sc1
    buffer_load_dwordx4 v[80:83], v0, s[8:11], s60 offen offset:1024 sc1
    buffer_load_dwordx4 v[84:87], v0, s[8:11], s60 offen offset:2048 sc1
    buffer_load_dwordx4 v[88:91], v0, s[8:11], s60 offen offset:3072 sc1
    s_waitcnt vmcnt(4)
    v_mfma_f32_16x16x32_bf16 v[92:95], v[56:59], v[72:75], 0
    v_bitop3_b32 v32, v56, v60, s77 bitop3:0x7e
    v_bitop3_b32 v33, v64, v68, s77 bitop3:0x7e
    v_mfma_f32_16x16x32_bf16 v[92:95], v[60:63], v[72:75], v[92:95]
    v_bitop3_b32 v32, v32, 1, v33 bitop3:0xc8
    v_cmp_ne_u32 vcc, 0, v32
    v_mfma_f32_16x16x32_bf16 v[92:95], v[64:67], v[72:75], v[92:95]
    v_mfma_f32_16x16x32_bf16 v[92:95], v[68:71], v[72:75], v[92:95]
    s_cbranch_vccz RP_41
    buffer_load_dwordx4 v[56:59], v0, s[8:11], s60 offen offset:0 sc1
    buffer_load_dwordx4 v[60:63], v0, s[8:11], s60 offen offset:1024 sc1
    buffer_load_dwordx4 v[64:67], v0, s[8:11], s60 offen offset:2048 sc1
    buffer_load_dwordx4 v[68:71], v0, s[8:11], s60 offen offset:3072 sc1
    s_add_u32 s73, s73, 1
    s_cmp_gt_u32 s73, 131072
    s_cbranch_scc1 RD_5
    s_waitcnt vmcnt(4)
    v_mfma_f32_16x16x32_bf16 v[92:95], v[76:79], v[72:75], 0
    v_bitop3_b32 v32, v76, v80, s77 bitop3:0x7e
    v_bitop3_b32 v33, v84, v88, s77 bitop3:0x7e
    v_mfma_f32_16x16x32_bf16 v[92:95], v[80:83], v[72:75], v[92:95]
    v_bitop3_b32 v32, v32, 1, v33 bitop3:0xc8
    v_cmp_ne_u32 vcc, 0, v32
    v_mfma_f32_16x16x32_bf16 v[92:95], v[84:87], v[72:75], v[92:95]
    v_mfma_f32_16x16x32_bf16 v[92:95], v[88:91], v[72:75], v[92:95]
    s_cbranch_vccnz RP_40
RP_41:
    s_nop 6
    v_permlane32_swap_b32 v92, v94
    v_permlane32_swap_b32 v93, v95
    v_pk_add_f32 v[92:93], v[92:93], v[94:95]
    v_cvt_pk_bf16_f32 v94, v92, v93
    v_cvt_pk_bf16_f32 v93, v92, v93
    s_nop 1
    v_permlane32_swap_b32 v94, v93
    v_mov_b32 v92, v94
    v_mov_b32 v95, v93
    s_nop 1
    v_permlane16_swap_b32 v92, v94
    v_permlane16_swap_b32 v93, v95
    s_mov_b64 exec, 0xff
    buffer_store_dwordx4 v[92:95], v34, s[8:11], s34 offen
    s_mov_b64 exec, -1
    s_branch RL_30
RG_38:
    buffer_load_dwordx4 v[76:79], v0, s[8:11], s32 offen sc1
    buffer_load_dwordx4 v[92:95], v0, s[8:11], s33 offen sc1
    s_add_u32 s73, s73, 1
    s_cmp_gt_u32 s73, 131072
    s_cbranch_scc1 RD_5
    s_waitcnt vmcnt(0)
    s_branch RG_37
RK_33:
    s_waitcnt vmcnt(0)
    v_lshlrev_b32 v60, 3, v0
    s_mov_b32 s56, 3149824
    buffer_load_dword v60, v60, s[8:11], s56 offen sc1
    s_add_u32 s73, s73, 1
    s_cmp_gt_u32 s73, 131072
    s_cbranch_scc1 RD_5
    s_waitcnt vmcnt(0)
    v_cmp_ne_u32 vcc, 32, v60
    s_nop 3
    s_ff1_i32_b64 s46, vcc
    s_cmp_gt_u32 s47, s46
    s_cbranch_scc1 RK_33
    s_branch RK_34
RG_36:
    buffer_load_dwordx4 v[56:59], v0, s[8:11], s30 offen sc1
    s_mov_b64 exec, 0xffff
    buffer_load_dwordx4 v[72:75], v0, s[8:11], s31 offen sc1
    s_mov_b64 exec, -1
    s_add_u32 s73, s73, 1
    s_cmp_gt_u32 s73, 131072
    s_cbranch_scc1 RD_5
    s_waitcnt vmcnt(0)
    s_branch RG_35
RN_39:
    ds_read_b128 v[16:19], v2 offset:0
    ds_read_b128 v[20:23], v2 offset:1024
    ds_read_b128 v[24:27], v2 offset:2048
    ds_read_b128 v[28:31], v2 offset:3072
    v_mov_b32 v32, 0
    v_mov_b32 v33, 0
    v_mov_b32 v34, 0
    v_mov_b32 v35, 0
    v_mov_b32 v36, 0
    v_mov_b32 v37, 0
    v_mov_b32 v38, 0
    v_mov_b32 v39, 0
    v_mov_b32 v40, 0
    v_mov_b32 v41, 0
    v_mov_b32 v42, 0
    v_mov_b32 v43, 0
    v_mov_b32 v44, 0
    v_mov_b32 v45, 0
    v_mov_b32 v46, 0
    v_mov_b32 v47, 0
    v_mov_b32 v48, 0
    v_mov_b32 v49, 0
    v_mov_b32 v50, 0
    v_mov_b32 v51, 0
    v_mov_b32 v52, 0
    v_mov_b32 v53, 0
    v_mov_b32 v54, 0
    v_mov_b32 v55, 0
    s_add_u32 s30, s36, s70
    s_add_u32 s31, s71, s70
    s_add_u32 s32, s37, s70
    s_add_u32 s33, s72, s70
    s_add_u32 s24, s24, 1
    s_add_u32 s67, s67, 131072
    s_add_u32 s44, s44, s45
    s_add_u32 s47, s47, 1
    s_add_u32 s3, s3, 512
    s_mov_b32 s73, 0
    s_branch RL_30
RF_31:
    s_nop 7
    v_cvt_pk_bf16_f32 v72, v48, v49
    v_cvt_pk_bf16_f32 v73, v50, v51
    v_cvt_pk_bf16_f32 v74, v52, v53
    v_cvt_pk_bf16_f32 v75, v54, v55
    buffer_store_dwordx4 v[72:75], v0, s[20:23], s67 offen sc1
    s_waitcnt vmcnt(0) lgkmcnt(0)
    s_barrier
    s_add_u32 s3, s3, 512
    s_mov_b64 exec, s[4:5]
    buffer_atomic_add v1, off, s[8:11], s3 sc1
    s_mov_b64 exec, -1
    s_branch RD_5
RV_16:
RK_44:
    s_waitcnt vmcnt(0)
    v_lshlrev_b32 v60, 3, v0
    s_mov_b32 s56, 3149824
    buffer_load_dword v60, v60, s[8:11], s56 offen sc1
    s_add_u32 s73, s73, 1
    s_cmp_gt_u32 s73, 131072
    s_cbranch_scc1 RD_5
    s_waitcnt vmcnt(0)
    v_cmp_ne_u32 vcc, 32, v60
    s_nop 3
    s_ff1_i32_b64 s46, vcc
    s_cmp_gt_u32 s47, s46
    s_cbranch_scc1 RK_44
    s_lshl_b32 m0, s27, 10
    s_add_u32 s69, s65, 131072
    s_add_u32 s66, s65, s68
    buffer_load_dwordx4 v0, s[12:15], s65 offen sc1 lds
    s_add_u32 m0, m0, 4096
    buffer_load_dwordx4 v[8:11], v0, s[16:19], s66 offen sc1
    buffer_load_dwordx4 v0, s[12:15], s69 offen sc1 lds
    buffer_load_dwordx4 v[12:15], v0, s[16:19], s66 offen offset:1024 sc1
RL_42:
    s_cmp_gt_u32 s47, s46
    s_cbranch_scc1 RK_45
RK_46:
    s_barrier
    s_mov_b32 s25, s35
    s_and_b32 s56, s24, 1
    s_mul_i32 s56, s56, 327680
    s_add_u32 s57, s63, s56
    s_add_u32 s59, s74, s56
    s_add_u32 s60, s64, s56
    s_bfe_u32 s77, s24, 0x10001
    s_add_u32 s56, s24, 1
    s_mul_i32 s70, s56, 20480
    s_add_u32 s34, s62, s70
    s_add_u32 s35, s34, 5120
    s_add_u32 s65, s65, 262144
    s_lshl_b32 m0, s27, 10
    s_add_u32 s69, s65, 131072
    s_add_u32 s66, s65, s68
    s_nop 15
    buffer_load_dwordx4 v[56:59], v0, s[8:11], s30 offen sc1
    s_mov_b64 exec, 0xffff
    buffer_load_dwordx4 v[72:75], v0, s[8:11], s31 offen sc1
    s_mov_b64 exec, -1
    s_mov_b64 exec, 0xff
    buffer_store_dwordx4 v[92:95], v34, s[8:11], s25 offen sc1
    s_mov_b64 exec, -1
    v_mov_b32 v32, 0
    v_mov_b32 v33, 0
    v_mov_b32 v34, 0
    v_add_u32 v95, s29, v0
    s_waitcnt vmcnt(1) lgkmcnt(0)
RG_47:
    v_max_u32 v60, v56, v72
    v_cmp_eq_u32 vcc, -1, v60
    s_cbranch_vccnz RG_48
    ds_write_b128 v7, v[56:59]
    s_mov_b64 exec, 0xffff
    ds_write_b128 v95, v[72:75]
    s_mov_b64 exec, -1
    v_smfmac_f32_16x16x64_bf16 v[32:35], v[56:59], v[16:23], v1
    ds_read_b128 v[16:19], v2 offset:4096
    ds_read_b128 v[20:23], v2 offset:5120
    v_xor_b32 v60, 1024, v7
    v_xor_b32 v64, 2048, v7
    v_smfmac_f32_16x16x64_bf16 v[36:39], v[56:59], v[24:31], v1
    ds_read_b128 v[24:27], v2 offset:6144
    ds_read_b128 v[28:31], v2 offset:7168
    v_xor_b32 v68, 3072, v7
    s_waitcnt lgkmcnt(4)
    s_barrier
    ds_read_b128 v[72:75], v0 offset:8192
    ds_read_b128 v[60:63], v60
    ds_read_b128 v[64:67], v64
    ds_read_b128 v[68:71], v68
    v_smfmac_f32_16x16x64_bf16 v[40:43], v[56:59], v[96:103], v1
    buffer_load_dwordx4 v[76:79], v0, s[8:11], s32 offen sc1
    v_smfmac_f32_16x16x64_bf16 v[44:47], v[56:59], v[104:111], v1
    buffer_load_dwordx4 v[92:95], v0, s[8:11], s33 offen sc1
    v_smfmac_f32_16x16x64_bf16 v[48:51], v[56:59], v[112:119], v1
    v_smfmac_f32_16x16x64_bf16 v[52:55], v[56:59], v[120:127], v1
    s_waitcnt lgkmcnt(3)
    v_smfmac_f32_16x16x64_bf16 v[32:35], v[72:75], v[128:135], v1
    v_smfmac_f32_16x16x64_bf16 v[36:39], v[72:75], v[136:143], v1
    v_smfmac_f32_16x16x64_bf16 v[40:43], v[72:75], v[144:151], v1
    v_smfmac_f32_16x16x64_bf16 v[44:47], v[72:75], v[152:159], v1
    v_smfmac_f32_16x16x64_bf16 v[48:51], v[72:75], v[16:23], v1
    ds_read_b128 v[16:19], v2 offset:8192
    ds_read_b128 v[20:23], v2 offset:9216
    v_smfmac_f32_16x16x64_bf16 v[52:55], v[72:75], v[24:31], v1
    ds_read_b128 v[24:27], v2 offset:10240
    ds_read_b128 v[28:31], v2 offset:11264
    s_waitcnt lgkmcnt(6)
    v_smfmac_f32_16x16x64_bf16 v[32:35], v[60:63], v[160:167], v1
    v_smfmac_f32_16x16x64_bf16 v[36:39], v[60:63], v[168:175], v1
    v_smfmac_f32_16x16x64_bf16 v[40:43], v[60:63], v[176:183], v1
    v_smfmac_f32_16x16x64_bf16 v[44:47], v[60:63], v[184:191], v1
    s_waitcnt lgkmcnt(5)
    v_smfmac_f32_16x16x64_bf16 v[32:35], v[64:67], v[192:199], v1
    v_smfmac_f32_16x16x64_bf16 v[36:39], v[64:67], v[200:207], v1
    v_smfmac_f32_16x16x64_bf16 v[40:43], v[64:67], v[208:215], v1
    v_smfmac_f32_16x16x64_bf16 v[44:47], v[64:67], v[216:223], v1
    s_waitcnt lgkmcnt(4)
    s_waitcnt lgkmcnt(2)
    v_smfmac_f32_16x16x64_bf16 v[32:35], v[68:71], v[16:23], v1
    ds_read_b128 v[16:19], v2 offset:12288
    ds_read_b128 v[20:23], v2 offset:13312
    s_waitcnt lgkmcnt(2)
    v_smfmac_f32_16x16x64_bf16 v[36:39], v[68:71], v[24:31], v1
    ds_read_b128 v[24:27], v2 offset:14336
    ds_read_b128 v[28:31], v2 offset:15360
    s_barrier
    v_smfmac_f32_16x16x64_bf16 v[40:43], v[68:71], v[224:231], v1
    v_smfmac_f32_16x16x64_bf16 v[44:47], v[68:71], v[232:239], v1
    v_smfmac_f32_16x16x64_bf16 v[48:51], v[60:63], v[240:247], v1
    v_smfmac_f32_16x16x64_bf16 v[52:55], v[60:63], v[248:255], v1
    ds_read_b128 v[56:59], v2 offset:16384
    ds_read_b128 v[60:63], v2 offset:17408
    v_smfmac_f32_16x16x64_bf16 v[48:51], v[64:67], a[0:7], v1
    v_smfmac_f32_16x16x64_bf16 v[52:55], v[64:67], a[8:15], v1
    v_smfmac_f32_16x16x64_bf16 v[48:51], v[68:71], a[16:23], v1
    v_smfmac_f32_16x16x64_bf16 v[52:55], v[68:71], a[24:31], v1
    ds_read_b128 v[64:67], v2 offset:18432
    ds_read_b128 v[68:71], v2 offset:19456
    s_waitcnt vmcnt(0)
RG_49:
    v_max_u32 v72, v76, v92
    v_cmp_eq_u32 vcc, -1, v72
    s_cbranch_vccnz RG_50
    ds_write_b128 v7, v[76:79]
    s_waitcnt lgkmcnt(7)
    v_smfmac_f32_16x16x64_bf16 v[32:35], v[76:79], v[16:23], v1
    ds_read_b128 v[16:19], v2 offset:20480
    ds_read_b128 v[20:23], v2 offset:21504
    v_xor_b32 v80, 1024, v7
    v_xor_b32 v84, 2048, v7
    s_waitcnt lgkmcnt(7)
    v_smfmac_f32_16x16x64_bf16 v[36:39], v[76:79], v[24:31], v1
    ds_read_b128 v[24:27], v2 offset:22528
    ds_read_b128 v[28:31], v2 offset:23552
    v_xor_b32 v88, 3072, v7
    s_waitcnt lgkmcnt(4)
    s_barrier
    ds_read_b128 v[80:83], v80
    ds_read_b128 v[84:87], v84
    ds_read_b128 v[88:91], v88
    v_smfmac_f32_16x16x64_bf16 v[40:43], v[76:79], a[32:39], v1
    v_smfmac_f32_16x16x64_bf16 v[44:47], v[76:79], v[56:63], v1
    ds_read_b128 v[56:59], v2 offset:24576
    ds_read_b128 v[60:63], v2 offset:25600
    v_smfmac_f32_16x16x64_bf16 v[32:35], v[92:95], a[40:47], v1
    v_smfmac_f32_16x16x64_bf16 v[36:39], v[92:95], a[48:55], v1
    v_smfmac_f32_16x16x64_bf16 v[40:43], v[92:95], a[56:63], v1
    v_smfmac_f32_16x16x64_bf16 v[44:47], v[92:95], v[64:71], v1
    v_smfmac_f32_16x16x64_bf16 v[48:51], v[92:95], a[64:71], v1
    ds_read_b128 v[64:67], v0 offset:6144
    ds_read_b128 v[68:71], v0 offset:7168
    v_smfmac_f32_16x16x64_bf16 v[52:55], v[92:95], a[72:79], v1
    s_waitcnt lgkmcnt(6)
    v_smfmac_f32_16x16x64_bf16 v[32:35], v[80:83], v[16:23], v1
    v_lshlrev_b32 v94, 3, v0
    buffer_load_dword v94, v94, s[40:43], s44 offen sc1
    v_smfmac_f32_16x16x64_bf16 v[36:39], v[80:83], v[24:31], v1
    ds_read_b128 v[16:19], v0 offset:0
    ds_read_b128 v[20:23], v0 offset:1024
    ds_read_b128 v[24:27], v0 offset:2048
    ds_read_b128 v[28:31], v0 offset:3072
    s_waitcnt lgkmcnt(9)
    v_smfmac_f32_16x16x64_bf16 v[32:35], v[84:87], a[80:87], v1
    s_waitcnt lgkmcnt(6)
    v_smfmac_f32_16x16x64_bf16 v[36:39], v[84:87], v[56:63], v1
    v_smfmac_f32_16x16x64_bf16 v[32:35], v[88:91], a[88:95], v1
    ds_read_b128 v[56:59], v0 offset:4096
    ds_read_b128 v[60:63], v0 offset:5120
    v_smfmac_f32_16x16x64_bf16 v[36:39], v[88:91], a[96:103], v1
    v_smfmac_f32_16x16x64_bf16 v[40:43], v[80:83], a[104:111], v1
    s_mov_b64 exec, s[4:5]
    buffer_atomic_add v1, off, s[8:11], s3 sc1
    s_mov_b64 exec, -1
    v_smfmac_f32_16x16x64_bf16 v[44:47], v[80:83], a[112:119], v1
    v_smfmac_f32_16x16x64_bf16 v[40:43], v[84:87], a[120:127], v1
    v_permlane32_swap_b32 v32, v33
    v_permlane32_swap_b32 v34, v35
    v_smfmac_f32_16x16x64_bf16 v[44:47], v[84:87], a[128:135], v1
    v_permlane32_swap_b32 v36, v37
    v_permlane32_swap_b32 v38, v39
    v_smfmac_f32_16x16x64_bf16 v[40:43], v[88:91], a[136:143], v1
    v_add_f32 v32, v32, v33
    v_add_f32 v34, v34, v35
    v_smfmac_f32_16x16x64_bf16 v[44:47], v[88:91], a[144:151], v1
    v_add_f32 v36, v36, v37
    v_add_f32 v38, v38, v39
    v_smfmac_f32_16x16x64_bf16 v[48:51], v[76:79], a[152:159], v1
    v_cvt_pk_bf16_f32 v72, v32, v36
    v_cvt_pk_bf16_f32 v74, v34, v38
    v_smfmac_f32_16x16x64_bf16 v[52:55], v[76:79], a[160:167], v1
    v_smfmac_f32_16x16x64_bf16 v[48:51], v[80:83], a[168:175], v1
    v_permlane32_swap_b32 v40, v41
    v_permlane32_swap_b32 v42, v43
    v_permlane32_swap_b32 v44, v45
    v_permlane32_swap_b32 v46, v47
    v_smfmac_f32_16x16x64_bf16 v[52:55], v[80:83], a[176:183], v1
    v_add_f32 v40, v40, v41
    v_add_f32 v42, v42, v43
    v_add_f32 v44, v44, v45
    v_add_f32 v46, v46, v47
    v_smfmac_f32_16x16x64_bf16 v[48:51], v[84:87], a[184:191], v1
    v_cvt_pk_bf16_f32 v73, v40, v44
    v_cvt_pk_bf16_f32 v75, v42, v46
    ds_write_b64 v3, v[72:73]
    ds_write_b64 v3, v[74:75] offset:32
    v_smfmac_f32_16x16x64_bf16 v[52:55], v[84:87], a[192:199], v1
    s_waitcnt lgkmcnt(0)
    s_barrier
    ds_read_b128 v[32:35], v4 offset:8192
    ds_read_b128 v[36:39], v4 offset:8704
    ds_read_b128 v[40:43], v4 offset:9216
    ds_read_b128 v[44:47], v4 offset:9728
    v_smfmac_f32_16x16x64_bf16 v[48:51], v[88:91], a[200:207], v1
    ds_read_b128 v[76:79], v4 offset:10240
    ds_read_b128 v[80:83], v4 offset:10752
    ds_read_b128 v[84:87], v4 offset:11264
    v_smfmac_f32_16x16x64_bf16 v[52:55], v[88:91], a[208:215], v1
    ds_read_b128 v[88:91], v4 offset:11776
    s_cmp_eq_u32 s24, 63
    s_cbranch_scc1 RF_43
    s_waitcnt lgkmcnt(7)
    v_mfma_f32_16x16x32_bf16 v[16:19], v[16:19], v[32:35], 0
    v_mfma_f32_16x16x32_bf16 v[56:59], v[56:59], v[32:35], 0
    s_waitcnt lgkmcnt(6)
    v_mfma_f32_16x16x32_bf16 v[16:19], v[20:23], v[36:39], v[16:19]
    v_mfma_f32_16x16x32_bf16 v[56:59], v[60:63], v[36:39], v[56:59]
    buffer_load_dwordx4 v0, s[12:15], s65 offen sc1 lds
    s_add_u32 m0, m0, 4096
    s_waitcnt lgkmcnt(5)
    v_mfma_f32_16x16x32_bf16 v[16:19], v[24:27], v[40:43], v[16:19]
    v_mfma_f32_16x16x32_bf16 v[56:59], v[64:67], v[40:43], v[56:59]
    v_cvt_pk_bf16_f32 v72, v48, v49
    v_cvt_pk_bf16_f32 v73, v50, v51
    s_waitcnt lgkmcnt(4)
    v_mfma_f32_16x16x32_bf16 v[16:19], v[28:31], v[44:47], v[16:19]
    v_mfma_f32_16x16x32_bf16 v[56:59], v[68:71], v[44:47], v[56:59]
    v_cvt_pk_bf16_f32 v74, v52, v53
    v_cvt_pk_bf16_f32 v75, v54, v55
    s_waitcnt lgkmcnt(0)
    v_mfma_f32_16x16x32_bf16 v[76:79], v[76:79], v[32:35], 0
    v_mov_b32 v26, 0x3f003f00
    v_mov_b32 v27, 0x3f003f00
    v_add_u32 v48, s75, v4
    ds_read_b128 v[48:51], v48
    v_mfma_f32_16x16x32_bf16 v[76:79], v[80:83], v[36:39], v[76:79]
    v_mov_b32 v28, 0x3f803f80
    v_mov_b32 v29, 0x3f803f80
    v_mfma_f32_16x16x32_bf16 v[76:79], v[84:87], v[40:43], v[76:79]
    v_max3_f32 v92, v16, v17, v18
    v_max3_f32 v93, v56, v57, v58
    v_mfma_f32_16x16x32_bf16 v[76:79], v[88:91], v[44:47], v[76:79]
    v_max3_f32 v92, v92, v19, v59
    v_mov_b32 v30, 0x3f803f80
    v_mov_b32 v31, 0x3f803f80
    ds_read_b128 v[64:67], v2 offset:28672
    ds_read_b128 v[68:71], v2 offset:29696
    ds_read_b128 v[84:87], v2 offset:26624
    ds_read_b128 v[88:91], v2 offset:27648
    s_nop 0
    v_max3_f32 v93, v93, v76, v77
    v_max3_f32 v92, v92, v78, v79
    v_max_f32 v92, v92, v93
    v_mov_b32 v93, v92
    s_waitcnt lgkmcnt(4)
    buffer_store_dwordx4 v[48:51], v0, s[20:23], s67 offen sc1
    v_permlane32_swap_b32 v92, v93
    v_max_f32 v92, v92, v93
    v_mov_b32 v93, v92
    s_nop 1
    v_permlane16_swap_b32 v92, v93
    v_max_f32 v92, v92, v93
    v_mul_f32 v92, s76, v92
    v_fma_f32 v16, v16, s76, -v92
    v_fma_f32 v17, v17, s76, -v92
    v_fma_f32 v18, v18, s76, -v92
    v_fma_f32 v19, v19, s76, -v92
    v_exp_f32 v16, v16
    v_exp_f32 v17, v17
    v_exp_f32 v18, v18
    v_exp_f32 v19, v19
    v_cvt_pk_bf16_f32 v20, v16, v17
    v_cvt_pk_bf16_f32 v21, v18, v19
    v_fma_f32 v56, v56, s76, -v92
    v_fma_f32 v57, v57, s76, -v92
    v_fma_f32 v58, v58, s76, -v92
    v_fma_f32 v59, v59, s76, -v92
    v_exp_f32 v56, v56
    v_exp_f32 v57, v57
    v_exp_f32 v58, v58
    v_exp_f32 v59, v59
    v_cvt_pk_bf16_f32 v22, v56, v57
    v_cvt_pk_bf16_f32 v23, v58, v59
    v_fma_f32 v76, v76, s76, -v92
    v_fma_f32 v77, v77, s76, -v92
    v_fma_f32 v78, v78, s76, -v92
    v_fma_f32 v79, v79, s76, -v92
    v_mfma_f32_16x16x32_bf16 v[60:63], v[28:31], v[20:23], 0
    v_exp_f32 v76, v76
    v_mfma_f32_16x16x32_bf16 v[48:51], v[8:11], v[20:23], 0
    v_exp_f32 v77, v77
    v_mfma_f32_16x16x32_bf16 v[52:55], v[12:15], v[20:23], 0
    v_exp_f32 v78, v78
    v_exp_f32 v79, v79
    v_cvt_pk_bf16_f32 v24, v76, v77
    v_cvt_pk_bf16_f32 v25, v78, v79
    s_nop 1
    v_mfma_f32_16x16x16_bf16 v[60:63], v[26:27], v[24:25], v[60:63]
    buffer_load_dwordx4 v0, s[12:15], s69 offen sc1 lds
    v_mfma_f32_16x16x16_bf16 v[48:51], v[72:73], v[24:25], v[48:51]
    v_mfma_f32_16x16x16_bf16 v[52:55], v[74:75], v[24:25], v[52:55]
    v_mov_b32 v32, 0
    v_mov_b32 v33, 0
    v_mov_b32 v34, 0
    v_mov_b32 v35, 0
    v_mov_b32 v36, 0
    v_mov_b32 v37, 0
    v_rcp_f32 v92, v60
    v_mov_b32 v38, 0
    v_mul_f32 v48, v48, v92
    v_mul_f32 v49, v49, v92
    v_mul_f32 v50, v50, v92
    v_mul_f32 v51, v51, v92
    v_mul_f32 v52, v52, v92
    v_cvt_pk_bf16_f32 v76, v48, v52
    v_mul_f32 v53, v53, v92
    v_cvt_pk_bf16_f32 v77, v49, v53
    v_mul_f32 v54, v54, v92
    v_cvt_pk_bf16_f32 v78, v50, v54
    v_mul_f32 v55, v55, v92
    v_cvt_pk_bf16_f32 v79, v51, v55
    ds_write_b128 v5, v[76:79]
    v_mov_b32 v80, 0
    v_mov_b32 v81, 0
    v_mov_b32 v82, 0
    v_mov_b32 v83, 0
    v_mov_b32 v39, 0
    v_mov_b32 v40, 0
    v_mov_b32 v41, 0
    v_mov_b32 v42, 0
    v_mov_b32 v43, 0
    v_mov_b32 v44, 0
    v_mov_b32 v45, 0
    v_mov_b32 v46, 0
    v_mov_b32 v47, 0
    s_waitcnt lgkmcnt(0)
    s_barrier
    ds_read_b128 v[48:51], v0 offset:12288
    ds_read_b128 v[52:55], v0 offset:13312
    ds_read_b128 v[16:19], v2 offset:30720
    ds_read_b128 v[20:23], v2 offset:31744
    ds_read_b128 v[24:27], v2 offset:32768
    ds_read_b128 v[28:31], v2 offset:33792
    ds_read_b128 v[56:59], v2 offset:34816
    ds_read_b128 v[60:63], v2 offset:35840
    buffer_load_dwordx4 v[8:11], v0, s[16:19], s66 offen sc1
    s_waitcnt lgkmcnt(7)
    v_smfmac_f32_16x16x64_bf16 v[80:83], v[48:51], a[216:223], v1
    s_waitcnt lgkmcnt(6)
    v_smfmac_f32_16x16x64_bf16 v[80:83], v[52:55], a[224:231], v1
    v_smfmac_f32_16x16x64_bf16 v[32:35], v[48:51], a[232:239], v1
    buffer_load_dwordx4 v[12:15], v0, s[16:19], s66 offen offset:1024 sc1
    v_smfmac_f32_16x16x64_bf16 v[36:39], v[48:51], a[240:247], v1
    v_permlane32_swap_b32 v80, v82
    v_permlane32_swap_b32 v81, v83
    v_smfmac_f32_16x16x64_bf16 v[32:35], v[52:55], a[248:255], v1
    v_pk_add_f32 v[80:81], v[80:81], v[82:83]
    v_cvt_pk_bf16_f32 v82, v80, v81
    v_smfmac_f32_16x16x64_bf16 v[36:39], v[52:55], v[84:91], v1
    v_cvt_pk_bf16_f32 v81, v80, v81
    s_nop 1
    v_smfmac_f32_16x16x64_bf16 v[40:43], v[48:51], v[64:71], v1
    v_permlane32_swap_b32 v82, v81
    v_mov_b32 v80, v82
    s_waitcnt lgkmcnt(4)
    v_smfmac_f32_16x16x64_bf16 v[44:47], v[48:51], v[16:23], v1
    v_mov_b32 v83, v81
    s_nop 1
    s_waitcnt lgkmcnt(2)
    v_smfmac_f32_16x16x64_bf16 v[40:43], v[52:55], v[24:31], v1
    v_permlane16_swap_b32 v80, v82
    v_permlane16_swap_b32 v81, v83
    s_waitcnt lgkmcnt(0)
    v_smfmac_f32_16x16x64_bf16 v[44:47], v[52:55], v[56:63], v1
    v_and_or_b32 v80, v80, -2, s77
    v_permlane32_swap_b32 v32, v36
    v_permlane32_swap_b32 v33, v37
    v_permlane32_swap_b32 v34, v38
    v_permlane32_swap_b32 v35, v39
    v_pk_add_f32 v[32:33], v[32:33], v[36:37]
    v_pk_add_f32 v[34:35], v[34:35], v[38:39]
    v_cvt_pk_bf16_f32 v32, v32, v33
    v_cvt_pk_bf16_f32 v33, v34, v35
    v_permlane32_swap_b32 v40, v44
    v_permlane32_swap_b32 v41, v45
    v_permlane32_swap_b32 v42, v46
    v_permlane32_swap_b32 v43, v47
    v_pk_add_f32 v[40:41], v[40:41], v[44:45]
    v_pk_add_f32 v[42:43], v[42:43], v[46:47]
    v_and_or_b32 v32, v32, -2, s77
    v_cvt_pk_bf16_f32 v34, v40, v41
    v_cvt_pk_bf16_f32 v35, v42, v43
    buffer_store_dwordx4 v[32:35], v6, s[8:11], s57 offen sc1
    s_mov_b64 exec, 0xffff
    buffer_store_dwordx4 v[80:83], v6, s[8:11], s59 offen sc1
    s_mov_b64 exec, -1
    s_cmp_ge_u32 s39, 40
    s_cbranch_scc1 RN_51
    ds_read_b128 v[16:19], v2 offset:0
    ds_read_b128 v[20:23], v2 offset:1024
    ds_read_b128 v[24:27], v2 offset:2048
    ds_read_b128 v[28:31], v2 offset:3072
    buffer_load_dwordx4 v[56:59], v0, s[8:11], s60 offen offset:0 sc1
    buffer_load_dwordx4 v[60:63], v0, s[8:11], s60 offen offset:1024 sc1
    buffer_load_dwordx4 v[64:67], v0, s[8:11], s60 offen offset:2048 sc1
    buffer_load_dwordx4 v[68:71], v0, s[8:11], s60 offen offset:3072 sc1
    v_mov_b32 v32, 0
    v_mov_b32 v33, 0
    v_mov_b32 v34, 0
    v_mov_b32 v35, 0
    v_mov_b32 v36, 0
    v_mov_b32 v37, 0
    v_mov_b32 v38, 0
    v_mov_b32 v39, 0
    v_mov_b32 v40, 0
    v_mov_b32 v41, 0
    v_mov_b32 v42, 0
    v_mov_b32 v43, 0
    v_mov_b32 v44, 0
    v_mov_b32 v45, 0
    v_mov_b32 v46, 0
    v_mov_b32 v47, 0
    v_mov_b32 v48, 0
    v_mov_b32 v49, 0
    v_mov_b32 v50, 0
    v_mov_b32 v51, 0
    v_mov_b32 v52, 0
    v_mov_b32 v53, 0
    v_mov_b32 v54, 0
    v_mov_b32 v55, 0
    s_add_u32 s30, s36, s70
    s_add_u32 s31, s71, s70
    s_add_u32 s32, s37, s70
    s_add_u32 s33, s72, s70
    s_add_u32 s24, s24, 1
    s_add_u32 s67, s67, 131072
    s_add_u32 s44, s44, s45
    s_add_u32 s47, s47, 1
    s_add_u32 s3, s3, 512
    s_mov_b32 s73, 0
    v_mov_b32 v32, 0x3f80
    v_lshlrev_b32 v32, v0, v32
    v_cndmask_b32 v72, 0, v32, s[48:49]
    v_cndmask_b32 v73, 0, v32, s[50:51]
    v_cndmask_b32 v74, 0, v32, s[52:53]
    v_cndmask_b32 v75, 0, v32, s[54:55]
    v_and_b32 v33, 0x40, v0
    v_and_b32 v34, 0x30, v0
    v_lshl_add_u32 v34, v33, s61, v34
RP_52:
    buffer_load_dwordx4 v[76:79], v0, s[8:11], s60 offen offset:0 sc1
    buffer_load_dwordx4 v[80:83], v0, s[8:11], s60 offen offset:1024 sc1
    buffer_load_dwordx4 v[84:87], v0, s[8:11], s60 offen offset:2048 sc1
    buffer_load_dwordx4 v[88:91], v0, s[8:11], s60 offen offset:3072 sc1
    s_waitcnt vmcnt(4)
    v_mfma_f32_16x16x32_bf16 v[92:95], v[56:59], v[72:75], 0
    v_bitop3_b32 v32, v56, v60, s77 bitop3:0x7e
    v_bitop3_b32 v33, v64, v68, s77 bitop3:0x7e
    v_mfma_f32_16x16x32_bf16 v[92:95], v[60:63], v[72:75], v[92:95]
    v_bitop3_b32 v32, v32, 1, v33 bitop3:0xc8
    v_cmp_ne_u32 vcc, 0, v32
    v_mfma_f32_16x16x32_bf16 v[92:95], v[64:67], v[72:75], v[92:95]
    v_mfma_f32_16x16x32_bf16 v[92:95], v[68:71], v[72:75], v[92:95]
    s_cbranch_vccz RP_53
    buffer_load_dwordx4 v[56:59], v0, s[8:11], s60 offen offset:0 sc1
    buffer_load_dwordx4 v[60:63], v0, s[8:11], s60 offen offset:1024 sc1
    buffer_load_dwordx4 v[64:67], v0, s[8:11], s60 offen offset:2048 sc1
    buffer_load_dwordx4 v[68:71], v0, s[8:11], s60 offen offset:3072 sc1
    s_add_u32 s73, s73, 1
    s_cmp_gt_u32 s73, 131072
    s_cbranch_scc1 RD_5
    s_waitcnt vmcnt(4)
    v_mfma_f32_16x16x32_bf16 v[92:95], v[76:79], v[72:75], 0
    v_bitop3_b32 v32, v76, v80, s77 bitop3:0x7e
    v_bitop3_b32 v33, v84, v88, s77 bitop3:0x7e
    v_mfma_f32_16x16x32_bf16 v[92:95], v[80:83], v[72:75], v[92:95]
    v_bitop3_b32 v32, v32, 1, v33 bitop3:0xc8
    v_cmp_ne_u32 vcc, 0, v32
    v_mfma_f32_16x16x32_bf16 v[92:95], v[84:87], v[72:75], v[92:95]
    v_mfma_f32_16x16x32_bf16 v[92:95], v[88:91], v[72:75], v[92:95]
    s_cbranch_vccnz RP_52
RP_53:
    s_nop 6
    v_permlane32_swap_b32 v92, v94
    v_permlane32_swap_b32 v93, v95
    v_pk_add_f32 v[92:93], v[92:93], v[94:95]
    v_cvt_pk_bf16_f32 v94, v92, v93
    v_cvt_pk_bf16_f32 v93, v92, v93
    s_nop 1
    v_permlane32_swap_b32 v94, v93
    v_mov_b32 v92, v94
    v_mov_b32 v95, v93
    s_nop 1
    v_permlane16_swap_b32 v92, v94
    v_permlane16_swap_b32 v93, v95
    s_mov_b64 exec, 0xff
    buffer_store_dwordx4 v[92:95], v34, s[8:11], s34 offen sc1
    s_mov_b64 exec, -1
    s_branch RL_42
RG_50:
    buffer_load_dwordx4 v[76:79], v0, s[8:11], s32 offen sc1
    buffer_load_dwordx4 v[92:95], v0, s[8:11], s33 offen sc1
    s_add_u32 s73, s73, 1
    s_cmp_gt_u32 s73, 131072
    s_cbranch_scc1 RD_5
    s_waitcnt vmcnt(0)
    s_branch RG_49
RK_45:
    s_waitcnt vmcnt(0)
    v_lshlrev_b32 v60, 3, v0
    s_mov_b32 s56, 3149824
    buffer_load_dword v60, v60, s[8:11], s56 offen sc1
    s_add_u32 s73, s73, 1
    s_cmp_gt_u32 s73, 131072
    s_cbranch_scc1 RD_5
    s_waitcnt vmcnt(0)
    v_cmp_ne_u32 vcc, 32, v60
    s_nop 3
    s_ff1_i32_b64 s46, vcc
    s_cmp_gt_u32 s47, s46
    s_cbranch_scc1 RK_45
    s_branch RK_46
RG_48:
    buffer_load_dwordx4 v[56:59], v0, s[8:11], s30 offen sc1
    s_mov_b64 exec, 0xffff
    buffer_load_dwordx4 v[72:75], v0, s[8:11], s31 offen sc1
    s_mov_b64 exec, -1
    s_add_u32 s73, s73, 1
    s_cmp_gt_u32 s73, 131072
    s_cbranch_scc1 RD_5
    s_waitcnt vmcnt(0)
    s_branch RG_47
RN_51:
    ds_read_b128 v[16:19], v2 offset:0
    ds_read_b128 v[20:23], v2 offset:1024
    ds_read_b128 v[24:27], v2 offset:2048
    ds_read_b128 v[28:31], v2 offset:3072
    v_mov_b32 v32, 0
    v_mov_b32 v33, 0
    v_mov_b32 v34, 0
    v_mov_b32 v35, 0
    v_mov_b32 v36, 0
    v_mov_b32 v37, 0
    v_mov_b32 v38, 0
    v_mov_b32 v39, 0
    v_mov_b32 v40, 0
    v_mov_b32 v41, 0
    v_mov_b32 v42, 0
    v_mov_b32 v43, 0
    v_mov_b32 v44, 0
    v_mov_b32 v45, 0
    v_mov_b32 v46, 0
    v_mov_b32 v47, 0
    v_mov_b32 v48, 0
    v_mov_b32 v49, 0
    v_mov_b32 v50, 0
    v_mov_b32 v51, 0
    v_mov_b32 v52, 0
    v_mov_b32 v53, 0
    v_mov_b32 v54, 0
    v_mov_b32 v55, 0
    s_add_u32 s30, s36, s70
    s_add_u32 s31, s71, s70
    s_add_u32 s32, s37, s70
    s_add_u32 s33, s72, s70
    s_add_u32 s24, s24, 1
    s_add_u32 s67, s67, 131072
    s_add_u32 s44, s44, s45
    s_add_u32 s47, s47, 1
    s_add_u32 s3, s3, 512
    s_mov_b32 s73, 0
    s_branch RL_42
RF_43:
    v_add_u32 v72, s75, v4
    ds_read_b128 v[72:75], v72
    s_waitcnt lgkmcnt(0)
    buffer_store_dwordx4 v[72:75], v0, s[20:23], s67 offen sc1
    s_waitcnt vmcnt(0) lgkmcnt(0)
    s_barrier
    s_add_u32 s3, s3, 512
    s_mov_b64 exec, s[4:5]
    buffer_atomic_add v1, off, s[8:11], s3 sc1
    s_mov_b64 exec, -1
    s_branch RD_5
RV_17:
RK_56:
    s_waitcnt vmcnt(0)
    v_lshlrev_b32 v60, 3, v0
    s_mov_b32 s56, 3149824
    buffer_load_dword v60, v60, s[8:11], s56 offen sc1
    s_add_u32 s73, s73, 1
    s_cmp_gt_u32 s73, 131072
    s_cbranch_scc1 RD_5
    s_waitcnt vmcnt(0)
    v_cmp_ne_u32 vcc, 32, v60
    s_nop 3
    s_ff1_i32_b64 s46, vcc
    s_cmp_gt_u32 s47, s46
    s_cbranch_scc1 RK_56
    s_lshl_b32 m0, s27, 10
    s_add_u32 s69, s65, 131072
    s_add_u32 s66, s65, s68
    buffer_load_dwordx4 v0, s[12:15], s65 offen sc1 lds
    s_add_u32 m0, m0, 4096
    buffer_load_dwordx4 v[8:11], v0, s[16:19], s66 offen sc1
    buffer_load_dwordx4 v0, s[12:15], s69 offen sc1 lds
    buffer_load_dwordx4 v[12:15], v0, s[16:19], s66 offen offset:1024 sc1
RL_54:
    s_cmp_gt_u32 s47, s46
    s_cbranch_scc1 RK_57
RK_58:
    s_barrier
    s_mov_b32 s25, s35
    s_and_b32 s56, s24, 1
    s_mul_i32 s56, s56, 327680
    s_add_u32 s57, s63, s56
    s_add_u32 s59, s74, s56
    s_add_u32 s60, s64, s56
    s_bfe_u32 s77, s24, 0x10001
    s_add_u32 s56, s24, 1
    s_mul_i32 s70, s56, 20480
    s_add_u32 s34, s62, s70
    s_add_u32 s35, s34, 5120
    s_add_u32 s65, s65, 262144
    s_lshl_b32 m0, s27, 10
    s_add_u32 s69, s65, 131072
    s_add_u32 s66, s65, s68
    s_nop 15
    buffer_load_dwordx4 v[56:59], v0, s[8:11], s30 offen sc1
    s_mov_b64 exec, 0xffff
    buffer_load_dwordx4 v[72:75], v0, s[8:11], s31 offen sc1
    s_mov_b64 exec, -1
    s_mov_b64 exec, 0xff
    buffer_store_dwordx4 v[92:95], v34, s[8:11], s25 offen sc1
    s_mov_b64 exec, -1
    v_mov_b32 v32, 0
    v_mov_b32 v33, 0
    v_mov_b32 v34, 0
    v_add_u32 v95, s29, v0
    s_waitcnt vmcnt(1) lgkmcnt(0)
RG_59:
    v_max_u32 v60, v56, v72
    v_cmp_eq_u32 vcc, -1, v60
    s_cbranch_vccnz RG_60
    ds_write_b128 v7, v[56:59]
    s_mov_b64 exec, 0xffff
    ds_write_b128 v95, v[72:75]
    s_mov_b64 exec, -1
    v_smfmac_f32_16x16x64_bf16 v[32:35], v[56:59], v[16:23], v1
    ds_read_b128 v[16:19], v2 offset:4096
    ds_read_b128 v[20:23], v2 offset:5120
    v_xor_b32 v60, 1024, v7
    v_xor_b32 v64, 2048, v7
    v_smfmac_f32_16x16x64_bf16 v[36:39], v[56:59], v[24:31], v1
    ds_read_b128 v[24:27], v2 offset:6144
    ds_read_b128 v[28:31], v2 offset:7168
    v_xor_b32 v68, 3072, v7
    s_waitcnt lgkmcnt(4)
    s_barrier
    ds_read_b128 v[72:75], v0 offset:8192
    ds_read_b128 v[60:63], v60
    ds_read_b128 v[64:67], v64
    ds_read_b128 v[68:71], v68
    v_smfmac_f32_16x16x64_bf16 v[40:43], v[56:59], v[96:103], v1
    buffer_load_dwordx4 v[76:79], v0, s[8:11], s32 offen sc1
    v_smfmac_f32_16x16x64_bf16 v[44:47], v[56:59], v[104:111], v1
    buffer_load_dwordx4 v[92:95], v0, s[8:11], s33 offen sc1
    v_smfmac_f32_16x16x64_bf16 v[48:51], v[56:59], v[112:119], v1
    v_smfmac_f32_16x16x64_bf16 v[52:55], v[56:59], v[120:127], v1
    s_waitcnt lgkmcnt(3)
    v_smfmac_f32_16x16x64_bf16 v[32:35], v[72:75], v[128:135], v1
    v_smfmac_f32_16x16x64_bf16 v[36:39], v[72:75], v[136:143], v1
    v_smfmac_f32_16x16x64_bf16 v[40:43], v[72:75], v[144:151], v1
    v_smfmac_f32_16x16x64_bf16 v[44:47], v[72:75], v[152:159], v1
    v_smfmac_f32_16x16x64_bf16 v[48:51], v[72:75], v[16:23], v1
    ds_read_b128 v[16:19], v2 offset:8192
    ds_read_b128 v[20:23], v2 offset:9216
    v_smfmac_f32_16x16x64_bf16 v[52:55], v[72:75], v[24:31], v1
    ds_read_b128 v[24:27], v2 offset:10240
    ds_read_b128 v[28:31], v2 offset:11264
    s_waitcnt lgkmcnt(6)
    v_smfmac_f32_16x16x64_bf16 v[32:35], v[60:63], v[160:167], v1
    v_smfmac_f32_16x16x64_bf16 v[36:39], v[60:63], v[168:175], v1
    v_smfmac_f32_16x16x64_bf16 v[40:43], v[60:63], v[176:183], v1
    v_smfmac_f32_16x16x64_bf16 v[44:47], v[60:63], v[184:191], v1
    s_waitcnt lgkmcnt(5)
    v_smfmac_f32_16x16x64_bf16 v[32:35], v[64:67], v[192:199], v1
    v_smfmac_f32_16x16x64_bf16 v[36:39], v[64:67], v[200:207], v1
    v_smfmac_f32_16x16x64_bf16 v[40:43], v[64:67], v[208:215], v1
    v_smfmac_f32_16x16x64_bf16 v[44:47], v[64:67], v[216:223], v1
    s_waitcnt lgkmcnt(4)
    s_waitcnt lgkmcnt(2)
    v_smfmac_f32_16x16x64_bf16 v[32:35], v[68:71], v[16:23], v1
    ds_read_b128 v[16:19], v2 offset:12288
    ds_read_b128 v[20:23], v2 offset:13312
    s_waitcnt lgkmcnt(2)
    v_smfmac_f32_16x16x64_bf16 v[36:39], v[68:71], v[24:31], v1
    ds_read_b128 v[24:27], v2 offset:14336
    ds_read_b128 v[28:31], v2 offset:15360
    s_barrier
    v_smfmac_f32_16x16x64_bf16 v[40:43], v[68:71], v[224:231], v1
    v_smfmac_f32_16x16x64_bf16 v[44:47], v[68:71], v[232:239], v1
    v_smfmac_f32_16x16x64_bf16 v[48:51], v[60:63], v[240:247], v1
    v_smfmac_f32_16x16x64_bf16 v[52:55], v[60:63], v[248:255], v1
    ds_read_b128 v[56:59], v2 offset:16384
    ds_read_b128 v[60:63], v2 offset:17408
    v_smfmac_f32_16x16x64_bf16 v[48:51], v[64:67], a[0:7], v1
    v_smfmac_f32_16x16x64_bf16 v[52:55], v[64:67], a[8:15], v1
    v_smfmac_f32_16x16x64_bf16 v[48:51], v[68:71], a[16:23], v1
    v_smfmac_f32_16x16x64_bf16 v[52:55], v[68:71], a[24:31], v1
    ds_read_b128 v[64:67], v2 offset:18432
    ds_read_b128 v[68:71], v2 offset:19456
    s_waitcnt vmcnt(0)
RG_61:
    v_max_u32 v72, v76, v92
    v_cmp_eq_u32 vcc, -1, v72
    s_cbranch_vccnz RG_62
    ds_write_b128 v7, v[76:79]
    s_waitcnt lgkmcnt(7)
    v_smfmac_f32_16x16x64_bf16 v[32:35], v[76:79], v[16:23], v1
    ds_read_b128 v[16:19], v2 offset:20480
    ds_read_b128 v[20:23], v2 offset:21504
    v_xor_b32 v80, 1024, v7
    v_xor_b32 v84, 2048, v7
    s_waitcnt lgkmcnt(7)
    v_smfmac_f32_16x16x64_bf16 v[36:39], v[76:79], v[24:31], v1
    ds_read_b128 v[24:27], v2 offset:22528
    ds_read_b128 v[28:31], v2 offset:23552
    v_xor_b32 v88, 3072, v7
    s_waitcnt lgkmcnt(4)
    s_barrier
    ds_read_b128 v[80:83], v80
    ds_read_b128 v[84:87], v84
    ds_read_b128 v[88:91], v88
    v_smfmac_f32_16x16x64_bf16 v[40:43], v[76:79], a[32:39], v1
    v_smfmac_f32_16x16x64_bf16 v[44:47], v[76:79], v[56:63], v1
    ds_read_b128 v[56:59], v2 offset:24576
    ds_read_b128 v[60:63], v2 offset:25600
    v_smfmac_f32_16x16x64_bf16 v[32:35], v[92:95], a[40:47], v1
    v_smfmac_f32_16x16x64_bf16 v[36:39], v[92:95], a[48:55], v1
    v_smfmac_f32_16x16x64_bf16 v[40:43], v[92:95], a[56:63], v1
    v_smfmac_f32_16x16x64_bf16 v[44:47], v[92:95], v[64:71], v1
    v_smfmac_f32_16x16x64_bf16 v[48:51], v[92:95], a[64:71], v1
    ds_read_b128 v[64:67], v0 offset:6144
    ds_read_b128 v[68:71], v0 offset:7168
    v_smfmac_f32_16x16x64_bf16 v[52:55], v[92:95], a[72:79], v1
    s_waitcnt lgkmcnt(6)
    v_smfmac_f32_16x16x64_bf16 v[32:35], v[80:83], v[16:23], v1
    v_lshlrev_b32 v94, 3, v0
    buffer_load_dword v94, v94, s[40:43], s44 offen sc1
    v_smfmac_f32_16x16x64_bf16 v[36:39], v[80:83], v[24:31], v1
    ds_read_b128 v[16:19], v0 offset:0
    ds_read_b128 v[20:23], v0 offset:1024
    ds_read_b128 v[24:27], v0 offset:2048
    ds_read_b128 v[28:31], v0 offset:3072
    s_waitcnt lgkmcnt(9)
    v_smfmac_f32_16x16x64_bf16 v[32:35], v[84:87], a[80:87], v1
    s_waitcnt lgkmcnt(6)
    v_smfmac_f32_16x16x64_bf16 v[36:39], v[84:87], v[56:63], v1
    v_smfmac_f32_16x16x64_bf16 v[32:35], v[88:91], a[88:95], v1
    ds_read_b128 v[56:59], v0 offset:4096
    ds_read_b128 v[60:63], v0 offset:5120
    v_smfmac_f32_16x16x64_bf16 v[36:39], v[88:91], a[96:103], v1
    v_smfmac_f32_16x16x64_bf16 v[40:43], v[80:83], a[104:111], v1
    s_mov_b64 exec, s[4:5]
    buffer_atomic_add v1, off, s[8:11], s3 sc1
    s_mov_b64 exec, -1
    v_smfmac_f32_16x16x64_bf16 v[44:47], v[80:83], a[112:119], v1
    v_smfmac_f32_16x16x64_bf16 v[40:43], v[84:87], a[120:127], v1
    v_permlane32_swap_b32 v32, v33
    v_permlane32_swap_b32 v34, v35
    v_smfmac_f32_16x16x64_bf16 v[44:47], v[84:87], a[128:135], v1
    v_permlane32_swap_b32 v36, v37
    v_permlane32_swap_b32 v38, v39
    v_smfmac_f32_16x16x64_bf16 v[40:43], v[88:91], a[136:143], v1
    v_add_f32 v32, v32, v33
    v_add_f32 v34, v34, v35
    v_smfmac_f32_16x16x64_bf16 v[44:47], v[88:91], a[144:151], v1
    v_add_f32 v36, v36, v37
    v_add_f32 v38, v38, v39
    v_smfmac_f32_16x16x64_bf16 v[48:51], v[76:79], a[152:159], v1
    v_cvt_pk_bf16_f32 v72, v32, v36
    v_cvt_pk_bf16_f32 v74, v34, v38
    v_smfmac_f32_16x16x64_bf16 v[52:55], v[76:79], a[160:167], v1
    v_smfmac_f32_16x16x64_bf16 v[48:51], v[80:83], a[168:175], v1
    v_permlane32_swap_b32 v40, v41
    v_permlane32_swap_b32 v42, v43
    v_permlane32_swap_b32 v44, v45
    v_permlane32_swap_b32 v46, v47
    v_smfmac_f32_16x16x64_bf16 v[52:55], v[80:83], a[176:183], v1
    v_add_f32 v40, v40, v41
    v_add_f32 v42, v42, v43
    v_add_f32 v44, v44, v45
    v_add_f32 v46, v46, v47
    v_smfmac_f32_16x16x64_bf16 v[48:51], v[84:87], a[184:191], v1
    v_cvt_pk_bf16_f32 v73, v40, v44
    v_cvt_pk_bf16_f32 v75, v42, v46
    ds_write_b64 v3, v[72:73]
    ds_write_b64 v3, v[74:75] offset:32
    v_smfmac_f32_16x16x64_bf16 v[52:55], v[84:87], a[192:199], v1
    s_waitcnt lgkmcnt(0)
    s_barrier
    ds_read_b128 v[32:35], v4 offset:8192
    ds_read_b128 v[36:39], v4 offset:8704
    ds_read_b128 v[40:43], v4 offset:9216
    ds_read_b128 v[44:47], v4 offset:9728
    v_smfmac_f32_16x16x64_bf16 v[48:51], v[88:91], a[200:207], v1
    ds_read_b128 v[76:79], v4 offset:10240
    ds_read_b128 v[80:83], v4 offset:10752
    ds_read_b128 v[84:87], v4 offset:11264
    v_smfmac_f32_16x16x64_bf16 v[52:55], v[88:91], a[208:215], v1
    ds_read_b128 v[88:91], v4 offset:11776
    s_cmp_eq_u32 s24, 63
    s_cbranch_scc1 RF_55
    s_waitcnt lgkmcnt(7)
    v_mfma_f32_16x16x32_bf16 v[16:19], v[16:19], v[32:35], 0
    v_mfma_f32_16x16x32_bf16 v[56:59], v[56:59], v[32:35], 0
    s_waitcnt lgkmcnt(6)
    v_mfma_f32_16x16x32_bf16 v[16:19], v[20:23], v[36:39], v[16:19]
    v_mfma_f32_16x16x32_bf16 v[56:59], v[60:63], v[36:39], v[56:59]
    buffer_load_dwordx4 v0, s[12:15], s65 offen sc1 lds
    s_add_u32 m0, m0, 4096
    s_waitcnt lgkmcnt(5)
    v_mfma_f32_16x16x32_bf16 v[16:19], v[24:27], v[40:43], v[16:19]
    v_mfma_f32_16x16x32_bf16 v[56:59], v[64:67], v[40:43], v[56:59]
    v_cvt_pk_bf16_f32 v72, v48, v49
    v_cvt_pk_bf16_f32 v73, v50, v51
    s_waitcnt lgkmcnt(4)
    v_mfma_f32_16x16x32_bf16 v[16:19], v[28:31], v[44:47], v[16:19]
    v_mfma_f32_16x16x32_bf16 v[56:59], v[68:71], v[44:47], v[56:59]
    v_cvt_pk_bf16_f32 v74, v52, v53
    v_cvt_pk_bf16_f32 v75, v54, v55
    s_waitcnt lgkmcnt(0)
    v_mfma_f32_16x16x32_bf16 v[76:79], v[76:79], v[32:35], 0
    v_mov_b32 v26, 0x3f003f00
    v_mov_b32 v27, 0x3f003f00
    v_mfma_f32_16x16x32_bf16 v[76:79], v[80:83], v[36:39], v[76:79]
    v_mov_b32 v28, 0x3f803f80
    v_mov_b32 v29, 0x3f803f80
    v_mfma_f32_16x16x32_bf16 v[76:79], v[84:87], v[40:43], v[76:79]
    v_max3_f32 v92, v16, v17, v18
    v_max3_f32 v93, v56, v57, v58
    v_mfma_f32_16x16x32_bf16 v[76:79], v[88:91], v[44:47], v[76:79]
    v_max3_f32 v92, v92, v19, v59
    v_mov_b32 v30, 0x3f803f80
    v_mov_b32 v31, 0x3f803f80
    ds_read_b128 v[64:67], v2 offset:28672
    ds_read_b128 v[68:71], v2 offset:29696
    ds_read_b128 v[84:87], v2 offset:26624
    ds_read_b128 v[88:91], v2 offset:27648
    s_nop 0
    v_max3_f32 v93, v93, v76, v77
    v_max3_f32 v92, v92, v78, v79
    v_max_f32 v92, v92, v93
    v_mov_b32 v93, v92
    s_waitcnt lgkmcnt(4)
    buffer_store_dwordx4 v[72:75], v0, s[20:23], s67 offen sc1
    v_permlane32_swap_b32 v92, v93
    v_max_f32 v92, v92, v93
    v_mov_b32 v93, v92
    s_nop 1
    v_permlane16_swap_b32 v92, v93
    v_max_f32 v92, v92, v93
    v_mul_f32 v92, s76, v92
    v_fma_f32 v16, v16, s76, -v92
    v_fma_f32 v17, v17, s76, -v92
    v_fma_f32 v18, v18, s76, -v92
    v_fma_f32 v19, v19, s76, -v92
    v_exp_f32 v16, v16
    v_exp_f32 v17, v17
    v_exp_f32 v18, v18
    v_exp_f32 v19, v19
    v_cvt_pk_bf16_f32 v20, v16, v17
    v_cvt_pk_bf16_f32 v21, v18, v19
    v_fma_f32 v56, v56, s76, -v92
    v_fma_f32 v57, v57, s76, -v92
    v_fma_f32 v58, v58, s76, -v92
    v_fma_f32 v59, v59, s76, -v92
    v_exp_f32 v56, v56
    v_exp_f32 v57, v57
    v_exp_f32 v58, v58
    v_exp_f32 v59, v59
    v_cvt_pk_bf16_f32 v22, v56, v57
    v_cvt_pk_bf16_f32 v23, v58, v59
    v_fma_f32 v76, v76, s76, -v92
    v_fma_f32 v77, v77, s76, -v92
    v_fma_f32 v78, v78, s76, -v92
    v_fma_f32 v79, v79, s76, -v92
    v_mfma_f32_16x16x32_bf16 v[60:63], v[28:31], v[20:23], 0
    v_exp_f32 v76, v76
    v_mfma_f32_16x16x32_bf16 v[48:51], v[8:11], v[20:23], 0
    v_exp_f32 v77, v77
    v_mfma_f32_16x16x32_bf16 v[52:55], v[12:15], v[20:23], 0
    v_exp_f32 v78, v78
    v_exp_f32 v79, v79
    v_cvt_pk_bf16_f32 v24, v76, v77
    v_cvt_pk_bf16_f32 v25, v78, v79
    s_nop 1
    v_mfma_f32_16x16x16_bf16 v[60:63], v[26:27], v[24:25], v[60:63]
    buffer_load_dwordx4 v0, s[12:15], s69 offen sc1 lds
    v_mfma_f32_16x16x16_bf16 v[48:51], v[72:73], v[24:25], v[48:51]
    v_mfma_f32_16x16x16_bf16 v[52:55], v[74:75], v[24:25], v[52:55]
    v_mov_b32 v32, 0
    v_mov_b32 v33, 0
    v_mov_b32 v34, 0
    v_mov_b32 v35, 0
    v_mov_b32 v36, 0
    v_mov_b32 v37, 0
    v_rcp_f32 v92, v60
    v_mov_b32 v38, 0
    v_mul_f32 v48, v48, v92
    v_mul_f32 v49, v49, v92
    v_mul_f32 v50, v50, v92
    v_mul_f32 v51, v51, v92
    v_mul_f32 v52, v52, v92
    v_cvt_pk_bf16_f32 v76, v48, v52
    v_mul_f32 v53, v53, v92
    v_cvt_pk_bf16_f32 v77, v49, v53
    v_mul_f32 v54, v54, v92
    v_cvt_pk_bf16_f32 v78, v50, v54
    v_mul_f32 v55, v55, v92
    v_cvt_pk_bf16_f32 v79, v51, v55
    ds_write_b128 v5, v[76:79]
    v_mov_b32 v80, 0
    v_mov_b32 v81, 0
    v_mov_b32 v82, 0
    v_mov_b32 v83, 0
    v_mov_b32 v39, 0
    v_mov_b32 v40, 0
    v_mov_b32 v41, 0
    v_mov_b32 v42, 0
    v_mov_b32 v43, 0
    v_mov_b32 v44, 0
    v_mov_b32 v45, 0
    v_mov_b32 v46, 0
    v_mov_b32 v47, 0
    s_waitcnt lgkmcnt(0)
    s_barrier
    ds_read_b128 v[48:51], v0 offset:12288
    ds_read_b128 v[52:55], v0 offset:13312
    ds_read_b128 v[16:19], v2 offset:30720
    ds_read_b128 v[20:23], v2 offset:31744
    ds_read_b128 v[24:27], v2 offset:32768
    ds_read_b128 v[28:31], v2 offset:33792
    ds_read_b128 v[56:59], v2 offset:34816
    ds_read_b128 v[60:63], v2 offset:35840
    buffer_load_dwordx4 v[8:11], v0, s[16:19], s66 offen sc1
    s_waitcnt lgkmcnt(7)
    v_smfmac_f32_16x16x64_bf16 v[80:83], v[48:51], a[216:223], v1
    s_waitcnt lgkmcnt(6)
    v_smfmac_f32_16x16x64_bf16 v[80:83], v[52:55], a[224:231], v1
    v_smfmac_f32_16x16x64_bf16 v[32:35], v[48:51], a[232:239], v1
    buffer_load_dwordx4 v[12:15], v0, s[16:19], s66 offen offset:1024 sc1
    v_smfmac_f32_16x16x64_bf16 v[36:39], v[48:51], a[240:247], v1
    v_permlane32_swap_b32 v80, v82
    v_permlane32_swap_b32 v81, v83
    v_smfmac_f32_16x16x64_bf16 v[32:35], v[52:55], a[248:255], v1
    v_pk_add_f32 v[80:81], v[80:81], v[82:83]
    v_cvt_pk_bf16_f32 v82, v80, v81
    v_smfmac_f32_16x16x64_bf16 v[36:39], v[52:55], v[84:91], v1
    v_cvt_pk_bf16_f32 v81, v80, v81
    s_nop 1
    v_smfmac_f32_16x16x64_bf16 v[40:43], v[48:51], v[64:71], v1
    v_permlane32_swap_b32 v82, v81
    v_mov_b32 v80, v82
    s_waitcnt lgkmcnt(4)
    v_smfmac_f32_16x16x64_bf16 v[44:47], v[48:51], v[16:23], v1
    v_mov_b32 v83, v81
    s_nop 1
    s_waitcnt lgkmcnt(2)
    v_smfmac_f32_16x16x64_bf16 v[40:43], v[52:55], v[24:31], v1
    v_permlane16_swap_b32 v80, v82
    v_permlane16_swap_b32 v81, v83
    s_waitcnt lgkmcnt(0)
    v_smfmac_f32_16x16x64_bf16 v[44:47], v[52:55], v[56:63], v1
    v_and_or_b32 v80, v80, -2, s77
    v_permlane32_swap_b32 v32, v36
    v_permlane32_swap_b32 v33, v37
    v_permlane32_swap_b32 v34, v38
    v_permlane32_swap_b32 v35, v39
    v_pk_add_f32 v[32:33], v[32:33], v[36:37]
    v_pk_add_f32 v[34:35], v[34:35], v[38:39]
    v_cvt_pk_bf16_f32 v32, v32, v33
    v_cvt_pk_bf16_f32 v33, v34, v35
    v_permlane32_swap_b32 v40, v44
    v_permlane32_swap_b32 v41, v45
    v_permlane32_swap_b32 v42, v46
    v_permlane32_swap_b32 v43, v47
    v_pk_add_f32 v[40:41], v[40:41], v[44:45]
    v_pk_add_f32 v[42:43], v[42:43], v[46:47]
    v_and_or_b32 v32, v32, -2, s77
    v_cvt_pk_bf16_f32 v34, v40, v41
    v_cvt_pk_bf16_f32 v35, v42, v43
    buffer_store_dwordx4 v[32:35], v6, s[8:11], s57 offen sc1
    s_mov_b64 exec, 0xffff
    buffer_store_dwordx4 v[80:83], v6, s[8:11], s59 offen sc1
    s_mov_b64 exec, -1
    s_cmp_ge_u32 s39, 40
    s_cbranch_scc1 RN_63
    ds_read_b128 v[16:19], v2 offset:0
    ds_read_b128 v[20:23], v2 offset:1024
    ds_read_b128 v[24:27], v2 offset:2048
    ds_read_b128 v[28:31], v2 offset:3072
    buffer_load_dwordx4 v[56:59], v0, s[8:11], s60 offen offset:0 sc1
    buffer_load_dwordx4 v[60:63], v0, s[8:11], s60 offen offset:1024 sc1
    buffer_load_dwordx4 v[64:67], v0, s[8:11], s60 offen offset:2048 sc1
    buffer_load_dwordx4 v[68:71], v0, s[8:11], s60 offen offset:3072 sc1
    v_mov_b32 v32, 0
    v_mov_b32 v33, 0
    v_mov_b32 v34, 0
    v_mov_b32 v35, 0
    v_mov_b32 v36, 0
    v_mov_b32 v37, 0
    v_mov_b32 v38, 0
    v_mov_b32 v39, 0
    v_mov_b32 v40, 0
    v_mov_b32 v41, 0
    v_mov_b32 v42, 0
    v_mov_b32 v43, 0
    v_mov_b32 v44, 0
    v_mov_b32 v45, 0
    v_mov_b32 v46, 0
    v_mov_b32 v47, 0
    v_mov_b32 v48, 0
    v_mov_b32 v49, 0
    v_mov_b32 v50, 0
    v_mov_b32 v51, 0
    v_mov_b32 v52, 0
    v_mov_b32 v53, 0
    v_mov_b32 v54, 0
    v_mov_b32 v55, 0
    s_add_u32 s30, s36, s70
    s_add_u32 s31, s71, s70
    s_add_u32 s32, s37, s70
    s_add_u32 s33, s72, s70
    s_add_u32 s24, s24, 1
    s_add_u32 s67, s67, 131072
    s_add_u32 s44, s44, s45
    s_add_u32 s47, s47, 1
    s_add_u32 s3, s3, 512
    s_mov_b32 s73, 0
    v_mov_b32 v32, 0x3f80
    v_lshlrev_b32 v32, v0, v32
    v_cndmask_b32 v72, 0, v32, s[48:49]
    v_cndmask_b32 v73, 0, v32, s[50:51]
    v_cndmask_b32 v74, 0, v32, s[52:53]
    v_cndmask_b32 v75, 0, v32, s[54:55]
    v_and_b32 v33, 0x40, v0
    v_and_b32 v34, 0x30, v0
    v_lshl_add_u32 v34, v33, s61, v34
RP_64:
    buffer_load_dwordx4 v[76:79], v0, s[8:11], s60 offen offset:0 sc1
    buffer_load_dwordx4 v[80:83], v0, s[8:11], s60 offen offset:1024 sc1
    buffer_load_dwordx4 v[84:87], v0, s[8:11], s60 offen offset:2048 sc1
    buffer_load_dwordx4 v[88:91], v0, s[8:11], s60 offen offset:3072 sc1
    s_waitcnt vmcnt(4)
    v_mfma_f32_16x16x32_bf16 v[92:95], v[56:59], v[72:75], 0
    v_bitop3_b32 v32, v56, v60, s77 bitop3:0x7e
    v_bitop3_b32 v33, v64, v68, s77 bitop3:0x7e
    v_mfma_f32_16x16x32_bf16 v[92:95], v[60:63], v[72:75], v[92:95]
    v_bitop3_b32 v32, v32, 1, v33 bitop3:0xc8
    v_cmp_ne_u32 vcc, 0, v32
    v_mfma_f32_16x16x32_bf16 v[92:95], v[64:67], v[72:75], v[92:95]
    v_mfma_f32_16x16x32_bf16 v[92:95], v[68:71], v[72:75], v[92:95]
    s_cbranch_vccz RP_65
    buffer_load_dwordx4 v[56:59], v0, s[8:11], s60 offen offset:0 sc1
    buffer_load_dwordx4 v[60:63], v0, s[8:11], s60 offen offset:1024 sc1
    buffer_load_dwordx4 v[64:67], v0, s[8:11], s60 offen offset:2048 sc1
    buffer_load_dwordx4 v[68:71], v0, s[8:11], s60 offen offset:3072 sc1
    s_add_u32 s73, s73, 1
    s_cmp_gt_u32 s73, 131072
    s_cbranch_scc1 RD_5
    s_waitcnt vmcnt(4)
    v_mfma_f32_16x16x32_bf16 v[92:95], v[76:79], v[72:75], 0
    v_bitop3_b32 v32, v76, v80, s77 bitop3:0x7e
    v_bitop3_b32 v33, v84, v88, s77 bitop3:0x7e
    v_mfma_f32_16x16x32_bf16 v[92:95], v[80:83], v[72:75], v[92:95]
    v_bitop3_b32 v32, v32, 1, v33 bitop3:0xc8
    v_cmp_ne_u32 vcc, 0, v32
    v_mfma_f32_16x16x32_bf16 v[92:95], v[84:87], v[72:75], v[92:95]
    v_mfma_f32_16x16x32_bf16 v[92:95], v[88:91], v[72:75], v[92:95]
    s_cbranch_vccnz RP_64
RP_65:
    s_nop 6
    v_permlane32_swap_b32 v92, v94
    v_permlane32_swap_b32 v93, v95
    v_pk_add_f32 v[92:93], v[92:93], v[94:95]
    v_cvt_pk_bf16_f32 v94, v92, v93
    v_cvt_pk_bf16_f32 v93, v92, v93
    s_nop 1
    v_permlane32_swap_b32 v94, v93
    v_mov_b32 v92, v94
    v_mov_b32 v95, v93
    s_nop 1
    v_permlane16_swap_b32 v92, v94
    v_permlane16_swap_b32 v93, v95
    s_mov_b64 exec, 0xff
    buffer_store_dwordx4 v[92:95], v34, s[8:11], s34 offen sc1
    s_mov_b64 exec, -1
    s_branch RL_54
RG_62:
    buffer_load_dwordx4 v[76:79], v0, s[8:11], s32 offen sc1
    buffer_load_dwordx4 v[92:95], v0, s[8:11], s33 offen sc1
    s_add_u32 s73, s73, 1
    s_cmp_gt_u32 s73, 131072
    s_cbranch_scc1 RD_5
    s_waitcnt vmcnt(0)
    s_branch RG_61
RK_57:
    s_waitcnt vmcnt(0)
    v_lshlrev_b32 v60, 3, v0
    s_mov_b32 s56, 3149824
    buffer_load_dword v60, v60, s[8:11], s56 offen sc1
    s_add_u32 s73, s73, 1
    s_cmp_gt_u32 s73, 131072
    s_cbranch_scc1 RD_5
    s_waitcnt vmcnt(0)
    v_cmp_ne_u32 vcc, 32, v60
    s_nop 3
    s_ff1_i32_b64 s46, vcc
    s_cmp_gt_u32 s47, s46
    s_cbranch_scc1 RK_57
    s_branch RK_58
RG_60:
    buffer_load_dwordx4 v[56:59], v0, s[8:11], s30 offen sc1
    s_mov_b64 exec, 0xffff
    buffer_load_dwordx4 v[72:75], v0, s[8:11], s31 offen sc1
    s_mov_b64 exec, -1
    s_add_u32 s73, s73, 1
    s_cmp_gt_u32 s73, 131072
    s_cbranch_scc1 RD_5
    s_waitcnt vmcnt(0)
    s_branch RG_59
RN_63:
    ds_read_b128 v[16:19], v2 offset:0
    ds_read_b128 v[20:23], v2 offset:1024
    ds_read_b128 v[24:27], v2 offset:2048
    ds_read_b128 v[28:31], v2 offset:3072
    v_mov_b32 v32, 0
    v_mov_b32 v33, 0
    v_mov_b32 v34, 0
    v_mov_b32 v35, 0
    v_mov_b32 v36, 0
    v_mov_b32 v37, 0
    v_mov_b32 v38, 0
    v_mov_b32 v39, 0
    v_mov_b32 v40, 0
    v_mov_b32 v41, 0
    v_mov_b32 v42, 0
    v_mov_b32 v43, 0
    v_mov_b32 v44, 0
    v_mov_b32 v45, 0
    v_mov_b32 v46, 0
    v_mov_b32 v47, 0
    v_mov_b32 v48, 0
    v_mov_b32 v49, 0
    v_mov_b32 v50, 0
    v_mov_b32 v51, 0
    v_mov_b32 v52, 0
    v_mov_b32 v53, 0
    v_mov_b32 v54, 0
    v_mov_b32 v55, 0
    s_add_u32 s30, s36, s70
    s_add_u32 s31, s71, s70
    s_add_u32 s32, s37, s70
    s_add_u32 s33, s72, s70
    s_add_u32 s24, s24, 1
    s_add_u32 s67, s67, 131072
    s_add_u32 s44, s44, s45
    s_add_u32 s47, s47, 1
    s_add_u32 s3, s3, 512
    s_mov_b32 s73, 0
    s_branch RL_54
RF_55:
    s_nop 7
    v_cvt_pk_bf16_f32 v72, v48, v49
    v_cvt_pk_bf16_f32 v73, v50, v51
    v_cvt_pk_bf16_f32 v74, v52, v53
    v_cvt_pk_bf16_f32 v75, v54, v55
    buffer_store_dwordx4 v[72:75], v0, s[20:23], s67 offen sc1
    s_waitcnt vmcnt(0) lgkmcnt(0)
    s_barrier
    s_add_u32 s3, s3, 512
    s_mov_b64 exec, s[4:5]
    buffer_atomic_add v1, off, s[8:11], s3 sc1
    s_mov_b64 exec, -1
    s_branch RD_5
RD_5:
    s_endpgm
RW_13:
    s_load_dwordx2 s[4:5], s[0:1], 96
    s_waitcnt lgkmcnt(0)
    s_add_u32 s8, s4, 0x8300000
    s_addc_u32 s9, s5, 0
    s_and_b32 s9, s9, 0xffff
    s_mov_b32 s10, 0x10000
    s_mov_b32 s11, 0x20000
    v_mov_b32 v3, 131072
    v_cmp_eq_u32 vcc, 0, v0
    s_and_b64 exec, exec, vcc
    s_cbranch_execz RW_66
    v_mov_b32 v2, 1
    buffer_atomic_add v2, off, s[8:11], 0 offset:1408 sc0 sc1
    s_waitcnt vmcnt(0)
    ds_write_b32 v3, v2
    s_waitcnt lgkmcnt(0)
RW_66:
    s_mov_b64 exec, -1
    s_barrier
    ds_read_b32 v2, v3
    s_waitcnt lgkmcnt(0)
    v_readfirstlane_b32 s2, v2
    s_barrier
    s_cmp_ge_u32 s2, 192
    s_cbranch_scc1 RW_67
    s_add_u32 s2, s2, 64
    s_cmp_ge_u32 s2, 192
    s_cselect_b32 s3, 192, 0
    s_sub_u32 s2, s2, s3
    s_lshr_b32 s3, s2, 6
    s_lshl_b32 s4, s3, 3
    s_add_u32 s4, s0, s4
    s_addc_u32 s5, s1, 0
    s_load_dwordx2 s[4:5], s[4:5], 16
    s_load_dwordx2 s[6:7], s[0:1], 96
    v_lshrrev_b32 v1, 6, v0
    s_nop 0
    v_readfirstlane_b32 s23, v1
    s_and_b32 s21, s2, 3
    s_lshr_b32 s24, s2, 2
    s_and_b32 s24, s24, 15
    s_lshl_b32 s24, s24, 2
    s_add_u32 s24, s24, s23
    s_lshl_b32 s20, s24, 7
    s_waitcnt lgkmcnt(0)
    s_add_u32 s8, s4, 0x0
    s_addc_u32 s9, s5, 0
    s_and_b32 s9, s9, 0xffff
    s_mov_b32 s10, 0x500000
    s_mov_b32 s11, 0x20000
    s_add_u32 s12, s6, 0x0
    s_addc_u32 s13, s7, 0
    s_and_b32 s13, s13, 0xffff
    s_mov_b32 s14, 0x280000
    s_mov_b32 s15, 0x20000
    s_add_u32 s40, s6, 0x8300000
    s_addc_u32 s41, s7, 0
    s_and_b32 s41, s41, 0xffff
    s_mov_b32 s42, 0x10000
    s_mov_b32 s43, 0x20000
    s_cmp_eq_u32 s3, 0
    s_mov_b32 s39, 4096
    s_cselect_b32 s39, 12416, s39
    s_lshl_b32 s25, s3, 24
    s_add_u32 s6, s6, s25
    s_addc_u32 s7, s7, 0
    s_add_u32 s16, s6, 0x400000
    s_addc_u32 s17, s7, 0
    s_and_b32 s17, s17, 0xffff
    s_mov_b32 s18, 0x1000000
    s_mov_b32 s19, 0x20000
    s_cmp_eq_u32 s3, 2
    s_cbranch_scc1 QV_68
    s_lshl_b32 s22, s24, 11
    v_and_b32 v1, 63, v0
    v_lshrrev_b32 v3, 4, v1
    v_mul_u32_u24 v2, 65536, v3
    v_and_b32 v3, 15, v1
    v_lshl_add_u32 v2, v3, 3, v2
    v_lshlrev_b32 v1, 4, v1
    s_mul_i32 s28, s23, 10240
    s_mov_b32 s30, 0
    s_mov_b32 s31, s21
    s_mul_i32 s27, s31, 40960
    s_add_u32 s27, s27, s28
    s_add_u32 s29, s30, s28
    s_mov_b32 m0, s29
    s_nop 0
    buffer_load_dwordx4 v1, s[12:15], s27 offen offset:0 lds
    buffer_load_dwordx4 v1, s[12:15], s27 offen offset:1024 lds
    buffer_load_dwordx4 v1, s[12:15], s27 offen offset:2048 lds
    buffer_load_dwordx4 v1, s[12:15], s27 offen offset:3072 lds
    s_add_u32 s27, s27, 4096
    s_add_u32 s29, s29, 4096
    s_mov_b32 m0, s29
    s_nop 0
    buffer_load_dwordx4 v1, s[12:15], s27 offen offset:0 lds
    buffer_load_dwordx4 v1, s[12:15], s27 offen offset:1024 lds
    buffer_load_dwordx4 v1, s[12:15], s27 offen offset:2048 lds
    buffer_load_dwordx4 v1, s[12:15], s27 offen offset:3072 lds
    s_add_u32 s27, s27, 4096
    s_add_u32 s29, s29, 4096
    s_mov_b32 m0, s29
    s_nop 0
    buffer_load_dwordx4 v1, s[12:15], s27 offen offset:0 lds
    buffer_load_dwordx4 v1, s[12:15], s27 offen offset:1024 lds
    s_mov_b32 s30, 40960
    s_add_u32 s31, s31, 4
    s_mul_i32 s27, s31, 40960
    s_add_u32 s27, s27, s28
    s_add_u32 s29, s30, s28
    s_mov_b32 m0, s29
    s_nop 0
    buffer_load_dwordx4 v1, s[12:15], s27 offen offset:0 lds
    buffer_load_dwordx4 v1, s[12:15], s27 offen offset:1024 lds
    buffer_load_dwordx4 v1, s[12:15], s27 offen offset:2048 lds
    buffer_load_dwordx4 v1, s[12:15], s27 offen offset:3072 lds
    s_add_u32 s27, s27, 4096
    s_add_u32 s29, s29, 4096
    s_mov_b32 m0, s29
    s_nop 0
    buffer_load_dwordx4 v1, s[12:15], s27 offen offset:0 lds
    buffer_load_dwordx4 v1, s[12:15], s27 offen offset:1024 lds
    buffer_load_dwordx4 v1, s[12:15], s27 offen offset:2048 lds
    buffer_load_dwordx4 v1, s[12:15], s27 offen offset:3072 lds
    s_add_u32 s27, s27, 4096
    s_add_u32 s29, s29, 4096
    s_mov_b32 m0, s29
    s_nop 0
    buffer_load_dwordx4 v1, s[12:15], s27 offen offset:0 lds
    buffer_load_dwordx4 v1, s[12:15], s27 offen offset:1024 lds
    s_mov_b32 s24, 0x05040100
    s_mov_b32 s25, 0x07060302
    s_mov_b32 s26, s20
    buffer_load_dwordx2 v[64:65], v2, s[8:11], s26 offen
    s_add_u32 s26, s26, 0x2000
    buffer_load_dwordx2 v[66:67], v2, s[8:11], s26 offen
    s_add_u32 s26, s26, 0x2000
    buffer_load_dwordx2 v[68:69], v2, s[8:11], s26 offen
    s_add_u32 s26, s26, 0x2000
    buffer_load_dwordx2 v[70:71], v2, s[8:11], s26 offen
    s_add_u32 s26, s26, 0x2000
    buffer_load_dwordx2 v[72:73], v2, s[8:11], s26 offen
    s_add_u32 s26, s26, 0x2000
    buffer_load_dwordx2 v[74:75], v2, s[8:11], s26 offen
    s_add_u32 s26, s26, 0x2000
    buffer_load_dwordx2 v[76:77], v2, s[8:11], s26 offen
    s_add_u32 s26, s26, 0x2000
    buffer_load_dwordx2 v[78:79], v2, s[8:11], s26 offen
    s_add_u32 s26, s26, 0x32000
    buffer_load_dwordx2 v[80:81], v2, s[8:11], s26 offen
    s_add_u32 s26, s26, 0x2000
    buffer_load_dwordx2 v[82:83], v2, s[8:11], s26 offen
    s_add_u32 s26, s26, 0x2000
    buffer_load_dwordx2 v[84:85], v2, s[8:11], s26 offen
    s_add_u32 s26, s26, 0x2000
    buffer_load_dwordx2 v[86:87], v2, s[8:11], s26 offen
    s_add_u32 s26, s26, 0x2000
    buffer_load_dwordx2 v[88:89], v2, s[8:11], s26 offen
    s_add_u32 s26, s26, 0x2000
    buffer_load_dwordx2 v[90:91], v2, s[8:11], s26 offen
    s_add_u32 s26, s26, 0x2000
    buffer_load_dwordx2 v[92:93], v2, s[8:11], s26 offen
    s_add_u32 s26, s26, 0x2000
    buffer_load_dwordx2 v[94:95], v2, s[8:11], s26 offen
    s_add_u32 s26, s26, 0x32000
    buffer_load_dwordx2 v[96:97], v2, s[8:11], s26 offen
    s_add_u32 s26, s26, 0x2000
    buffer_load_dwordx2 v[98:99], v2, s[8:11], s26 offen
    s_add_u32 s26, s26, 0x2000
    buffer_load_dwordx2 v[100:101], v2, s[8:11], s26 offen
    s_add_u32 s26, s26, 0x2000
    buffer_load_dwordx2 v[102:103], v2, s[8:11], s26 offen
    s_add_u32 s26, s26, 0x2000
    buffer_load_dwordx2 v[104:105], v2, s[8:11], s26 offen
    s_add_u32 s26, s26, 0x2000
    buffer_load_dwordx2 v[106:107], v2, s[8:11], s26 offen
    s_add_u32 s26, s26, 0x2000
    buffer_load_dwordx2 v[108:109], v2, s[8:11], s26 offen
    s_add_u32 s26, s26, 0x2000
    buffer_load_dwordx2 v[110:111], v2, s[8:11], s26 offen
    s_add_u32 s26, s26, 0x32000
    buffer_load_dwordx2 v[112:113], v2, s[8:11], s26 offen
    s_add_u32 s26, s26, 0x2000
    buffer_load_dwordx2 v[114:115], v2, s[8:11], s26 offen
    s_add_u32 s26, s26, 0x2000
    buffer_load_dwordx2 v[116:117], v2, s[8:11], s26 offen
    s_add_u32 s26, s26, 0x2000
    buffer_load_dwordx2 v[118:119], v2, s[8:11], s26 offen
    s_add_u32 s26, s26, 0x2000
    buffer_load_dwordx2 v[120:121], v2, s[8:11], s26 offen
    s_add_u32 s26, s26, 0x2000
    buffer_load_dwordx2 v[122:123], v2, s[8:11], s26 offen
    s_add_u32 s26, s26, 0x2000
    buffer_load_dwordx2 v[124:125], v2, s[8:11], s26 offen
    s_add_u32 s26, s26, 0x2000
    buffer_load_dwordx2 v[126:127], v2, s[8:11], s26 offen
    s_add_u32 s26, s26, 0x32000
    buffer_load_dwordx2 v[128:129], v2, s[8:11], s26 offen
    s_add_u32 s26, s26, 0x2000
    buffer_load_dwordx2 v[130:131], v2, s[8:11], s26 offen
    s_add_u32 s26, s26, 0x2000
    buffer_load_dwordx2 v[132:133], v2, s[8:11], s26 offen
    s_add_u32 s26, s26, 0x2000
    buffer_load_dwordx2 v[134:135], v2, s[8:11], s26 offen
    s_add_u32 s26, s26, 0x2000
    buffer_load_dwordx2 v[136:137], v2, s[8:11], s26 offen
    s_add_u32 s26, s26, 0x2000
    buffer_load_dwordx2 v[138:139], v2, s[8:11], s26 offen
    s_add_u32 s26, s26, 0x2000
    buffer_load_dwordx2 v[140:141], v2, s[8:11], s26 offen
    s_add_u32 s26, s26, 0x2000
    buffer_load_dwordx2 v[142:143], v2, s[8:11], s26 offen
    s_add_u32 s26, s26, 0x32000
    buffer_load_dwordx2 v[144:145], v2, s[8:11], s26 offen
    s_add_u32 s26, s26, 0x2000
    buffer_load_dwordx2 v[146:147], v2, s[8:11], s26 offen
    s_add_u32 s26, s26, 0x2000
    buffer_load_dwordx2 v[148:149], v2, s[8:11], s26 offen
    s_add_u32 s26, s26, 0x2000
    buffer_load_dwordx2 v[150:151], v2, s[8:11], s26 offen
    s_add_u32 s26, s26, 0x2000
    buffer_load_dwordx2 v[152:153], v2, s[8:11], s26 offen
    s_add_u32 s26, s26, 0x2000
    buffer_load_dwordx2 v[154:155], v2, s[8:11], s26 offen
    s_add_u32 s26, s26, 0x2000
    buffer_load_dwordx2 v[156:157], v2, s[8:11], s26 offen
    s_add_u32 s26, s26, 0x2000
    buffer_load_dwordx2 v[158:159], v2, s[8:11], s26 offen
    s_add_u32 s26, s26, 0x32000
    buffer_load_dwordx2 v[160:161], v2, s[8:11], s26 offen
    s_add_u32 s26, s26, 0x2000
    buffer_load_dwordx2 v[162:163], v2, s[8:11], s26 offen
    s_add_u32 s26, s26, 0x2000
    buffer_load_dwordx2 v[164:165], v2, s[8:11], s26 offen
    s_add_u32 s26, s26, 0x2000
    buffer_load_dwordx2 v[166:167], v2, s[8:11], s26 offen
    s_add_u32 s26, s26, 0x2000
    buffer_load_dwordx2 v[168:169], v2, s[8:11], s26 offen
    s_add_u32 s26, s26, 0x2000
    buffer_load_dwordx2 v[170:171], v2, s[8:11], s26 offen
    s_add_u32 s26, s26, 0x2000
    buffer_load_dwordx2 v[172:173], v2, s[8:11], s26 offen
    s_add_u32 s26, s26, 0x2000
    buffer_load_dwordx2 v[174:175], v2, s[8:11], s26 offen
    s_add_u32 s26, s26, 0x32000
    buffer_load_dwordx2 v[176:177], v2, s[8:11], s26 offen
    s_add_u32 s26, s26, 0x2000
    buffer_load_dwordx2 v[178:179], v2, s[8:11], s26 offen
    s_add_u32 s26, s26, 0x2000
    buffer_load_dwordx2 v[180:181], v2, s[8:11], s26 offen
    s_add_u32 s26, s26, 0x2000
    buffer_load_dwordx2 v[182:183], v2, s[8:11], s26 offen
    s_add_u32 s26, s26, 0x2000
    buffer_load_dwordx2 v[184:185], v2, s[8:11], s26 offen
    s_add_u32 s26, s26, 0x2000
    buffer_load_dwordx2 v[186:187], v2, s[8:11], s26 offen
    s_add_u32 s26, s26, 0x2000
    buffer_load_dwordx2 v[188:189], v2, s[8:11], s26 offen
    s_add_u32 s26, s26, 0x2000
    buffer_load_dwordx2 v[190:191], v2, s[8:11], s26 offen
    s_add_u32 s26, s26, 0x32000
    s_waitcnt vmcnt(56)
    v_perm_b32 v4, v66, v64, s24
    v_accvgpr_write_b32 a0, v4
    v_perm_b32 v5, v70, v68, s24
    v_accvgpr_write_b32 a1, v5
    v_perm_b32 v4, v74, v72, s24
    v_accvgpr_write_b32 a2, v4
    v_perm_b32 v5, v78, v76, s24
    v_accvgpr_write_b32 a3, v5
    v_perm_b32 v4, v66, v64, s25
    v_accvgpr_write_b32 a4, v4
    v_perm_b32 v5, v70, v68, s25
    v_accvgpr_write_b32 a5, v5
    v_perm_b32 v4, v74, v72, s25
    v_accvgpr_write_b32 a6, v4
    v_perm_b32 v5, v78, v76, s25
    v_accvgpr_write_b32 a7, v5
    v_perm_b32 v4, v67, v65, s24
    v_accvgpr_write_b32 a8, v4
    v_perm_b32 v5, v71, v69, s24
    v_accvgpr_write_b32 a9, v5
    v_perm_b32 v4, v75, v73, s24
    v_accvgpr_write_b32 a10, v4
    v_perm_b32 v5, v79, v77, s24
    v_accvgpr_write_b32 a11, v5
    v_perm_b32 v4, v67, v65, s25
    v_accvgpr_write_b32 a12, v4
    v_perm_b32 v5, v71, v69, s25
    v_accvgpr_write_b32 a13, v5
    v_perm_b32 v4, v75, v73, s25
    v_accvgpr_write_b32 a14, v4
    v_perm_b32 v5, v79, v77, s25
    v_accvgpr_write_b32 a15, v5
    buffer_load_dwordx2 v[64:65], v2, s[8:11], s26 offen
    s_add_u32 s26, s26, 0x2000
    buffer_load_dwordx2 v[66:67], v2, s[8:11], s26 offen
    s_add_u32 s26, s26, 0x2000
    buffer_load_dwordx2 v[68:69], v2, s[8:11], s26 offen
    s_add_u32 s26, s26, 0x2000
    buffer_load_dwordx2 v[70:71], v2, s[8:11], s26 offen
    s_add_u32 s26, s26, 0x2000
    buffer_load_dwordx2 v[72:73], v2, s[8:11], s26 offen
    s_add_u32 s26, s26, 0x2000
    buffer_load_dwordx2 v[74:75], v2, s[8:11], s26 offen
    s_add_u32 s26, s26, 0x2000
    buffer_load_dwordx2 v[76:77], v2, s[8:11], s26 offen
    s_add_u32 s26, s26, 0x2000
    buffer_load_dwordx2 v[78:79], v2, s[8:11], s26 offen
    s_add_u32 s26, s26, 0x32000
    s_waitcnt vmcnt(56)
    v_perm_b32 v4, v82, v80, s24
    v_accvgpr_write_b32 a16, v4
    v_perm_b32 v5, v86, v84, s24
    v_accvgpr_write_b32 a17, v5
    v_perm_b32 v4, v90, v88, s24
    v_accvgpr_write_b32 a18, v4
    v_perm_b32 v5, v94, v92, s24
    v_accvgpr_write_b32 a19, v5
    v_perm_b32 v4, v82, v80, s25
    v_accvgpr_write_b32 a20, v4
    v_perm_b32 v5, v86, v84, s25
    v_accvgpr_write_b32 a21, v5
    v_perm_b32 v4, v90, v88, s25
    v_accvgpr_write_b32 a22, v4
    v_perm_b32 v5, v94, v92, s25
    v_accvgpr_write_b32 a23, v5
    v_perm_b32 v4, v83, v81, s24
    v_accvgpr_write_b32 a24, v4
    v_perm_b32 v5, v87, v85, s24
    v_accvgpr_write_b32 a25, v5
    v_perm_b32 v4, v91, v89, s24
    v_accvgpr_write_b32 a26, v4
    v_perm_b32 v5, v95, v93, s24
    v_accvgpr_write_b32 a27, v5
    v_perm_b32 v4, v83, v81, s25
    v_accvgpr_write_b32 a28, v4
    v_perm_b32 v5, v87, v85, s25
    v_accvgpr_write_b32 a29, v5
    v_perm_b32 v4, v91, v89, s25
    v_accvgpr_write_b32 a30, v4
    v_perm_b32 v5, v95, v93, s25
    v_accvgpr_write_b32 a31, v5
    buffer_load_dwordx2 v[80:81], v2, s[8:11], s26 offen
    s_add_u32 s26, s26, 0x2000
    buffer_load_dwordx2 v[82:83], v2, s[8:11], s26 offen
    s_add_u32 s26, s26, 0x2000
    buffer_load_dwordx2 v[84:85], v2, s[8:11], s26 offen
    s_add_u32 s26, s26, 0x2000
    buffer_load_dwordx2 v[86:87], v2, s[8:11], s26 offen
    s_add_u32 s26, s26, 0x2000
    buffer_load_dwordx2 v[88:89], v2, s[8:11], s26 offen
    s_add_u32 s26, s26, 0x2000
    buffer_load_dwordx2 v[90:91], v2, s[8:11], s26 offen
    s_add_u32 s26, s26, 0x2000
    buffer_load_dwordx2 v[92:93], v2, s[8:11], s26 offen
    s_add_u32 s26, s26, 0x2000
    buffer_load_dwordx2 v[94:95], v2, s[8:11], s26 offen
    s_add_u32 s26, s26, 0x32000
    s_waitcnt vmcnt(56)
    v_perm_b32 v4, v98, v96, s24
    v_accvgpr_write_b32 a32, v4
    v_perm_b32 v5, v102, v100, s24
    v_accvgpr_write_b32 a33, v5
    v_perm_b32 v4, v106, v104, s24
    v_accvgpr_write_b32 a34, v4
    v_perm_b32 v5, v110, v108, s24
    v_accvgpr_write_b32 a35, v5
    v_perm_b32 v4, v98, v96, s25
    v_accvgpr_write_b32 a36, v4
    v_perm_b32 v5, v102, v100, s25
    v_accvgpr_write_b32 a37, v5
    v_perm_b32 v4, v106, v104, s25
    v_accvgpr_write_b32 a38, v4
    v_perm_b32 v5, v110, v108, s25
    v_accvgpr_write_b32 a39, v5
    v_perm_b32 v4, v99, v97, s24
    v_accvgpr_write_b32 a40, v4
    v_perm_b32 v5, v103, v101, s24
    v_accvgpr_write_b32 a41, v5
    v_perm_b32 v4, v107, v105, s24
    v_accvgpr_write_b32 a42, v4
    v_perm_b32 v5, v111, v109, s24
    v_accvgpr_write_b32 a43, v5
    v_perm_b32 v4, v99, v97, s25
    v_accvgpr_write_b32 a44, v4
    v_perm_b32 v5, v103, v101, s25
    v_accvgpr_write_b32 a45, v5
    v_perm_b32 v4, v107, v105, s25
    v_accvgpr_write_b32 a46, v4
    v_perm_b32 v5, v111, v109, s25
    v_accvgpr_write_b32 a47, v5
    buffer_load_dwordx2 v[96:97], v2, s[8:11], s26 offen
    s_add_u32 s26, s26, 0x2000
    buffer_load_dwordx2 v[98:99], v2, s[8:11], s26 offen
    s_add_u32 s26, s26, 0x2000
    buffer_load_dwordx2 v[100:101], v2, s[8:11], s26 offen
    s_add_u32 s26, s26, 0x2000
    buffer_load_dwordx2 v[102:103], v2, s[8:11], s26 offen
    s_add_u32 s26, s26, 0x2000
    buffer_load_dwordx2 v[104:105], v2, s[8:11], s26 offen
    s_add_u32 s26, s26, 0x2000
    buffer_load_dwordx2 v[106:107], v2, s[8:11], s26 offen
    s_add_u32 s26, s26, 0x2000
    buffer_load_dwordx2 v[108:109], v2, s[8:11], s26 offen
    s_add_u32 s26, s26, 0x2000
    buffer_load_dwordx2 v[110:111], v2, s[8:11], s26 offen
    s_add_u32 s26, s26, 0x32000
    s_waitcnt vmcnt(56)
    v_perm_b32 v4, v114, v112, s24
    v_accvgpr_write_b32 a48, v4
    v_perm_b32 v5, v118, v116, s24
    v_accvgpr_write_b32 a49, v5
    v_perm_b32 v4, v122, v120, s24
    v_accvgpr_write_b32 a50, v4
    v_perm_b32 v5, v126, v124, s24
    v_accvgpr_write_b32 a51, v5
    v_perm_b32 v4, v114, v112, s25
    v_accvgpr_write_b32 a52, v4
    v_perm_b32 v5, v118, v116, s25
    v_accvgpr_write_b32 a53, v5
    v_perm_b32 v4, v122, v120, s25
    v_accvgpr_write_b32 a54, v4
    v_perm_b32 v5, v126, v124, s25
    v_accvgpr_write_b32 a55, v5
    v_perm_b32 v4, v115, v113, s24
    v_accvgpr_write_b32 a56, v4
    v_perm_b32 v5, v119, v117, s24
    v_accvgpr_write_b32 a57, v5
    v_perm_b32 v4, v123, v121, s24
    v_accvgpr_write_b32 a58, v4
    v_perm_b32 v5, v127, v125, s24
    v_accvgpr_write_b32 a59, v5
    v_perm_b32 v4, v115, v113, s25
    v_accvgpr_write_b32 a60, v4
    v_perm_b32 v5, v119, v117, s25
    v_accvgpr_write_b32 a61, v5
    v_perm_b32 v4, v123, v121, s25
    v_accvgpr_write_b32 a62, v4
    v_perm_b32 v5, v127, v125, s25
    v_accvgpr_write_b32 a63, v5
    buffer_load_dwordx2 v[112:113], v2, s[8:11], s26 offen
    s_add_u32 s26, s26, 0x2000
    buffer_load_dwordx2 v[114:115], v2, s[8:11], s26 offen
    s_add_u32 s26, s26, 0x2000
    buffer_load_dwordx2 v[116:117], v2, s[8:11], s26 offen
    s_add_u32 s26, s26, 0x2000
    buffer_load_dwordx2 v[118:119], v2, s[8:11], s26 offen
    s_add_u32 s26, s26, 0x2000
    buffer_load_dwordx2 v[120:121], v2, s[8:11], s26 offen
    s_add_u32 s26, s26, 0x2000
    buffer_load_dwordx2 v[122:123], v2, s[8:11], s26 offen
    s_add_u32 s26, s26, 0x2000
    buffer_load_dwordx2 v[124:125], v2, s[8:11], s26 offen
    s_add_u32 s26, s26, 0x2000
    buffer_load_dwordx2 v[126:127], v2, s[8:11], s26 offen
    s_add_u32 s26, s26, 0x32000
    s_waitcnt vmcnt(56)
    v_perm_b32 v4, v130, v128, s24
    v_accvgpr_write_b32 a64, v4
    v_perm_b32 v5, v134, v132, s24
    v_accvgpr_write_b32 a65, v5
    v_perm_b32 v4, v138, v136, s24
    v_accvgpr_write_b32 a66, v4
    v_perm_b32 v5, v142, v140, s24
    v_accvgpr_write_b32 a67, v5
    v_perm_b32 v4, v130, v128, s25
    v_accvgpr_write_b32 a68, v4
    v_perm_b32 v5, v134, v132, s25
    v_accvgpr_write_b32 a69, v5
    v_perm_b32 v4, v138, v136, s25
    v_accvgpr_write_b32 a70, v4
    v_perm_b32 v5, v142, v140, s25
    v_accvgpr_write_b32 a71, v5
    v_perm_b32 v4, v131, v129, s24
    v_accvgpr_write_b32 a72, v4
    v_perm_b32 v5, v135, v133, s24
    v_accvgpr_write_b32 a73, v5
    v_perm_b32 v4, v139, v137, s24
    v_accvgpr_write_b32 a74, v4
    v_perm_b32 v5, v143, v141, s24
    v_accvgpr_write_b32 a75, v5
    v_perm_b32 v4, v131, v129, s25
    v_accvgpr_write_b32 a76, v4
    v_perm_b32 v5, v135, v133, s25
    v_accvgpr_write_b32 a77, v5
    v_perm_b32 v4, v139, v137, s25
    v_accvgpr_write_b32 a78, v4
    v_perm_b32 v5, v143, v141, s25
    v_accvgpr_write_b32 a79, v5
    buffer_load_dwordx2 v[128:129], v2, s[8:11], s26 offen
    s_add_u32 s26, s26, 0x2000
    buffer_load_dwordx2 v[130:131], v2, s[8:11], s26 offen
    s_add_u32 s26, s26, 0x2000
    buffer_load_dwordx2 v[132:133], v2, s[8:11], s26 offen
    s_add_u32 s26, s26, 0x2000
    buffer_load_dwordx2 v[134:135], v2, s[8:11], s26 offen
    s_add_u32 s26, s26, 0x2000
    buffer_load_dwordx2 v[136:137], v2, s[8:11], s26 offen
    s_add_u32 s26, s26, 0x2000
    buffer_load_dwordx2 v[138:139], v2, s[8:11], s26 offen
    s_add_u32 s26, s26, 0x2000
    buffer_load_dwordx2 v[140:141], v2, s[8:11], s26 offen
    s_add_u32 s26, s26, 0x2000
    buffer_load_dwordx2 v[142:143], v2, s[8:11], s26 offen
    s_add_u32 s26, s26, 0x32000
    s_waitcnt vmcnt(56)
    v_perm_b32 v4, v146, v144, s24
    v_accvgpr_write_b32 a80, v4
    v_perm_b32 v5, v150, v148, s24
    v_accvgpr_write_b32 a81, v5
    v_perm_b32 v4, v154, v152, s24
    v_accvgpr_write_b32 a82, v4
    v_perm_b32 v5, v158, v156, s24
    v_accvgpr_write_b32 a83, v5
    v_perm_b32 v4, v146, v144, s25
    v_accvgpr_write_b32 a84, v4
    v_perm_b32 v5, v150, v148, s25
    v_accvgpr_write_b32 a85, v5
    v_perm_b32 v4, v154, v152, s25
    v_accvgpr_write_b32 a86, v4
    v_perm_b32 v5, v158, v156, s25
    v_accvgpr_write_b32 a87, v5
    v_perm_b32 v4, v147, v145, s24
    v_accvgpr_write_b32 a88, v4
    v_perm_b32 v5, v151, v149, s24
    v_accvgpr_write_b32 a89, v5
    v_perm_b32 v4, v155, v153, s24
    v_accvgpr_write_b32 a90, v4
    v_perm_b32 v5, v159, v157, s24
    v_accvgpr_write_b32 a91, v5
    v_perm_b32 v4, v147, v145, s25
    v_accvgpr_write_b32 a92, v4
    v_perm_b32 v5, v151, v149, s25
    v_accvgpr_write_b32 a93, v5
    v_perm_b32 v4, v155, v153, s25
    v_accvgpr_write_b32 a94, v4
    v_perm_b32 v5, v159, v157, s25
    v_accvgpr_write_b32 a95, v5
    buffer_load_dwordx2 v[144:145], v2, s[8:11], s26 offen
    s_add_u32 s26, s26, 0x2000
    buffer_load_dwordx2 v[146:147], v2, s[8:11], s26 offen
    s_add_u32 s26, s26, 0x2000
    buffer_load_dwordx2 v[148:149], v2, s[8:11], s26 offen
    s_add_u32 s26, s26, 0x2000
    buffer_load_dwordx2 v[150:151], v2, s[8:11], s26 offen
    s_add_u32 s26, s26, 0x2000
    buffer_load_dwordx2 v[152:153], v2, s[8:11], s26 offen
    s_add_u32 s26, s26, 0x2000
    buffer_load_dwordx2 v[154:155], v2, s[8:11], s26 offen
    s_add_u32 s26, s26, 0x2000
    buffer_load_dwordx2 v[156:157], v2, s[8:11], s26 offen
    s_add_u32 s26, s26, 0x2000
    buffer_load_dwordx2 v[158:159], v2, s[8:11], s26 offen
    s_add_u32 s26, s26, 0x32000
    s_waitcnt vmcnt(56)
    v_perm_b32 v4, v162, v160, s24
    v_accvgpr_write_b32 a96, v4
    v_perm_b32 v5, v166, v164, s24
    v_accvgpr_write_b32 a97, v5
    v_perm_b32 v4, v170, v168, s24
    v_accvgpr_write_b32 a98, v4
    v_perm_b32 v5, v174, v172, s24
    v_accvgpr_write_b32 a99, v5
    v_perm_b32 v4, v162, v160, s25
    v_accvgpr_write_b32 a100, v4
    v_perm_b32 v5, v166, v164, s25
    v_accvgpr_write_b32 a101, v5
    v_perm_b32 v4, v170, v168, s25
    v_accvgpr_write_b32 a102, v4
    v_perm_b32 v5, v174, v172, s25
    v_accvgpr_write_b32 a103, v5
    v_perm_b32 v4, v163, v161, s24
    v_accvgpr_write_b32 a104, v4
    v_perm_b32 v5, v167, v165, s24
    v_accvgpr_write_b32 a105, v5
    v_perm_b32 v4, v171, v169, s24
    v_accvgpr_write_b32 a106, v4
    v_perm_b32 v5, v175, v173, s24
    v_accvgpr_write_b32 a107, v5
    v_perm_b32 v4, v163, v161, s25
    v_accvgpr_write_b32 a108, v4
    v_perm_b32 v5, v167, v165, s25
    v_accvgpr_write_b32 a109, v5
    v_perm_b32 v4, v171, v169, s25
    v_accvgpr_write_b32 a110, v4
    v_perm_b32 v5, v175, v173, s25
    v_accvgpr_write_b32 a111, v5
    buffer_load_dwordx2 v[160:161], v2, s[8:11], s26 offen
    s_add_u32 s26, s26, 0x2000
    buffer_load_dwordx2 v[162:163], v2, s[8:11], s26 offen
    s_add_u32 s26, s26, 0x2000
    buffer_load_dwordx2 v[164:165], v2, s[8:11], s26 offen
    s_add_u32 s26, s26, 0x2000
    buffer_load_dwordx2 v[166:167], v2, s[8:11], s26 offen
    s_add_u32 s26, s26, 0x2000
    buffer_load_dwordx2 v[168:169], v2, s[8:11], s26 offen
    s_add_u32 s26, s26, 0x2000
    buffer_load_dwordx2 v[170:171], v2, s[8:11], s26 offen
    s_add_u32 s26, s26, 0x2000
    buffer_load_dwordx2 v[172:173], v2, s[8:11], s26 offen
    s_add_u32 s26, s26, 0x2000
    buffer_load_dwordx2 v[174:175], v2, s[8:11], s26 offen
    s_add_u32 s26, s26, 0x32000
    s_waitcnt vmcnt(56)
    v_perm_b32 v4, v178, v176, s24
    v_accvgpr_write_b32 a112, v4
    v_perm_b32 v5, v182, v180, s24
    v_accvgpr_write_b32 a113, v5
    v_perm_b32 v4, v186, v184, s24
    v_accvgpr_write_b32 a114, v4
    v_perm_b32 v5, v190, v188, s24
    v_accvgpr_write_b32 a115, v5
    v_perm_b32 v4, v178, v176, s25
    v_accvgpr_write_b32 a116, v4
    v_perm_b32 v5, v182, v180, s25
    v_accvgpr_write_b32 a117, v5
    v_perm_b32 v4, v186, v184, s25
    v_accvgpr_write_b32 a118, v4
    v_perm_b32 v5, v190, v188, s25
    v_accvgpr_write_b32 a119, v5
    v_perm_b32 v4, v179, v177, s24
    v_accvgpr_write_b32 a120, v4
    v_perm_b32 v5, v183, v181, s24
    v_accvgpr_write_b32 a121, v5
    v_perm_b32 v4, v187, v185, s24
    v_accvgpr_write_b32 a122, v4
    v_perm_b32 v5, v191, v189, s24
    v_accvgpr_write_b32 a123, v5
    v_perm_b32 v4, v179, v177, s25
    v_accvgpr_write_b32 a124, v4
    v_perm_b32 v5, v183, v181, s25
    v_accvgpr_write_b32 a125, v5
    v_perm_b32 v4, v187, v185, s25
    v_accvgpr_write_b32 a126, v4
    v_perm_b32 v5, v191, v189, s25
    v_accvgpr_write_b32 a127, v5
    buffer_load_dwordx2 v[176:177], v2, s[8:11], s26 offen
    s_add_u32 s26, s26, 0x2000
    buffer_load_dwordx2 v[178:179], v2, s[8:11], s26 offen
    s_add_u32 s26, s26, 0x2000
    buffer_load_dwordx2 v[180:181], v2, s[8:11], s26 offen
    s_add_u32 s26, s26, 0x2000
    buffer_load_dwordx2 v[182:183], v2, s[8:11], s26 offen
    s_add_u32 s26, s26, 0x2000
    buffer_load_dwordx2 v[184:185], v2, s[8:11], s26 offen
    s_add_u32 s26, s26, 0x2000
    buffer_load_dwordx2 v[186:187], v2, s[8:11], s26 offen
    s_add_u32 s26, s26, 0x2000
    buffer_load_dwordx2 v[188:189], v2, s[8:11], s26 offen
    s_add_u32 s26, s26, 0x2000
    buffer_load_dwordx2 v[190:191], v2, s[8:11], s26 offen
    s_add_u32 s26, s26, 0x32000
    s_waitcnt vmcnt(56)
    v_perm_b32 v4, v66, v64, s24
    v_accvgpr_write_b32 a128, v4
    v_perm_b32 v5, v70, v68, s24
    v_accvgpr_write_b32 a129, v5
    v_perm_b32 v4, v74, v72, s24
    v_accvgpr_write_b32 a130, v4
    v_perm_b32 v5, v78, v76, s24
    v_accvgpr_write_b32 a131, v5
    v_perm_b32 v4, v66, v64, s25
    v_accvgpr_write_b32 a132, v4
    v_perm_b32 v5, v70, v68, s25
    v_accvgpr_write_b32 a133, v5
    v_perm_b32 v4, v74, v72, s25
    v_accvgpr_write_b32 a134, v4
    v_perm_b32 v5, v78, v76, s25
    v_accvgpr_write_b32 a135, v5
    v_perm_b32 v4, v67, v65, s24
    v_accvgpr_write_b32 a136, v4
    v_perm_b32 v5, v71, v69, s24
    v_accvgpr_write_b32 a137, v5
    v_perm_b32 v4, v75, v73, s24
    v_accvgpr_write_b32 a138, v4
    v_perm_b32 v5, v79, v77, s24
    v_accvgpr_write_b32 a139, v5
    v_perm_b32 v4, v67, v65, s25
    v_accvgpr_write_b32 a140, v4
    v_perm_b32 v5, v71, v69, s25
    v_accvgpr_write_b32 a141, v5
    v_perm_b32 v4, v75, v73, s25
    v_accvgpr_write_b32 a142, v4
    v_perm_b32 v5, v79, v77, s25
    v_accvgpr_write_b32 a143, v5
    buffer_load_dwordx2 v[64:65], v2, s[8:11], s26 offen
    s_add_u32 s26, s26, 0x2000
    buffer_load_dwordx2 v[66:67], v2, s[8:11], s26 offen
    s_add_u32 s26, s26, 0x2000
    buffer_load_dwordx2 v[68:69], v2, s[8:11], s26 offen
    s_add_u32 s26, s26, 0x2000
    buffer_load_dwordx2 v[70:71], v2, s[8:11], s26 offen
    s_add_u32 s26, s26, 0x2000
    buffer_load_dwordx2 v[72:73], v2, s[8:11], s26 offen
    s_add_u32 s26, s26, 0x2000
    buffer_load_dwordx2 v[74:75], v2, s[8:11], s26 offen
    s_add_u32 s26, s26, 0x2000
    buffer_load_dwordx2 v[76:77], v2, s[8:11], s26 offen
    s_add_u32 s26, s26, 0x2000
    buffer_load_dwordx2 v[78:79], v2, s[8:11], s26 offen
    s_add_u32 s26, s26, 0x32000
    s_waitcnt vmcnt(56)
    v_perm_b32 v4, v82, v80, s24
    v_accvgpr_write_b32 a144, v4
    v_perm_b32 v5, v86, v84, s24
    v_accvgpr_write_b32 a145, v5
    v_perm_b32 v4, v90, v88, s24
    v_accvgpr_write_b32 a146, v4
    v_perm_b32 v5, v94, v92, s24
    v_accvgpr_write_b32 a147, v5
    v_perm_b32 v4, v82, v80, s25
    v_accvgpr_write_b32 a148, v4
    v_perm_b32 v5, v86, v84, s25
    v_accvgpr_write_b32 a149, v5
    v_perm_b32 v4, v90, v88, s25
    v_accvgpr_write_b32 a150, v4
    v_perm_b32 v5, v94, v92, s25
    v_accvgpr_write_b32 a151, v5
    v_perm_b32 v4, v83, v81, s24
    v_accvgpr_write_b32 a152, v4
    v_perm_b32 v5, v87, v85, s24
    v_accvgpr_write_b32 a153, v5
    v_perm_b32 v4, v91, v89, s24
    v_accvgpr_write_b32 a154, v4
    v_perm_b32 v5, v95, v93, s24
    v_accvgpr_write_b32 a155, v5
    v_perm_b32 v4, v83, v81, s25
    v_accvgpr_write_b32 a156, v4
    v_perm_b32 v5, v87, v85, s25
    v_accvgpr_write_b32 a157, v5
    v_perm_b32 v4, v91, v89, s25
    v_accvgpr_write_b32 a158, v4
    v_perm_b32 v5, v95, v93, s25
    v_accvgpr_write_b32 a159, v5
    buffer_load_dwordx2 v[80:81], v2, s[8:11], s26 offen
    s_add_u32 s26, s26, 0x2000
    buffer_load_dwordx2 v[82:83], v2, s[8:11], s26 offen
    s_add_u32 s26, s26, 0x2000
    buffer_load_dwordx2 v[84:85], v2, s[8:11], s26 offen
    s_add_u32 s26, s26, 0x2000
    buffer_load_dwordx2 v[86:87], v2, s[8:11], s26 offen
    s_add_u32 s26, s26, 0x2000
    buffer_load_dwordx2 v[88:89], v2, s[8:11], s26 offen
    s_add_u32 s26, s26, 0x2000
    buffer_load_dwordx2 v[90:91], v2, s[8:11], s26 offen
    s_add_u32 s26, s26, 0x2000
    buffer_load_dwordx2 v[92:93], v2, s[8:11], s26 offen
    s_add_u32 s26, s26, 0x2000
    buffer_load_dwordx2 v[94:95], v2, s[8:11], s26 offen
    s_add_u32 s26, s26, 0x32000
    s_waitcnt vmcnt(56)
    v_perm_b32 v4, v98, v96, s24
    v_accvgpr_write_b32 a160, v4
    v_perm_b32 v5, v102, v100, s24
    v_accvgpr_write_b32 a161, v5
    v_perm_b32 v4, v106, v104, s24
    v_accvgpr_write_b32 a162, v4
    v_perm_b32 v5, v110, v108, s24
    v_accvgpr_write_b32 a163, v5
    v_perm_b32 v4, v98, v96, s25
    v_accvgpr_write_b32 a164, v4
    v_perm_b32 v5, v102, v100, s25
    v_accvgpr_write_b32 a165, v5
    v_perm_b32 v4, v106, v104, s25
    v_accvgpr_write_b32 a166, v4
    v_perm_b32 v5, v110, v108, s25
    v_accvgpr_write_b32 a167, v5
    v_perm_b32 v4, v99, v97, s24
    v_accvgpr_write_b32 a168, v4
    v_perm_b32 v5, v103, v101, s24
    v_accvgpr_write_b32 a169, v5
    v_perm_b32 v4, v107, v105, s24
    v_accvgpr_write_b32 a170, v4
    v_perm_b32 v5, v111, v109, s24
    v_accvgpr_write_b32 a171, v5
    v_perm_b32 v4, v99, v97, s25
    v_accvgpr_write_b32 a172, v4
    v_perm_b32 v5, v103, v101, s25
    v_accvgpr_write_b32 a173, v5
    v_perm_b32 v4, v107, v105, s25
    v_accvgpr_write_b32 a174, v4
    v_perm_b32 v5, v111, v109, s25
    v_accvgpr_write_b32 a175, v5
    buffer_load_dwordx2 v[96:97], v2, s[8:11], s26 offen
    s_add_u32 s26, s26, 0x2000
    buffer_load_dwordx2 v[98:99], v2, s[8:11], s26 offen
    s_add_u32 s26, s26, 0x2000
    buffer_load_dwordx2 v[100:101], v2, s[8:11], s26 offen
    s_add_u32 s26, s26, 0x2000
    buffer_load_dwordx2 v[102:103], v2, s[8:11], s26 offen
    s_add_u32 s26, s26, 0x2000
    buffer_load_dwordx2 v[104:105], v2, s[8:11], s26 offen
    s_add_u32 s26, s26, 0x2000
    buffer_load_dwordx2 v[106:107], v2, s[8:11], s26 offen
    s_add_u32 s26, s26, 0x2000
    buffer_load_dwordx2 v[108:109], v2, s[8:11], s26 offen
    s_add_u32 s26, s26, 0x2000
    buffer_load_dwordx2 v[110:111], v2, s[8:11], s26 offen
    s_add_u32 s26, s26, 0x32000
    s_waitcnt vmcnt(56)
    v_perm_b32 v4, v114, v112, s24
    v_accvgpr_write_b32 a176, v4
    v_perm_b32 v5, v118, v116, s24
    v_accvgpr_write_b32 a177, v5
    v_perm_b32 v4, v122, v120, s24
    v_accvgpr_write_b32 a178, v4
    v_perm_b32 v5, v126, v124, s24
    v_accvgpr_write_b32 a179, v5
    v_perm_b32 v4, v114, v112, s25
    v_accvgpr_write_b32 a180, v4
    v_perm_b32 v5, v118, v116, s25
    v_accvgpr_write_b32 a181, v5
    v_perm_b32 v4, v122, v120, s25
    v_accvgpr_write_b32 a182, v4
    v_perm_b32 v5, v126, v124, s25
    v_accvgpr_write_b32 a183, v5
    v_perm_b32 v4, v115, v113, s24
    v_accvgpr_write_b32 a184, v4
    v_perm_b32 v5, v119, v117, s24
    v_accvgpr_write_b32 a185, v5
    v_perm_b32 v4, v123, v121, s24
    v_accvgpr_write_b32 a186, v4
    v_perm_b32 v5, v127, v125, s24
    v_accvgpr_write_b32 a187, v5
    v_perm_b32 v4, v115, v113, s25
    v_accvgpr_write_b32 a188, v4
    v_perm_b32 v5, v119, v117, s25
    v_accvgpr_write_b32 a189, v5
    v_perm_b32 v4, v123, v121, s25
    v_accvgpr_write_b32 a190, v4
    v_perm_b32 v5, v127, v125, s25
    v_accvgpr_write_b32 a191, v5
    buffer_load_dwordx2 v[112:113], v2, s[8:11], s26 offen
    s_add_u32 s26, s26, 0x2000
    buffer_load_dwordx2 v[114:115], v2, s[8:11], s26 offen
    s_add_u32 s26, s26, 0x2000
    buffer_load_dwordx2 v[116:117], v2, s[8:11], s26 offen
    s_add_u32 s26, s26, 0x2000
    buffer_load_dwordx2 v[118:119], v2, s[8:11], s26 offen
    s_add_u32 s26, s26, 0x2000
    buffer_load_dwordx2 v[120:121], v2, s[8:11], s26 offen
    s_add_u32 s26, s26, 0x2000
    buffer_load_dwordx2 v[122:123], v2, s[8:11], s26 offen
    s_add_u32 s26, s26, 0x2000
    buffer_load_dwordx2 v[124:125], v2, s[8:11], s26 offen
    s_add_u32 s26, s26, 0x2000
    buffer_load_dwordx2 v[126:127], v2, s[8:11], s26 offen
    s_add_u32 s26, s26, 0x32000
    s_waitcnt vmcnt(56)
    v_perm_b32 v4, v130, v128, s24
    v_accvgpr_write_b32 a192, v4
    v_perm_b32 v5, v134, v132, s24
    v_accvgpr_write_b32 a193, v5
    v_perm_b32 v4, v138, v136, s24
    v_accvgpr_write_b32 a194, v4
    v_perm_b32 v5, v142, v140, s24
    v_accvgpr_write_b32 a195, v5
    v_perm_b32 v4, v130, v128, s25
    v_accvgpr_write_b32 a196, v4
    v_perm_b32 v5, v134, v132, s25
    v_accvgpr_write_b32 a197, v5
    v_perm_b32 v4, v138, v136, s25
    v_accvgpr_write_b32 a198, v4
    v_perm_b32 v5, v142, v140, s25
    v_accvgpr_write_b32 a199, v5
    v_perm_b32 v4, v131, v129, s24
    v_accvgpr_write_b32 a200, v4
    v_perm_b32 v5, v135, v133, s24
    v_accvgpr_write_b32 a201, v5
    v_perm_b32 v4, v139, v137, s24
    v_accvgpr_write_b32 a202, v4
    v_perm_b32 v5, v143, v141, s24
    v_accvgpr_write_b32 a203, v5
    v_perm_b32 v4, v131, v129, s25
    v_accvgpr_write_b32 a204, v4
    v_perm_b32 v5, v135, v133, s25
    v_accvgpr_write_b32 a205, v5
    v_perm_b32 v4, v139, v137, s25
    v_accvgpr_write_b32 a206, v4
    v_perm_b32 v5, v143, v141, s25
    v_accvgpr_write_b32 a207, v5
    s_waitcnt vmcnt(48)
    v_perm_b32 v4, v146, v144, s24
    v_accvgpr_write_b32 a208, v4
    v_perm_b32 v5, v150, v148, s24
    v_accvgpr_write_b32 a209, v5
    v_perm_b32 v4, v154, v152, s24
    v_accvgpr_write_b32 a210, v4
    v_perm_b32 v5, v158, v156, s24
    v_accvgpr_write_b32 a211, v5
    v_perm_b32 v4, v146, v144, s25
    v_accvgpr_write_b32 a212, v4
    v_perm_b32 v5, v150, v148, s25
    v_accvgpr_write_b32 a213, v5
    v_perm_b32 v4, v154, v152, s25
    v_accvgpr_write_b32 a214, v4
    v_perm_b32 v5, v158, v156, s25
    v_accvgpr_write_b32 a215, v5
    v_perm_b32 v4, v147, v145, s24
    v_accvgpr_write_b32 a216, v4
    v_perm_b32 v5, v151, v149, s24
    v_accvgpr_write_b32 a217, v5
    v_perm_b32 v4, v155, v153, s24
    v_accvgpr_write_b32 a218, v4
    v_perm_b32 v5, v159, v157, s24
    v_accvgpr_write_b32 a219, v5
    v_perm_b32 v4, v147, v145, s25
    v_accvgpr_write_b32 a220, v4
    v_perm_b32 v5, v151, v149, s25
    v_accvgpr_write_b32 a221, v5
    v_perm_b32 v4, v155, v153, s25
    v_accvgpr_write_b32 a222, v4
    v_perm_b32 v5, v159, v157, s25
    v_accvgpr_write_b32 a223, v5
    s_waitcnt vmcnt(40)
    v_perm_b32 v4, v162, v160, s24
    v_accvgpr_write_b32 a224, v4
    v_perm_b32 v5, v166, v164, s24
    v_accvgpr_write_b32 a225, v5
    v_perm_b32 v4, v170, v168, s24
    v_accvgpr_write_b32 a226, v4
    v_perm_b32 v5, v174, v172, s24
    v_accvgpr_write_b32 a227, v5
    v_perm_b32 v4, v162, v160, s25
    v_accvgpr_write_b32 a228, v4
    v_perm_b32 v5, v166, v164, s25
    v_accvgpr_write_b32 a229, v5
    v_perm_b32 v4, v170, v168, s25
    v_accvgpr_write_b32 a230, v4
    v_perm_b32 v5, v174, v172, s25
    v_accvgpr_write_b32 a231, v5
    v_perm_b32 v4, v163, v161, s24
    v_accvgpr_write_b32 a232, v4
    v_perm_b32 v5, v167, v165, s24
    v_accvgpr_write_b32 a233, v5
    v_perm_b32 v4, v171, v169, s24
    v_accvgpr_write_b32 a234, v4
    v_perm_b32 v5, v175, v173, s24
    v_accvgpr_write_b32 a235, v5
    v_perm_b32 v4, v163, v161, s25
    v_accvgpr_write_b32 a236, v4
    v_perm_b32 v5, v167, v165, s25
    v_accvgpr_write_b32 a237, v5
    v_perm_b32 v4, v171, v169, s25
    v_accvgpr_write_b32 a238, v4
    v_perm_b32 v5, v175, v173, s25
    v_accvgpr_write_b32 a239, v5
    s_waitcnt vmcnt(32)
    v_perm_b32 v4, v178, v176, s24
    v_accvgpr_write_b32 a240, v4
    v_perm_b32 v5, v182, v180, s24
    v_accvgpr_write_b32 a241, v5
    v_perm_b32 v4, v186, v184, s24
    v_accvgpr_write_b32 a242, v4
    v_perm_b32 v5, v190, v188, s24
    v_accvgpr_write_b32 a243, v5
    v_perm_b32 v4, v178, v176, s25
    v_accvgpr_write_b32 a244, v4
    v_perm_b32 v5, v182, v180, s25
    v_accvgpr_write_b32 a245, v5
    v_perm_b32 v4, v186, v184, s25
    v_accvgpr_write_b32 a246, v4
    v_perm_b32 v5, v190, v188, s25
    v_accvgpr_write_b32 a247, v5
    v_perm_b32 v4, v179, v177, s24
    v_accvgpr_write_b32 a248, v4
    v_perm_b32 v5, v183, v181, s24
    v_accvgpr_write_b32 a249, v5
    v_perm_b32 v4, v187, v185, s24
    v_accvgpr_write_b32 a250, v4
    v_perm_b32 v5, v191, v189, s24
    v_accvgpr_write_b32 a251, v5
    v_perm_b32 v4, v179, v177, s25
    v_accvgpr_write_b32 a252, v4
    v_perm_b32 v5, v183, v181, s25
    v_accvgpr_write_b32 a253, v5
    v_perm_b32 v4, v187, v185, s25
    v_accvgpr_write_b32 a254, v4
    v_perm_b32 v5, v191, v189, s25
    v_accvgpr_write_b32 a255, v5
    s_waitcnt vmcnt(24)
    v_perm_b32 v192, v66, v64, s24
    v_perm_b32 v193, v70, v68, s24
    v_perm_b32 v194, v74, v72, s24
    v_perm_b32 v195, v78, v76, s24
    v_perm_b32 v196, v66, v64, s25
    v_perm_b32 v197, v70, v68, s25
    v_perm_b32 v198, v74, v72, s25
    v_perm_b32 v199, v78, v76, s25
    v_perm_b32 v200, v67, v65, s24
    v_perm_b32 v201, v71, v69, s24
    v_perm_b32 v202, v75, v73, s24
    v_perm_b32 v203, v79, v77, s24
    v_perm_b32 v204, v67, v65, s25
    v_perm_b32 v205, v71, v69, s25
    v_perm_b32 v206, v75, v73, s25
    v_perm_b32 v207, v79, v77, s25
    s_waitcnt vmcnt(16)
    v_perm_b32 v208, v82, v80, s24
    v_perm_b32 v209, v86, v84, s24
    v_perm_b32 v210, v90, v88, s24
    v_perm_b32 v211, v94, v92, s24
    v_perm_b32 v212, v82, v80, s25
    v_perm_b32 v213, v86, v84, s25
    v_perm_b32 v214, v90, v88, s25
    v_perm_b32 v215, v94, v92, s25
    v_perm_b32 v216, v83, v81, s24
    v_perm_b32 v217, v87, v85, s24
    v_perm_b32 v218, v91, v89, s24
    v_perm_b32 v219, v95, v93, s24
    v_perm_b32 v220, v83, v81, s25
    v_perm_b32 v221, v87, v85, s25
    v_perm_b32 v222, v91, v89, s25
    v_perm_b32 v223, v95, v93, s25
    s_waitcnt vmcnt(8)
    v_perm_b32 v224, v98, v96, s24
    v_perm_b32 v225, v102, v100, s24
    v_perm_b32 v226, v106, v104, s24
    v_perm_b32 v227, v110, v108, s24
    v_perm_b32 v228, v98, v96, s25
    v_perm_b32 v229, v102, v100, s25
    v_perm_b32 v230, v106, v104, s25
    v_perm_b32 v231, v110, v108, s25
    v_perm_b32 v232, v99, v97, s24
    v_perm_b32 v233, v103, v101, s24
    v_perm_b32 v234, v107, v105, s24
    v_perm_b32 v235, v111, v109, s24
    v_perm_b32 v236, v99, v97, s25
    v_perm_b32 v237, v103, v101, s25
    v_perm_b32 v238, v107, v105, s25
    v_perm_b32 v239, v111, v109, s25
    s_waitcnt vmcnt(0)
    v_perm_b32 v240, v114, v112, s24
    v_perm_b32 v241, v118, v116, s24
    v_perm_b32 v242, v122, v120, s24
    v_perm_b32 v243, v126, v124, s24
    v_perm_b32 v244, v114, v112, s25
    v_perm_b32 v245, v118, v116, s25
    v_perm_b32 v246, v122, v120, s25
    v_perm_b32 v247, v126, v124, s25
    v_perm_b32 v248, v115, v113, s24
    v_perm_b32 v249, v119, v117, s24
    v_perm_b32 v250, v123, v121, s24
    v_perm_b32 v251, v127, v125, s24
    v_perm_b32 v252, v115, v113, s25
    v_perm_b32 v253, v119, v117, s25
    v_perm_b32 v254, v123, v121, s25
    v_perm_b32 v255, v127, v125, s25
    s_sub_u32 s27, s27, 8192
    s_sub_u32 s29, s29, 8192
    s_add_u32 m0, s29, 4096
    s_add_u32 s38, s27, 4096
    s_mov_b32 s30, 81920
    s_mov_b32 s32, 0
    s_mov_b32 s33, 0
    s_mov_b32 s34, s21
    s_mov_b32 s37, 64
    v_mov_b32 v3, v1
    s_waitcnt vmcnt(0)
    s_barrier
    ds_read_b128 v[128:131], v3 offset:0
    ds_read_b128 v[132:135], v3 offset:20480
    ds_read_b128 v[136:139], v3 offset:1024
    ds_read_b128 v[140:143], v3 offset:21504
    ds_read_b128 v[144:147], v3 offset:2048
    ds_read_b128 v[148:151], v3 offset:22528
WS_69:
    ds_read_b128 v[152:155], v3 offset:3072
    ds_read_b128 v[156:159], v3 offset:23552
    s_waitcnt lgkmcnt(6)
    v_mfma_f32_16x16x32_bf16 v[64:67], a[0:3], v[128:131], 0
    v_mfma_f32_16x16x32_bf16 v[68:71], a[4:7], v[128:131], 0
    v_mfma_f32_16x16x32_bf16 v[72:75], a[8:11], v[128:131], 0
    v_mfma_f32_16x16x32_bf16 v[76:79], a[12:15], v[128:131], 0
    v_mfma_f32_16x16x32_bf16 v[80:83], a[0:3], v[132:135], 0
    v_mfma_f32_16x16x32_bf16 v[84:87], a[4:7], v[132:135], 0
    v_mfma_f32_16x16x32_bf16 v[88:91], a[8:11], v[132:135], 0
    v_mfma_f32_16x16x32_bf16 v[92:95], a[12:15], v[132:135], 0
    ds_read_b128 v[128:131], v3 offset:4096
    ds_read_b128 v[132:135], v3 offset:24576
    s_waitcnt lgkmcnt(6)
    s_cmp_eq_u32 s33, 0
    s_cbranch_scc1 WS_70
    v_mfma_f32_16x16x32_bf16 v[64:67], a[16:19], v[136:139], v[64:67]
    v_cvt_pk_bf16_f32 v160, v96, v100
    v_cvt_pk_bf16_f32 v161, v104, v108
    v_mfma_f32_16x16x32_bf16 v[68:71], a[20:23], v[136:139], v[68:71]
    v_cvt_pk_bf16_f32 v162, v97, v101
    v_cvt_pk_bf16_f32 v163, v105, v109
    v_mfma_f32_16x16x32_bf16 v[72:75], a[24:27], v[136:139], v[72:75]
    buffer_store_dwordx4 v[160:163], v1, s[16:19], s35 offen offset:0 sc1
    v_cvt_pk_bf16_f32 v164, v98, v102
    v_mfma_f32_16x16x32_bf16 v[76:79], a[28:31], v[136:139], v[76:79]
    v_cvt_pk_bf16_f32 v165, v106, v110
    v_cvt_pk_bf16_f32 v166, v99, v103
    v_mfma_f32_16x16x32_bf16 v[80:83], a[16:19], v[140:143], v[80:83]
    v_cvt_pk_bf16_f32 v167, v107, v111
    buffer_store_dwordx4 v[164:167], v1, s[16:19], s35 offen offset:1024 sc1
    v_mfma_f32_16x16x32_bf16 v[84:87], a[20:23], v[140:143], v[84:87]
    v_cvt_pk_bf16_f32 v168, v112, v116
    v_cvt_pk_bf16_f32 v169, v120, v124
    v_mfma_f32_16x16x32_bf16 v[88:91], a[24:27], v[140:143], v[88:91]
    v_cvt_pk_bf16_f32 v170, v113, v117
    v_cvt_pk_bf16_f32 v171, v121, v125
    v_mfma_f32_16x16x32_bf16 v[92:95], a[28:31], v[140:143], v[92:95]
    buffer_store_dwordx4 v[168:171], v1, s[16:19], s36 offen offset:0 sc1
    v_cvt_pk_bf16_f32 v172, v114, v118
    ds_read_b128 v[136:139], v3 offset:5120
    ds_read_b128 v[140:143], v3 offset:25600
    s_waitcnt lgkmcnt(6)
    v_mfma_f32_16x16x32_bf16 v[64:67], a[32:35], v[144:147], v[64:67]
    v_cvt_pk_bf16_f32 v173, v122, v126
    v_cvt_pk_bf16_f32 v174, v115, v119
    v_mfma_f32_16x16x32_bf16 v[68:71], a[36:39], v[144:147], v[68:71]
    v_cvt_pk_bf16_f32 v175, v123, v127
    buffer_store_dwordx4 v[172:175], v1, s[16:19], s36 offen offset:1024 sc1
    v_mfma_f32_16x16x32_bf16 v[72:75], a[40:43], v[144:147], v[72:75]
    v_mfma_f32_16x16x32_bf16 v[76:79], a[44:47], v[144:147], v[76:79]
    v_mfma_f32_16x16x32_bf16 v[80:83], a[32:35], v[148:151], v[80:83]
    v_mfma_f32_16x16x32_bf16 v[84:87], a[36:39], v[148:151], v[84:87]
    v_mfma_f32_16x16x32_bf16 v[88:91], a[40:43], v[148:151], v[88:91]
    v_mfma_f32_16x16x32_bf16 v[92:95], a[44:47], v[148:151], v[92:95]
    ds_read_b128 v[144:147], v3 offset:6144
    ds_read_b128 v[148:151], v3 offset:26624
    s_waitcnt lgkmcnt(6)
    v_mfma_f32_16x16x32_bf16 v[64:67], a[48:51], v[152:155], v[64:67]
    v_mfma_f32_16x16x32_bf16 v[68:71], a[52:55], v[152:155], v[68:71]
    v_mfma_f32_16x16x32_bf16 v[72:75], a[56:59], v[152:155], v[72:75]
    v_mfma_f32_16x16x32_bf16 v[76:79], a[60:63], v[152:155], v[76:79]
    v_mfma_f32_16x16x32_bf16 v[80:83], a[48:51], v[156:159], v[80:83]
    v_mfma_f32_16x16x32_bf16 v[84:87], a[52:55], v[156:159], v[84:87]
    v_mfma_f32_16x16x32_bf16 v[88:91], a[56:59], v[156:159], v[88:91]
    v_mfma_f32_16x16x32_bf16 v[92:95], a[60:63], v[156:159], v[92:95]
    ds_read_b128 v[152:155], v3 offset:7168
    ds_read_b128 v[156:159], v3 offset:27648
    s_waitcnt lgkmcnt(6)
    v_mfma_f32_16x16x32_bf16 v[64:67], a[64:67], v[128:131], v[64:67]
    v_mfma_f32_16x16x32_bf16 v[68:71], a[68:71], v[128:131], v[68:71]
    v_mfma_f32_16x16x32_bf16 v[72:75], a[72:75], v[128:131], v[72:75]
    v_mfma_f32_16x16x32_bf16 v[76:79], a[76:79], v[128:131], v[76:79]
    v_mfma_f32_16x16x32_bf16 v[80:83], a[64:67], v[132:135], v[80:83]
    v_mfma_f32_16x16x32_bf16 v[84:87], a[68:71], v[132:135], v[84:87]
    v_mfma_f32_16x16x32_bf16 v[88:91], a[72:75], v[132:135], v[88:91]
    v_mfma_f32_16x16x32_bf16 v[92:95], a[76:79], v[132:135], v[92:95]
    ds_read_b128 v[128:131], v3 offset:8192
    ds_read_b128 v[132:135], v3 offset:28672
    s_waitcnt lgkmcnt(6)
    v_mfma_f32_16x16x32_bf16 v[64:67], a[80:83], v[136:139], v[64:67]
    v_mfma_f32_16x16x32_bf16 v[68:71], a[84:87], v[136:139], v[68:71]
    v_mfma_f32_16x16x32_bf16 v[72:75], a[88:91], v[136:139], v[72:75]
    v_mfma_f32_16x16x32_bf16 v[76:79], a[92:95], v[136:139], v[76:79]
    v_mfma_f32_16x16x32_bf16 v[80:83], a[80:83], v[140:143], v[80:83]
    v_mfma_f32_16x16x32_bf16 v[84:87], a[84:87], v[140:143], v[84:87]
    v_mfma_f32_16x16x32_bf16 v[88:91], a[88:91], v[140:143], v[88:91]
    v_mfma_f32_16x16x32_bf16 v[92:95], a[92:95], v[140:143], v[92:95]
    ds_read_b128 v[136:139], v3 offset:9216
    ds_read_b128 v[140:143], v3 offset:29696
    s_waitcnt lgkmcnt(6)
    v_mfma_f32_16x16x32_bf16 v[64:67], a[96:99], v[144:147], v[64:67]
    v_mfma_f32_16x16x32_bf16 v[68:71], a[100:103], v[144:147], v[68:71]
    v_mfma_f32_16x16x32_bf16 v[72:75], a[104:107], v[144:147], v[72:75]
    v_mfma_f32_16x16x32_bf16 v[76:79], a[108:111], v[144:147], v[76:79]
    v_mfma_f32_16x16x32_bf16 v[80:83], a[96:99], v[148:151], v[80:83]
    v_mfma_f32_16x16x32_bf16 v[84:87], a[100:103], v[148:151], v[84:87]
    v_mfma_f32_16x16x32_bf16 v[88:91], a[104:107], v[148:151], v[88:91]
    v_mfma_f32_16x16x32_bf16 v[92:95], a[108:111], v[148:151], v[92:95]
    ds_read_b128 v[144:147], v3 offset:10240
    ds_read_b128 v[148:151], v3 offset:30720
    s_waitcnt lgkmcnt(6)
    v_mfma_f32_16x16x32_bf16 v[64:67], a[112:115], v[152:155], v[64:67]
    v_mfma_f32_16x16x32_bf16 v[68:71], a[116:119], v[152:155], v[68:71]
    v_mfma_f32_16x16x32_bf16 v[72:75], a[120:123], v[152:155], v[72:75]
    v_mfma_f32_16x16x32_bf16 v[76:79], a[124:127], v[152:155], v[76:79]
    v_mfma_f32_16x16x32_bf16 v[80:83], a[112:115], v[156:159], v[80:83]
    v_mfma_f32_16x16x32_bf16 v[84:87], a[116:119], v[156:159], v[84:87]
    v_mfma_f32_16x16x32_bf16 v[88:91], a[120:123], v[156:159], v[88:91]
    v_mfma_f32_16x16x32_bf16 v[92:95], a[124:127], v[156:159], v[92:95]
    ds_read_b128 v[152:155], v3 offset:11264
    ds_read_b128 v[156:159], v3 offset:31744
    s_waitcnt lgkmcnt(6)
    v_mfma_f32_16x16x32_bf16 v[64:67], a[128:131], v[128:131], v[64:67]
    v_mfma_f32_16x16x32_bf16 v[68:71], a[132:135], v[128:131], v[68:71]
    v_mfma_f32_16x16x32_bf16 v[72:75], a[136:139], v[128:131], v[72:75]
    v_mfma_f32_16x16x32_bf16 v[76:79], a[140:143], v[128:131], v[76:79]
    v_mfma_f32_16x16x32_bf16 v[80:83], a[128:131], v[132:135], v[80:83]
    v_mfma_f32_16x16x32_bf16 v[84:87], a[132:135], v[132:135], v[84:87]
    v_mfma_f32_16x16x32_bf16 v[88:91], a[136:139], v[132:135], v[88:91]
    v_mfma_f32_16x16x32_bf16 v[92:95], a[140:143], v[132:135], v[92:95]
    s_branch WS_71
WS_70:
    v_mfma_f32_16x16x32_bf16 v[64:67], a[16:19], v[136:139], v[64:67]
    v_mfma_f32_16x16x32_bf16 v[68:71], a[20:23], v[136:139], v[68:71]
    v_mfma_f32_16x16x32_bf16 v[72:75], a[24:27], v[136:139], v[72:75]
    v_mfma_f32_16x16x32_bf16 v[76:79], a[28:31], v[136:139], v[76:79]
    v_mfma_f32_16x16x32_bf16 v[80:83], a[16:19], v[140:143], v[80:83]
    v_mfma_f32_16x16x32_bf16 v[84:87], a[20:23], v[140:143], v[84:87]
    v_mfma_f32_16x16x32_bf16 v[88:91], a[24:27], v[140:143], v[88:91]
    v_mfma_f32_16x16x32_bf16 v[92:95], a[28:31], v[140:143], v[92:95]
    ds_read_b128 v[136:139], v3 offset:5120
    ds_read_b128 v[140:143], v3 offset:25600
    s_waitcnt lgkmcnt(6)
    v_mfma_f32_16x16x32_bf16 v[64:67], a[32:35], v[144:147], v[64:67]
    v_mfma_f32_16x16x32_bf16 v[68:71], a[36:39], v[144:147], v[68:71]
    v_mfma_f32_16x16x32_bf16 v[72:75], a[40:43], v[144:147], v[72:75]
    v_mfma_f32_16x16x32_bf16 v[76:79], a[44:47], v[144:147], v[76:79]
    v_mfma_f32_16x16x32_bf16 v[80:83], a[32:35], v[148:151], v[80:83]
    v_mfma_f32_16x16x32_bf16 v[84:87], a[36:39], v[148:151], v[84:87]
    v_mfma_f32_16x16x32_bf16 v[88:91], a[40:43], v[148:151], v[88:91]
    v_mfma_f32_16x16x32_bf16 v[92:95], a[44:47], v[148:151], v[92:95]
    ds_read_b128 v[144:147], v3 offset:6144
    ds_read_b128 v[148:151], v3 offset:26624
    s_waitcnt lgkmcnt(6)
    v_mfma_f32_16x16x32_bf16 v[64:67], a[48:51], v[152:155], v[64:67]
    v_mfma_f32_16x16x32_bf16 v[68:71], a[52:55], v[152:155], v[68:71]
    v_mfma_f32_16x16x32_bf16 v[72:75], a[56:59], v[152:155], v[72:75]
    v_mfma_f32_16x16x32_bf16 v[76:79], a[60:63], v[152:155], v[76:79]
    v_mfma_f32_16x16x32_bf16 v[80:83], a[48:51], v[156:159], v[80:83]
    v_mfma_f32_16x16x32_bf16 v[84:87], a[52:55], v[156:159], v[84:87]
    v_mfma_f32_16x16x32_bf16 v[88:91], a[56:59], v[156:159], v[88:91]
    v_mfma_f32_16x16x32_bf16 v[92:95], a[60:63], v[156:159], v[92:95]
    ds_read_b128 v[152:155], v3 offset:7168
    ds_read_b128 v[156:159], v3 offset:27648
    s_waitcnt lgkmcnt(6)
    v_mfma_f32_16x16x32_bf16 v[64:67], a[64:67], v[128:131], v[64:67]
    v_mfma_f32_16x16x32_bf16 v[68:71], a[68:71], v[128:131], v[68:71]
    v_mfma_f32_16x16x32_bf16 v[72:75], a[72:75], v[128:131], v[72:75]
    v_mfma_f32_16x16x32_bf16 v[76:79], a[76:79], v[128:131], v[76:79]
    v_mfma_f32_16x16x32_bf16 v[80:83], a[64:67], v[132:135], v[80:83]
    v_mfma_f32_16x16x32_bf16 v[84:87], a[68:71], v[132:135], v[84:87]
    v_mfma_f32_16x16x32_bf16 v[88:91], a[72:75], v[132:135], v[88:91]
    v_mfma_f32_16x16x32_bf16 v[92:95], a[76:79], v[132:135], v[92:95]
    ds_read_b128 v[128:131], v3 offset:8192
    ds_read_b128 v[132:135], v3 offset:28672
    s_waitcnt lgkmcnt(6)
    v_mfma_f32_16x16x32_bf16 v[64:67], a[80:83], v[136:139], v[64:67]
    v_mfma_f32_16x16x32_bf16 v[68:71], a[84:87], v[136:139], v[68:71]
    v_mfma_f32_16x16x32_bf16 v[72:75], a[88:91], v[136:139], v[72:75]
    v_mfma_f32_16x16x32_bf16 v[76:79], a[92:95], v[136:139], v[76:79]
    v_mfma_f32_16x16x32_bf16 v[80:83], a[80:83], v[140:143], v[80:83]
    v_mfma_f32_16x16x32_bf16 v[84:87], a[84:87], v[140:143], v[84:87]
    v_mfma_f32_16x16x32_bf16 v[88:91], a[88:91], v[140:143], v[88:91]
    v_mfma_f32_16x16x32_bf16 v[92:95], a[92:95], v[140:143], v[92:95]
    ds_read_b128 v[136:139], v3 offset:9216
    ds_read_b128 v[140:143], v3 offset:29696
    s_waitcnt lgkmcnt(6)
    v_mfma_f32_16x16x32_bf16 v[64:67], a[96:99], v[144:147], v[64:67]
    v_mfma_f32_16x16x32_bf16 v[68:71], a[100:103], v[144:147], v[68:71]
    v_mfma_f32_16x16x32_bf16 v[72:75], a[104:107], v[144:147], v[72:75]
    v_mfma_f32_16x16x32_bf16 v[76:79], a[108:111], v[144:147], v[76:79]
    v_mfma_f32_16x16x32_bf16 v[80:83], a[96:99], v[148:151], v[80:83]
    v_mfma_f32_16x16x32_bf16 v[84:87], a[100:103], v[148:151], v[84:87]
    v_mfma_f32_16x16x32_bf16 v[88:91], a[104:107], v[148:151], v[88:91]
    v_mfma_f32_16x16x32_bf16 v[92:95], a[108:111], v[148:151], v[92:95]
    ds_read_b128 v[144:147], v3 offset:10240
    ds_read_b128 v[148:151], v3 offset:30720
    s_waitcnt lgkmcnt(6)
    v_mfma_f32_16x16x32_bf16 v[64:67], a[112:115], v[152:155], v[64:67]
    v_mfma_f32_16x16x32_bf16 v[68:71], a[116:119], v[152:155], v[68:71]
    v_mfma_f32_16x16x32_bf16 v[72:75], a[120:123], v[152:155], v[72:75]
    v_mfma_f32_16x16x32_bf16 v[76:79], a[124:127], v[152:155], v[76:79]
    v_mfma_f32_16x16x32_bf16 v[80:83], a[112:115], v[156:159], v[80:83]
    v_mfma_f32_16x16x32_bf16 v[84:87], a[116:119], v[156:159], v[84:87]
    v_mfma_f32_16x16x32_bf16 v[88:91], a[120:123], v[156:159], v[88:91]
    v_mfma_f32_16x16x32_bf16 v[92:95], a[124:127], v[156:159], v[92:95]
    ds_read_b128 v[152:155], v3 offset:11264
    ds_read_b128 v[156:159], v3 offset:31744
    s_waitcnt lgkmcnt(6)
    v_mfma_f32_16x16x32_bf16 v[64:67], a[128:131], v[128:131], v[64:67]
    v_mfma_f32_16x16x32_bf16 v[68:71], a[132:135], v[128:131], v[68:71]
    v_mfma_f32_16x16x32_bf16 v[72:75], a[136:139], v[128:131], v[72:75]
    v_mfma_f32_16x16x32_bf16 v[76:79], a[140:143], v[128:131], v[76:79]
    v_mfma_f32_16x16x32_bf16 v[80:83], a[128:131], v[132:135], v[80:83]
    v_mfma_f32_16x16x32_bf16 v[84:87], a[132:135], v[132:135], v[84:87]
    v_mfma_f32_16x16x32_bf16 v[88:91], a[136:139], v[132:135], v[88:91]
    v_mfma_f32_16x16x32_bf16 v[92:95], a[140:143], v[132:135], v[92:95]
WS_71:
    ds_read_b128 v[128:131], v3 offset:12288
    ds_read_b128 v[132:135], v3 offset:32768
    s_waitcnt lgkmcnt(6)
    v_mfma_f32_16x16x32_bf16 v[64:67], a[144:147], v[136:139], v[64:67]
    v_mfma_f32_16x16x32_bf16 v[68:71], a[148:151], v[136:139], v[68:71]
    buffer_load_dwordx4 v1, s[12:15], s38 offen offset:2048 lds
    v_mfma_f32_16x16x32_bf16 v[72:75], a[152:155], v[136:139], v[72:75]
    v_mfma_f32_16x16x32_bf16 v[76:79], a[156:159], v[136:139], v[76:79]
    v_mfma_f32_16x16x32_bf16 v[80:83], a[144:147], v[140:143], v[80:83]
    v_mfma_f32_16x16x32_bf16 v[84:87], a[148:151], v[140:143], v[84:87]
    v_mfma_f32_16x16x32_bf16 v[88:91], a[152:155], v[140:143], v[88:91]
    v_mfma_f32_16x16x32_bf16 v[92:95], a[156:159], v[140:143], v[92:95]
    ds_read_b128 v[136:139], v3 offset:13312
    ds_read_b128 v[140:143], v3 offset:33792
    s_waitcnt lgkmcnt(6)
    v_mfma_f32_16x16x32_bf16 v[64:67], a[160:163], v[144:147], v[64:67]
    v_mfma_f32_16x16x32_bf16 v[68:71], a[164:167], v[144:147], v[68:71]
    buffer_load_dwordx4 v1, s[12:15], s38 offen offset:3072 lds
    v_mfma_f32_16x16x32_bf16 v[72:75], a[168:171], v[144:147], v[72:75]
    v_mfma_f32_16x16x32_bf16 v[76:79], a[172:175], v[144:147], v[76:79]
    v_mfma_f32_16x16x32_bf16 v[80:83], a[160:163], v[148:151], v[80:83]
    v_mfma_f32_16x16x32_bf16 v[84:87], a[164:167], v[148:151], v[84:87]
    v_mfma_f32_16x16x32_bf16 v[88:91], a[168:171], v[148:151], v[88:91]
    v_mfma_f32_16x16x32_bf16 v[92:95], a[172:175], v[148:151], v[92:95]
    ds_read_b128 v[144:147], v3 offset:14336
    ds_read_b128 v[148:151], v3 offset:34816
    s_waitcnt lgkmcnt(6)
    v_mfma_f32_16x16x32_bf16 v[64:67], a[176:179], v[152:155], v[64:67]
    v_mfma_f32_16x16x32_bf16 v[68:71], a[180:183], v[152:155], v[68:71]
    s_add_u32 m0, s29, 8192
    s_add_u32 s38, s27, 8192
    buffer_load_dwordx4 v1, s[12:15], s38 offen offset:0 lds
    v_mfma_f32_16x16x32_bf16 v[72:75], a[184:187], v[152:155], v[72:75]
    v_mfma_f32_16x16x32_bf16 v[76:79], a[188:191], v[152:155], v[76:79]
    v_mfma_f32_16x16x32_bf16 v[80:83], a[176:179], v[156:159], v[80:83]
    v_mfma_f32_16x16x32_bf16 v[84:87], a[180:183], v[156:159], v[84:87]
    v_mfma_f32_16x16x32_bf16 v[88:91], a[184:187], v[156:159], v[88:91]
    v_mfma_f32_16x16x32_bf16 v[92:95], a[188:191], v[156:159], v[92:95]
    ds_read_b128 v[152:155], v3 offset:15360
    ds_read_b128 v[156:159], v3 offset:35840
    s_waitcnt lgkmcnt(6)
    v_mfma_f32_16x16x32_bf16 v[64:67], a[192:195], v[128:131], v[64:67]
    v_mfma_f32_16x16x32_bf16 v[68:71], a[196:199], v[128:131], v[68:71]
    buffer_load_dwordx4 v1, s[12:15], s38 offen offset:1024 lds
    v_mfma_f32_16x16x32_bf16 v[72:75], a[200:203], v[128:131], v[72:75]
    v_mfma_f32_16x16x32_bf16 v[76:79], a[204:207], v[128:131], v[76:79]
    v_mfma_f32_16x16x32_bf16 v[80:83], a[192:195], v[132:135], v[80:83]
    v_mfma_f32_16x16x32_bf16 v[84:87], a[196:199], v[132:135], v[84:87]
    v_mfma_f32_16x16x32_bf16 v[88:91], a[200:203], v[132:135], v[88:91]
    v_mfma_f32_16x16x32_bf16 v[92:95], a[204:207], v[132:135], v[92:95]
    ds_read_b128 v[128:131], v3 offset:16384
    ds_read_b128 v[132:135], v3 offset:36864
    s_waitcnt lgkmcnt(6)
    v_mfma_f32_16x16x32_bf16 v[64:67], a[208:211], v[136:139], v[64:67]
    v_mfma_f32_16x16x32_bf16 v[68:71], a[212:215], v[136:139], v[68:71]
    v_mfma_f32_16x16x32_bf16 v[72:75], a[216:219], v[136:139], v[72:75]
    v_mfma_f32_16x16x32_bf16 v[76:79], a[220:223], v[136:139], v[76:79]
    v_mfma_f32_16x16x32_bf16 v[80:83], a[208:211], v[140:143], v[80:83]
    v_mfma_f32_16x16x32_bf16 v[84:87], a[212:215], v[140:143], v[84:87]
    v_mfma_f32_16x16x32_bf16 v[88:91], a[216:219], v[140:143], v[88:91]
    v_mfma_f32_16x16x32_bf16 v[92:95], a[220:223], v[140:143], v[92:95]
    ds_read_b128 v[136:139], v3 offset:17408
    ds_read_b128 v[140:143], v3 offset:37888
    s_waitcnt lgkmcnt(6)
    v_mfma_f32_16x16x32_bf16 v[64:67], a[224:227], v[144:147], v[64:67]
    v_mfma_f32_16x16x32_bf16 v[68:71], a[228:231], v[144:147], v[68:71]
    v_mfma_f32_16x16x32_bf16 v[72:75], a[232:235], v[144:147], v[72:75]
    v_mfma_f32_16x16x32_bf16 v[76:79], a[236:239], v[144:147], v[76:79]
    v_mfma_f32_16x16x32_bf16 v[80:83], a[224:227], v[148:151], v[80:83]
    v_mfma_f32_16x16x32_bf16 v[84:87], a[228:231], v[148:151], v[84:87]
    v_mfma_f32_16x16x32_bf16 v[88:91], a[232:235], v[148:151], v[88:91]
    v_mfma_f32_16x16x32_bf16 v[92:95], a[236:239], v[148:151], v[92:95]
    ds_read_b128 v[144:147], v3 offset:18432
    ds_read_b128 v[148:151], v3 offset:38912
    s_waitcnt lgkmcnt(6)
    v_mfma_f32_16x16x32_bf16 v[64:67], a[240:243], v[152:155], v[64:67]
    v_mfma_f32_16x16x32_bf16 v[68:71], a[244:247], v[152:155], v[68:71]
    v_mfma_f32_16x16x32_bf16 v[72:75], a[248:251], v[152:155], v[72:75]
    v_mfma_f32_16x16x32_bf16 v[76:79], a[252:255], v[152:155], v[76:79]
    v_mfma_f32_16x16x32_bf16 v[80:83], a[240:243], v[156:159], v[80:83]
    v_mfma_f32_16x16x32_bf16 v[84:87], a[244:247], v[156:159], v[84:87]
    v_mfma_f32_16x16x32_bf16 v[88:91], a[248:251], v[156:159], v[88:91]
    v_mfma_f32_16x16x32_bf16 v[92:95], a[252:255], v[156:159], v[92:95]
    ds_read_b128 v[152:155], v3 offset:19456
    ds_read_b128 v[156:159], v3 offset:39936
    s_waitcnt lgkmcnt(6)
    v_mfma_f32_16x16x32_bf16 v[64:67], v[192:195], v[128:131], v[64:67]
    v_mfma_f32_16x16x32_bf16 v[68:71], v[196:199], v[128:131], v[68:71]
    v_mfma_f32_16x16x32_bf16 v[72:75], v[200:203], v[128:131], v[72:75]
    v_mfma_f32_16x16x32_bf16 v[76:79], v[204:207], v[128:131], v[76:79]
    v_mfma_f32_16x16x32_bf16 v[80:83], v[192:195], v[132:135], v[80:83]
    v_mfma_f32_16x16x32_bf16 v[84:87], v[196:199], v[132:135], v[84:87]
    v_mfma_f32_16x16x32_bf16 v[88:91], v[200:203], v[132:135], v[88:91]
    v_mfma_f32_16x16x32_bf16 v[92:95], v[204:207], v[132:135], v[92:95]
    s_waitcnt vmcnt(0)
    s_barrier
    s_cmp_lg_u32 s23, 0
    s_cbranch_scc1 SG_72
    s_lshl_b32 s44, s37, 7
    s_add_u32 s44, s44, s39
    s_mov_b64 exec, 1
    v_mov_b32 v4, 1
    buffer_atomic_add v4, off, s[40:43], s44 sc1
    s_mov_b64 exec, -1
SG_72:
    s_add_u32 s31, s31, 4
    s_mul_i32 s27, s31, 40960
    s_add_u32 s27, s27, s28
    s_add_u32 s29, s30, s28
    s_add_u32 s30, s30, 40960
    s_cmp_eq_u32 s30, 122880
    s_cselect_b32 s30, 0, s30
    s_add_u32 s32, s32, 40960
    s_cmp_eq_u32 s32, 122880
    s_cselect_b32 s32, 0, s32
    v_add_u32 v3, s32, v1
    ds_read_b128 v[128:131], v3 offset:0
    ds_read_b128 v[132:135], v3 offset:20480
    s_waitcnt lgkmcnt(6)
    v_mfma_f32_16x16x32_bf16 v[64:67], v[208:211], v[136:139], v[64:67]
    v_mfma_f32_16x16x32_bf16 v[68:71], v[212:215], v[136:139], v[68:71]
    s_add_u32 m0, s29, 0
    s_add_u32 s38, s27, 0
    buffer_load_dwordx4 v1, s[12:15], s38 offen offset:0 lds
    v_mfma_f32_16x16x32_bf16 v[72:75], v[216:219], v[136:139], v[72:75]
    v_mfma_f32_16x16x32_bf16 v[76:79], v[220:223], v[136:139], v[76:79]
    v_mfma_f32_16x16x32_bf16 v[80:83], v[208:211], v[140:143], v[80:83]
    v_mfma_f32_16x16x32_bf16 v[84:87], v[212:215], v[140:143], v[84:87]
    buffer_load_dwordx4 v1, s[12:15], s38 offen offset:1024 lds
    v_mfma_f32_16x16x32_bf16 v[88:91], v[216:219], v[140:143], v[88:91]
    v_mfma_f32_16x16x32_bf16 v[92:95], v[220:223], v[140:143], v[92:95]
    ds_read_b128 v[136:139], v3 offset:1024
    ds_read_b128 v[140:143], v3 offset:21504
    s_waitcnt lgkmcnt(6)
    v_mfma_f32_16x16x32_bf16 v[64:67], v[224:227], v[144:147], v[64:67]
    v_mfma_f32_16x16x32_bf16 v[68:71], v[228:231], v[144:147], v[68:71]
    buffer_load_dwordx4 v1, s[12:15], s38 offen offset:2048 lds
    v_mfma_f32_16x16x32_bf16 v[72:75], v[232:235], v[144:147], v[72:75]
    v_mfma_f32_16x16x32_bf16 v[76:79], v[236:239], v[144:147], v[76:79]
    v_mfma_f32_16x16x32_bf16 v[80:83], v[224:227], v[148:151], v[80:83]
    v_mfma_f32_16x16x32_bf16 v[84:87], v[228:231], v[148:151], v[84:87]
    buffer_load_dwordx4 v1, s[12:15], s38 offen offset:3072 lds
    v_mfma_f32_16x16x32_bf16 v[88:91], v[232:235], v[148:151], v[88:91]
    v_mfma_f32_16x16x32_bf16 v[92:95], v[236:239], v[148:151], v[92:95]
    ds_read_b128 v[144:147], v3 offset:2048
    ds_read_b128 v[148:151], v3 offset:22528
    s_waitcnt lgkmcnt(6)
    v_mfma_f32_16x16x32_bf16 v[64:67], v[240:243], v[152:155], v[64:67]
    v_mfma_f32_16x16x32_bf16 v[68:71], v[244:247], v[152:155], v[68:71]
    s_add_u32 m0, s29, 4096
    s_add_u32 s38, s27, 4096
    buffer_load_dwordx4 v1, s[12:15], s38 offen offset:0 lds
    v_mfma_f32_16x16x32_bf16 v[72:75], v[248:251], v[152:155], v[72:75]
    v_mfma_f32_16x16x32_bf16 v[76:79], v[252:255], v[152:155], v[76:79]
    v_mfma_f32_16x16x32_bf16 v[80:83], v[240:243], v[156:159], v[80:83]
    v_mfma_f32_16x16x32_bf16 v[84:87], v[244:247], v[156:159], v[84:87]
    buffer_load_dwordx4 v1, s[12:15], s38 offen offset:1024 lds
    v_mfma_f32_16x16x32_bf16 v[88:91], v[248:251], v[156:159], v[88:91]
    v_mfma_f32_16x16x32_bf16 v[92:95], v[252:255], v[156:159], v[92:95]
    s_mov_b32 s37, s34
    s_mul_i32 s35, s37, 262144
    s_add_u32 s35, s35, s22
    s_add_u32 s36, s35, 131072
    s_add_u32 s34, s34, 4
    ds_read_b128 v[152:155], v3 offset:3072
    ds_read_b128 v[156:159], v3 offset:23552
    s_waitcnt lgkmcnt(6)
    v_mfma_f32_16x16x32_bf16 v[96:99], a[0:3], v[128:131], 0
    v_mfma_f32_16x16x32_bf16 v[100:103], a[4:7], v[128:131], 0
    v_mfma_f32_16x16x32_bf16 v[104:107], a[8:11], v[128:131], 0
    v_mfma_f32_16x16x32_bf16 v[108:111], a[12:15], v[128:131], 0
    v_mfma_f32_16x16x32_bf16 v[112:115], a[0:3], v[132:135], 0
    v_mfma_f32_16x16x32_bf16 v[116:119], a[4:7], v[132:135], 0
    v_mfma_f32_16x16x32_bf16 v[120:123], a[8:11], v[132:135], 0
    v_mfma_f32_16x16x32_bf16 v[124:127], a[12:15], v[132:135], 0
    ds_read_b128 v[128:131], v3 offset:4096
    ds_read_b128 v[132:135], v3 offset:24576
    s_waitcnt lgkmcnt(6)
    v_mfma_f32_16x16x32_bf16 v[96:99], a[16:19], v[136:139], v[96:99]
    v_cvt_pk_bf16_f32 v160, v64, v68
    v_cvt_pk_bf16_f32 v161, v72, v76
    v_mfma_f32_16x16x32_bf16 v[100:103], a[20:23], v[136:139], v[100:103]
    v_cvt_pk_bf16_f32 v162, v65, v69
    v_cvt_pk_bf16_f32 v163, v73, v77
    v_mfma_f32_16x16x32_bf16 v[104:107], a[24:27], v[136:139], v[104:107]
    buffer_store_dwordx4 v[160:163], v1, s[16:19], s35 offen offset:0 sc1
    v_cvt_pk_bf16_f32 v164, v66, v70
    v_mfma_f32_16x16x32_bf16 v[108:111], a[28:31], v[136:139], v[108:111]
    v_cvt_pk_bf16_f32 v165, v74, v78
    v_cvt_pk_bf16_f32 v166, v67, v71
    v_mfma_f32_16x16x32_bf16 v[112:115], a[16:19], v[140:143], v[112:115]
    v_cvt_pk_bf16_f32 v167, v75, v79
    buffer_store_dwordx4 v[164:167], v1, s[16:19], s35 offen offset:1024 sc1
    v_mfma_f32_16x16x32_bf16 v[116:119], a[20:23], v[140:143], v[116:119]
    v_cvt_pk_bf16_f32 v168, v80, v84
    v_cvt_pk_bf16_f32 v169, v88, v92
    v_mfma_f32_16x16x32_bf16 v[120:123], a[24:27], v[140:143], v[120:123]
    v_cvt_pk_bf16_f32 v170, v81, v85
    v_cvt_pk_bf16_f32 v171, v89, v93
    v_mfma_f32_16x16x32_bf16 v[124:127], a[28:31], v[140:143], v[124:127]
    buffer_store_dwordx4 v[168:171], v1, s[16:19], s36 offen offset:0 sc1
    v_cvt_pk_bf16_f32 v172, v82, v86
    ds_read_b128 v[136:139], v3 offset:5120
    ds_read_b128 v[140:143], v3 offset:25600
    s_waitcnt lgkmcnt(6)
    v_mfma_f32_16x16x32_bf16 v[96:99], a[32:35], v[144:147], v[96:99]
    v_cvt_pk_bf16_f32 v173, v90, v94
    v_cvt_pk_bf16_f32 v174, v83, v87
    v_mfma_f32_16x16x32_bf16 v[100:103], a[36:39], v[144:147], v[100:103]
    v_cvt_pk_bf16_f32 v175, v91, v95
    buffer_store_dwordx4 v[172:175], v1, s[16:19], s36 offen offset:1024 sc1
    v_mfma_f32_16x16x32_bf16 v[104:107], a[40:43], v[144:147], v[104:107]
    v_mfma_f32_16x16x32_bf16 v[108:111], a[44:47], v[144:147], v[108:111]
    v_mfma_f32_16x16x32_bf16 v[112:115], a[32:35], v[148:151], v[112:115]
    v_mfma_f32_16x16x32_bf16 v[116:119], a[36:39], v[148:151], v[116:119]
    v_mfma_f32_16x16x32_bf16 v[120:123], a[40:43], v[148:151], v[120:123]
    v_mfma_f32_16x16x32_bf16 v[124:127], a[44:47], v[148:151], v[124:127]
    ds_read_b128 v[144:147], v3 offset:6144
    ds_read_b128 v[148:151], v3 offset:26624
    s_waitcnt lgkmcnt(6)
    v_mfma_f32_16x16x32_bf16 v[96:99], a[48:51], v[152:155], v[96:99]
    v_mfma_f32_16x16x32_bf16 v[100:103], a[52:55], v[152:155], v[100:103]
    v_mfma_f32_16x16x32_bf16 v[104:107], a[56:59], v[152:155], v[104:107]
    v_mfma_f32_16x16x32_bf16 v[108:111], a[60:63], v[152:155], v[108:111]
    v_mfma_f32_16x16x32_bf16 v[112:115], a[48:51], v[156:159], v[112:115]
    v_mfma_f32_16x16x32_bf16 v[116:119], a[52:55], v[156:159], v[116:119]
    v_mfma_f32_16x16x32_bf16 v[120:123], a[56:59], v[156:159], v[120:123]
    v_mfma_f32_16x16x32_bf16 v[124:127], a[60:63], v[156:159], v[124:127]
    ds_read_b128 v[152:155], v3 offset:7168
    ds_read_b128 v[156:159], v3 offset:27648
    s_waitcnt lgkmcnt(6)
    v_mfma_f32_16x16x32_bf16 v[96:99], a[64:67], v[128:131], v[96:99]
    v_mfma_f32_16x16x32_bf16 v[100:103], a[68:71], v[128:131], v[100:103]
    v_mfma_f32_16x16x32_bf16 v[104:107], a[72:75], v[128:131], v[104:107]
    v_mfma_f32_16x16x32_bf16 v[108:111], a[76:79], v[128:131], v[108:111]
    v_mfma_f32_16x16x32_bf16 v[112:115], a[64:67], v[132:135], v[112:115]
    v_mfma_f32_16x16x32_bf16 v[116:119], a[68:71], v[132:135], v[116:119]
    v_mfma_f32_16x16x32_bf16 v[120:123], a[72:75], v[132:135], v[120:123]
    v_mfma_f32_16x16x32_bf16 v[124:127], a[76:79], v[132:135], v[124:127]
    ds_read_b128 v[128:131], v3 offset:8192
    ds_read_b128 v[132:135], v3 offset:28672
    s_waitcnt lgkmcnt(6)
    v_mfma_f32_16x16x32_bf16 v[96:99], a[80:83], v[136:139], v[96:99]
    v_mfma_f32_16x16x32_bf16 v[100:103], a[84:87], v[136:139], v[100:103]
    v_mfma_f32_16x16x32_bf16 v[104:107], a[88:91], v[136:139], v[104:107]
    v_mfma_f32_16x16x32_bf16 v[108:111], a[92:95], v[136:139], v[108:111]
    v_mfma_f32_16x16x32_bf16 v[112:115], a[80:83], v[140:143], v[112:115]
    v_mfma_f32_16x16x32_bf16 v[116:119], a[84:87], v[140:143], v[116:119]
    v_mfma_f32_16x16x32_bf16 v[120:123], a[88:91], v[140:143], v[120:123]
    v_mfma_f32_16x16x32_bf16 v[124:127], a[92:95], v[140:143], v[124:127]
    ds_read_b128 v[136:139], v3 offset:9216
    ds_read_b128 v[140:143], v3 offset:29696
    s_waitcnt lgkmcnt(6)
    v_mfma_f32_16x16x32_bf16 v[96:99], a[96:99], v[144:147], v[96:99]
    v_mfma_f32_16x16x32_bf16 v[100:103], a[100:103], v[144:147], v[100:103]
    v_mfma_f32_16x16x32_bf16 v[104:107], a[104:107], v[144:147], v[104:107]
    v_mfma_f32_16x16x32_bf16 v[108:111], a[108:111], v[144:147], v[108:111]
    v_mfma_f32_16x16x32_bf16 v[112:115], a[96:99], v[148:151], v[112:115]
    v_mfma_f32_16x16x32_bf16 v[116:119], a[100:103], v[148:151], v[116:119]
    v_mfma_f32_16x16x32_bf16 v[120:123], a[104:107], v[148:151], v[120:123]
    v_mfma_f32_16x16x32_bf16 v[124:127], a[108:111], v[148:151], v[124:127]
    ds_read_b128 v[144:147], v3 offset:10240
    ds_read_b128 v[148:151], v3 offset:30720
    s_waitcnt lgkmcnt(6)
    v_mfma_f32_16x16x32_bf16 v[96:99], a[112:115], v[152:155], v[96:99]
    v_mfma_f32_16x16x32_bf16 v[100:103], a[116:119], v[152:155], v[100:103]
    v_mfma_f32_16x16x32_bf16 v[104:107], a[120:123], v[152:155], v[104:107]
    v_mfma_f32_16x16x32_bf16 v[108:111], a[124:127], v[152:155], v[108:111]
    v_mfma_f32_16x16x32_bf16 v[112:115], a[112:115], v[156:159], v[112:115]
    v_mfma_f32_16x16x32_bf16 v[116:119], a[116:119], v[156:159], v[116:119]
    v_mfma_f32_16x16x32_bf16 v[120:123], a[120:123], v[156:159], v[120:123]
    v_mfma_f32_16x16x32_bf16 v[124:127], a[124:127], v[156:159], v[124:127]
    ds_read_b128 v[152:155], v3 offset:11264
    ds_read_b128 v[156:159], v3 offset:31744
    s_waitcnt lgkmcnt(6)
    v_mfma_f32_16x16x32_bf16 v[96:99], a[128:131], v[128:131], v[96:99]
    v_mfma_f32_16x16x32_bf16 v[100:103], a[132:135], v[128:131], v[100:103]
    v_mfma_f32_16x16x32_bf16 v[104:107], a[136:139], v[128:131], v[104:107]
    v_mfma_f32_16x16x32_bf16 v[108:111], a[140:143], v[128:131], v[108:111]
    v_mfma_f32_16x16x32_bf16 v[112:115], a[128:131], v[132:135], v[112:115]
    v_mfma_f32_16x16x32_bf16 v[116:119], a[132:135], v[132:135], v[116:119]
    v_mfma_f32_16x16x32_bf16 v[120:123], a[136:139], v[132:135], v[120:123]
    v_mfma_f32_16x16x32_bf16 v[124:127], a[140:143], v[132:135], v[124:127]
    ds_read_b128 v[128:131], v3 offset:12288
    ds_read_b128 v[132:135], v3 offset:32768
    s_waitcnt lgkmcnt(6)
    v_mfma_f32_16x16x32_bf16 v[96:99], a[144:147], v[136:139], v[96:99]
    v_mfma_f32_16x16x32_bf16 v[100:103], a[148:151], v[136:139], v[100:103]
    buffer_load_dwordx4 v1, s[12:15], s38 offen offset:2048 lds
    v_mfma_f32_16x16x32_bf16 v[104:107], a[152:155], v[136:139], v[104:107]
    v_mfma_f32_16x16x32_bf16 v[108:111], a[156:159], v[136:139], v[108:111]
    v_mfma_f32_16x16x32_bf16 v[112:115], a[144:147], v[140:143], v[112:115]
    v_mfma_f32_16x16x32_bf16 v[116:119], a[148:151], v[140:143], v[116:119]
    v_mfma_f32_16x16x32_bf16 v[120:123], a[152:155], v[140:143], v[120:123]
    v_mfma_f32_16x16x32_bf16 v[124:127], a[156:159], v[140:143], v[124:127]
    ds_read_b128 v[136:139], v3 offset:13312
    ds_read_b128 v[140:143], v3 offset:33792
    s_waitcnt lgkmcnt(6)
    v_mfma_f32_16x16x32_bf16 v[96:99], a[160:163], v[144:147], v[96:99]
    v_mfma_f32_16x16x32_bf16 v[100:103], a[164:167], v[144:147], v[100:103]
    buffer_load_dwordx4 v1, s[12:15], s38 offen offset:3072 lds
    v_mfma_f32_16x16x32_bf16 v[104:107], a[168:171], v[144:147], v[104:107]
    v_mfma_f32_16x16x32_bf16 v[108:111], a[172:175], v[144:147], v[108:111]
    v_mfma_f32_16x16x32_bf16 v[112:115], a[160:163], v[148:151], v[112:115]
    v_mfma_f32_16x16x32_bf16 v[116:119], a[164:167], v[148:151], v[116:119]
    v_mfma_f32_16x16x32_bf16 v[120:123], a[168:171], v[148:151], v[120:123]
    v_mfma_f32_16x16x32_bf16 v[124:127], a[172:175], v[148:151], v[124:127]
    ds_read_b128 v[144:147], v3 offset:14336
    ds_read_b128 v[148:151], v3 offset:34816
    s_waitcnt lgkmcnt(6)
    v_mfma_f32_16x16x32_bf16 v[96:99], a[176:179], v[152:155], v[96:99]
    v_mfma_f32_16x16x32_bf16 v[100:103], a[180:183], v[152:155], v[100:103]
    s_add_u32 m0, s29, 8192
    s_add_u32 s38, s27, 8192
    buffer_load_dwordx4 v1, s[12:15], s38 offen offset:0 lds
    v_mfma_f32_16x16x32_bf16 v[104:107], a[184:187], v[152:155], v[104:107]
    v_mfma_f32_16x16x32_bf16 v[108:111], a[188:191], v[152:155], v[108:111]
    v_mfma_f32_16x16x32_bf16 v[112:115], a[176:179], v[156:159], v[112:115]
    v_mfma_f32_16x16x32_bf16 v[116:119], a[180:183], v[156:159], v[116:119]
    v_mfma_f32_16x16x32_bf16 v[120:123], a[184:187], v[156:159], v[120:123]
    v_mfma_f32_16x16x32_bf16 v[124:127], a[188:191], v[156:159], v[124:127]
    ds_read_b128 v[152:155], v3 offset:15360
    ds_read_b128 v[156:159], v3 offset:35840
    s_waitcnt lgkmcnt(6)
    v_mfma_f32_16x16x32_bf16 v[96:99], a[192:195], v[128:131], v[96:99]
    v_mfma_f32_16x16x32_bf16 v[100:103], a[196:199], v[128:131], v[100:103]
    buffer_load_dwordx4 v1, s[12:15], s38 offen offset:1024 lds
    v_mfma_f32_16x16x32_bf16 v[104:107], a[200:203], v[128:131], v[104:107]
    v_mfma_f32_16x16x32_bf16 v[108:111], a[204:207], v[128:131], v[108:111]
    v_mfma_f32_16x16x32_bf16 v[112:115], a[192:195], v[132:135], v[112:115]
    v_mfma_f32_16x16x32_bf16 v[116:119], a[196:199], v[132:135], v[116:119]
    v_mfma_f32_16x16x32_bf16 v[120:123], a[200:203], v[132:135], v[120:123]
    v_mfma_f32_16x16x32_bf16 v[124:127], a[204:207], v[132:135], v[124:127]
    ds_read_b128 v[128:131], v3 offset:16384
    ds_read_b128 v[132:135], v3 offset:36864
    s_waitcnt lgkmcnt(6)
    v_mfma_f32_16x16x32_bf16 v[96:99], a[208:211], v[136:139], v[96:99]
    v_mfma_f32_16x16x32_bf16 v[100:103], a[212:215], v[136:139], v[100:103]
    v_mfma_f32_16x16x32_bf16 v[104:107], a[216:219], v[136:139], v[104:107]
    v_mfma_f32_16x16x32_bf16 v[108:111], a[220:223], v[136:139], v[108:111]
    v_mfma_f32_16x16x32_bf16 v[112:115], a[208:211], v[140:143], v[112:115]
    v_mfma_f32_16x16x32_bf16 v[116:119], a[212:215], v[140:143], v[116:119]
    v_mfma_f32_16x16x32_bf16 v[120:123], a[216:219], v[140:143], v[120:123]
    v_mfma_f32_16x16x32_bf16 v[124:127], a[220:223], v[140:143], v[124:127]
    ds_read_b128 v[136:139], v3 offset:17408
    ds_read_b128 v[140:143], v3 offset:37888
    s_waitcnt lgkmcnt(6)
    v_mfma_f32_16x16x32_bf16 v[96:99], a[224:227], v[144:147], v[96:99]
    v_mfma_f32_16x16x32_bf16 v[100:103], a[228:231], v[144:147], v[100:103]
    v_mfma_f32_16x16x32_bf16 v[104:107], a[232:235], v[144:147], v[104:107]
    v_mfma_f32_16x16x32_bf16 v[108:111], a[236:239], v[144:147], v[108:111]
    v_mfma_f32_16x16x32_bf16 v[112:115], a[224:227], v[148:151], v[112:115]
    v_mfma_f32_16x16x32_bf16 v[116:119], a[228:231], v[148:151], v[116:119]
    v_mfma_f32_16x16x32_bf16 v[120:123], a[232:235], v[148:151], v[120:123]
    v_mfma_f32_16x16x32_bf16 v[124:127], a[236:239], v[148:151], v[124:127]
    ds_read_b128 v[144:147], v3 offset:18432
    ds_read_b128 v[148:151], v3 offset:38912
    s_waitcnt lgkmcnt(6)
    v_mfma_f32_16x16x32_bf16 v[96:99], a[240:243], v[152:155], v[96:99]
    v_mfma_f32_16x16x32_bf16 v[100:103], a[244:247], v[152:155], v[100:103]
    v_mfma_f32_16x16x32_bf16 v[104:107], a[248:251], v[152:155], v[104:107]
    v_mfma_f32_16x16x32_bf16 v[108:111], a[252:255], v[152:155], v[108:111]
    v_mfma_f32_16x16x32_bf16 v[112:115], a[240:243], v[156:159], v[112:115]
    v_mfma_f32_16x16x32_bf16 v[116:119], a[244:247], v[156:159], v[116:119]
    v_mfma_f32_16x16x32_bf16 v[120:123], a[248:251], v[156:159], v[120:123]
    v_mfma_f32_16x16x32_bf16 v[124:127], a[252:255], v[156:159], v[124:127]
    ds_read_b128 v[152:155], v3 offset:19456
    ds_read_b128 v[156:159], v3 offset:39936
    s_waitcnt lgkmcnt(6)
    v_mfma_f32_16x16x32_bf16 v[96:99], v[192:195], v[128:131], v[96:99]
    v_mfma_f32_16x16x32_bf16 v[100:103], v[196:199], v[128:131], v[100:103]
    v_mfma_f32_16x16x32_bf16 v[104:107], v[200:203], v[128:131], v[104:107]
    v_mfma_f32_16x16x32_bf16 v[108:111], v[204:207], v[128:131], v[108:111]
    v_mfma_f32_16x16x32_bf16 v[112:115], v[192:195], v[132:135], v[112:115]
    v_mfma_f32_16x16x32_bf16 v[116:119], v[196:199], v[132:135], v[116:119]
    v_mfma_f32_16x16x32_bf16 v[120:123], v[200:203], v[132:135], v[120:123]
    v_mfma_f32_16x16x32_bf16 v[124:127], v[204:207], v[132:135], v[124:127]
    s_waitcnt vmcnt(0)
    s_barrier
    s_cmp_lg_u32 s23, 0
    s_cbranch_scc1 SG_73
    s_lshl_b32 s44, s37, 7
    s_add_u32 s44, s44, s39
    s_mov_b64 exec, 1
    v_mov_b32 v4, 1
    buffer_atomic_add v4, off, s[40:43], s44 sc1
    s_mov_b64 exec, -1
SG_73:
    s_add_u32 s31, s31, 4
    s_mul_i32 s27, s31, 40960
    s_add_u32 s27, s27, s28
    s_add_u32 s29, s30, s28
    s_add_u32 s30, s30, 40960
    s_cmp_eq_u32 s30, 122880
    s_cselect_b32 s30, 0, s30
    s_add_u32 s32, s32, 40960
    s_cmp_eq_u32 s32, 122880
    s_cselect_b32 s32, 0, s32
    v_add_u32 v3, s32, v1
    ds_read_b128 v[128:131], v3 offset:0
    ds_read_b128 v[132:135], v3 offset:20480
    s_waitcnt lgkmcnt(6)
    v_mfma_f32_16x16x32_bf16 v[96:99], v[208:211], v[136:139], v[96:99]
    v_mfma_f32_16x16x32_bf16 v[100:103], v[212:215], v[136:139], v[100:103]
    s_add_u32 m0, s29, 0
    s_add_u32 s38, s27, 0
    buffer_load_dwordx4 v1, s[12:15], s38 offen offset:0 lds
    v_mfma_f32_16x16x32_bf16 v[104:107], v[216:219], v[136:139], v[104:107]
    v_mfma_f32_16x16x32_bf16 v[108:111], v[220:223], v[136:139], v[108:111]
    v_mfma_f32_16x16x32_bf16 v[112:115], v[208:211], v[140:143], v[112:115]
    v_mfma_f32_16x16x32_bf16 v[116:119], v[212:215], v[140:143], v[116:119]
    buffer_load_dwordx4 v1, s[12:15], s38 offen offset:1024 lds
    v_mfma_f32_16x16x32_bf16 v[120:123], v[216:219], v[140:143], v[120:123]
    v_mfma_f32_16x16x32_bf16 v[124:127], v[220:223], v[140:143], v[124:127]
    ds_read_b128 v[136:139], v3 offset:1024
    ds_read_b128 v[140:143], v3 offset:21504
    s_waitcnt lgkmcnt(6)
    v_mfma_f32_16x16x32_bf16 v[96:99], v[224:227], v[144:147], v[96:99]
    v_mfma_f32_16x16x32_bf16 v[100:103], v[228:231], v[144:147], v[100:103]
    buffer_load_dwordx4 v1, s[12:15], s38 offen offset:2048 lds
    v_mfma_f32_16x16x32_bf16 v[104:107], v[232:235], v[144:147], v[104:107]
    v_mfma_f32_16x16x32_bf16 v[108:111], v[236:239], v[144:147], v[108:111]
    v_mfma_f32_16x16x32_bf16 v[112:115], v[224:227], v[148:151], v[112:115]
    v_mfma_f32_16x16x32_bf16 v[116:119], v[228:231], v[148:151], v[116:119]
    buffer_load_dwordx4 v1, s[12:15], s38 offen offset:3072 lds
    v_mfma_f32_16x16x32_bf16 v[120:123], v[232:235], v[148:151], v[120:123]
    v_mfma_f32_16x16x32_bf16 v[124:127], v[236:239], v[148:151], v[124:127]
    ds_read_b128 v[144:147], v3 offset:2048
    ds_read_b128 v[148:151], v3 offset:22528
    s_waitcnt lgkmcnt(6)
    v_mfma_f32_16x16x32_bf16 v[96:99], v[240:243], v[152:155], v[96:99]
    v_mfma_f32_16x16x32_bf16 v[100:103], v[244:247], v[152:155], v[100:103]
    s_add_u32 m0, s29, 4096
    s_add_u32 s38, s27, 4096
    buffer_load_dwordx4 v1, s[12:15], s38 offen offset:0 lds
    v_mfma_f32_16x16x32_bf16 v[104:107], v[248:251], v[152:155], v[104:107]
    v_mfma_f32_16x16x32_bf16 v[108:111], v[252:255], v[152:155], v[108:111]
    v_mfma_f32_16x16x32_bf16 v[112:115], v[240:243], v[156:159], v[112:115]
    v_mfma_f32_16x16x32_bf16 v[116:119], v[244:247], v[156:159], v[116:119]
    buffer_load_dwordx4 v1, s[12:15], s38 offen offset:1024 lds
    v_mfma_f32_16x16x32_bf16 v[120:123], v[248:251], v[156:159], v[120:123]
    v_mfma_f32_16x16x32_bf16 v[124:127], v[252:255], v[156:159], v[124:127]
    s_mov_b32 s37, s34
    s_mul_i32 s35, s37, 262144
    s_add_u32 s35, s35, s22
    s_add_u32 s36, s35, 131072
    s_add_u32 s34, s34, 4
    s_add_u32 s33, s33, 2
    s_cmp_lt_u32 s33, 16
    s_cbranch_scc1 WS_69
    s_nop 7
    v_cvt_pk_bf16_f32 v160, v96, v100
    v_cvt_pk_bf16_f32 v161, v104, v108
    v_cvt_pk_bf16_f32 v162, v97, v101
    v_cvt_pk_bf16_f32 v163, v105, v109
    buffer_store_dwordx4 v[160:163], v1, s[16:19], s35 offen offset:0 sc1
    v_cvt_pk_bf16_f32 v164, v98, v102
    v_cvt_pk_bf16_f32 v165, v106, v110
    v_cvt_pk_bf16_f32 v166, v99, v103
    v_cvt_pk_bf16_f32 v167, v107, v111
    buffer_store_dwordx4 v[164:167], v1, s[16:19], s35 offen offset:1024 sc1
    v_cvt_pk_bf16_f32 v168, v112, v116
    v_cvt_pk_bf16_f32 v169, v120, v124
    v_cvt_pk_bf16_f32 v170, v113, v117
    v_cvt_pk_bf16_f32 v171, v121, v125
    buffer_store_dwordx4 v[168:171], v1, s[16:19], s36 offen offset:0 sc1
    v_cvt_pk_bf16_f32 v172, v114, v118
    v_cvt_pk_bf16_f32 v173, v122, v126
    v_cvt_pk_bf16_f32 v174, v115, v119
    v_cvt_pk_bf16_f32 v175, v123, v127
    buffer_store_dwordx4 v[172:175], v1, s[16:19], s36 offen offset:1024 sc1
    s_waitcnt lgkmcnt(0) vmcnt(0)
    s_barrier
    s_cmp_lg_u32 s23, 0
    s_cbranch_scc1 SG_74
    s_lshl_b32 s44, s37, 7
    s_add_u32 s44, s44, s39
    s_mov_b64 exec, 1
    v_mov_b32 v4, 1
    buffer_atomic_add v4, off, s[40:43], s44 sc1
    s_mov_b64 exec, -1
SG_74:
    s_branch RW_13
QV_68:
    s_lshl_b32 s22, s24, 12
    v_and_b32 v1, 63, v0
    v_lshrrev_b32 v3, 4, v1
    v_mul_u32_u24 v2, 65536, v3
    v_and_b32 v3, 15, v1
    v_lshl_add_u32 v2, v3, 3, v2
    v_lshlrev_b32 v1, 4, v1
    s_mul_i32 s28, s23, 10240
    s_mov_b32 s30, 0
    s_mov_b32 s31, s21
    s_mul_i32 s27, s31, 40960
    s_add_u32 s27, s27, s28
    s_add_u32 s29, s30, s28
    s_mov_b32 m0, s29
    s_nop 0
    buffer_load_dwordx4 v1, s[12:15], s27 offen offset:0 lds
    buffer_load_dwordx4 v1, s[12:15], s27 offen offset:1024 lds
    buffer_load_dwordx4 v1, s[12:15], s27 offen offset:2048 lds
    buffer_load_dwordx4 v1, s[12:15], s27 offen offset:3072 lds
    s_add_u32 s27, s27, 4096
    s_add_u32 s29, s29, 4096
    s_mov_b32 m0, s29
    s_nop 0
    buffer_load_dwordx4 v1, s[12:15], s27 offen offset:0 lds
    buffer_load_dwordx4 v1, s[12:15], s27 offen offset:1024 lds
    buffer_load_dwordx4 v1, s[12:15], s27 offen offset:2048 lds
    buffer_load_dwordx4 v1, s[12:15], s27 offen offset:3072 lds
    s_add_u32 s27, s27, 4096
    s_add_u32 s29, s29, 4096
    s_mov_b32 m0, s29
    s_nop 0
    buffer_load_dwordx4 v1, s[12:15], s27 offen offset:0 lds
    buffer_load_dwordx4 v1, s[12:15], s27 offen offset:1024 lds
    s_mov_b32 s30, 40960
    s_add_u32 s31, s31, 4
    s_mul_i32 s27, s31, 40960
    s_add_u32 s27, s27, s28
    s_add_u32 s29, s30, s28
    s_mov_b32 m0, s29
    s_nop 0
    buffer_load_dwordx4 v1, s[12:15], s27 offen offset:0 lds
    buffer_load_dwordx4 v1, s[12:15], s27 offen offset:1024 lds
    buffer_load_dwordx4 v1, s[12:15], s27 offen offset:2048 lds
    buffer_load_dwordx4 v1, s[12:15], s27 offen offset:3072 lds
    s_add_u32 s27, s27, 4096
    s_add_u32 s29, s29, 4096
    s_mov_b32 m0, s29
    s_nop 0
    buffer_load_dwordx4 v1, s[12:15], s27 offen offset:0 lds
    buffer_load_dwordx4 v1, s[12:15], s27 offen offset:1024 lds
    buffer_load_dwordx4 v1, s[12:15], s27 offen offset:2048 lds
    buffer_load_dwordx4 v1, s[12:15], s27 offen offset:3072 lds
    s_add_u32 s27, s27, 4096
    s_add_u32 s29, s29, 4096
    s_mov_b32 m0, s29
    s_nop 0
    buffer_load_dwordx4 v1, s[12:15], s27 offen offset:0 lds
    buffer_load_dwordx4 v1, s[12:15], s27 offen offset:1024 lds
    s_mov_b32 s24, 0x05040100
    s_mov_b32 s25, 0x07060302
    s_mov_b32 s26, s20
    buffer_load_dwordx2 v[64:65], v2, s[8:11], s26 offen
    s_add_u32 s26, s26, 0x2000
    buffer_load_dwordx2 v[66:67], v2, s[8:11], s26 offen
    s_add_u32 s26, s26, 0x2000
    buffer_load_dwordx2 v[68:69], v2, s[8:11], s26 offen
    s_add_u32 s26, s26, 0x2000
    buffer_load_dwordx2 v[70:71], v2, s[8:11], s26 offen
    s_add_u32 s26, s26, 0x2000
    buffer_load_dwordx2 v[72:73], v2, s[8:11], s26 offen
    s_add_u32 s26, s26, 0x2000
    buffer_load_dwordx2 v[74:75], v2, s[8:11], s26 offen
    s_add_u32 s26, s26, 0x2000
    buffer_load_dwordx2 v[76:77], v2, s[8:11], s26 offen
    s_add_u32 s26, s26, 0x2000
    buffer_load_dwordx2 v[78:79], v2, s[8:11], s26 offen
    s_add_u32 s26, s26, 0x32000
    buffer_load_dwordx2 v[80:81], v2, s[8:11], s26 offen
    s_add_u32 s26, s26, 0x2000
    buffer_load_dwordx2 v[82:83], v2, s[8:11], s26 offen
    s_add_u32 s26, s26, 0x2000
    buffer_load_dwordx2 v[84:85], v2, s[8:11], s26 offen
    s_add_u32 s26, s26, 0x2000
    buffer_load_dwordx2 v[86:87], v2, s[8:11], s26 offen
    s_add_u32 s26, s26, 0x2000
    buffer_load_dwordx2 v[88:89], v2, s[8:11], s26 offen
    s_add_u32 s26, s26, 0x2000
    buffer_load_dwordx2 v[90:91], v2, s[8:11], s26 offen
    s_add_u32 s26, s26, 0x2000
    buffer_load_dwordx2 v[92:93], v2, s[8:11], s26 offen
    s_add_u32 s26, s26, 0x2000
    buffer_load_dwordx2 v[94:95], v2, s[8:11], s26 offen
    s_add_u32 s26, s26, 0x32000
    buffer_load_dwordx2 v[96:97], v2, s[8:11], s26 offen
    s_add_u32 s26, s26, 0x2000
    buffer_load_dwordx2 v[98:99], v2, s[8:11], s26 offen
    s_add_u32 s26, s26, 0x2000
    buffer_load_dwordx2 v[100:101], v2, s[8:11], s26 offen
    s_add_u32 s26, s26, 0x2000
    buffer_load_dwordx2 v[102:103], v2, s[8:11], s26 offen
    s_add_u32 s26, s26, 0x2000
    buffer_load_dwordx2 v[104:105], v2, s[8:11], s26 offen
    s_add_u32 s26, s26, 0x2000
    buffer_load_dwordx2 v[106:107], v2, s[8:11], s26 offen
    s_add_u32 s26, s26, 0x2000
    buffer_load_dwordx2 v[108:109], v2, s[8:11], s26 offen
    s_add_u32 s26, s26, 0x2000
    buffer_load_dwordx2 v[110:111], v2, s[8:11], s26 offen
    s_add_u32 s26, s26, 0x32000
    buffer_load_dwordx2 v[112:113], v2, s[8:11], s26 offen
    s_add_u32 s26, s26, 0x2000
    buffer_load_dwordx2 v[114:115], v2, s[8:11], s26 offen
    s_add_u32 s26, s26, 0x2000
    buffer_load_dwordx2 v[116:117], v2, s[8:11], s26 offen
    s_add_u32 s26, s26, 0x2000
    buffer_load_dwordx2 v[118:119], v2, s[8:11], s26 offen
    s_add_u32 s26, s26, 0x2000
    buffer_load_dwordx2 v[120:121], v2, s[8:11], s26 offen
    s_add_u32 s26, s26, 0x2000
    buffer_load_dwordx2 v[122:123], v2, s[8:11], s26 offen
    s_add_u32 s26, s26, 0x2000
    buffer_load_dwordx2 v[124:125], v2, s[8:11], s26 offen
    s_add_u32 s26, s26, 0x2000
    buffer_load_dwordx2 v[126:127], v2, s[8:11], s26 offen
    s_add_u32 s26, s26, 0x32000
    buffer_load_dwordx2 v[128:129], v2, s[8:11], s26 offen
    s_add_u32 s26, s26, 0x2000
    buffer_load_dwordx2 v[130:131], v2, s[8:11], s26 offen
    s_add_u32 s26, s26, 0x2000
    buffer_load_dwordx2 v[132:133], v2, s[8:11], s26 offen
    s_add_u32 s26, s26, 0x2000
    buffer_load_dwordx2 v[134:135], v2, s[8:11], s26 offen
    s_add_u32 s26, s26, 0x2000
    buffer_load_dwordx2 v[136:137], v2, s[8:11], s26 offen
    s_add_u32 s26, s26, 0x2000
    buffer_load_dwordx2 v[138:139], v2, s[8:11], s26 offen
    s_add_u32 s26, s26, 0x2000
    buffer_load_dwordx2 v[140:141], v2, s[8:11], s26 offen
    s_add_u32 s26, s26, 0x2000
    buffer_load_dwordx2 v[142:143], v2, s[8:11], s26 offen
    s_add_u32 s26, s26, 0x32000
    buffer_load_dwordx2 v[144:145], v2, s[8:11], s26 offen
    s_add_u32 s26, s26, 0x2000
    buffer_load_dwordx2 v[146:147], v2, s[8:11], s26 offen
    s_add_u32 s26, s26, 0x2000
    buffer_load_dwordx2 v[148:149], v2, s[8:11], s26 offen
    s_add_u32 s26, s26, 0x2000
    buffer_load_dwordx2 v[150:151], v2, s[8:11], s26 offen
    s_add_u32 s26, s26, 0x2000
    buffer_load_dwordx2 v[152:153], v2, s[8:11], s26 offen
    s_add_u32 s26, s26, 0x2000
    buffer_load_dwordx2 v[154:155], v2, s[8:11], s26 offen
    s_add_u32 s26, s26, 0x2000
    buffer_load_dwordx2 v[156:157], v2, s[8:11], s26 offen
    s_add_u32 s26, s26, 0x2000
    buffer_load_dwordx2 v[158:159], v2, s[8:11], s26 offen
    s_add_u32 s26, s26, 0x32000
    buffer_load_dwordx2 v[160:161], v2, s[8:11], s26 offen
    s_add_u32 s26, s26, 0x2000
    buffer_load_dwordx2 v[162:163], v2, s[8:11], s26 offen
    s_add_u32 s26, s26, 0x2000
    buffer_load_dwordx2 v[164:165], v2, s[8:11], s26 offen
    s_add_u32 s26, s26, 0x2000
    buffer_load_dwordx2 v[166:167], v2, s[8:11], s26 offen
    s_add_u32 s26, s26, 0x2000
    buffer_load_dwordx2 v[168:169], v2, s[8:11], s26 offen
    s_add_u32 s26, s26, 0x2000
    buffer_load_dwordx2 v[170:171], v2, s[8:11], s26 offen
    s_add_u32 s26, s26, 0x2000
    buffer_load_dwordx2 v[172:173], v2, s[8:11], s26 offen
    s_add_u32 s26, s26, 0x2000
    buffer_load_dwordx2 v[174:175], v2, s[8:11], s26 offen
    s_add_u32 s26, s26, 0x32000
    buffer_load_dwordx2 v[176:177], v2, s[8:11], s26 offen
    s_add_u32 s26, s26, 0x2000
    buffer_load_dwordx2 v[178:179], v2, s[8:11], s26 offen
    s_add_u32 s26, s26, 0x2000
    buffer_load_dwordx2 v[180:181], v2, s[8:11], s26 offen
    s_add_u32 s26, s26, 0x2000
    buffer_load_dwordx2 v[182:183], v2, s[8:11], s26 offen
    s_add_u32 s26, s26, 0x2000
    buffer_load_dwordx2 v[184:185], v2, s[8:11], s26 offen
    s_add_u32 s26, s26, 0x2000
    buffer_load_dwordx2 v[186:187], v2, s[8:11], s26 offen
    s_add_u32 s26, s26, 0x2000
    buffer_load_dwordx2 v[188:189], v2, s[8:11], s26 offen
    s_add_u32 s26, s26, 0x2000
    buffer_load_dwordx2 v[190:191], v2, s[8:11], s26 offen
    s_add_u32 s26, s26, 0x32000
    s_waitcnt vmcnt(56)
    v_perm_b32 v4, v66, v64, s24
    v_accvgpr_write_b32 a0, v4
    v_perm_b32 v5, v70, v68, s24
    v_accvgpr_write_b32 a1, v5
    v_perm_b32 v4, v74, v72, s24
    v_accvgpr_write_b32 a2, v4
    v_perm_b32 v5, v78, v76, s24
    v_accvgpr_write_b32 a3, v5
    v_perm_b32 v4, v66, v64, s25
    v_accvgpr_write_b32 a4, v4
    v_perm_b32 v5, v70, v68, s25
    v_accvgpr_write_b32 a5, v5
    v_perm_b32 v4, v74, v72, s25
    v_accvgpr_write_b32 a6, v4
    v_perm_b32 v5, v78, v76, s25
    v_accvgpr_write_b32 a7, v5
    v_perm_b32 v4, v67, v65, s24
    v_accvgpr_write_b32 a8, v4
    v_perm_b32 v5, v71, v69, s24
    v_accvgpr_write_b32 a9, v5
    v_perm_b32 v4, v75, v73, s24
    v_accvgpr_write_b32 a10, v4
    v_perm_b32 v5, v79, v77, s24
    v_accvgpr_write_b32 a11, v5
    v_perm_b32 v4, v67, v65, s25
    v_accvgpr_write_b32 a12, v4
    v_perm_b32 v5, v71, v69, s25
    v_accvgpr_write_b32 a13, v5
    v_perm_b32 v4, v75, v73, s25
    v_accvgpr_write_b32 a14, v4
    v_perm_b32 v5, v79, v77, s25
    v_accvgpr_write_b32 a15, v5
    buffer_load_dwordx2 v[64:65], v2, s[8:11], s26 offen
    s_add_u32 s26, s26, 0x2000
    buffer_load_dwordx2 v[66:67], v2, s[8:11], s26 offen
    s_add_u32 s26, s26, 0x2000
    buffer_load_dwordx2 v[68:69], v2, s[8:11], s26 offen
    s_add_u32 s26, s26, 0x2000
    buffer_load_dwordx2 v[70:71], v2, s[8:11], s26 offen
    s_add_u32 s26, s26, 0x2000
    buffer_load_dwordx2 v[72:73], v2, s[8:11], s26 offen
    s_add_u32 s26, s26, 0x2000
    buffer_load_dwordx2 v[74:75], v2, s[8:11], s26 offen
    s_add_u32 s26, s26, 0x2000
    buffer_load_dwordx2 v[76:77], v2, s[8:11], s26 offen
    s_add_u32 s26, s26, 0x2000
    buffer_load_dwordx2 v[78:79], v2, s[8:11], s26 offen
    s_add_u32 s26, s26, 0x32000
    s_waitcnt vmcnt(56)
    v_perm_b32 v4, v82, v80, s24
    v_accvgpr_write_b32 a16, v4
    v_perm_b32 v5, v86, v84, s24
    v_accvgpr_write_b32 a17, v5
    v_perm_b32 v4, v90, v88, s24
    v_accvgpr_write_b32 a18, v4
    v_perm_b32 v5, v94, v92, s24
    v_accvgpr_write_b32 a19, v5
    v_perm_b32 v4, v82, v80, s25
    v_accvgpr_write_b32 a20, v4
    v_perm_b32 v5, v86, v84, s25
    v_accvgpr_write_b32 a21, v5
    v_perm_b32 v4, v90, v88, s25
    v_accvgpr_write_b32 a22, v4
    v_perm_b32 v5, v94, v92, s25
    v_accvgpr_write_b32 a23, v5
    v_perm_b32 v4, v83, v81, s24
    v_accvgpr_write_b32 a24, v4
    v_perm_b32 v5, v87, v85, s24
    v_accvgpr_write_b32 a25, v5
    v_perm_b32 v4, v91, v89, s24
    v_accvgpr_write_b32 a26, v4
    v_perm_b32 v5, v95, v93, s24
    v_accvgpr_write_b32 a27, v5
    v_perm_b32 v4, v83, v81, s25
    v_accvgpr_write_b32 a28, v4
    v_perm_b32 v5, v87, v85, s25
    v_accvgpr_write_b32 a29, v5
    v_perm_b32 v4, v91, v89, s25
    v_accvgpr_write_b32 a30, v4
    v_perm_b32 v5, v95, v93, s25
    v_accvgpr_write_b32 a31, v5
    buffer_load_dwordx2 v[80:81], v2, s[8:11], s26 offen
    s_add_u32 s26, s26, 0x2000
    buffer_load_dwordx2 v[82:83], v2, s[8:11], s26 offen
    s_add_u32 s26, s26, 0x2000
    buffer_load_dwordx2 v[84:85], v2, s[8:11], s26 offen
    s_add_u32 s26, s26, 0x2000
    buffer_load_dwordx2 v[86:87], v2, s[8:11], s26 offen
    s_add_u32 s26, s26, 0x2000
    buffer_load_dwordx2 v[88:89], v2, s[8:11], s26 offen
    s_add_u32 s26, s26, 0x2000
    buffer_load_dwordx2 v[90:91], v2, s[8:11], s26 offen
    s_add_u32 s26, s26, 0x2000
    buffer_load_dwordx2 v[92:93], v2, s[8:11], s26 offen
    s_add_u32 s26, s26, 0x2000
    buffer_load_dwordx2 v[94:95], v2, s[8:11], s26 offen
    s_add_u32 s26, s26, 0x32000
    s_waitcnt vmcnt(56)
    v_perm_b32 v4, v98, v96, s24
    v_accvgpr_write_b32 a32, v4
    v_perm_b32 v5, v102, v100, s24
    v_accvgpr_write_b32 a33, v5
    v_perm_b32 v4, v106, v104, s24
    v_accvgpr_write_b32 a34, v4
    v_perm_b32 v5, v110, v108, s24
    v_accvgpr_write_b32 a35, v5
    v_perm_b32 v4, v98, v96, s25
    v_accvgpr_write_b32 a36, v4
    v_perm_b32 v5, v102, v100, s25
    v_accvgpr_write_b32 a37, v5
    v_perm_b32 v4, v106, v104, s25
    v_accvgpr_write_b32 a38, v4
    v_perm_b32 v5, v110, v108, s25
    v_accvgpr_write_b32 a39, v5
    v_perm_b32 v4, v99, v97, s24
    v_accvgpr_write_b32 a40, v4
    v_perm_b32 v5, v103, v101, s24
    v_accvgpr_write_b32 a41, v5
    v_perm_b32 v4, v107, v105, s24
    v_accvgpr_write_b32 a42, v4
    v_perm_b32 v5, v111, v109, s24
    v_accvgpr_write_b32 a43, v5
    v_perm_b32 v4, v99, v97, s25
    v_accvgpr_write_b32 a44, v4
    v_perm_b32 v5, v103, v101, s25
    v_accvgpr_write_b32 a45, v5
    v_perm_b32 v4, v107, v105, s25
    v_accvgpr_write_b32 a46, v4
    v_perm_b32 v5, v111, v109, s25
    v_accvgpr_write_b32 a47, v5
    buffer_load_dwordx2 v[96:97], v2, s[8:11], s26 offen
    s_add_u32 s26, s26, 0x2000
    buffer_load_dwordx2 v[98:99], v2, s[8:11], s26 offen
    s_add_u32 s26, s26, 0x2000
    buffer_load_dwordx2 v[100:101], v2, s[8:11], s26 offen
    s_add_u32 s26, s26, 0x2000
    buffer_load_dwordx2 v[102:103], v2, s[8:11], s26 offen
    s_add_u32 s26, s26, 0x2000
    buffer_load_dwordx2 v[104:105], v2, s[8:11], s26 offen
    s_add_u32 s26, s26, 0x2000
    buffer_load_dwordx2 v[106:107], v2, s[8:11], s26 offen
    s_add_u32 s26, s26, 0x2000
    buffer_load_dwordx2 v[108:109], v2, s[8:11], s26 offen
    s_add_u32 s26, s26, 0x2000
    buffer_load_dwordx2 v[110:111], v2, s[8:11], s26 offen
    s_add_u32 s26, s26, 0x32000
    s_waitcnt vmcnt(56)
    v_perm_b32 v4, v114, v112, s24
    v_accvgpr_write_b32 a48, v4
    v_perm_b32 v5, v118, v116, s24
    v_accvgpr_write_b32 a49, v5
    v_perm_b32 v4, v122, v120, s24
    v_accvgpr_write_b32 a50, v4
    v_perm_b32 v5, v126, v124, s24
    v_accvgpr_write_b32 a51, v5
    v_perm_b32 v4, v114, v112, s25
    v_accvgpr_write_b32 a52, v4
    v_perm_b32 v5, v118, v116, s25
    v_accvgpr_write_b32 a53, v5
    v_perm_b32 v4, v122, v120, s25
    v_accvgpr_write_b32 a54, v4
    v_perm_b32 v5, v126, v124, s25
    v_accvgpr_write_b32 a55, v5
    v_perm_b32 v4, v115, v113, s24
    v_accvgpr_write_b32 a56, v4
    v_perm_b32 v5, v119, v117, s24
    v_accvgpr_write_b32 a57, v5
    v_perm_b32 v4, v123, v121, s24
    v_accvgpr_write_b32 a58, v4
    v_perm_b32 v5, v127, v125, s24
    v_accvgpr_write_b32 a59, v5
    v_perm_b32 v4, v115, v113, s25
    v_accvgpr_write_b32 a60, v4
    v_perm_b32 v5, v119, v117, s25
    v_accvgpr_write_b32 a61, v5
    v_perm_b32 v4, v123, v121, s25
    v_accvgpr_write_b32 a62, v4
    v_perm_b32 v5, v127, v125, s25
    v_accvgpr_write_b32 a63, v5
    buffer_load_dwordx2 v[112:113], v2, s[8:11], s26 offen
    s_add_u32 s26, s26, 0x2000
    buffer_load_dwordx2 v[114:115], v2, s[8:11], s26 offen
    s_add_u32 s26, s26, 0x2000
    buffer_load_dwordx2 v[116:117], v2, s[8:11], s26 offen
    s_add_u32 s26, s26, 0x2000
    buffer_load_dwordx2 v[118:119], v2, s[8:11], s26 offen
    s_add_u32 s26, s26, 0x2000
    buffer_load_dwordx2 v[120:121], v2, s[8:11], s26 offen
    s_add_u32 s26, s26, 0x2000
    buffer_load_dwordx2 v[122:123], v2, s[8:11], s26 offen
    s_add_u32 s26, s26, 0x2000
    buffer_load_dwordx2 v[124:125], v2, s[8:11], s26 offen
    s_add_u32 s26, s26, 0x2000
    buffer_load_dwordx2 v[126:127], v2, s[8:11], s26 offen
    s_add_u32 s26, s26, 0x32000
    s_waitcnt vmcnt(56)
    v_perm_b32 v4, v130, v128, s24
    v_accvgpr_write_b32 a64, v4
    v_perm_b32 v5, v134, v132, s24
    v_accvgpr_write_b32 a65, v5
    v_perm_b32 v4, v138, v136, s24
    v_accvgpr_write_b32 a66, v4
    v_perm_b32 v5, v142, v140, s24
    v_accvgpr_write_b32 a67, v5
    v_perm_b32 v4, v130, v128, s25
    v_accvgpr_write_b32 a68, v4
    v_perm_b32 v5, v134, v132, s25
    v_accvgpr_write_b32 a69, v5
    v_perm_b32 v4, v138, v136, s25
    v_accvgpr_write_b32 a70, v4
    v_perm_b32 v5, v142, v140, s25
    v_accvgpr_write_b32 a71, v5
    v_perm_b32 v4, v131, v129, s24
    v_accvgpr_write_b32 a72, v4
    v_perm_b32 v5, v135, v133, s24
    v_accvgpr_write_b32 a73, v5
    v_perm_b32 v4, v139, v137, s24
    v_accvgpr_write_b32 a74, v4
    v_perm_b32 v5, v143, v141, s24
    v_accvgpr_write_b32 a75, v5
    v_perm_b32 v4, v131, v129, s25
    v_accvgpr_write_b32 a76, v4
    v_perm_b32 v5, v135, v133, s25
    v_accvgpr_write_b32 a77, v5
    v_perm_b32 v4, v139, v137, s25
    v_accvgpr_write_b32 a78, v4
    v_perm_b32 v5, v143, v141, s25
    v_accvgpr_write_b32 a79, v5
    buffer_load_dwordx2 v[128:129], v2, s[8:11], s26 offen
    s_add_u32 s26, s26, 0x2000
    buffer_load_dwordx2 v[130:131], v2, s[8:11], s26 offen
    s_add_u32 s26, s26, 0x2000
    buffer_load_dwordx2 v[132:133], v2, s[8:11], s26 offen
    s_add_u32 s26, s26, 0x2000
    buffer_load_dwordx2 v[134:135], v2, s[8:11], s26 offen
    s_add_u32 s26, s26, 0x2000
    buffer_load_dwordx2 v[136:137], v2, s[8:11], s26 offen
    s_add_u32 s26, s26, 0x2000
    buffer_load_dwordx2 v[138:139], v2, s[8:11], s26 offen
    s_add_u32 s26, s26, 0x2000
    buffer_load_dwordx2 v[140:141], v2, s[8:11], s26 offen
    s_add_u32 s26, s26, 0x2000
    buffer_load_dwordx2 v[142:143], v2, s[8:11], s26 offen
    s_add_u32 s26, s26, 0x32000
    s_waitcnt vmcnt(56)
    v_perm_b32 v4, v146, v144, s24
    v_accvgpr_write_b32 a80, v4
    v_perm_b32 v5, v150, v148, s24
    v_accvgpr_write_b32 a81, v5
    v_perm_b32 v4, v154, v152, s24
    v_accvgpr_write_b32 a82, v4
    v_perm_b32 v5, v158, v156, s24
    v_accvgpr_write_b32 a83, v5
    v_perm_b32 v4, v146, v144, s25
    v_accvgpr_write_b32 a84, v4
    v_perm_b32 v5, v150, v148, s25
    v_accvgpr_write_b32 a85, v5
    v_perm_b32 v4, v154, v152, s25
    v_accvgpr_write_b32 a86, v4
    v_perm_b32 v5, v158, v156, s25
    v_accvgpr_write_b32 a87, v5
    v_perm_b32 v4, v147, v145, s24
    v_accvgpr_write_b32 a88, v4
    v_perm_b32 v5, v151, v149, s24
    v_accvgpr_write_b32 a89, v5
    v_perm_b32 v4, v155, v153, s24
    v_accvgpr_write_b32 a90, v4
    v_perm_b32 v5, v159, v157, s24
    v_accvgpr_write_b32 a91, v5
    v_perm_b32 v4, v147, v145, s25
    v_accvgpr_write_b32 a92, v4
    v_perm_b32 v5, v151, v149, s25
    v_accvgpr_write_b32 a93, v5
    v_perm_b32 v4, v155, v153, s25
    v_accvgpr_write_b32 a94, v4
    v_perm_b32 v5, v159, v157, s25
    v_accvgpr_write_b32 a95, v5
    buffer_load_dwordx2 v[144:145], v2, s[8:11], s26 offen
    s_add_u32 s26, s26, 0x2000
    buffer_load_dwordx2 v[146:147], v2, s[8:11], s26 offen
    s_add_u32 s26, s26, 0x2000
    buffer_load_dwordx2 v[148:149], v2, s[8:11], s26 offen
    s_add_u32 s26, s26, 0x2000
    buffer_load_dwordx2 v[150:151], v2, s[8:11], s26 offen
    s_add_u32 s26, s26, 0x2000
    buffer_load_dwordx2 v[152:153], v2, s[8:11], s26 offen
    s_add_u32 s26, s26, 0x2000
    buffer_load_dwordx2 v[154:155], v2, s[8:11], s26 offen
    s_add_u32 s26, s26, 0x2000
    buffer_load_dwordx2 v[156:157], v2, s[8:11], s26 offen
    s_add_u32 s26, s26, 0x2000
    buffer_load_dwordx2 v[158:159], v2, s[8:11], s26 offen
    s_add_u32 s26, s26, 0x32000
    s_waitcnt vmcnt(56)
    v_perm_b32 v4, v162, v160, s24
    v_accvgpr_write_b32 a96, v4
    v_perm_b32 v5, v166, v164, s24
    v_accvgpr_write_b32 a97, v5
    v_perm_b32 v4, v170, v168, s24
    v_accvgpr_write_b32 a98, v4
    v_perm_b32 v5, v174, v172, s24
    v_accvgpr_write_b32 a99, v5
    v_perm_b32 v4, v162, v160, s25
    v_accvgpr_write_b32 a100, v4
    v_perm_b32 v5, v166, v164, s25
    v_accvgpr_write_b32 a101, v5
    v_perm_b32 v4, v170, v168, s25
    v_accvgpr_write_b32 a102, v4
    v_perm_b32 v5, v174, v172, s25
    v_accvgpr_write_b32 a103, v5
    v_perm_b32 v4, v163, v161, s24
    v_accvgpr_write_b32 a104, v4
    v_perm_b32 v5, v167, v165, s24
    v_accvgpr_write_b32 a105, v5
    v_perm_b32 v4, v171, v169, s24
    v_accvgpr_write_b32 a106, v4
    v_perm_b32 v5, v175, v173, s24
    v_accvgpr_write_b32 a107, v5
    v_perm_b32 v4, v163, v161, s25
    v_accvgpr_write_b32 a108, v4
    v_perm_b32 v5, v167, v165, s25
    v_accvgpr_write_b32 a109, v5
    v_perm_b32 v4, v171, v169, s25
    v_accvgpr_write_b32 a110, v4
    v_perm_b32 v5, v175, v173, s25
    v_accvgpr_write_b32 a111, v5
    buffer_load_dwordx2 v[160:161], v2, s[8:11], s26 offen
    s_add_u32 s26, s26, 0x2000
    buffer_load_dwordx2 v[162:163], v2, s[8:11], s26 offen
    s_add_u32 s26, s26, 0x2000
    buffer_load_dwordx2 v[164:165], v2, s[8:11], s26 offen
    s_add_u32 s26, s26, 0x2000
    buffer_load_dwordx2 v[166:167], v2, s[8:11], s26 offen
    s_add_u32 s26, s26, 0x2000
    buffer_load_dwordx2 v[168:169], v2, s[8:11], s26 offen
    s_add_u32 s26, s26, 0x2000
    buffer_load_dwordx2 v[170:171], v2, s[8:11], s26 offen
    s_add_u32 s26, s26, 0x2000
    buffer_load_dwordx2 v[172:173], v2, s[8:11], s26 offen
    s_add_u32 s26, s26, 0x2000
    buffer_load_dwordx2 v[174:175], v2, s[8:11], s26 offen
    s_add_u32 s26, s26, 0x32000
    s_waitcnt vmcnt(56)
    v_perm_b32 v4, v178, v176, s24
    v_accvgpr_write_b32 a112, v4
    v_perm_b32 v5, v182, v180, s24
    v_accvgpr_write_b32 a113, v5
    v_perm_b32 v4, v186, v184, s24
    v_accvgpr_write_b32 a114, v4
    v_perm_b32 v5, v190, v188, s24
    v_accvgpr_write_b32 a115, v5
    v_perm_b32 v4, v178, v176, s25
    v_accvgpr_write_b32 a116, v4
    v_perm_b32 v5, v182, v180, s25
    v_accvgpr_write_b32 a117, v5
    v_perm_b32 v4, v186, v184, s25
    v_accvgpr_write_b32 a118, v4
    v_perm_b32 v5, v190, v188, s25
    v_accvgpr_write_b32 a119, v5
    v_perm_b32 v4, v179, v177, s24
    v_accvgpr_write_b32 a120, v4
    v_perm_b32 v5, v183, v181, s24
    v_accvgpr_write_b32 a121, v5
    v_perm_b32 v4, v187, v185, s24
    v_accvgpr_write_b32 a122, v4
    v_perm_b32 v5, v191, v189, s24
    v_accvgpr_write_b32 a123, v5
    v_perm_b32 v4, v179, v177, s25
    v_accvgpr_write_b32 a124, v4
    v_perm_b32 v5, v183, v181, s25
    v_accvgpr_write_b32 a125, v5
    v_perm_b32 v4, v187, v185, s25
    v_accvgpr_write_b32 a126, v4
    v_perm_b32 v5, v191, v189, s25
    v_accvgpr_write_b32 a127, v5
    buffer_load_dwordx2 v[176:177], v2, s[8:11], s26 offen
    s_add_u32 s26, s26, 0x2000
    buffer_load_dwordx2 v[178:179], v2, s[8:11], s26 offen
    s_add_u32 s26, s26, 0x2000
    buffer_load_dwordx2 v[180:181], v2, s[8:11], s26 offen
    s_add_u32 s26, s26, 0x2000
    buffer_load_dwordx2 v[182:183], v2, s[8:11], s26 offen
    s_add_u32 s26, s26, 0x2000
    buffer_load_dwordx2 v[184:185], v2, s[8:11], s26 offen
    s_add_u32 s26, s26, 0x2000
    buffer_load_dwordx2 v[186:187], v2, s[8:11], s26 offen
    s_add_u32 s26, s26, 0x2000
    buffer_load_dwordx2 v[188:189], v2, s[8:11], s26 offen
    s_add_u32 s26, s26, 0x2000
    buffer_load_dwordx2 v[190:191], v2, s[8:11], s26 offen
    s_add_u32 s26, s26, 0x32000
    s_waitcnt vmcnt(56)
    v_perm_b32 v4, v66, v64, s24
    v_accvgpr_write_b32 a128, v4
    v_perm_b32 v5, v70, v68, s24
    v_accvgpr_write_b32 a129, v5
    v_perm_b32 v4, v74, v72, s24
    v_accvgpr_write_b32 a130, v4
    v_perm_b32 v5, v78, v76, s24
    v_accvgpr_write_b32 a131, v5
    v_perm_b32 v4, v66, v64, s25
    v_accvgpr_write_b32 a132, v4
    v_perm_b32 v5, v70, v68, s25
    v_accvgpr_write_b32 a133, v5
    v_perm_b32 v4, v74, v72, s25
    v_accvgpr_write_b32 a134, v4
    v_perm_b32 v5, v78, v76, s25
    v_accvgpr_write_b32 a135, v5
    v_perm_b32 v4, v67, v65, s24
    v_accvgpr_write_b32 a136, v4
    v_perm_b32 v5, v71, v69, s24
    v_accvgpr_write_b32 a137, v5
    v_perm_b32 v4, v75, v73, s24
    v_accvgpr_write_b32 a138, v4
    v_perm_b32 v5, v79, v77, s24
    v_accvgpr_write_b32 a139, v5
    v_perm_b32 v4, v67, v65, s25
    v_accvgpr_write_b32 a140, v4
    v_perm_b32 v5, v71, v69, s25
    v_accvgpr_write_b32 a141, v5
    v_perm_b32 v4, v75, v73, s25
    v_accvgpr_write_b32 a142, v4
    v_perm_b32 v5, v79, v77, s25
    v_accvgpr_write_b32 a143, v5
    buffer_load_dwordx2 v[64:65], v2, s[8:11], s26 offen
    s_add_u32 s26, s26, 0x2000
    buffer_load_dwordx2 v[66:67], v2, s[8:11], s26 offen
    s_add_u32 s26, s26, 0x2000
    buffer_load_dwordx2 v[68:69], v2, s[8:11], s26 offen
    s_add_u32 s26, s26, 0x2000
    buffer_load_dwordx2 v[70:71], v2, s[8:11], s26 offen
    s_add_u32 s26, s26, 0x2000
    buffer_load_dwordx2 v[72:73], v2, s[8:11], s26 offen
    s_add_u32 s26, s26, 0x2000
    buffer_load_dwordx2 v[74:75], v2, s[8:11], s26 offen
    s_add_u32 s26, s26, 0x2000
    buffer_load_dwordx2 v[76:77], v2, s[8:11], s26 offen
    s_add_u32 s26, s26, 0x2000
    buffer_load_dwordx2 v[78:79], v2, s[8:11], s26 offen
    s_add_u32 s26, s26, 0x32000
    s_waitcnt vmcnt(56)
    v_perm_b32 v4, v82, v80, s24
    v_accvgpr_write_b32 a144, v4
    v_perm_b32 v5, v86, v84, s24
    v_accvgpr_write_b32 a145, v5
    v_perm_b32 v4, v90, v88, s24
    v_accvgpr_write_b32 a146, v4
    v_perm_b32 v5, v94, v92, s24
    v_accvgpr_write_b32 a147, v5
    v_perm_b32 v4, v82, v80, s25
    v_accvgpr_write_b32 a148, v4
    v_perm_b32 v5, v86, v84, s25
    v_accvgpr_write_b32 a149, v5
    v_perm_b32 v4, v90, v88, s25
    v_accvgpr_write_b32 a150, v4
    v_perm_b32 v5, v94, v92, s25
    v_accvgpr_write_b32 a151, v5
    v_perm_b32 v4, v83, v81, s24
    v_accvgpr_write_b32 a152, v4
    v_perm_b32 v5, v87, v85, s24
    v_accvgpr_write_b32 a153, v5
    v_perm_b32 v4, v91, v89, s24
    v_accvgpr_write_b32 a154, v4
    v_perm_b32 v5, v95, v93, s24
    v_accvgpr_write_b32 a155, v5
    v_perm_b32 v4, v83, v81, s25
    v_accvgpr_write_b32 a156, v4
    v_perm_b32 v5, v87, v85, s25
    v_accvgpr_write_b32 a157, v5
    v_perm_b32 v4, v91, v89, s25
    v_accvgpr_write_b32 a158, v4
    v_perm_b32 v5, v95, v93, s25
    v_accvgpr_write_b32 a159, v5
    buffer_load_dwordx2 v[80:81], v2, s[8:11], s26 offen
    s_add_u32 s26, s26, 0x2000
    buffer_load_dwordx2 v[82:83], v2, s[8:11], s26 offen
    s_add_u32 s26, s26, 0x2000
    buffer_load_dwordx2 v[84:85], v2, s[8:11], s26 offen
    s_add_u32 s26, s26, 0x2000
    buffer_load_dwordx2 v[86:87], v2, s[8:11], s26 offen
    s_add_u32 s26, s26, 0x2000
    buffer_load_dwordx2 v[88:89], v2, s[8:11], s26 offen
    s_add_u32 s26, s26, 0x2000
    buffer_load_dwordx2 v[90:91], v2, s[8:11], s26 offen
    s_add_u32 s26, s26, 0x2000
    buffer_load_dwordx2 v[92:93], v2, s[8:11], s26 offen
    s_add_u32 s26, s26, 0x2000
    buffer_load_dwordx2 v[94:95], v2, s[8:11], s26 offen
    s_add_u32 s26, s26, 0x32000
    s_waitcnt vmcnt(56)
    v_perm_b32 v4, v98, v96, s24
    v_accvgpr_write_b32 a160, v4
    v_perm_b32 v5, v102, v100, s24
    v_accvgpr_write_b32 a161, v5
    v_perm_b32 v4, v106, v104, s24
    v_accvgpr_write_b32 a162, v4
    v_perm_b32 v5, v110, v108, s24
    v_accvgpr_write_b32 a163, v5
    v_perm_b32 v4, v98, v96, s25
    v_accvgpr_write_b32 a164, v4
    v_perm_b32 v5, v102, v100, s25
    v_accvgpr_write_b32 a165, v5
    v_perm_b32 v4, v106, v104, s25
    v_accvgpr_write_b32 a166, v4
    v_perm_b32 v5, v110, v108, s25
    v_accvgpr_write_b32 a167, v5
    v_perm_b32 v4, v99, v97, s24
    v_accvgpr_write_b32 a168, v4
    v_perm_b32 v5, v103, v101, s24
    v_accvgpr_write_b32 a169, v5
    v_perm_b32 v4, v107, v105, s24
    v_accvgpr_write_b32 a170, v4
    v_perm_b32 v5, v111, v109, s24
    v_accvgpr_write_b32 a171, v5
    v_perm_b32 v4, v99, v97, s25
    v_accvgpr_write_b32 a172, v4
    v_perm_b32 v5, v103, v101, s25
    v_accvgpr_write_b32 a173, v5
    v_perm_b32 v4, v107, v105, s25
    v_accvgpr_write_b32 a174, v4
    v_perm_b32 v5, v111, v109, s25
    v_accvgpr_write_b32 a175, v5
    buffer_load_dwordx2 v[96:97], v2, s[8:11], s26 offen
    s_add_u32 s26, s26, 0x2000
    buffer_load_dwordx2 v[98:99], v2, s[8:11], s26 offen
    s_add_u32 s26, s26, 0x2000
    buffer_load_dwordx2 v[100:101], v2, s[8:11], s26 offen
    s_add_u32 s26, s26, 0x2000
    buffer_load_dwordx2 v[102:103], v2, s[8:11], s26 offen
    s_add_u32 s26, s26, 0x2000
    buffer_load_dwordx2 v[104:105], v2, s[8:11], s26 offen
    s_add_u32 s26, s26, 0x2000
    buffer_load_dwordx2 v[106:107], v2, s[8:11], s26 offen
    s_add_u32 s26, s26, 0x2000
    buffer_load_dwordx2 v[108:109], v2, s[8:11], s26 offen
    s_add_u32 s26, s26, 0x2000
    buffer_load_dwordx2 v[110:111], v2, s[8:11], s26 offen
    s_add_u32 s26, s26, 0x32000
    s_waitcnt vmcnt(56)
    v_perm_b32 v4, v114, v112, s24
    v_accvgpr_write_b32 a176, v4
    v_perm_b32 v5, v118, v116, s24
    v_accvgpr_write_b32 a177, v5
    v_perm_b32 v4, v122, v120, s24
    v_accvgpr_write_b32 a178, v4
    v_perm_b32 v5, v126, v124, s24
    v_accvgpr_write_b32 a179, v5
    v_perm_b32 v4, v114, v112, s25
    v_accvgpr_write_b32 a180, v4
    v_perm_b32 v5, v118, v116, s25
    v_accvgpr_write_b32 a181, v5
    v_perm_b32 v4, v122, v120, s25
    v_accvgpr_write_b32 a182, v4
    v_perm_b32 v5, v126, v124, s25
    v_accvgpr_write_b32 a183, v5
    v_perm_b32 v4, v115, v113, s24
    v_accvgpr_write_b32 a184, v4
    v_perm_b32 v5, v119, v117, s24
    v_accvgpr_write_b32 a185, v5
    v_perm_b32 v4, v123, v121, s24
    v_accvgpr_write_b32 a186, v4
    v_perm_b32 v5, v127, v125, s24
    v_accvgpr_write_b32 a187, v5
    v_perm_b32 v4, v115, v113, s25
    v_accvgpr_write_b32 a188, v4
    v_perm_b32 v5, v119, v117, s25
    v_accvgpr_write_b32 a189, v5
    v_perm_b32 v4, v123, v121, s25
    v_accvgpr_write_b32 a190, v4
    v_perm_b32 v5, v127, v125, s25
    v_accvgpr_write_b32 a191, v5
    buffer_load_dwordx2 v[112:113], v2, s[8:11], s26 offen
    s_add_u32 s26, s26, 0x2000
    buffer_load_dwordx2 v[114:115], v2, s[8:11], s26 offen
    s_add_u32 s26, s26, 0x2000
    buffer_load_dwordx2 v[116:117], v2, s[8:11], s26 offen
    s_add_u32 s26, s26, 0x2000
    buffer_load_dwordx2 v[118:119], v2, s[8:11], s26 offen
    s_add_u32 s26, s26, 0x2000
    buffer_load_dwordx2 v[120:121], v2, s[8:11], s26 offen
    s_add_u32 s26, s26, 0x2000
    buffer_load_dwordx2 v[122:123], v2, s[8:11], s26 offen
    s_add_u32 s26, s26, 0x2000
    buffer_load_dwordx2 v[124:125], v2, s[8:11], s26 offen
    s_add_u32 s26, s26, 0x2000
    buffer_load_dwordx2 v[126:127], v2, s[8:11], s26 offen
    s_add_u32 s26, s26, 0x32000
    s_waitcnt vmcnt(56)
    v_perm_b32 v4, v130, v128, s24
    v_accvgpr_write_b32 a192, v4
    v_perm_b32 v5, v134, v132, s24
    v_accvgpr_write_b32 a193, v5
    v_perm_b32 v4, v138, v136, s24
    v_accvgpr_write_b32 a194, v4
    v_perm_b32 v5, v142, v140, s24
    v_accvgpr_write_b32 a195, v5
    v_perm_b32 v4, v130, v128, s25
    v_accvgpr_write_b32 a196, v4
    v_perm_b32 v5, v134, v132, s25
    v_accvgpr_write_b32 a197, v5
    v_perm_b32 v4, v138, v136, s25
    v_accvgpr_write_b32 a198, v4
    v_perm_b32 v5, v142, v140, s25
    v_accvgpr_write_b32 a199, v5
    v_perm_b32 v4, v131, v129, s24
    v_accvgpr_write_b32 a200, v4
    v_perm_b32 v5, v135, v133, s24
    v_accvgpr_write_b32 a201, v5
    v_perm_b32 v4, v139, v137, s24
    v_accvgpr_write_b32 a202, v4
    v_perm_b32 v5, v143, v141, s24
    v_accvgpr_write_b32 a203, v5
    v_perm_b32 v4, v131, v129, s25
    v_accvgpr_write_b32 a204, v4
    v_perm_b32 v5, v135, v133, s25
    v_accvgpr_write_b32 a205, v5
    v_perm_b32 v4, v139, v137, s25
    v_accvgpr_write_b32 a206, v4
    v_perm_b32 v5, v143, v141, s25
    v_accvgpr_write_b32 a207, v5
    s_waitcnt vmcnt(48)
    v_perm_b32 v4, v146, v144, s24
    v_accvgpr_write_b32 a208, v4
    v_perm_b32 v5, v150, v148, s24
    v_accvgpr_write_b32 a209, v5
    v_perm_b32 v4, v154, v152, s24
    v_accvgpr_write_b32 a210, v4
    v_perm_b32 v5, v158, v156, s24
    v_accvgpr_write_b32 a211, v5
    v_perm_b32 v4, v146, v144, s25
    v_accvgpr_write_b32 a212, v4
    v_perm_b32 v5, v150, v148, s25
    v_accvgpr_write_b32 a213, v5
    v_perm_b32 v4, v154, v152, s25
    v_accvgpr_write_b32 a214, v4
    v_perm_b32 v5, v158, v156, s25
    v_accvgpr_write_b32 a215, v5
    v_perm_b32 v4, v147, v145, s24
    v_accvgpr_write_b32 a216, v4
    v_perm_b32 v5, v151, v149, s24
    v_accvgpr_write_b32 a217, v5
    v_perm_b32 v4, v155, v153, s24
    v_accvgpr_write_b32 a218, v4
    v_perm_b32 v5, v159, v157, s24
    v_accvgpr_write_b32 a219, v5
    v_perm_b32 v4, v147, v145, s25
    v_accvgpr_write_b32 a220, v4
    v_perm_b32 v5, v151, v149, s25
    v_accvgpr_write_b32 a221, v5
    v_perm_b32 v4, v155, v153, s25
    v_accvgpr_write_b32 a222, v4
    v_perm_b32 v5, v159, v157, s25
    v_accvgpr_write_b32 a223, v5
    s_waitcnt vmcnt(40)
    v_perm_b32 v4, v162, v160, s24
    v_accvgpr_write_b32 a224, v4
    v_perm_b32 v5, v166, v164, s24
    v_accvgpr_write_b32 a225, v5
    v_perm_b32 v4, v170, v168, s24
    v_accvgpr_write_b32 a226, v4
    v_perm_b32 v5, v174, v172, s24
    v_accvgpr_write_b32 a227, v5
    v_perm_b32 v4, v162, v160, s25
    v_accvgpr_write_b32 a228, v4
    v_perm_b32 v5, v166, v164, s25
    v_accvgpr_write_b32 a229, v5
    v_perm_b32 v4, v170, v168, s25
    v_accvgpr_write_b32 a230, v4
    v_perm_b32 v5, v174, v172, s25
    v_accvgpr_write_b32 a231, v5
    v_perm_b32 v4, v163, v161, s24
    v_accvgpr_write_b32 a232, v4
    v_perm_b32 v5, v167, v165, s24
    v_accvgpr_write_b32 a233, v5
    v_perm_b32 v4, v171, v169, s24
    v_accvgpr_write_b32 a234, v4
    v_perm_b32 v5, v175, v173, s24
    v_accvgpr_write_b32 a235, v5
    v_perm_b32 v4, v163, v161, s25
    v_accvgpr_write_b32 a236, v4
    v_perm_b32 v5, v167, v165, s25
    v_accvgpr_write_b32 a237, v5
    v_perm_b32 v4, v171, v169, s25
    v_accvgpr_write_b32 a238, v4
    v_perm_b32 v5, v175, v173, s25
    v_accvgpr_write_b32 a239, v5
    s_waitcnt vmcnt(32)
    v_perm_b32 v4, v178, v176, s24
    v_accvgpr_write_b32 a240, v4
    v_perm_b32 v5, v182, v180, s24
    v_accvgpr_write_b32 a241, v5
    v_perm_b32 v4, v186, v184, s24
    v_accvgpr_write_b32 a242, v4
    v_perm_b32 v5, v190, v188, s24
    v_accvgpr_write_b32 a243, v5
    v_perm_b32 v4, v178, v176, s25
    v_accvgpr_write_b32 a244, v4
    v_perm_b32 v5, v182, v180, s25
    v_accvgpr_write_b32 a245, v5
    v_perm_b32 v4, v186, v184, s25
    v_accvgpr_write_b32 a246, v4
    v_perm_b32 v5, v190, v188, s25
    v_accvgpr_write_b32 a247, v5
    v_perm_b32 v4, v179, v177, s24
    v_accvgpr_write_b32 a248, v4
    v_perm_b32 v5, v183, v181, s24
    v_accvgpr_write_b32 a249, v5
    v_perm_b32 v4, v187, v185, s24
    v_accvgpr_write_b32 a250, v4
    v_perm_b32 v5, v191, v189, s24
    v_accvgpr_write_b32 a251, v5
    v_perm_b32 v4, v179, v177, s25
    v_accvgpr_write_b32 a252, v4
    v_perm_b32 v5, v183, v181, s25
    v_accvgpr_write_b32 a253, v5
    v_perm_b32 v4, v187, v185, s25
    v_accvgpr_write_b32 a254, v4
    v_perm_b32 v5, v191, v189, s25
    v_accvgpr_write_b32 a255, v5
    s_waitcnt vmcnt(24)
    v_perm_b32 v192, v66, v64, s24
    v_perm_b32 v193, v70, v68, s24
    v_perm_b32 v194, v74, v72, s24
    v_perm_b32 v195, v78, v76, s24
    v_perm_b32 v196, v66, v64, s25
    v_perm_b32 v197, v70, v68, s25
    v_perm_b32 v198, v74, v72, s25
    v_perm_b32 v199, v78, v76, s25
    v_perm_b32 v200, v67, v65, s24
    v_perm_b32 v201, v71, v69, s24
    v_perm_b32 v202, v75, v73, s24
    v_perm_b32 v203, v79, v77, s24
    v_perm_b32 v204, v67, v65, s25
    v_perm_b32 v205, v71, v69, s25
    v_perm_b32 v206, v75, v73, s25
    v_perm_b32 v207, v79, v77, s25
    s_waitcnt vmcnt(16)
    v_perm_b32 v208, v82, v80, s24
    v_perm_b32 v209, v86, v84, s24
    v_perm_b32 v210, v90, v88, s24
    v_perm_b32 v211, v94, v92, s24
    v_perm_b32 v212, v82, v80, s25
    v_perm_b32 v213, v86, v84, s25
    v_perm_b32 v214, v90, v88, s25
    v_perm_b32 v215, v94, v92, s25
    v_perm_b32 v216, v83, v81, s24
    v_perm_b32 v217, v87, v85, s24
    v_perm_b32 v218, v91, v89, s24
    v_perm_b32 v219, v95, v93, s24
    v_perm_b32 v220, v83, v81, s25
    v_perm_b32 v221, v87, v85, s25
    v_perm_b32 v222, v91, v89, s25
    v_perm_b32 v223, v95, v93, s25
    s_waitcnt vmcnt(8)
    v_perm_b32 v224, v98, v96, s24
    v_perm_b32 v225, v102, v100, s24
    v_perm_b32 v226, v106, v104, s24
    v_perm_b32 v227, v110, v108, s24
    v_perm_b32 v228, v98, v96, s25
    v_perm_b32 v229, v102, v100, s25
    v_perm_b32 v230, v106, v104, s25
    v_perm_b32 v231, v110, v108, s25
    v_perm_b32 v232, v99, v97, s24
    v_perm_b32 v233, v103, v101, s24
    v_perm_b32 v234, v107, v105, s24
    v_perm_b32 v235, v111, v109, s24
    v_perm_b32 v236, v99, v97, s25
    v_perm_b32 v237, v103, v101, s25
    v_perm_b32 v238, v107, v105, s25
    v_perm_b32 v239, v111, v109, s25
    s_waitcnt vmcnt(0)
    v_perm_b32 v240, v114, v112, s24
    v_perm_b32 v241, v118, v116, s24
    v_perm_b32 v242, v122, v120, s24
    v_perm_b32 v243, v126, v124, s24
    v_perm_b32 v244, v114, v112, s25
    v_perm_b32 v245, v118, v116, s25
    v_perm_b32 v246, v122, v120, s25
    v_perm_b32 v247, v126, v124, s25
    v_perm_b32 v248, v115, v113, s24
    v_perm_b32 v249, v119, v117, s24
    v_perm_b32 v250, v123, v121, s24
    v_perm_b32 v251, v127, v125, s24
    v_perm_b32 v252, v115, v113, s25
    v_perm_b32 v253, v119, v117, s25
    v_perm_b32 v254, v123, v121, s25
    v_perm_b32 v255, v127, v125, s25
    s_sub_u32 s27, s27, 8192
    s_sub_u32 s29, s29, 8192
    s_add_u32 m0, s29, 4096
    s_add_u32 s38, s27, 4096
    s_mov_b32 s30, 81920
    s_mov_b32 s32, 0
    s_mov_b32 s33, 0
    s_mov_b32 s34, s21
    s_mov_b32 s37, 64
    v_mov_b32 v3, v1
    s_waitcnt vmcnt(0)
    s_barrier
    ds_read_b128 v[128:131], v3 offset:0
    ds_read_b128 v[132:135], v3 offset:20480
    ds_read_b128 v[136:139], v3 offset:1024
    ds_read_b128 v[140:143], v3 offset:21504
    ds_read_b128 v[144:147], v3 offset:2048
    ds_read_b128 v[148:151], v3 offset:22528
WS_75:
    ds_read_b128 v[152:155], v3 offset:3072
    ds_read_b128 v[156:159], v3 offset:23552
    s_waitcnt lgkmcnt(6)
    v_mfma_f32_16x16x32_bf16 v[64:67], v[128:131], a[0:3], 0
    v_mfma_f32_16x16x32_bf16 v[68:71], v[128:131], a[4:7], 0
    v_mfma_f32_16x16x32_bf16 v[72:75], v[128:131], a[8:11], 0
    v_mfma_f32_16x16x32_bf16 v[76:79], v[128:131], a[12:15], 0
    v_mfma_f32_16x16x32_bf16 v[80:83], v[132:135], a[0:3], 0
    v_mfma_f32_16x16x32_bf16 v[84:87], v[132:135], a[4:7], 0
    v_mfma_f32_16x16x32_bf16 v[88:91], v[132:135], a[8:11], 0
    v_mfma_f32_16x16x32_bf16 v[92:95], v[132:135], a[12:15], 0
    ds_read_b128 v[128:131], v3 offset:4096
    ds_read_b128 v[132:135], v3 offset:24576
    s_waitcnt lgkmcnt(6)
    s_cmp_eq_u32 s33, 0
    s_cbranch_scc1 WS_76
    v_mfma_f32_16x16x32_bf16 v[64:67], v[136:139], a[16:19], v[64:67]
    v_cvt_pk_bf16_f32 v160, v96, v97
    v_cvt_pk_bf16_f32 v161, v98, v99
    v_mfma_f32_16x16x32_bf16 v[68:71], v[136:139], a[20:23], v[68:71]
    v_cvt_pk_bf16_f32 v162, v112, v113
    v_cvt_pk_bf16_f32 v163, v114, v115
    v_mfma_f32_16x16x32_bf16 v[72:75], v[136:139], a[24:27], v[72:75]
    buffer_store_dwordx4 v[160:163], v1, s[16:19], s35 offen offset:0 sc1
    v_cvt_pk_bf16_f32 v164, v100, v101
    v_mfma_f32_16x16x32_bf16 v[76:79], v[136:139], a[28:31], v[76:79]
    v_cvt_pk_bf16_f32 v165, v102, v103
    v_cvt_pk_bf16_f32 v166, v116, v117
    v_mfma_f32_16x16x32_bf16 v[80:83], v[140:143], a[16:19], v[80:83]
    v_cvt_pk_bf16_f32 v167, v118, v119
    buffer_store_dwordx4 v[164:167], v1, s[16:19], s35 offen offset:1024 sc1
    v_mfma_f32_16x16x32_bf16 v[84:87], v[140:143], a[20:23], v[84:87]
    v_cvt_pk_bf16_f32 v168, v104, v105
    v_cvt_pk_bf16_f32 v169, v106, v107
    v_mfma_f32_16x16x32_bf16 v[88:91], v[140:143], a[24:27], v[88:91]
    v_cvt_pk_bf16_f32 v170, v120, v121
    v_cvt_pk_bf16_f32 v171, v122, v123
    v_mfma_f32_16x16x32_bf16 v[92:95], v[140:143], a[28:31], v[92:95]
    buffer_store_dwordx4 v[168:171], v1, s[16:19], s35 offen offset:2048 sc1
    v_cvt_pk_bf16_f32 v172, v108, v109
    ds_read_b128 v[136:139], v3 offset:5120
    ds_read_b128 v[140:143], v3 offset:25600
    s_waitcnt lgkmcnt(6)
    v_mfma_f32_16x16x32_bf16 v[64:67], v[144:147], a[32:35], v[64:67]
    v_cvt_pk_bf16_f32 v173, v110, v111
    v_cvt_pk_bf16_f32 v174, v124, v125
    v_mfma_f32_16x16x32_bf16 v[68:71], v[144:147], a[36:39], v[68:71]
    v_cvt_pk_bf16_f32 v175, v126, v127
    buffer_store_dwordx4 v[172:175], v1, s[16:19], s35 offen offset:3072 sc1
    v_mfma_f32_16x16x32_bf16 v[72:75], v[144:147], a[40:43], v[72:75]
    v_mfma_f32_16x16x32_bf16 v[76:79], v[144:147], a[44:47], v[76:79]
    v_mfma_f32_16x16x32_bf16 v[80:83], v[148:151], a[32:35], v[80:83]
    v_mfma_f32_16x16x32_bf16 v[84:87], v[148:151], a[36:39], v[84:87]
    v_mfma_f32_16x16x32_bf16 v[88:91], v[148:151], a[40:43], v[88:91]
    v_mfma_f32_16x16x32_bf16 v[92:95], v[148:151], a[44:47], v[92:95]
    ds_read_b128 v[144:147], v3 offset:6144
    ds_read_b128 v[148:151], v3 offset:26624
    s_waitcnt lgkmcnt(6)
    v_mfma_f32_16x16x32_bf16 v[64:67], v[152:155], a[48:51], v[64:67]
    v_mfma_f32_16x16x32_bf16 v[68:71], v[152:155], a[52:55], v[68:71]
    v_mfma_f32_16x16x32_bf16 v[72:75], v[152:155], a[56:59], v[72:75]
    v_mfma_f32_16x16x32_bf16 v[76:79], v[152:155], a[60:63], v[76:79]
    v_mfma_f32_16x16x32_bf16 v[80:83], v[156:159], a[48:51], v[80:83]
    v_mfma_f32_16x16x32_bf16 v[84:87], v[156:159], a[52:55], v[84:87]
    v_mfma_f32_16x16x32_bf16 v[88:91], v[156:159], a[56:59], v[88:91]
    v_mfma_f32_16x16x32_bf16 v[92:95], v[156:159], a[60:63], v[92:95]
    ds_read_b128 v[152:155], v3 offset:7168
    ds_read_b128 v[156:159], v3 offset:27648
    s_waitcnt lgkmcnt(6)
    v_mfma_f32_16x16x32_bf16 v[64:67], v[128:131], a[64:67], v[64:67]
    v_mfma_f32_16x16x32_bf16 v[68:71], v[128:131], a[68:71], v[68:71]
    v_mfma_f32_16x16x32_bf16 v[72:75], v[128:131], a[72:75], v[72:75]
    v_mfma_f32_16x16x32_bf16 v[76:79], v[128:131], a[76:79], v[76:79]
    v_mfma_f32_16x16x32_bf16 v[80:83], v[132:135], a[64:67], v[80:83]
    v_mfma_f32_16x16x32_bf16 v[84:87], v[132:135], a[68:71], v[84:87]
    v_mfma_f32_16x16x32_bf16 v[88:91], v[132:135], a[72:75], v[88:91]
    v_mfma_f32_16x16x32_bf16 v[92:95], v[132:135], a[76:79], v[92:95]
    ds_read_b128 v[128:131], v3 offset:8192
    ds_read_b128 v[132:135], v3 offset:28672
    s_waitcnt lgkmcnt(6)
    v_mfma_f32_16x16x32_bf16 v[64:67], v[136:139], a[80:83], v[64:67]
    v_mfma_f32_16x16x32_bf16 v[68:71], v[136:139], a[84:87], v[68:71]
    v_mfma_f32_16x16x32_bf16 v[72:75], v[136:139], a[88:91], v[72:75]
    v_mfma_f32_16x16x32_bf16 v[76:79], v[136:139], a[92:95], v[76:79]
    v_mfma_f32_16x16x32_bf16 v[80:83], v[140:143], a[80:83], v[80:83]
    v_mfma_f32_16x16x32_bf16 v[84:87], v[140:143], a[84:87], v[84:87]
    v_mfma_f32_16x16x32_bf16 v[88:91], v[140:143], a[88:91], v[88:91]
    v_mfma_f32_16x16x32_bf16 v[92:95], v[140:143], a[92:95], v[92:95]
    ds_read_b128 v[136:139], v3 offset:9216
    ds_read_b128 v[140:143], v3 offset:29696
    s_waitcnt lgkmcnt(6)
    v_mfma_f32_16x16x32_bf16 v[64:67], v[144:147], a[96:99], v[64:67]
    v_mfma_f32_16x16x32_bf16 v[68:71], v[144:147], a[100:103], v[68:71]
    v_mfma_f32_16x16x32_bf16 v[72:75], v[144:147], a[104:107], v[72:75]
    v_mfma_f32_16x16x32_bf16 v[76:79], v[144:147], a[108:111], v[76:79]
    v_mfma_f32_16x16x32_bf16 v[80:83], v[148:151], a[96:99], v[80:83]
    v_mfma_f32_16x16x32_bf16 v[84:87], v[148:151], a[100:103], v[84:87]
    v_mfma_f32_16x16x32_bf16 v[88:91], v[148:151], a[104:107], v[88:91]
    v_mfma_f32_16x16x32_bf16 v[92:95], v[148:151], a[108:111], v[92:95]
    ds_read_b128 v[144:147], v3 offset:10240
    ds_read_b128 v[148:151], v3 offset:30720
    s_waitcnt lgkmcnt(6)
    v_mfma_f32_16x16x32_bf16 v[64:67], v[152:155], a[112:115], v[64:67]
    v_mfma_f32_16x16x32_bf16 v[68:71], v[152:155], a[116:119], v[68:71]
    v_mfma_f32_16x16x32_bf16 v[72:75], v[152:155], a[120:123], v[72:75]
    v_mfma_f32_16x16x32_bf16 v[76:79], v[152:155], a[124:127], v[76:79]
    v_mfma_f32_16x16x32_bf16 v[80:83], v[156:159], a[112:115], v[80:83]
    v_mfma_f32_16x16x32_bf16 v[84:87], v[156:159], a[116:119], v[84:87]
    v_mfma_f32_16x16x32_bf16 v[88:91], v[156:159], a[120:123], v[88:91]
    v_mfma_f32_16x16x32_bf16 v[92:95], v[156:159], a[124:127], v[92:95]
    ds_read_b128 v[152:155], v3 offset:11264
    ds_read_b128 v[156:159], v3 offset:31744
    s_waitcnt lgkmcnt(6)
    v_mfma_f32_16x16x32_bf16 v[64:67], v[128:131], a[128:131], v[64:67]
    v_mfma_f32_16x16x32_bf16 v[68:71], v[128:131], a[132:135], v[68:71]
    v_mfma_f32_16x16x32_bf16 v[72:75], v[128:131], a[136:139], v[72:75]
    v_mfma_f32_16x16x32_bf16 v[76:79], v[128:131], a[140:143], v[76:79]
    v_mfma_f32_16x16x32_bf16 v[80:83], v[132:135], a[128:131], v[80:83]
    v_mfma_f32_16x16x32_bf16 v[84:87], v[132:135], a[132:135], v[84:87]
    v_mfma_f32_16x16x32_bf16 v[88:91], v[132:135], a[136:139], v[88:91]
    v_mfma_f32_16x16x32_bf16 v[92:95], v[132:135], a[140:143], v[92:95]
    s_branch WS_77
WS_76:
    v_mfma_f32_16x16x32_bf16 v[64:67], v[136:139], a[16:19], v[64:67]
    v_mfma_f32_16x16x32_bf16 v[68:71], v[136:139], a[20:23], v[68:71]
    v_mfma_f32_16x16x32_bf16 v[72:75], v[136:139], a[24:27], v[72:75]
    v_mfma_f32_16x16x32_bf16 v[76:79], v[136:139], a[28:31], v[76:79]
    v_mfma_f32_16x16x32_bf16 v[80:83], v[140:143], a[16:19], v[80:83]
    v_mfma_f32_16x16x32_bf16 v[84:87], v[140:143], a[20:23], v[84:87]
    v_mfma_f32_16x16x32_bf16 v[88:91], v[140:143], a[24:27], v[88:91]
    v_mfma_f32_16x16x32_bf16 v[92:95], v[140:143], a[28:31], v[92:95]
    ds_read_b128 v[136:139], v3 offset:5120
    ds_read_b128 v[140:143], v3 offset:25600
    s_waitcnt lgkmcnt(6)
    v_mfma_f32_16x16x32_bf16 v[64:67], v[144:147], a[32:35], v[64:67]
    v_mfma_f32_16x16x32_bf16 v[68:71], v[144:147], a[36:39], v[68:71]
    v_mfma_f32_16x16x32_bf16 v[72:75], v[144:147], a[40:43], v[72:75]
    v_mfma_f32_16x16x32_bf16 v[76:79], v[144:147], a[44:47], v[76:79]
    v_mfma_f32_16x16x32_bf16 v[80:83], v[148:151], a[32:35], v[80:83]
    v_mfma_f32_16x16x32_bf16 v[84:87], v[148:151], a[36:39], v[84:87]
    v_mfma_f32_16x16x32_bf16 v[88:91], v[148:151], a[40:43], v[88:91]
    v_mfma_f32_16x16x32_bf16 v[92:95], v[148:151], a[44:47], v[92:95]
    ds_read_b128 v[144:147], v3 offset:6144
    ds_read_b128 v[148:151], v3 offset:26624
    s_waitcnt lgkmcnt(6)
    v_mfma_f32_16x16x32_bf16 v[64:67], v[152:155], a[48:51], v[64:67]
    v_mfma_f32_16x16x32_bf16 v[68:71], v[152:155], a[52:55], v[68:71]
    v_mfma_f32_16x16x32_bf16 v[72:75], v[152:155], a[56:59], v[72:75]
    v_mfma_f32_16x16x32_bf16 v[76:79], v[152:155], a[60:63], v[76:79]
    v_mfma_f32_16x16x32_bf16 v[80:83], v[156:159], a[48:51], v[80:83]
    v_mfma_f32_16x16x32_bf16 v[84:87], v[156:159], a[52:55], v[84:87]
    v_mfma_f32_16x16x32_bf16 v[88:91], v[156:159], a[56:59], v[88:91]
    v_mfma_f32_16x16x32_bf16 v[92:95], v[156:159], a[60:63], v[92:95]
    ds_read_b128 v[152:155], v3 offset:7168
    ds_read_b128 v[156:159], v3 offset:27648
    s_waitcnt lgkmcnt(6)
    v_mfma_f32_16x16x32_bf16 v[64:67], v[128:131], a[64:67], v[64:67]
    v_mfma_f32_16x16x32_bf16 v[68:71], v[128:131], a[68:71], v[68:71]
    v_mfma_f32_16x16x32_bf16 v[72:75], v[128:131], a[72:75], v[72:75]
    v_mfma_f32_16x16x32_bf16 v[76:79], v[128:131], a[76:79], v[76:79]
    v_mfma_f32_16x16x32_bf16 v[80:83], v[132:135], a[64:67], v[80:83]
    v_mfma_f32_16x16x32_bf16 v[84:87], v[132:135], a[68:71], v[84:87]
    v_mfma_f32_16x16x32_bf16 v[88:91], v[132:135], a[72:75], v[88:91]
    v_mfma_f32_16x16x32_bf16 v[92:95], v[132:135], a[76:79], v[92:95]
    ds_read_b128 v[128:131], v3 offset:8192
    ds_read_b128 v[132:135], v3 offset:28672
    s_waitcnt lgkmcnt(6)
    v_mfma_f32_16x16x32_bf16 v[64:67], v[136:139], a[80:83], v[64:67]
    v_mfma_f32_16x16x32_bf16 v[68:71], v[136:139], a[84:87], v[68:71]
    v_mfma_f32_16x16x32_bf16 v[72:75], v[136:139], a[88:91], v[72:75]
    v_mfma_f32_16x16x32_bf16 v[76:79], v[136:139], a[92:95], v[76:79]
    v_mfma_f32_16x16x32_bf16 v[80:83], v[140:143], a[80:83], v[80:83]
    v_mfma_f32_16x16x32_bf16 v[84:87], v[140:143], a[84:87], v[84:87]
    v_mfma_f32_16x16x32_bf16 v[88:91], v[140:143], a[88:91], v[88:91]
    v_mfma_f32_16x16x32_bf16 v[92:95], v[140:143], a[92:95], v[92:95]
    ds_read_b128 v[136:139], v3 offset:9216
    ds_read_b128 v[140:143], v3 offset:29696
    s_waitcnt lgkmcnt(6)
    v_mfma_f32_16x16x32_bf16 v[64:67], v[144:147], a[96:99], v[64:67]
    v_mfma_f32_16x16x32_bf16 v[68:71], v[144:147], a[100:103], v[68:71]
    v_mfma_f32_16x16x32_bf16 v[72:75], v[144:147], a[104:107], v[72:75]
    v_mfma_f32_16x16x32_bf16 v[76:79], v[144:147], a[108:111], v[76:79]
    v_mfma_f32_16x16x32_bf16 v[80:83], v[148:151], a[96:99], v[80:83]
    v_mfma_f32_16x16x32_bf16 v[84:87], v[148:151], a[100:103], v[84:87]
    v_mfma_f32_16x16x32_bf16 v[88:91], v[148:151], a[104:107], v[88:91]
    v_mfma_f32_16x16x32_bf16 v[92:95], v[148:151], a[108:111], v[92:95]
    ds_read_b128 v[144:147], v3 offset:10240
    ds_read_b128 v[148:151], v3 offset:30720
    s_waitcnt lgkmcnt(6)
    v_mfma_f32_16x16x32_bf16 v[64:67], v[152:155], a[112:115], v[64:67]
    v_mfma_f32_16x16x32_bf16 v[68:71], v[152:155], a[116:119], v[68:71]
    v_mfma_f32_16x16x32_bf16 v[72:75], v[152:155], a[120:123], v[72:75]
    v_mfma_f32_16x16x32_bf16 v[76:79], v[152:155], a[124:127], v[76:79]
    v_mfma_f32_16x16x32_bf16 v[80:83], v[156:159], a[112:115], v[80:83]
    v_mfma_f32_16x16x32_bf16 v[84:87], v[156:159], a[116:119], v[84:87]
    v_mfma_f32_16x16x32_bf16 v[88:91], v[156:159], a[120:123], v[88:91]
    v_mfma_f32_16x16x32_bf16 v[92:95], v[156:159], a[124:127], v[92:95]
    ds_read_b128 v[152:155], v3 offset:11264
    ds_read_b128 v[156:159], v3 offset:31744
    s_waitcnt lgkmcnt(6)
    v_mfma_f32_16x16x32_bf16 v[64:67], v[128:131], a[128:131], v[64:67]
    v_mfma_f32_16x16x32_bf16 v[68:71], v[128:131], a[132:135], v[68:71]
    v_mfma_f32_16x16x32_bf16 v[72:75], v[128:131], a[136:139], v[72:75]
    v_mfma_f32_16x16x32_bf16 v[76:79], v[128:131], a[140:143], v[76:79]
    v_mfma_f32_16x16x32_bf16 v[80:83], v[132:135], a[128:131], v[80:83]
    v_mfma_f32_16x16x32_bf16 v[84:87], v[132:135], a[132:135], v[84:87]
    v_mfma_f32_16x16x32_bf16 v[88:91], v[132:135], a[136:139], v[88:91]
    v_mfma_f32_16x16x32_bf16 v[92:95], v[132:135], a[140:143], v[92:95]
WS_77:
    ds_read_b128 v[128:131], v3 offset:12288
    ds_read_b128 v[132:135], v3 offset:32768
    s_waitcnt lgkmcnt(6)
    v_mfma_f32_16x16x32_bf16 v[64:67], v[136:139], a[144:147], v[64:67]
    v_mfma_f32_16x16x32_bf16 v[68:71], v[136:139], a[148:151], v[68:71]
    buffer_load_dwordx4 v1, s[12:15], s38 offen offset:2048 lds
    v_mfma_f32_16x16x32_bf16 v[72:75], v[136:139], a[152:155], v[72:75]
    v_mfma_f32_16x16x32_bf16 v[76:79], v[136:139], a[156:159], v[76:79]
    v_mfma_f32_16x16x32_bf16 v[80:83], v[140:143], a[144:147], v[80:83]
    v_mfma_f32_16x16x32_bf16 v[84:87], v[140:143], a[148:151], v[84:87]
    v_mfma_f32_16x16x32_bf16 v[88:91], v[140:143], a[152:155], v[88:91]
    v_mfma_f32_16x16x32_bf16 v[92:95], v[140:143], a[156:159], v[92:95]
    ds_read_b128 v[136:139], v3 offset:13312
    ds_read_b128 v[140:143], v3 offset:33792
    s_waitcnt lgkmcnt(6)
    v_mfma_f32_16x16x32_bf16 v[64:67], v[144:147], a[160:163], v[64:67]
    v_mfma_f32_16x16x32_bf16 v[68:71], v[144:147], a[164:167], v[68:71]
    buffer_load_dwordx4 v1, s[12:15], s38 offen offset:3072 lds
    v_mfma_f32_16x16x32_bf16 v[72:75], v[144:147], a[168:171], v[72:75]
    v_mfma_f32_16x16x32_bf16 v[76:79], v[144:147], a[172:175], v[76:79]
    v_mfma_f32_16x16x32_bf16 v[80:83], v[148:151], a[160:163], v[80:83]
    v_mfma_f32_16x16x32_bf16 v[84:87], v[148:151], a[164:167], v[84:87]
    v_mfma_f32_16x16x32_bf16 v[88:91], v[148:151], a[168:171], v[88:91]
    v_mfma_f32_16x16x32_bf16 v[92:95], v[148:151], a[172:175], v[92:95]
    ds_read_b128 v[144:147], v3 offset:14336
    ds_read_b128 v[148:151], v3 offset:34816
    s_waitcnt lgkmcnt(6)
    v_mfma_f32_16x16x32_bf16 v[64:67], v[152:155], a[176:179], v[64:67]
    v_mfma_f32_16x16x32_bf16 v[68:71], v[152:155], a[180:183], v[68:71]
    s_add_u32 m0, s29, 8192
    s_add_u32 s38, s27, 8192
    buffer_load_dwordx4 v1, s[12:15], s38 offen offset:0 lds
    v_mfma_f32_16x16x32_bf16 v[72:75], v[152:155], a[184:187], v[72:75]
    v_mfma_f32_16x16x32_bf16 v[76:79], v[152:155], a[188:191], v[76:79]
    v_mfma_f32_16x16x32_bf16 v[80:83], v[156:159], a[176:179], v[80:83]
    v_mfma_f32_16x16x32_bf16 v[84:87], v[156:159], a[180:183], v[84:87]
    v_mfma_f32_16x16x32_bf16 v[88:91], v[156:159], a[184:187], v[88:91]
    v_mfma_f32_16x16x32_bf16 v[92:95], v[156:159], a[188:191], v[92:95]
    ds_read_b128 v[152:155], v3 offset:15360
    ds_read_b128 v[156:159], v3 offset:35840
    s_waitcnt lgkmcnt(6)
    v_mfma_f32_16x16x32_bf16 v[64:67], v[128:131], a[192:195], v[64:67]
    v_mfma_f32_16x16x32_bf16 v[68:71], v[128:131], a[196:199], v[68:71]
    buffer_load_dwordx4 v1, s[12:15], s38 offen offset:1024 lds
    v_mfma_f32_16x16x32_bf16 v[72:75], v[128:131], a[200:203], v[72:75]
    v_mfma_f32_16x16x32_bf16 v[76:79], v[128:131], a[204:207], v[76:79]
    v_mfma_f32_16x16x32_bf16 v[80:83], v[132:135], a[192:195], v[80:83]
    v_mfma_f32_16x16x32_bf16 v[84:87], v[132:135], a[196:199], v[84:87]
    v_mfma_f32_16x16x32_bf16 v[88:91], v[132:135], a[200:203], v[88:91]
    v_mfma_f32_16x16x32_bf16 v[92:95], v[132:135], a[204:207], v[92:95]
    ds_read_b128 v[128:131], v3 offset:16384
    ds_read_b128 v[132:135], v3 offset:36864
    s_waitcnt lgkmcnt(6)
    v_mfma_f32_16x16x32_bf16 v[64:67], v[136:139], a[208:211], v[64:67]
    v_mfma_f32_16x16x32_bf16 v[68:71], v[136:139], a[212:215], v[68:71]
    v_mfma_f32_16x16x32_bf16 v[72:75], v[136:139], a[216:219], v[72:75]
    v_mfma_f32_16x16x32_bf16 v[76:79], v[136:139], a[220:223], v[76:79]
    v_mfma_f32_16x16x32_bf16 v[80:83], v[140:143], a[208:211], v[80:83]
    v_mfma_f32_16x16x32_bf16 v[84:87], v[140:143], a[212:215], v[84:87]
    v_mfma_f32_16x16x32_bf16 v[88:91], v[140:143], a[216:219], v[88:91]
    v_mfma_f32_16x16x32_bf16 v[92:95], v[140:143], a[220:223], v[92:95]
    ds_read_b128 v[136:139], v3 offset:17408
    ds_read_b128 v[140:143], v3 offset:37888
    s_waitcnt lgkmcnt(6)
    v_mfma_f32_16x16x32_bf16 v[64:67], v[144:147], a[224:227], v[64:67]
    v_mfma_f32_16x16x32_bf16 v[68:71], v[144:147], a[228:231], v[68:71]
    v_mfma_f32_16x16x32_bf16 v[72:75], v[144:147], a[232:235], v[72:75]
    v_mfma_f32_16x16x32_bf16 v[76:79], v[144:147], a[236:239], v[76:79]
    v_mfma_f32_16x16x32_bf16 v[80:83], v[148:151], a[224:227], v[80:83]
    v_mfma_f32_16x16x32_bf16 v[84:87], v[148:151], a[228:231], v[84:87]
    v_mfma_f32_16x16x32_bf16 v[88:91], v[148:151], a[232:235], v[88:91]
    v_mfma_f32_16x16x32_bf16 v[92:95], v[148:151], a[236:239], v[92:95]
    ds_read_b128 v[144:147], v3 offset:18432
    ds_read_b128 v[148:151], v3 offset:38912
    s_waitcnt lgkmcnt(6)
    v_mfma_f32_16x16x32_bf16 v[64:67], v[152:155], a[240:243], v[64:67]
    v_mfma_f32_16x16x32_bf16 v[68:71], v[152:155], a[244:247], v[68:71]
    v_mfma_f32_16x16x32_bf16 v[72:75], v[152:155], a[248:251], v[72:75]
    v_mfma_f32_16x16x32_bf16 v[76:79], v[152:155], a[252:255], v[76:79]
    v_mfma_f32_16x16x32_bf16 v[80:83], v[156:159], a[240:243], v[80:83]
    v_mfma_f32_16x16x32_bf16 v[84:87], v[156:159], a[244:247], v[84:87]
    v_mfma_f32_16x16x32_bf16 v[88:91], v[156:159], a[248:251], v[88:91]
    v_mfma_f32_16x16x32_bf16 v[92:95], v[156:159], a[252:255], v[92:95]
    ds_read_b128 v[152:155], v3 offset:19456
    ds_read_b128 v[156:159], v3 offset:39936
    s_waitcnt lgkmcnt(6)
    v_mfma_f32_16x16x32_bf16 v[64:67], v[128:131], v[192:195], v[64:67]
    v_mfma_f32_16x16x32_bf16 v[68:71], v[128:131], v[196:199], v[68:71]
    v_mfma_f32_16x16x32_bf16 v[72:75], v[128:131], v[200:203], v[72:75]
    v_mfma_f32_16x16x32_bf16 v[76:79], v[128:131], v[204:207], v[76:79]
    v_mfma_f32_16x16x32_bf16 v[80:83], v[132:135], v[192:195], v[80:83]
    v_mfma_f32_16x16x32_bf16 v[84:87], v[132:135], v[196:199], v[84:87]
    v_mfma_f32_16x16x32_bf16 v[88:91], v[132:135], v[200:203], v[88:91]
    v_mfma_f32_16x16x32_bf16 v[92:95], v[132:135], v[204:207], v[92:95]
    s_waitcnt vmcnt(0)
    s_barrier
    s_cmp_lg_u32 s23, 0
    s_cbranch_scc1 SG_78
    s_lshl_b32 s44, s37, 7
    s_add_u32 s44, s44, s39
    s_mov_b64 exec, 1
    v_mov_b32 v4, 1
    buffer_atomic_add v4, off, s[40:43], s44 sc1
    s_mov_b64 exec, -1
SG_78:
    s_add_u32 s31, s31, 4
    s_mul_i32 s27, s31, 40960
    s_add_u32 s27, s27, s28
    s_add_u32 s29, s30, s28
    s_add_u32 s30, s30, 40960
    s_cmp_eq_u32 s30, 122880
    s_cselect_b32 s30, 0, s30
    s_add_u32 s32, s32, 40960
    s_cmp_eq_u32 s32, 122880
    s_cselect_b32 s32, 0, s32
    v_add_u32 v3, s32, v1
    ds_read_b128 v[128:131], v3 offset:0
    ds_read_b128 v[132:135], v3 offset:20480
    s_waitcnt lgkmcnt(6)
    v_mfma_f32_16x16x32_bf16 v[64:67], v[136:139], v[208:211], v[64:67]
    v_mfma_f32_16x16x32_bf16 v[68:71], v[136:139], v[212:215], v[68:71]
    s_add_u32 m0, s29, 0
    s_add_u32 s38, s27, 0
    buffer_load_dwordx4 v1, s[12:15], s38 offen offset:0 lds
    v_mfma_f32_16x16x32_bf16 v[72:75], v[136:139], v[216:219], v[72:75]
    v_mfma_f32_16x16x32_bf16 v[76:79], v[136:139], v[220:223], v[76:79]
    v_mfma_f32_16x16x32_bf16 v[80:83], v[140:143], v[208:211], v[80:83]
    v_mfma_f32_16x16x32_bf16 v[84:87], v[140:143], v[212:215], v[84:87]
    buffer_load_dwordx4 v1, s[12:15], s38 offen offset:1024 lds
    v_mfma_f32_16x16x32_bf16 v[88:91], v[140:143], v[216:219], v[88:91]
    v_mfma_f32_16x16x32_bf16 v[92:95], v[140:143], v[220:223], v[92:95]
    ds_read_b128 v[136:139], v3 offset:1024
    ds_read_b128 v[140:143], v3 offset:21504
    s_waitcnt lgkmcnt(6)
    v_mfma_f32_16x16x32_bf16 v[64:67], v[144:147], v[224:227], v[64:67]
    v_mfma_f32_16x16x32_bf16 v[68:71], v[144:147], v[228:231], v[68:71]
    buffer_load_dwordx4 v1, s[12:15], s38 offen offset:2048 lds
    v_mfma_f32_16x16x32_bf16 v[72:75], v[144:147], v[232:235], v[72:75]
    v_mfma_f32_16x16x32_bf16 v[76:79], v[144:147], v[236:239], v[76:79]
    v_mfma_f32_16x16x32_bf16 v[80:83], v[148:151], v[224:227], v[80:83]
    v_mfma_f32_16x16x32_bf16 v[84:87], v[148:151], v[228:231], v[84:87]
    buffer_load_dwordx4 v1, s[12:15], s38 offen offset:3072 lds
    v_mfma_f32_16x16x32_bf16 v[88:91], v[148:151], v[232:235], v[88:91]
    v_mfma_f32_16x16x32_bf16 v[92:95], v[148:151], v[236:239], v[92:95]
    ds_read_b128 v[144:147], v3 offset:2048
    ds_read_b128 v[148:151], v3 offset:22528
    s_waitcnt lgkmcnt(6)
    v_mfma_f32_16x16x32_bf16 v[64:67], v[152:155], v[240:243], v[64:67]
    v_mfma_f32_16x16x32_bf16 v[68:71], v[152:155], v[244:247], v[68:71]
    s_add_u32 m0, s29, 4096
    s_add_u32 s38, s27, 4096
    buffer_load_dwordx4 v1, s[12:15], s38 offen offset:0 lds
    v_mfma_f32_16x16x32_bf16 v[72:75], v[152:155], v[248:251], v[72:75]
    v_mfma_f32_16x16x32_bf16 v[76:79], v[152:155], v[252:255], v[76:79]
    v_mfma_f32_16x16x32_bf16 v[80:83], v[156:159], v[240:243], v[80:83]
    v_mfma_f32_16x16x32_bf16 v[84:87], v[156:159], v[244:247], v[84:87]
    buffer_load_dwordx4 v1, s[12:15], s38 offen offset:1024 lds
    v_mfma_f32_16x16x32_bf16 v[88:91], v[156:159], v[248:251], v[88:91]
    v_mfma_f32_16x16x32_bf16 v[92:95], v[156:159], v[252:255], v[92:95]
    s_mov_b32 s37, s34
    s_mul_i32 s35, s37, 262144
    s_add_u32 s35, s35, s22
    s_add_u32 s34, s34, 4
    ds_read_b128 v[152:155], v3 offset:3072
    ds_read_b128 v[156:159], v3 offset:23552
    s_waitcnt lgkmcnt(6)
    v_mfma_f32_16x16x32_bf16 v[96:99], v[128:131], a[0:3], 0
    v_mfma_f32_16x16x32_bf16 v[100:103], v[128:131], a[4:7], 0
    v_mfma_f32_16x16x32_bf16 v[104:107], v[128:131], a[8:11], 0
    v_mfma_f32_16x16x32_bf16 v[108:111], v[128:131], a[12:15], 0
    v_mfma_f32_16x16x32_bf16 v[112:115], v[132:135], a[0:3], 0
    v_mfma_f32_16x16x32_bf16 v[116:119], v[132:135], a[4:7], 0
    v_mfma_f32_16x16x32_bf16 v[120:123], v[132:135], a[8:11], 0
    v_mfma_f32_16x16x32_bf16 v[124:127], v[132:135], a[12:15], 0
    ds_read_b128 v[128:131], v3 offset:4096
    ds_read_b128 v[132:135], v3 offset:24576
    s_waitcnt lgkmcnt(6)
    v_mfma_f32_16x16x32_bf16 v[96:99], v[136:139], a[16:19], v[96:99]
    v_cvt_pk_bf16_f32 v160, v64, v65
    v_cvt_pk_bf16_f32 v161, v66, v67
    v_mfma_f32_16x16x32_bf16 v[100:103], v[136:139], a[20:23], v[100:103]
    v_cvt_pk_bf16_f32 v162, v80, v81
    v_cvt_pk_bf16_f32 v163, v82, v83
    v_mfma_f32_16x16x32_bf16 v[104:107], v[136:139], a[24:27], v[104:107]
    buffer_store_dwordx4 v[160:163], v1, s[16:19], s35 offen offset:0 sc1
    v_cvt_pk_bf16_f32 v164, v68, v69
    v_mfma_f32_16x16x32_bf16 v[108:111], v[136:139], a[28:31], v[108:111]
    v_cvt_pk_bf16_f32 v165, v70, v71
    v_cvt_pk_bf16_f32 v166, v84, v85
    v_mfma_f32_16x16x32_bf16 v[112:115], v[140:143], a[16:19], v[112:115]
    v_cvt_pk_bf16_f32 v167, v86, v87
    buffer_store_dwordx4 v[164:167], v1, s[16:19], s35 offen offset:1024 sc1
    v_mfma_f32_16x16x32_bf16 v[116:119], v[140:143], a[20:23], v[116:119]
    v_cvt_pk_bf16_f32 v168, v72, v73
    v_cvt_pk_bf16_f32 v169, v74, v75
    v_mfma_f32_16x16x32_bf16 v[120:123], v[140:143], a[24:27], v[120:123]
    v_cvt_pk_bf16_f32 v170, v88, v89
    v_cvt_pk_bf16_f32 v171, v90, v91
    v_mfma_f32_16x16x32_bf16 v[124:127], v[140:143], a[28:31], v[124:127]
    buffer_store_dwordx4 v[168:171], v1, s[16:19], s35 offen offset:2048 sc1
    v_cvt_pk_bf16_f32 v172, v76, v77
    ds_read_b128 v[136:139], v3 offset:5120
    ds_read_b128 v[140:143], v3 offset:25600
    s_waitcnt lgkmcnt(6)
    v_mfma_f32_16x16x32_bf16 v[96:99], v[144:147], a[32:35], v[96:99]
    v_cvt_pk_bf16_f32 v173, v78, v79
    v_cvt_pk_bf16_f32 v174, v92, v93
    v_mfma_f32_16x16x32_bf16 v[100:103], v[144:147], a[36:39], v[100:103]
    v_cvt_pk_bf16_f32 v175, v94, v95
    buffer_store_dwordx4 v[172:175], v1, s[16:19], s35 offen offset:3072 sc1
    v_mfma_f32_16x16x32_bf16 v[104:107], v[144:147], a[40:43], v[104:107]
    v_mfma_f32_16x16x32_bf16 v[108:111], v[144:147], a[44:47], v[108:111]
    v_mfma_f32_16x16x32_bf16 v[112:115], v[148:151], a[32:35], v[112:115]
    v_mfma_f32_16x16x32_bf16 v[116:119], v[148:151], a[36:39], v[116:119]
    v_mfma_f32_16x16x32_bf16 v[120:123], v[148:151], a[40:43], v[120:123]
    v_mfma_f32_16x16x32_bf16 v[124:127], v[148:151], a[44:47], v[124:127]
    ds_read_b128 v[144:147], v3 offset:6144
    ds_read_b128 v[148:151], v3 offset:26624
    s_waitcnt lgkmcnt(6)
    v_mfma_f32_16x16x32_bf16 v[96:99], v[152:155], a[48:51], v[96:99]
    v_mfma_f32_16x16x32_bf16 v[100:103], v[152:155], a[52:55], v[100:103]
    v_mfma_f32_16x16x32_bf16 v[104:107], v[152:155], a[56:59], v[104:107]
    v_mfma_f32_16x16x32_bf16 v[108:111], v[152:155], a[60:63], v[108:111]
    v_mfma_f32_16x16x32_bf16 v[112:115], v[156:159], a[48:51], v[112:115]
    v_mfma_f32_16x16x32_bf16 v[116:119], v[156:159], a[52:55], v[116:119]
    v_mfma_f32_16x16x32_bf16 v[120:123], v[156:159], a[56:59], v[120:123]
    v_mfma_f32_16x16x32_bf16 v[124:127], v[156:159], a[60:63], v[124:127]
    ds_read_b128 v[152:155], v3 offset:7168
    ds_read_b128 v[156:159], v3 offset:27648
    s_waitcnt lgkmcnt(6)
    v_mfma_f32_16x16x32_bf16 v[96:99], v[128:131], a[64:67], v[96:99]
    v_mfma_f32_16x16x32_bf16 v[100:103], v[128:131], a[68:71], v[100:103]
    v_mfma_f32_16x16x32_bf16 v[104:107], v[128:131], a[72:75], v[104:107]
    v_mfma_f32_16x16x32_bf16 v[108:111], v[128:131], a[76:79], v[108:111]
    v_mfma_f32_16x16x32_bf16 v[112:115], v[132:135], a[64:67], v[112:115]
    v_mfma_f32_16x16x32_bf16 v[116:119], v[132:135], a[68:71], v[116:119]
    v_mfma_f32_16x16x32_bf16 v[120:123], v[132:135], a[72:75], v[120:123]
    v_mfma_f32_16x16x32_bf16 v[124:127], v[132:135], a[76:79], v[124:127]
    ds_read_b128 v[128:131], v3 offset:8192
    ds_read_b128 v[132:135], v3 offset:28672
    s_waitcnt lgkmcnt(6)
    v_mfma_f32_16x16x32_bf16 v[96:99], v[136:139], a[80:83], v[96:99]
    v_mfma_f32_16x16x32_bf16 v[100:103], v[136:139], a[84:87], v[100:103]
    v_mfma_f32_16x16x32_bf16 v[104:107], v[136:139], a[88:91], v[104:107]
    v_mfma_f32_16x16x32_bf16 v[108:111], v[136:139], a[92:95], v[108:111]
    v_mfma_f32_16x16x32_bf16 v[112:115], v[140:143], a[80:83], v[112:115]
    v_mfma_f32_16x16x32_bf16 v[116:119], v[140:143], a[84:87], v[116:119]
    v_mfma_f32_16x16x32_bf16 v[120:123], v[140:143], a[88:91], v[120:123]
    v_mfma_f32_16x16x32_bf16 v[124:127], v[140:143], a[92:95], v[124:127]
    ds_read_b128 v[136:139], v3 offset:9216
    ds_read_b128 v[140:143], v3 offset:29696
    s_waitcnt lgkmcnt(6)
    v_mfma_f32_16x16x32_bf16 v[96:99], v[144:147], a[96:99], v[96:99]
    v_mfma_f32_16x16x32_bf16 v[100:103], v[144:147], a[100:103], v[100:103]
    v_mfma_f32_16x16x32_bf16 v[104:107], v[144:147], a[104:107], v[104:107]
    v_mfma_f32_16x16x32_bf16 v[108:111], v[144:147], a[108:111], v[108:111]
    v_mfma_f32_16x16x32_bf16 v[112:115], v[148:151], a[96:99], v[112:115]
    v_mfma_f32_16x16x32_bf16 v[116:119], v[148:151], a[100:103], v[116:119]
    v_mfma_f32_16x16x32_bf16 v[120:123], v[148:151], a[104:107], v[120:123]
    v_mfma_f32_16x16x32_bf16 v[124:127], v[148:151], a[108:111], v[124:127]
    ds_read_b128 v[144:147], v3 offset:10240
    ds_read_b128 v[148:151], v3 offset:30720
    s_waitcnt lgkmcnt(6)
    v_mfma_f32_16x16x32_bf16 v[96:99], v[152:155], a[112:115], v[96:99]
    v_mfma_f32_16x16x32_bf16 v[100:103], v[152:155], a[116:119], v[100:103]
    v_mfma_f32_16x16x32_bf16 v[104:107], v[152:155], a[120:123], v[104:107]
    v_mfma_f32_16x16x32_bf16 v[108:111], v[152:155], a[124:127], v[108:111]
    v_mfma_f32_16x16x32_bf16 v[112:115], v[156:159], a[112:115], v[112:115]
    v_mfma_f32_16x16x32_bf16 v[116:119], v[156:159], a[116:119], v[116:119]
    v_mfma_f32_16x16x32_bf16 v[120:123], v[156:159], a[120:123], v[120:123]
    v_mfma_f32_16x16x32_bf16 v[124:127], v[156:159], a[124:127], v[124:127]
    ds_read_b128 v[152:155], v3 offset:11264
    ds_read_b128 v[156:159], v3 offset:31744
    s_waitcnt lgkmcnt(6)
    v_mfma_f32_16x16x32_bf16 v[96:99], v[128:131], a[128:131], v[96:99]
    v_mfma_f32_16x16x32_bf16 v[100:103], v[128:131], a[132:135], v[100:103]
    v_mfma_f32_16x16x32_bf16 v[104:107], v[128:131], a[136:139], v[104:107]
    v_mfma_f32_16x16x32_bf16 v[108:111], v[128:131], a[140:143], v[108:111]
    v_mfma_f32_16x16x32_bf16 v[112:115], v[132:135], a[128:131], v[112:115]
    v_mfma_f32_16x16x32_bf16 v[116:119], v[132:135], a[132:135], v[116:119]
    v_mfma_f32_16x16x32_bf16 v[120:123], v[132:135], a[136:139], v[120:123]
    v_mfma_f32_16x16x32_bf16 v[124:127], v[132:135], a[140:143], v[124:127]
    ds_read_b128 v[128:131], v3 offset:12288
    ds_read_b128 v[132:135], v3 offset:32768
    s_waitcnt lgkmcnt(6)
    v_mfma_f32_16x16x32_bf16 v[96:99], v[136:139], a[144:147], v[96:99]
    v_mfma_f32_16x16x32_bf16 v[100:103], v[136:139], a[148:151], v[100:103]
    buffer_load_dwordx4 v1, s[12:15], s38 offen offset:2048 lds
    v_mfma_f32_16x16x32_bf16 v[104:107], v[136:139], a[152:155], v[104:107]
    v_mfma_f32_16x16x32_bf16 v[108:111], v[136:139], a[156:159], v[108:111]
    v_mfma_f32_16x16x32_bf16 v[112:115], v[140:143], a[144:147], v[112:115]
    v_mfma_f32_16x16x32_bf16 v[116:119], v[140:143], a[148:151], v[116:119]
    v_mfma_f32_16x16x32_bf16 v[120:123], v[140:143], a[152:155], v[120:123]
    v_mfma_f32_16x16x32_bf16 v[124:127], v[140:143], a[156:159], v[124:127]
    ds_read_b128 v[136:139], v3 offset:13312
    ds_read_b128 v[140:143], v3 offset:33792
    s_waitcnt lgkmcnt(6)
    v_mfma_f32_16x16x32_bf16 v[96:99], v[144:147], a[160:163], v[96:99]
    v_mfma_f32_16x16x32_bf16 v[100:103], v[144:147], a[164:167], v[100:103]
    buffer_load_dwordx4 v1, s[12:15], s38 offen offset:3072 lds
    v_mfma_f32_16x16x32_bf16 v[104:107], v[144:147], a[168:171], v[104:107]
    v_mfma_f32_16x16x32_bf16 v[108:111], v[144:147], a[172:175], v[108:111]
    v_mfma_f32_16x16x32_bf16 v[112:115], v[148:151], a[160:163], v[112:115]
    v_mfma_f32_16x16x32_bf16 v[116:119], v[148:151], a[164:167], v[116:119]
    v_mfma_f32_16x16x32_bf16 v[120:123], v[148:151], a[168:171], v[120:123]
    v_mfma_f32_16x16x32_bf16 v[124:127], v[148:151], a[172:175], v[124:127]
    ds_read_b128 v[144:147], v3 offset:14336
    ds_read_b128 v[148:151], v3 offset:34816
    s_waitcnt lgkmcnt(6)
    v_mfma_f32_16x16x32_bf16 v[96:99], v[152:155], a[176:179], v[96:99]
    v_mfma_f32_16x16x32_bf16 v[100:103], v[152:155], a[180:183], v[100:103]
    s_add_u32 m0, s29, 8192
    s_add_u32 s38, s27, 8192
    buffer_load_dwordx4 v1, s[12:15], s38 offen offset:0 lds
    v_mfma_f32_16x16x32_bf16 v[104:107], v[152:155], a[184:187], v[104:107]
    v_mfma_f32_16x16x32_bf16 v[108:111], v[152:155], a[188:191], v[108:111]
    v_mfma_f32_16x16x32_bf16 v[112:115], v[156:159], a[176:179], v[112:115]
    v_mfma_f32_16x16x32_bf16 v[116:119], v[156:159], a[180:183], v[116:119]
    v_mfma_f32_16x16x32_bf16 v[120:123], v[156:159], a[184:187], v[120:123]
    v_mfma_f32_16x16x32_bf16 v[124:127], v[156:159], a[188:191], v[124:127]
    ds_read_b128 v[152:155], v3 offset:15360
    ds_read_b128 v[156:159], v3 offset:35840
    s_waitcnt lgkmcnt(6)
    v_mfma_f32_16x16x32_bf16 v[96:99], v[128:131], a[192:195], v[96:99]
    v_mfma_f32_16x16x32_bf16 v[100:103], v[128:131], a[196:199], v[100:103]
    buffer_load_dwordx4 v1, s[12:15], s38 offen offset:1024 lds
    v_mfma_f32_16x16x32_bf16 v[104:107], v[128:131], a[200:203], v[104:107]
    v_mfma_f32_16x16x32_bf16 v[108:111], v[128:131], a[204:207], v[108:111]
    v_mfma_f32_16x16x32_bf16 v[112:115], v[132:135], a[192:195], v[112:115]
    v_mfma_f32_16x16x32_bf16 v[116:119], v[132:135], a[196:199], v[116:119]
    v_mfma_f32_16x16x32_bf16 v[120:123], v[132:135], a[200:203], v[120:123]
    v_mfma_f32_16x16x32_bf16 v[124:127], v[132:135], a[204:207], v[124:127]
    ds_read_b128 v[128:131], v3 offset:16384
    ds_read_b128 v[132:135], v3 offset:36864
    s_waitcnt lgkmcnt(6)
    v_mfma_f32_16x16x32_bf16 v[96:99], v[136:139], a[208:211], v[96:99]
    v_mfma_f32_16x16x32_bf16 v[100:103], v[136:139], a[212:215], v[100:103]
    v_mfma_f32_16x16x32_bf16 v[104:107], v[136:139], a[216:219], v[104:107]
    v_mfma_f32_16x16x32_bf16 v[108:111], v[136:139], a[220:223], v[108:111]
    v_mfma_f32_16x16x32_bf16 v[112:115], v[140:143], a[208:211], v[112:115]
    v_mfma_f32_16x16x32_bf16 v[116:119], v[140:143], a[212:215], v[116:119]
    v_mfma_f32_16x16x32_bf16 v[120:123], v[140:143], a[216:219], v[120:123]
    v_mfma_f32_16x16x32_bf16 v[124:127], v[140:143], a[220:223], v[124:127]
    ds_read_b128 v[136:139], v3 offset:17408
    ds_read_b128 v[140:143], v3 offset:37888
    s_waitcnt lgkmcnt(6)
    v_mfma_f32_16x16x32_bf16 v[96:99], v[144:147], a[224:227], v[96:99]
    v_mfma_f32_16x16x32_bf16 v[100:103], v[144:147], a[228:231], v[100:103]
    v_mfma_f32_16x16x32_bf16 v[104:107], v[144:147], a[232:235], v[104:107]
    v_mfma_f32_16x16x32_bf16 v[108:111], v[144:147], a[236:239], v[108:111]
    v_mfma_f32_16x16x32_bf16 v[112:115], v[148:151], a[224:227], v[112:115]
    v_mfma_f32_16x16x32_bf16 v[116:119], v[148:151], a[228:231], v[116:119]
    v_mfma_f32_16x16x32_bf16 v[120:123], v[148:151], a[232:235], v[120:123]
    v_mfma_f32_16x16x32_bf16 v[124:127], v[148:151], a[236:239], v[124:127]
    ds_read_b128 v[144:147], v3 offset:18432
    ds_read_b128 v[148:151], v3 offset:38912
    s_waitcnt lgkmcnt(6)
    v_mfma_f32_16x16x32_bf16 v[96:99], v[152:155], a[240:243], v[96:99]
    v_mfma_f32_16x16x32_bf16 v[100:103], v[152:155], a[244:247], v[100:103]
    v_mfma_f32_16x16x32_bf16 v[104:107], v[152:155], a[248:251], v[104:107]
    v_mfma_f32_16x16x32_bf16 v[108:111], v[152:155], a[252:255], v[108:111]
    v_mfma_f32_16x16x32_bf16 v[112:115], v[156:159], a[240:243], v[112:115]
    v_mfma_f32_16x16x32_bf16 v[116:119], v[156:159], a[244:247], v[116:119]
    v_mfma_f32_16x16x32_bf16 v[120:123], v[156:159], a[248:251], v[120:123]
    v_mfma_f32_16x16x32_bf16 v[124:127], v[156:159], a[252:255], v[124:127]
    ds_read_b128 v[152:155], v3 offset:19456
    ds_read_b128 v[156:159], v3 offset:39936
    s_waitcnt lgkmcnt(6)
    v_mfma_f32_16x16x32_bf16 v[96:99], v[128:131], v[192:195], v[96:99]
    v_mfma_f32_16x16x32_bf16 v[100:103], v[128:131], v[196:199], v[100:103]
    v_mfma_f32_16x16x32_bf16 v[104:107], v[128:131], v[200:203], v[104:107]
    v_mfma_f32_16x16x32_bf16 v[108:111], v[128:131], v[204:207], v[108:111]
    v_mfma_f32_16x16x32_bf16 v[112:115], v[132:135], v[192:195], v[112:115]
    v_mfma_f32_16x16x32_bf16 v[116:119], v[132:135], v[196:199], v[116:119]
    v_mfma_f32_16x16x32_bf16 v[120:123], v[132:135], v[200:203], v[120:123]
    v_mfma_f32_16x16x32_bf16 v[124:127], v[132:135], v[204:207], v[124:127]
    s_waitcnt vmcnt(0)
    s_barrier
    s_cmp_lg_u32 s23, 0
    s_cbranch_scc1 SG_79
    s_lshl_b32 s44, s37, 7
    s_add_u32 s44, s44, s39
    s_mov_b64 exec, 1
    v_mov_b32 v4, 1
    buffer_atomic_add v4, off, s[40:43], s44 sc1
    s_mov_b64 exec, -1
SG_79:
    s_add_u32 s31, s31, 4
    s_mul_i32 s27, s31, 40960
    s_add_u32 s27, s27, s28
    s_add_u32 s29, s30, s28
    s_add_u32 s30, s30, 40960
    s_cmp_eq_u32 s30, 122880
    s_cselect_b32 s30, 0, s30
    s_add_u32 s32, s32, 40960
    s_cmp_eq_u32 s32, 122880
    s_cselect_b32 s32, 0, s32
    v_add_u32 v3, s32, v1
    ds_read_b128 v[128:131], v3 offset:0
    ds_read_b128 v[132:135], v3 offset:20480
    s_waitcnt lgkmcnt(6)
    v_mfma_f32_16x16x32_bf16 v[96:99], v[136:139], v[208:211], v[96:99]
    v_mfma_f32_16x16x32_bf16 v[100:103], v[136:139], v[212:215], v[100:103]
    s_add_u32 m0, s29, 0
    s_add_u32 s38, s27, 0
    buffer_load_dwordx4 v1, s[12:15], s38 offen offset:0 lds
    v_mfma_f32_16x16x32_bf16 v[104:107], v[136:139], v[216:219], v[104:107]
    v_mfma_f32_16x16x32_bf16 v[108:111], v[136:139], v[220:223], v[108:111]
    v_mfma_f32_16x16x32_bf16 v[112:115], v[140:143], v[208:211], v[112:115]
    v_mfma_f32_16x16x32_bf16 v[116:119], v[140:143], v[212:215], v[116:119]
    buffer_load_dwordx4 v1, s[12:15], s38 offen offset:1024 lds
    v_mfma_f32_16x16x32_bf16 v[120:123], v[140:143], v[216:219], v[120:123]
    v_mfma_f32_16x16x32_bf16 v[124:127], v[140:143], v[220:223], v[124:127]
    ds_read_b128 v[136:139], v3 offset:1024
    ds_read_b128 v[140:143], v3 offset:21504
    s_waitcnt lgkmcnt(6)
    v_mfma_f32_16x16x32_bf16 v[96:99], v[144:147], v[224:227], v[96:99]
    v_mfma_f32_16x16x32_bf16 v[100:103], v[144:147], v[228:231], v[100:103]
    buffer_load_dwordx4 v1, s[12:15], s38 offen offset:2048 lds
    v_mfma_f32_16x16x32_bf16 v[104:107], v[144:147], v[232:235], v[104:107]
    v_mfma_f32_16x16x32_bf16 v[108:111], v[144:147], v[236:239], v[108:111]
    v_mfma_f32_16x16x32_bf16 v[112:115], v[148:151], v[224:227], v[112:115]
    v_mfma_f32_16x16x32_bf16 v[116:119], v[148:151], v[228:231], v[116:119]
    buffer_load_dwordx4 v1, s[12:15], s38 offen offset:3072 lds
    v_mfma_f32_16x16x32_bf16 v[120:123], v[148:151], v[232:235], v[120:123]
    v_mfma_f32_16x16x32_bf16 v[124:127], v[148:151], v[236:239], v[124:127]
    ds_read_b128 v[144:147], v3 offset:2048
    ds_read_b128 v[148:151], v3 offset:22528
    s_waitcnt lgkmcnt(6)
    v_mfma_f32_16x16x32_bf16 v[96:99], v[152:155], v[240:243], v[96:99]
    v_mfma_f32_16x16x32_bf16 v[100:103], v[152:155], v[244:247], v[100:103]
    s_add_u32 m0, s29, 4096
    s_add_u32 s38, s27, 4096
    buffer_load_dwordx4 v1, s[12:15], s38 offen offset:0 lds
    v_mfma_f32_16x16x32_bf16 v[104:107], v[152:155], v[248:251], v[104:107]
    v_mfma_f32_16x16x32_bf16 v[108:111], v[152:155], v[252:255], v[108:111]
    v_mfma_f32_16x16x32_bf16 v[112:115], v[156:159], v[240:243], v[112:115]
    v_mfma_f32_16x16x32_bf16 v[116:119], v[156:159], v[244:247], v[116:119]
    buffer_load_dwordx4 v1, s[12:15], s38 offen offset:1024 lds
    v_mfma_f32_16x16x32_bf16 v[120:123], v[156:159], v[248:251], v[120:123]
    v_mfma_f32_16x16x32_bf16 v[124:127], v[156:159], v[252:255], v[124:127]
    s_mov_b32 s37, s34
    s_mul_i32 s35, s37, 262144
    s_add_u32 s35, s35, s22
    s_add_u32 s34, s34, 4
    s_add_u32 s33, s33, 2
    s_cmp_lt_u32 s33, 16
    s_cbranch_scc1 WS_75
    s_nop 7
    v_cvt_pk_bf16_f32 v160, v96, v97
    v_cvt_pk_bf16_f32 v161, v98, v99
    v_cvt_pk_bf16_f32 v162, v112, v113
    v_cvt_pk_bf16_f32 v163, v114, v115
    buffer_store_dwordx4 v[160:163], v1, s[16:19], s35 offen offset:0 sc1
    v_cvt_pk_bf16_f32 v164, v100, v101
    v_cvt_pk_bf16_f32 v165, v102, v103
    v_cvt_pk_bf16_f32 v166, v116, v117
    v_cvt_pk_bf16_f32 v167, v118, v119
    buffer_store_dwordx4 v[164:167], v1, s[16:19], s35 offen offset:1024 sc1
    v_cvt_pk_bf16_f32 v168, v104, v105
    v_cvt_pk_bf16_f32 v169, v106, v107
    v_cvt_pk_bf16_f32 v170, v120, v121
    v_cvt_pk_bf16_f32 v171, v122, v123
    buffer_store_dwordx4 v[168:171], v1, s[16:19], s35 offen offset:2048 sc1
    v_cvt_pk_bf16_f32 v172, v108, v109
    v_cvt_pk_bf16_f32 v173, v110, v111
    v_cvt_pk_bf16_f32 v174, v124, v125
    v_cvt_pk_bf16_f32 v175, v126, v127
    buffer_store_dwordx4 v[172:175], v1, s[16:19], s35 offen offset:3072 sc1
    s_waitcnt lgkmcnt(0) vmcnt(0)
    s_barrier
    s_cmp_lg_u32 s23, 0
    s_cbranch_scc1 SG_80
    s_lshl_b32 s44, s37, 7
    s_add_u32 s44, s44, s39
    s_mov_b64 exec, 1
    v_mov_b32 v4, 1
    buffer_atomic_add v4, off, s[40:43], s44 sc1
    s_mov_b64 exec, -1
SG_80:
    s_branch RW_13
RW_67:
    s_sub_u32 s2, s2, 192
    s_mov_b64 s[6:7], s[4:5]
    s_add_u32 s48, s4, 0x8300000
    s_addc_u32 s49, s5, 0
    s_and_b32 s49, s49, 0xffff
    s_mov_b32 s50, 0x20000
    s_mov_b32 s51, 0x20000
    v_lshrrev_b32 v1, 6, v0
    s_nop 0
    v_readfirstlane_b32 s23, v1
    s_cmp_ge_u32 s2, 32
    s_cbranch_scc1 RW_81
    v_and_b32 v3, 63, v0
    v_lshlrev_b32 v1, 4, v3
    v_lshlrev_b32 v2, 3, v3
    v_lshrrev_b32 v8, 4, v3
    v_lshlrev_b32 v8, 2, v8
    v_and_b32 v9, 15, v3
    v_mov_b32 v10, 0xf149f2ca
    v_add_u32 v11, 0, v8
    v_cmp_gt_u32 vcc, v11, v9
    s_nop 1
    v_cndmask_b32 v4, 0, v10, vcc
    v_add_u32 v11, 1, v8
    v_cmp_gt_u32 vcc, v11, v9
    s_nop 1
    v_cndmask_b32 v5, 0, v10, vcc
    v_add_u32 v11, 2, v8
    v_cmp_gt_u32 vcc, v11, v9
    s_nop 1
    v_cndmask_b32 v6, 0, v10, vcc
    v_add_u32 v11, 3, v8
    v_cmp_gt_u32 vcc, v11, v9
    s_nop 1
    v_cndmask_b32 v7, 0, v10, vcc
    s_mov_b32 s30, 0x3e0293ee
    s_add_u32 s8, s6, 0x400000
    s_addc_u32 s9, s7, 0
    s_and_b32 s9, s9, 0xffff
    s_mov_b32 s10, 0x4000000
    s_mov_b32 s11, 0x20000
    s_add_u32 s12, s6, 0x4400000
    s_addc_u32 s13, s7, 0
    s_and_b32 s13, s13, 0xffff
    s_mov_b32 s14, 0x1000000
    s_mov_b32 s15, 0x20000
    s_lshr_b32 s52, s2, 3
    s_and_b32 s19, s2, 7
    s_lshl_b32 s17, s19, 2
    s_add_u32 s17, s17, s23
    s_lshl_b32 s18, s17, 12
    s_mov_b32 s31, s23
AL_82:
    s_lshl_b32 s55, s52, 7
    s_add_u32 s55, s55, 12416
    s_lshl_b32 s56, s52, 3
    s_add_u32 s56, s56, s19
    s_lshr_b32 s57, s56, 1
    s_lshl_b32 s57, s57, 6
    s_add_u32 s57, s57, 49152
    s_lshl_b32 s56, s56, 6
    s_add_u32 s56, s56, 66048
    s_lshl_b32 s20, s52, 18
    s_add_u32 s21, s20, s18
    s_add_u32 s21, s21, s18
    s_add_u32 s20, s20, s18
    s_lshl_b32 s22, s52, 17
    s_add_u32 s22, s22, s18
    s_sub_u32 s58, s55, 8320
    s_cmp_lg_u32 s23, 0
    s_cbranch_scc1 FW_84
    s_mov_b32 s53, 0
FW_85:
    buffer_load_dword v255, off, s[48:51], s55 sc1
    s_add_u32 s53, s53, 1
    s_cmp_gt_u32 s53, 0x20000
    s_cbranch_scc1 FW_86
    s_waitcnt vmcnt(0)
    v_readfirstlane_b32 s54, v255
    s_cmp_lg_u32 s54, 16
    s_cbranch_scc1 FW_85
FW_86:
FW_87:
    buffer_load_dword v255, off, s[48:51], s58 sc1
    s_add_u32 s53, s53, 1
    s_cmp_gt_u32 s53, 0x20000
    s_cbranch_scc1 FW_88
    s_waitcnt vmcnt(0)
    v_readfirstlane_b32 s54, v255
    s_cmp_lg_u32 s54, 32
    s_cbranch_scc1 FW_87
FW_88:
FW_84:
    s_barrier
    s_add_u32 s23, s20, 131072
    s_add_u32 s24, s20, 16777216
    s_add_u32 s25, s23, 16777216
    s_add_u32 s26, s21, 33554432
    s_add_u32 s27, s26, 4096
    s_add_u32 s28, s22, 8388608
    buffer_load_dwordx4 v[16:19], v1, s[8:11], s20 offen offset:0 sc1
    buffer_load_dwordx4 v[48:51], v1, s[8:11], s24 offen offset:0 sc1
    buffer_load_dwordx4 v[32:35], v1, s[8:11], s23 offen offset:0 sc1
    buffer_load_dwordx4 v[64:67], v1, s[8:11], s25 offen offset:0 sc1
    buffer_load_dwordx4 v[20:23], v1, s[8:11], s20 offen offset:1024 sc1
    buffer_load_dwordx4 v[52:55], v1, s[8:11], s24 offen offset:1024 sc1
    buffer_load_dwordx4 v[36:39], v1, s[8:11], s23 offen offset:1024 sc1
    buffer_load_dwordx4 v[68:71], v1, s[8:11], s25 offen offset:1024 sc1
    buffer_load_dwordx4 v[24:27], v1, s[8:11], s20 offen offset:2048 sc1
    buffer_load_dwordx4 v[56:59], v1, s[8:11], s24 offen offset:2048 sc1
    buffer_load_dwordx4 v[40:43], v1, s[8:11], s23 offen offset:2048 sc1
    buffer_load_dwordx4 v[72:75], v1, s[8:11], s25 offen offset:2048 sc1
    buffer_load_dwordx4 v[28:31], v1, s[8:11], s20 offen offset:3072 sc1
    buffer_load_dwordx4 v[60:63], v1, s[8:11], s24 offen offset:3072 sc1
    buffer_load_dwordx4 v[44:47], v1, s[8:11], s23 offen offset:3072 sc1
    buffer_load_dwordx4 v[76:79], v1, s[8:11], s25 offen offset:3072 sc1
    buffer_load_dwordx4 v[98:101], v1, s[8:11], s26 offen offset:0 sc1
    buffer_load_dwordx4 v[104:107], v1, s[8:11], s26 offen offset:1024 sc1
    buffer_load_dwordx4 v[110:113], v1, s[8:11], s26 offen offset:2048 sc1
    buffer_load_dwordx4 v[116:119], v1, s[8:11], s26 offen offset:3072 sc1
    buffer_load_dwordx4 v[122:125], v1, s[8:11], s27 offen offset:0 sc1
    buffer_load_dwordx4 v[128:131], v1, s[8:11], s27 offen offset:1024 sc1
    buffer_load_dwordx4 v[134:137], v1, s[8:11], s27 offen offset:2048 sc1
    buffer_load_dwordx4 v[140:143], v1, s[8:11], s27 offen offset:3072 sc1
    s_waitcnt vmcnt(20)
    v_mfma_f32_16x16x32_bf16 v[148:151], v[48:51], v[16:19], v[4:7]
    v_mfma_f32_16x16x32_bf16 v[156:159], v[48:51], v[32:35], 0
    v_mfma_f32_16x16x32_bf16 v[160:163], v[64:67], v[32:35], v[4:7]
    s_waitcnt vmcnt(16)
    v_mfma_f32_16x16x32_bf16 v[148:151], v[52:55], v[20:23], v[148:151]
    v_mfma_f32_16x16x32_bf16 v[156:159], v[52:55], v[36:39], v[156:159]
    v_mfma_f32_16x16x32_bf16 v[160:163], v[68:71], v[36:39], v[160:163]
    s_waitcnt vmcnt(12)
    v_mfma_f32_16x16x32_bf16 v[148:151], v[56:59], v[24:27], v[148:151]
    v_mfma_f32_16x16x32_bf16 v[156:159], v[56:59], v[40:43], v[156:159]
    v_mfma_f32_16x16x32_bf16 v[160:163], v[72:75], v[40:43], v[160:163]
    s_waitcnt vmcnt(8)
    v_mfma_f32_16x16x32_bf16 v[148:151], v[60:63], v[28:31], v[148:151]
    v_mfma_f32_16x16x32_bf16 v[156:159], v[60:63], v[44:47], v[156:159]
    v_mfma_f32_16x16x32_bf16 v[160:163], v[76:79], v[44:47], v[160:163]
    s_mov_b32 s58, s23
    s_mov_b32 s23, s31
    s_cmp_lg_u32 s23, 0
    s_cbranch_scc1 FW_90
    s_mov_b32 s53, 0
FW_91:
    buffer_load_dword v255, off, s[48:51], s56 sc1
    s_add_u32 s53, s53, 1
    s_cmp_gt_u32 s53, 0x20000
    s_cbranch_scc1 FW_92
    s_waitcnt vmcnt(0)
    v_readfirstlane_b32 s54, v255
    s_cmp_lg_u32 s54, 139808
    s_cbranch_scc1 FW_91
FW_92:
FW_90:
    s_barrier
    s_mov_b32 s23, s58
    buffer_load_dwordx4 v[80:83], v1, s[12:15], s22 offen offset:0 sc1
    buffer_load_dwordx4 v[84:87], v1, s[12:15], s22 offen offset:1024 sc1
    buffer_load_dwordx4 v[88:91], v1, s[12:15], s22 offen offset:2048 sc1
    buffer_load_dwordx4 v[92:95], v1, s[12:15], s22 offen offset:3072 sc1
    buffer_load_dwordx2 v[96:97], v1, s[12:15], s28 offen offset:0 sc1
    buffer_load_dwordx2 v[102:103], v1, s[12:15], s28 offen offset:8 sc1
    buffer_load_dwordx2 v[108:109], v1, s[12:15], s28 offen offset:1024 sc1
    buffer_load_dwordx2 v[114:115], v1, s[12:15], s28 offen offset:1032 sc1
    buffer_load_dwordx2 v[120:121], v1, s[12:15], s28 offen offset:2048 sc1
    buffer_load_dwordx2 v[126:127], v1, s[12:15], s28 offen offset:2056 sc1
    buffer_load_dwordx2 v[132:133], v1, s[12:15], s28 offen offset:3072 sc1
    buffer_load_dwordx2 v[138:139], v1, s[12:15], s28 offen offset:3080 sc1
    s_waitcnt vmcnt(11)
    v_mfma_f32_16x16x32_bf16 v[144:147], v[80:83], v[16:19], 0
    v_mfma_f32_16x16x32_bf16 v[152:155], v[80:83], v[32:35], 0
    s_waitcnt vmcnt(10)
    v_mfma_f32_16x16x32_bf16 v[144:147], v[84:87], v[20:23], v[144:147]
    v_mfma_f32_16x16x32_bf16 v[152:155], v[84:87], v[36:39], v[152:155]
    s_waitcnt vmcnt(9)
    v_mfma_f32_16x16x32_bf16 v[144:147], v[88:91], v[24:27], v[144:147]
    v_mfma_f32_16x16x32_bf16 v[152:155], v[88:91], v[40:43], v[152:155]
    s_waitcnt vmcnt(8)
    v_mfma_f32_16x16x32_bf16 v[144:147], v[92:95], v[28:31], v[144:147]
    v_mfma_f32_16x16x32_bf16 v[152:155], v[92:95], v[44:47], v[152:155]
    s_nop 7
    v_max3_f32 v26, v144, v145, v146
    v_max3_f32 v26, v26, v147, v148
    v_max3_f32 v26, v26, v149, v150
    v_max_f32 v26, v26, v151
    v_mov_b32 v3, v26
    s_nop 1
    v_permlane32_swap_b32 v26, v3
    v_max_f32 v26, v26, v3
    v_mov_b32 v3, v26
    s_nop 1
    v_permlane16_swap_b32 v26, v3
    v_max_f32 v26, v26, v3
    v_mul_f32 v26, s30, v26
    v_fma_f32 v144, v144, s30, -v26
    v_fma_f32 v145, v145, s30, -v26
    v_fma_f32 v146, v146, s30, -v26
    v_fma_f32 v147, v147, s30, -v26
    v_fma_f32 v148, v148, s30, -v26
    v_fma_f32 v149, v149, s30, -v26
    v_fma_f32 v150, v150, s30, -v26
    v_fma_f32 v151, v151, s30, -v26
    v_exp_f32 v144, v144
    v_exp_f32 v145, v145
    v_exp_f32 v146, v146
    v_exp_f32 v147, v147
    v_exp_f32 v148, v148
    v_exp_f32 v149, v149
    v_exp_f32 v150, v150
    v_exp_f32 v151, v151
    v_add_f32 v28, v144, v145
    v_add_f32 v29, v146, v147
    v_add_f32 v28, v28, v29
    v_mul_f32 v28, 0.5, v28
    v_add_f32 v28, v28, v148
    v_add_f32 v28, v28, v149
    v_add_f32 v28, v28, v150
    v_add_f32 v28, v28, v151
    v_mov_b32 v3, v28
    s_nop 1
    v_permlane32_swap_b32 v28, v3
    v_add_f32 v28, v28, v3
    v_mov_b32 v3, v28
    s_nop 1
    v_permlane16_swap_b32 v28, v3
    v_add_f32 v28, v28, v3
    v_rcp_f32 v28, v28
    s_nop 0
    v_mul_f32 v144, v144, v28
    v_mul_f32 v145, v145, v28
    v_mul_f32 v146, v146, v28
    v_mul_f32 v147, v147, v28
    v_mul_f32 v148, v148, v28
    v_mul_f32 v149, v149, v28
    v_mul_f32 v150, v150, v28
    v_mul_f32 v151, v151, v28
    v_cvt_pk_bf16_f32 v16, v144, v145
    v_cvt_pk_bf16_f32 v17, v146, v147
    v_cvt_pk_bf16_f32 v18, v148, v149
    v_cvt_pk_bf16_f32 v19, v150, v151
    v_max3_f32 v27, v152, v153, v154
    v_max3_f32 v27, v27, v155, v156
    v_max3_f32 v27, v27, v157, v158
    v_max3_f32 v27, v27, v159, v160
    v_max3_f32 v27, v27, v161, v162
    v_max_f32 v27, v27, v163
    v_mov_b32 v3, v27
    s_nop 1
    v_permlane32_swap_b32 v27, v3
    v_max_f32 v27, v27, v3
    v_mov_b32 v3, v27
    s_nop 1
    v_permlane16_swap_b32 v27, v3
    v_max_f32 v27, v27, v3
    v_mul_f32 v27, s30, v27
    v_fma_f32 v152, v152, s30, -v27
    v_fma_f32 v153, v153, s30, -v27
    v_fma_f32 v154, v154, s30, -v27
    v_fma_f32 v155, v155, s30, -v27
    v_fma_f32 v156, v156, s30, -v27
    v_fma_f32 v157, v157, s30, -v27
    v_fma_f32 v158, v158, s30, -v27
    v_fma_f32 v159, v159, s30, -v27
    v_fma_f32 v160, v160, s30, -v27
    v_fma_f32 v161, v161, s30, -v27
    v_fma_f32 v162, v162, s30, -v27
    v_fma_f32 v163, v163, s30, -v27
    v_exp_f32 v152, v152
    v_exp_f32 v153, v153
    v_exp_f32 v154, v154
    v_exp_f32 v155, v155
    v_exp_f32 v156, v156
    v_exp_f32 v157, v157
    v_exp_f32 v158, v158
    v_exp_f32 v159, v159
    v_exp_f32 v160, v160
    v_exp_f32 v161, v161
    v_exp_f32 v162, v162
    v_exp_f32 v163, v163
    v_add_f32 v32, v152, v153
    v_add_f32 v33, v154, v155
    v_add_f32 v32, v32, v33
    v_mul_f32 v32, 0.5, v32
    v_add_f32 v32, v32, v156
    v_add_f32 v32, v32, v157
    v_add_f32 v32, v32, v158
    v_add_f32 v32, v32, v159
    v_add_f32 v32, v32, v160
    v_add_f32 v32, v32, v161
    v_add_f32 v32, v32, v162
    v_add_f32 v32, v32, v163
    v_mov_b32 v3, v32
    s_nop 1
    v_permlane32_swap_b32 v32, v3
    v_add_f32 v32, v32, v3
    v_mov_b32 v3, v32
    s_nop 1
    v_permlane16_swap_b32 v32, v3
    v_add_f32 v32, v32, v3
    v_rcp_f32 v32, v32
    s_nop 0
    v_mul_f32 v152, v152, v32
    v_mul_f32 v153, v153, v32
    v_mul_f32 v154, v154, v32
    v_mul_f32 v155, v155, v32
    v_mul_f32 v156, v156, v32
    v_mul_f32 v157, v157, v32
    v_mul_f32 v158, v158, v32
    v_mul_f32 v159, v159, v32
    v_mul_f32 v160, v160, v32
    v_mul_f32 v161, v161, v32
    v_mul_f32 v162, v162, v32
    v_mul_f32 v163, v163, v32
    v_cvt_pk_bf16_f32 v20, v152, v153
    v_cvt_pk_bf16_f32 v21, v154, v155
    v_cvt_pk_bf16_f32 v22, v156, v157
    v_cvt_pk_bf16_f32 v23, v158, v159
    v_cvt_pk_bf16_f32 v24, v160, v161
    v_cvt_pk_bf16_f32 v25, v162, v163
    s_waitcnt vmcnt(0)
    v_mfma_f32_16x16x32_bf16 v[32:35], v[96:99], v[16:19], 0
    v_mfma_f32_16x16x32_bf16 v[64:67], v[98:101], v[22:25], 0
    v_mfma_f32_16x16x32_bf16 v[36:39], v[102:105], v[16:19], 0
    v_mfma_f32_16x16x32_bf16 v[68:71], v[104:107], v[22:25], 0
    v_mfma_f32_16x16x32_bf16 v[40:43], v[108:111], v[16:19], 0
    v_mfma_f32_16x16x32_bf16 v[72:75], v[110:113], v[22:25], 0
    v_mfma_f32_16x16x32_bf16 v[44:47], v[114:117], v[16:19], 0
    v_mfma_f32_16x16x32_bf16 v[76:79], v[116:119], v[22:25], 0
    v_mfma_f32_16x16x32_bf16 v[48:51], v[120:123], v[16:19], 0
    v_mfma_f32_16x16x32_bf16 v[80:83], v[122:125], v[22:25], 0
    v_mfma_f32_16x16x32_bf16 v[52:55], v[126:129], v[16:19], 0
    v_mfma_f32_16x16x32_bf16 v[84:87], v[128:131], v[22:25], 0
    v_mfma_f32_16x16x32_bf16 v[56:59], v[132:135], v[16:19], 0
    v_mfma_f32_16x16x32_bf16 v[88:91], v[134:137], v[22:25], 0
    v_mfma_f32_16x16x32_bf16 v[60:63], v[138:141], v[16:19], 0
    v_mfma_f32_16x16x32_bf16 v[92:95], v[140:143], v[22:25], 0
    v_mfma_f32_16x16x16_bf16 v[64:67], v[96:97], v[20:21], v[64:67]
    v_mfma_f32_16x16x16_bf16 v[68:71], v[102:103], v[20:21], v[68:71]
    v_mfma_f32_16x16x16_bf16 v[72:75], v[108:109], v[20:21], v[72:75]
    v_mfma_f32_16x16x16_bf16 v[76:79], v[114:115], v[20:21], v[76:79]
    v_mfma_f32_16x16x16_bf16 v[80:83], v[120:121], v[20:21], v[80:83]
    v_mfma_f32_16x16x16_bf16 v[84:87], v[126:127], v[20:21], v[84:87]
    v_mfma_f32_16x16x16_bf16 v[88:91], v[132:133], v[20:21], v[88:91]
    v_mfma_f32_16x16x16_bf16 v[92:95], v[138:139], v[20:21], v[92:95]
    s_add_u32 s24, s20, 50331648
    s_add_u32 s25, s23, 50331648
    v_cvt_pk_bf16_f32 v144, v32, v36
    v_cvt_pk_bf16_f32 v145, v40, v44
    v_cvt_pk_bf16_f32 v146, v33, v37
    v_cvt_pk_bf16_f32 v147, v41, v45
    buffer_store_dwordx4 v[144:147], v1, s[8:11], s24 offen offset:0 sc1
    v_cvt_pk_bf16_f32 v148, v34, v38
    v_cvt_pk_bf16_f32 v149, v42, v46
    v_cvt_pk_bf16_f32 v150, v35, v39
    v_cvt_pk_bf16_f32 v151, v43, v47
    buffer_store_dwordx4 v[148:151], v1, s[8:11], s24 offen offset:1024 sc1
    v_cvt_pk_bf16_f32 v152, v48, v52
    v_cvt_pk_bf16_f32 v153, v56, v60
    v_cvt_pk_bf16_f32 v154, v49, v53
    v_cvt_pk_bf16_f32 v155, v57, v61
    buffer_store_dwordx4 v[152:155], v1, s[8:11], s24 offen offset:2048 sc1
    v_cvt_pk_bf16_f32 v156, v50, v54
    v_cvt_pk_bf16_f32 v157, v58, v62
    v_cvt_pk_bf16_f32 v158, v51, v55
    v_cvt_pk_bf16_f32 v159, v59, v63
    buffer_store_dwordx4 v[156:159], v1, s[8:11], s24 offen offset:3072 sc1
    s_nop 7
    v_cvt_pk_bf16_f32 v144, v64, v68
    v_cvt_pk_bf16_f32 v145, v72, v76
    v_cvt_pk_bf16_f32 v146, v65, v69
    v_cvt_pk_bf16_f32 v147, v73, v77
    buffer_store_dwordx4 v[144:147], v1, s[8:11], s25 offen offset:0 sc1
    v_cvt_pk_bf16_f32 v148, v66, v70
    v_cvt_pk_bf16_f32 v149, v74, v78
    v_cvt_pk_bf16_f32 v150, v67, v71
    v_cvt_pk_bf16_f32 v151, v75, v79
    buffer_store_dwordx4 v[148:151], v1, s[8:11], s25 offen offset:1024 sc1
    v_cvt_pk_bf16_f32 v152, v80, v84
    v_cvt_pk_bf16_f32 v153, v88, v92
    v_cvt_pk_bf16_f32 v154, v81, v85
    v_cvt_pk_bf16_f32 v155, v89, v93
    buffer_store_dwordx4 v[152:155], v1, s[8:11], s25 offen offset:2048 sc1
    v_cvt_pk_bf16_f32 v156, v82, v86
    v_cvt_pk_bf16_f32 v157, v90, v94
    v_cvt_pk_bf16_f32 v158, v83, v87
    v_cvt_pk_bf16_f32 v159, v91, v95
    buffer_store_dwordx4 v[156:159], v1, s[8:11], s25 offen offset:3072 sc1
    s_mov_b32 s23, s31
    s_waitcnt vmcnt(0) lgkmcnt(0)
    s_barrier
    s_cmp_lg_u32 s23, 0
    s_cbranch_scc1 FS_93
    s_mov_b64 exec, 1
    v_mov_b32 v255, 1
    buffer_atomic_add v255, off, s[48:51], s57 sc1
    s_mov_b64 exec, -1
FS_93:
    s_add_u32 s52, s52, 4
    s_cmp_lt_u32 s52, 64
    s_cbranch_scc1 AL_82
    s_branch RW_13
RW_81:
    s_sub_u32 s2, s2, 32
    s_cmp_ge_u32 s2, 80
    s_cbranch_scc1 RW_94
    s_load_dwordx2 s[4:5], s[0:1], 40
    s_lshr_b32 s34, s2, 4
    s_bfe_u32 s52, s2, 0x20002
    s_and_b32 s35, s2, 3
    s_lshl_b32 s37, s35, 2
    s_add_u32 s37, s37, s23
    s_mul_i32 s20, s37, 327680
    s_lshl_b32 s38, s34, 8
    s_add_u32 s20, s20, s38
    s_lshl_b32 s21, s52, 18
    s_lshl_b32 s38, s37, 13
    s_add_u32 s21, s21, s38
    s_mul_i32 s22, s52, 81920
    s_lshl_b32 s38, s34, 2
    s_add_u32 s38, s38, s23
    s_lshl_b32 s38, s38, 11
    s_add_u32 s22, s22, s38
    s_and_b32 s57, s2, 15
    s_lshl_b32 s57, s57, 6
    s_add_u32 s57, s57, 49152
    s_lshl_b32 s58, s52, 7
    s_add_u32 s58, s58, 24576
    s_waitcnt lgkmcnt(0)
    s_add_u32 s8, s4, 0x0
    s_addc_u32 s9, s5, 0
    s_and_b32 s9, s9, 0xffff
    s_mov_b32 s10, 0x500000
    s_mov_b32 s11, 0x20000
    s_add_u32 s12, s6, 0x3400000
    s_addc_u32 s13, s7, 0
    s_and_b32 s13, s13, 0xffff
    s_mov_b32 s14, 0x1000000
    s_mov_b32 s15, 0x20000
    s_mul_i32 s38, s35, 5242880
    s_add_u32 s6, s6, s38
    s_addc_u32 s7, s7, 0
    s_add_u32 s16, s6, 0x5400000
    s_addc_u32 s17, s7, 0
    s_and_b32 s17, s17, 0xffff
    s_mov_b32 s18, 0x500000
    s_mov_b32 s19, 0x20000
    v_and_b32 v1, 63, v0
    v_lshrrev_b32 v3, 4, v1
    v_mul_u32_u24 v2, 20480, v3
    v_and_b32 v3, 15, v1
    v_lshl_add_u32 v2, v3, 3, v2
    s_mov_b32 s44, s24
    v_lshlrev_b32 v1, 4, v1
    s_mov_b32 s24, 0x05040100
    s_mov_b32 s25, 0x07060302
    s_mov_b32 s26, s20
    buffer_load_dwordx2 v[16:17], v2, s[8:11], s26 offen
    s_add_u32 s26, s26, 0x500
    buffer_load_dwordx2 v[18:19], v2, s[8:11], s26 offen
    s_add_u32 s26, s26, 0x500
    buffer_load_dwordx2 v[20:21], v2, s[8:11], s26 offen
    s_add_u32 s26, s26, 0x500
    buffer_load_dwordx2 v[22:23], v2, s[8:11], s26 offen
    s_add_u32 s26, s26, 0x500
    buffer_load_dwordx2 v[24:25], v2, s[8:11], s26 offen
    s_add_u32 s26, s26, 0x500
    buffer_load_dwordx2 v[26:27], v2, s[8:11], s26 offen
    s_add_u32 s26, s26, 0x500
    buffer_load_dwordx2 v[28:29], v2, s[8:11], s26 offen
    s_add_u32 s26, s26, 0x500
    buffer_load_dwordx2 v[30:31], v2, s[8:11], s26 offen
    s_add_u32 s26, s26, 0xffffdd80
    buffer_load_dwordx2 v[32:33], v2, s[8:11], s26 offen
    s_add_u32 s26, s26, 0x500
    buffer_load_dwordx2 v[34:35], v2, s[8:11], s26 offen
    s_add_u32 s26, s26, 0x500
    buffer_load_dwordx2 v[36:37], v2, s[8:11], s26 offen
    s_add_u32 s26, s26, 0x500
    buffer_load_dwordx2 v[38:39], v2, s[8:11], s26 offen
    s_add_u32 s26, s26, 0x500
    buffer_load_dwordx2 v[40:41], v2, s[8:11], s26 offen
    s_add_u32 s26, s26, 0x500
    buffer_load_dwordx2 v[42:43], v2, s[8:11], s26 offen
    s_add_u32 s26, s26, 0x500
    buffer_load_dwordx2 v[44:45], v2, s[8:11], s26 offen
    s_add_u32 s26, s26, 0x500
    buffer_load_dwordx2 v[46:47], v2, s[8:11], s26 offen
    s_add_u32 s26, s26, 0x480
    buffer_load_dwordx2 v[48:49], v2, s[8:11], s26 offen
    s_add_u32 s26, s26, 0x500
    buffer_load_dwordx2 v[50:51], v2, s[8:11], s26 offen
    s_add_u32 s26, s26, 0x500
    buffer_load_dwordx2 v[52:53], v2, s[8:11], s26 offen
    s_add_u32 s26, s26, 0x500
    buffer_load_dwordx2 v[54:55], v2, s[8:11], s26 offen
    s_add_u32 s26, s26, 0x500
    buffer_load_dwordx2 v[56:57], v2, s[8:11], s26 offen
    s_add_u32 s26, s26, 0x500
    buffer_load_dwordx2 v[58:59], v2, s[8:11], s26 offen
    s_add_u32 s26, s26, 0x500
    buffer_load_dwordx2 v[60:61], v2, s[8:11], s26 offen
    s_add_u32 s26, s26, 0x500
    buffer_load_dwordx2 v[62:63], v2, s[8:11], s26 offen
    s_add_u32 s26, s26, 0xffffdd80
    buffer_load_dwordx2 v[64:65], v2, s[8:11], s26 offen
    s_add_u32 s26, s26, 0x500
    buffer_load_dwordx2 v[66:67], v2, s[8:11], s26 offen
    s_add_u32 s26, s26, 0x500
    buffer_load_dwordx2 v[68:69], v2, s[8:11], s26 offen
    s_add_u32 s26, s26, 0x500
    buffer_load_dwordx2 v[70:71], v2, s[8:11], s26 offen
    s_add_u32 s26, s26, 0x500
    buffer_load_dwordx2 v[72:73], v2, s[8:11], s26 offen
    s_add_u32 s26, s26, 0x500
    buffer_load_dwordx2 v[74:75], v2, s[8:11], s26 offen
    s_add_u32 s26, s26, 0x500
    buffer_load_dwordx2 v[76:77], v2, s[8:11], s26 offen
    s_add_u32 s26, s26, 0x500
    buffer_load_dwordx2 v[78:79], v2, s[8:11], s26 offen
    s_add_u32 s26, s26, 0xf480
    buffer_load_dwordx2 v[80:81], v2, s[8:11], s26 offen
    s_add_u32 s26, s26, 0x500
    buffer_load_dwordx2 v[82:83], v2, s[8:11], s26 offen
    s_add_u32 s26, s26, 0x500
    buffer_load_dwordx2 v[84:85], v2, s[8:11], s26 offen
    s_add_u32 s26, s26, 0x500
    buffer_load_dwordx2 v[86:87], v2, s[8:11], s26 offen
    s_add_u32 s26, s26, 0x500
    buffer_load_dwordx2 v[88:89], v2, s[8:11], s26 offen
    s_add_u32 s26, s26, 0x500
    buffer_load_dwordx2 v[90:91], v2, s[8:11], s26 offen
    s_add_u32 s26, s26, 0x500
    buffer_load_dwordx2 v[92:93], v2, s[8:11], s26 offen
    s_add_u32 s26, s26, 0x500
    buffer_load_dwordx2 v[94:95], v2, s[8:11], s26 offen
    s_add_u32 s26, s26, 0xffffdd80
    buffer_load_dwordx2 v[96:97], v2, s[8:11], s26 offen
    s_add_u32 s26, s26, 0x500
    buffer_load_dwordx2 v[98:99], v2, s[8:11], s26 offen
    s_add_u32 s26, s26, 0x500
    buffer_load_dwordx2 v[100:101], v2, s[8:11], s26 offen
    s_add_u32 s26, s26, 0x500
    buffer_load_dwordx2 v[102:103], v2, s[8:11], s26 offen
    s_add_u32 s26, s26, 0x500
    buffer_load_dwordx2 v[104:105], v2, s[8:11], s26 offen
    s_add_u32 s26, s26, 0x500
    buffer_load_dwordx2 v[106:107], v2, s[8:11], s26 offen
    s_add_u32 s26, s26, 0x500
    buffer_load_dwordx2 v[108:109], v2, s[8:11], s26 offen
    s_add_u32 s26, s26, 0x500
    buffer_load_dwordx2 v[110:111], v2, s[8:11], s26 offen
    s_add_u32 s26, s26, 0x480
    buffer_load_dwordx2 v[112:113], v2, s[8:11], s26 offen
    s_add_u32 s26, s26, 0x500
    buffer_load_dwordx2 v[114:115], v2, s[8:11], s26 offen
    s_add_u32 s26, s26, 0x500
    buffer_load_dwordx2 v[116:117], v2, s[8:11], s26 offen
    s_add_u32 s26, s26, 0x500
    buffer_load_dwordx2 v[118:119], v2, s[8:11], s26 offen
    s_add_u32 s26, s26, 0x500
    buffer_load_dwordx2 v[120:121], v2, s[8:11], s26 offen
    s_add_u32 s26, s26, 0x500
    buffer_load_dwordx2 v[122:123], v2, s[8:11], s26 offen
    s_add_u32 s26, s26, 0x500
    buffer_load_dwordx2 v[124:125], v2, s[8:11], s26 offen
    s_add_u32 s26, s26, 0x500
    buffer_load_dwordx2 v[126:127], v2, s[8:11], s26 offen
    s_add_u32 s26, s26, 0xffffdd80
    s_waitcnt vmcnt(48)
    v_perm_b32 v4, v18, v16, s24
    v_accvgpr_write_b32 a0, v4
    v_perm_b32 v5, v22, v20, s24
    v_accvgpr_write_b32 a1, v5
    v_perm_b32 v4, v26, v24, s24
    v_accvgpr_write_b32 a2, v4
    v_perm_b32 v5, v30, v28, s24
    v_accvgpr_write_b32 a3, v5
    v_perm_b32 v4, v18, v16, s25
    v_accvgpr_write_b32 a4, v4
    v_perm_b32 v5, v22, v20, s25
    v_accvgpr_write_b32 a5, v5
    v_perm_b32 v4, v26, v24, s25
    v_accvgpr_write_b32 a6, v4
    v_perm_b32 v5, v30, v28, s25
    v_accvgpr_write_b32 a7, v5
    v_perm_b32 v4, v19, v17, s24
    v_accvgpr_write_b32 a8, v4
    v_perm_b32 v5, v23, v21, s24
    v_accvgpr_write_b32 a9, v5
    v_perm_b32 v4, v27, v25, s24
    v_accvgpr_write_b32 a10, v4
    v_perm_b32 v5, v31, v29, s24
    v_accvgpr_write_b32 a11, v5
    v_perm_b32 v4, v19, v17, s25
    v_accvgpr_write_b32 a12, v4
    v_perm_b32 v5, v23, v21, s25
    v_accvgpr_write_b32 a13, v5
    v_perm_b32 v4, v27, v25, s25
    v_accvgpr_write_b32 a14, v4
    v_perm_b32 v5, v31, v29, s25
    v_accvgpr_write_b32 a15, v5
    buffer_load_dwordx2 v[16:17], v2, s[8:11], s26 offen
    s_add_u32 s26, s26, 0x500
    buffer_load_dwordx2 v[18:19], v2, s[8:11], s26 offen
    s_add_u32 s26, s26, 0x500
    buffer_load_dwordx2 v[20:21], v2, s[8:11], s26 offen
    s_add_u32 s26, s26, 0x500
    buffer_load_dwordx2 v[22:23], v2, s[8:11], s26 offen
    s_add_u32 s26, s26, 0x500
    buffer_load_dwordx2 v[24:25], v2, s[8:11], s26 offen
    s_add_u32 s26, s26, 0x500
    buffer_load_dwordx2 v[26:27], v2, s[8:11], s26 offen
    s_add_u32 s26, s26, 0x500
    buffer_load_dwordx2 v[28:29], v2, s[8:11], s26 offen
    s_add_u32 s26, s26, 0x500
    buffer_load_dwordx2 v[30:31], v2, s[8:11], s26 offen
    s_add_u32 s26, s26, 0xf480
    s_waitcnt vmcnt(48)
    v_perm_b32 v4, v34, v32, s24
    v_accvgpr_write_b32 a16, v4
    v_perm_b32 v5, v38, v36, s24
    v_accvgpr_write_b32 a17, v5
    v_perm_b32 v4, v42, v40, s24
    v_accvgpr_write_b32 a18, v4
    v_perm_b32 v5, v46, v44, s24
    v_accvgpr_write_b32 a19, v5
    v_perm_b32 v4, v34, v32, s25
    v_accvgpr_write_b32 a20, v4
    v_perm_b32 v5, v38, v36, s25
    v_accvgpr_write_b32 a21, v5
    v_perm_b32 v4, v42, v40, s25
    v_accvgpr_write_b32 a22, v4
    v_perm_b32 v5, v46, v44, s25
    v_accvgpr_write_b32 a23, v5
    v_perm_b32 v4, v35, v33, s24
    v_accvgpr_write_b32 a24, v4
    v_perm_b32 v5, v39, v37, s24
    v_accvgpr_write_b32 a25, v5
    v_perm_b32 v4, v43, v41, s24
    v_accvgpr_write_b32 a26, v4
    v_perm_b32 v5, v47, v45, s24
    v_accvgpr_write_b32 a27, v5
    v_perm_b32 v4, v35, v33, s25
    v_accvgpr_write_b32 a28, v4
    v_perm_b32 v5, v39, v37, s25
    v_accvgpr_write_b32 a29, v5
    v_perm_b32 v4, v43, v41, s25
    v_accvgpr_write_b32 a30, v4
    v_perm_b32 v5, v47, v45, s25
    v_accvgpr_write_b32 a31, v5
    buffer_load_dwordx2 v[32:33], v2, s[8:11], s26 offen
    s_add_u32 s26, s26, 0x500
    buffer_load_dwordx2 v[34:35], v2, s[8:11], s26 offen
    s_add_u32 s26, s26, 0x500
    buffer_load_dwordx2 v[36:37], v2, s[8:11], s26 offen
    s_add_u32 s26, s26, 0x500
    buffer_load_dwordx2 v[38:39], v2, s[8:11], s26 offen
    s_add_u32 s26, s26, 0x500
    buffer_load_dwordx2 v[40:41], v2, s[8:11], s26 offen
    s_add_u32 s26, s26, 0x500
    buffer_load_dwordx2 v[42:43], v2, s[8:11], s26 offen
    s_add_u32 s26, s26, 0x500
    buffer_load_dwordx2 v[44:45], v2, s[8:11], s26 offen
    s_add_u32 s26, s26, 0x500
    buffer_load_dwordx2 v[46:47], v2, s[8:11], s26 offen
    s_add_u32 s26, s26, 0xffffdd80
    s_waitcnt vmcnt(48)
    v_perm_b32 v4, v50, v48, s24
    v_accvgpr_write_b32 a32, v4
    v_perm_b32 v5, v54, v52, s24
    v_accvgpr_write_b32 a33, v5
    v_perm_b32 v4, v58, v56, s24
    v_accvgpr_write_b32 a34, v4
    v_perm_b32 v5, v62, v60, s24
    v_accvgpr_write_b32 a35, v5
    v_perm_b32 v4, v50, v48, s25
    v_accvgpr_write_b32 a36, v4
    v_perm_b32 v5, v54, v52, s25
    v_accvgpr_write_b32 a37, v5
    v_perm_b32 v4, v58, v56, s25
    v_accvgpr_write_b32 a38, v4
    v_perm_b32 v5, v62, v60, s25
    v_accvgpr_write_b32 a39, v5
    v_perm_b32 v4, v51, v49, s24
    v_accvgpr_write_b32 a40, v4
    v_perm_b32 v5, v55, v53, s24
    v_accvgpr_write_b32 a41, v5
    v_perm_b32 v4, v59, v57, s24
    v_accvgpr_write_b32 a42, v4
    v_perm_b32 v5, v63, v61, s24
    v_accvgpr_write_b32 a43, v5
    v_perm_b32 v4, v51, v49, s25
    v_accvgpr_write_b32 a44, v4
    v_perm_b32 v5, v55, v53, s25
    v_accvgpr_write_b32 a45, v5
    v_perm_b32 v4, v59, v57, s25
    v_accvgpr_write_b32 a46, v4
    v_perm_b32 v5, v63, v61, s25
    v_accvgpr_write_b32 a47, v5
    buffer_load_dwordx2 v[48:49], v2, s[8:11], s26 offen
    s_add_u32 s26, s26, 0x500
    buffer_load_dwordx2 v[50:51], v2, s[8:11], s26 offen
    s_add_u32 s26, s26, 0x500
    buffer_load_dwordx2 v[52:53], v2, s[8:11], s26 offen
    s_add_u32 s26, s26, 0x500
    buffer_load_dwordx2 v[54:55], v2, s[8:11], s26 offen
    s_add_u32 s26, s26, 0x500
    buffer_load_dwordx2 v[56:57], v2, s[8:11], s26 offen
    s_add_u32 s26, s26, 0x500
    buffer_load_dwordx2 v[58:59], v2, s[8:11], s26 offen
    s_add_u32 s26, s26, 0x500
    buffer_load_dwordx2 v[60:61], v2, s[8:11], s26 offen
    s_add_u32 s26, s26, 0x500
    buffer_load_dwordx2 v[62:63], v2, s[8:11], s26 offen
    s_add_u32 s26, s26, 0x480
    s_waitcnt vmcnt(48)
    v_perm_b32 v4, v66, v64, s24
    v_accvgpr_write_b32 a48, v4
    v_perm_b32 v5, v70, v68, s24
    v_accvgpr_write_b32 a49, v5
    v_perm_b32 v4, v74, v72, s24
    v_accvgpr_write_b32 a50, v4
    v_perm_b32 v5, v78, v76, s24
    v_accvgpr_write_b32 a51, v5
    v_perm_b32 v4, v66, v64, s25
    v_accvgpr_write_b32 a52, v4
    v_perm_b32 v5, v70, v68, s25
    v_accvgpr_write_b32 a53, v5
    v_perm_b32 v4, v74, v72, s25
    v_accvgpr_write_b32 a54, v4
    v_perm_b32 v5, v78, v76, s25
    v_accvgpr_write_b32 a55, v5
    v_perm_b32 v4, v67, v65, s24
    v_accvgpr_write_b32 a56, v4
    v_perm_b32 v5, v71, v69, s24
    v_accvgpr_write_b32 a57, v5
    v_perm_b32 v4, v75, v73, s24
    v_accvgpr_write_b32 a58, v4
    v_perm_b32 v5, v79, v77, s24
    v_accvgpr_write_b32 a59, v5
    v_perm_b32 v4, v67, v65, s25
    v_accvgpr_write_b32 a60, v4
    v_perm_b32 v5, v71, v69, s25
    v_accvgpr_write_b32 a61, v5
    v_perm_b32 v4, v75, v73, s25
    v_accvgpr_write_b32 a62, v4
    v_perm_b32 v5, v79, v77, s25
    v_accvgpr_write_b32 a63, v5
    buffer_load_dwordx2 v[64:65], v2, s[8:11], s26 offen
    s_add_u32 s26, s26, 0x500
    buffer_load_dwordx2 v[66:67], v2, s[8:11], s26 offen
    s_add_u32 s26, s26, 0x500
    buffer_load_dwordx2 v[68:69], v2, s[8:11], s26 offen
    s_add_u32 s26, s26, 0x500
    buffer_load_dwordx2 v[70:71], v2, s[8:11], s26 offen
    s_add_u32 s26, s26, 0x500
    buffer_load_dwordx2 v[72:73], v2, s[8:11], s26 offen
    s_add_u32 s26, s26, 0x500
    buffer_load_dwordx2 v[74:75], v2, s[8:11], s26 offen
    s_add_u32 s26, s26, 0x500
    buffer_load_dwordx2 v[76:77], v2, s[8:11], s26 offen
    s_add_u32 s26, s26, 0x500
    buffer_load_dwordx2 v[78:79], v2, s[8:11], s26 offen
    s_add_u32 s26, s26, 0xffffdd80
    s_waitcnt vmcnt(48)
    v_perm_b32 v4, v82, v80, s24
    v_accvgpr_write_b32 a64, v4
    v_perm_b32 v5, v86, v84, s24
    v_accvgpr_write_b32 a65, v5
    v_perm_b32 v4, v90, v88, s24
    v_accvgpr_write_b32 a66, v4
    v_perm_b32 v5, v94, v92, s24
    v_accvgpr_write_b32 a67, v5
    v_perm_b32 v4, v82, v80, s25
    v_accvgpr_write_b32 a68, v4
    v_perm_b32 v5, v86, v84, s25
    v_accvgpr_write_b32 a69, v5
    v_perm_b32 v4, v90, v88, s25
    v_accvgpr_write_b32 a70, v4
    v_perm_b32 v5, v94, v92, s25
    v_accvgpr_write_b32 a71, v5
    v_perm_b32 v4, v83, v81, s24
    v_accvgpr_write_b32 a72, v4
    v_perm_b32 v5, v87, v85, s24
    v_accvgpr_write_b32 a73, v5
    v_perm_b32 v4, v91, v89, s24
    v_accvgpr_write_b32 a74, v4
    v_perm_b32 v5, v95, v93, s24
    v_accvgpr_write_b32 a75, v5
    v_perm_b32 v4, v83, v81, s25
    v_accvgpr_write_b32 a76, v4
    v_perm_b32 v5, v87, v85, s25
    v_accvgpr_write_b32 a77, v5
    v_perm_b32 v4, v91, v89, s25
    v_accvgpr_write_b32 a78, v4
    v_perm_b32 v5, v95, v93, s25
    v_accvgpr_write_b32 a79, v5
    buffer_load_dwordx2 v[80:81], v2, s[8:11], s26 offen
    s_add_u32 s26, s26, 0x500
    buffer_load_dwordx2 v[82:83], v2, s[8:11], s26 offen
    s_add_u32 s26, s26, 0x500
    buffer_load_dwordx2 v[84:85], v2, s[8:11], s26 offen
    s_add_u32 s26, s26, 0x500
    buffer_load_dwordx2 v[86:87], v2, s[8:11], s26 offen
    s_add_u32 s26, s26, 0x500
    buffer_load_dwordx2 v[88:89], v2, s[8:11], s26 offen
    s_add_u32 s26, s26, 0x500
    buffer_load_dwordx2 v[90:91], v2, s[8:11], s26 offen
    s_add_u32 s26, s26, 0x500
    buffer_load_dwordx2 v[92:93], v2, s[8:11], s26 offen
    s_add_u32 s26, s26, 0x500
    buffer_load_dwordx2 v[94:95], v2, s[8:11], s26 offen
    s_add_u32 s26, s26, 0xf480
    s_waitcnt vmcnt(48)
    v_perm_b32 v4, v98, v96, s24
    v_accvgpr_write_b32 a80, v4
    v_perm_b32 v5, v102, v100, s24
    v_accvgpr_write_b32 a81, v5
    v_perm_b32 v4, v106, v104, s24
    v_accvgpr_write_b32 a82, v4
    v_perm_b32 v5, v110, v108, s24
    v_accvgpr_write_b32 a83, v5
    v_perm_b32 v4, v98, v96, s25
    v_accvgpr_write_b32 a84, v4
    v_perm_b32 v5, v102, v100, s25
    v_accvgpr_write_b32 a85, v5
    v_perm_b32 v4, v106, v104, s25
    v_accvgpr_write_b32 a86, v4
    v_perm_b32 v5, v110, v108, s25
    v_accvgpr_write_b32 a87, v5
    v_perm_b32 v4, v99, v97, s24
    v_accvgpr_write_b32 a88, v4
    v_perm_b32 v5, v103, v101, s24
    v_accvgpr_write_b32 a89, v5
    v_perm_b32 v4, v107, v105, s24
    v_accvgpr_write_b32 a90, v4
    v_perm_b32 v5, v111, v109, s24
    v_accvgpr_write_b32 a91, v5
    v_perm_b32 v4, v99, v97, s25
    v_accvgpr_write_b32 a92, v4
    v_perm_b32 v5, v103, v101, s25
    v_accvgpr_write_b32 a93, v5
    v_perm_b32 v4, v107, v105, s25
    v_accvgpr_write_b32 a94, v4
    v_perm_b32 v5, v111, v109, s25
    v_accvgpr_write_b32 a95, v5
    buffer_load_dwordx2 v[96:97], v2, s[8:11], s26 offen
    s_add_u32 s26, s26, 0x500
    buffer_load_dwordx2 v[98:99], v2, s[8:11], s26 offen
    s_add_u32 s26, s26, 0x500
    buffer_load_dwordx2 v[100:101], v2, s[8:11], s26 offen
    s_add_u32 s26, s26, 0x500
    buffer_load_dwordx2 v[102:103], v2, s[8:11], s26 offen
    s_add_u32 s26, s26, 0x500
    buffer_load_dwordx2 v[104:105], v2, s[8:11], s26 offen
    s_add_u32 s26, s26, 0x500
    buffer_load_dwordx2 v[106:107], v2, s[8:11], s26 offen
    s_add_u32 s26, s26, 0x500
    buffer_load_dwordx2 v[108:109], v2, s[8:11], s26 offen
    s_add_u32 s26, s26, 0x500
    buffer_load_dwordx2 v[110:111], v2, s[8:11], s26 offen
    s_add_u32 s26, s26, 0xffffdd80
    s_waitcnt vmcnt(48)
    v_perm_b32 v4, v114, v112, s24
    v_accvgpr_write_b32 a96, v4
    v_perm_b32 v5, v118, v116, s24
    v_accvgpr_write_b32 a97, v5
    v_perm_b32 v4, v122, v120, s24
    v_accvgpr_write_b32 a98, v4
    v_perm_b32 v5, v126, v124, s24
    v_accvgpr_write_b32 a99, v5
    v_perm_b32 v4, v114, v112, s25
    v_accvgpr_write_b32 a100, v4
    v_perm_b32 v5, v118, v116, s25
    v_accvgpr_write_b32 a101, v5
    v_perm_b32 v4, v122, v120, s25
    v_accvgpr_write_b32 a102, v4
    v_perm_b32 v5, v126, v124, s25
    v_accvgpr_write_b32 a103, v5
    v_perm_b32 v4, v115, v113, s24
    v_accvgpr_write_b32 a104, v4
    v_perm_b32 v5, v119, v117, s24
    v_accvgpr_write_b32 a105, v5
    v_perm_b32 v4, v123, v121, s24
    v_accvgpr_write_b32 a106, v4
    v_perm_b32 v5, v127, v125, s24
    v_accvgpr_write_b32 a107, v5
    v_perm_b32 v4, v115, v113, s25
    v_accvgpr_write_b32 a108, v4
    v_perm_b32 v5, v119, v117, s25
    v_accvgpr_write_b32 a109, v5
    v_perm_b32 v4, v123, v121, s25
    v_accvgpr_write_b32 a110, v4
    v_perm_b32 v5, v127, v125, s25
    v_accvgpr_write_b32 a111, v5
    buffer_load_dwordx2 v[112:113], v2, s[8:11], s26 offen
    s_add_u32 s26, s26, 0x500
    buffer_load_dwordx2 v[114:115], v2, s[8:11], s26 offen
    s_add_u32 s26, s26, 0x500
    buffer_load_dwordx2 v[116:117], v2, s[8:11], s26 offen
    s_add_u32 s26, s26, 0x500
    buffer_load_dwordx2 v[118:119], v2, s[8:11], s26 offen
    s_add_u32 s26, s26, 0x500
    buffer_load_dwordx2 v[120:121], v2, s[8:11], s26 offen
    s_add_u32 s26, s26, 0x500
    buffer_load_dwordx2 v[122:123], v2, s[8:11], s26 offen
    s_add_u32 s26, s26, 0x500
    buffer_load_dwordx2 v[124:125], v2, s[8:11], s26 offen
    s_add_u32 s26, s26, 0x500
    buffer_load_dwordx2 v[126:127], v2, s[8:11], s26 offen
    s_add_u32 s26, s26, 0x480
    s_waitcnt vmcnt(48)
    v_perm_b32 v4, v18, v16, s24
    v_accvgpr_write_b32 a112, v4
    v_perm_b32 v5, v22, v20, s24
    v_accvgpr_write_b32 a113, v5
    v_perm_b32 v4, v26, v24, s24
    v_accvgpr_write_b32 a114, v4
    v_perm_b32 v5, v30, v28, s24
    v_accvgpr_write_b32 a115, v5
    v_perm_b32 v4, v18, v16, s25
    v_accvgpr_write_b32 a116, v4
    v_perm_b32 v5, v22, v20, s25
    v_accvgpr_write_b32 a117, v5
    v_perm_b32 v4, v26, v24, s25
    v_accvgpr_write_b32 a118, v4
    v_perm_b32 v5, v30, v28, s25
    v_accvgpr_write_b32 a119, v5
    v_perm_b32 v4, v19, v17, s24
    v_accvgpr_write_b32 a120, v4
    v_perm_b32 v5, v23, v21, s24
    v_accvgpr_write_b32 a121, v5
    v_perm_b32 v4, v27, v25, s24
    v_accvgpr_write_b32 a122, v4
    v_perm_b32 v5, v31, v29, s24
    v_accvgpr_write_b32 a123, v5
    v_perm_b32 v4, v19, v17, s25
    v_accvgpr_write_b32 a124, v4
    v_perm_b32 v5, v23, v21, s25
    v_accvgpr_write_b32 a125, v5
    v_perm_b32 v4, v27, v25, s25
    v_accvgpr_write_b32 a126, v4
    v_perm_b32 v5, v31, v29, s25
    v_accvgpr_write_b32 a127, v5
    buffer_load_dwordx2 v[16:17], v2, s[8:11], s26 offen
    s_add_u32 s26, s26, 0x500
    buffer_load_dwordx2 v[18:19], v2, s[8:11], s26 offen
    s_add_u32 s26, s26, 0x500
    buffer_load_dwordx2 v[20:21], v2, s[8:11], s26 offen
    s_add_u32 s26, s26, 0x500
    buffer_load_dwordx2 v[22:23], v2, s[8:11], s26 offen
    s_add_u32 s26, s26, 0x500
    buffer_load_dwordx2 v[24:25], v2, s[8:11], s26 offen
    s_add_u32 s26, s26, 0x500
    buffer_load_dwordx2 v[26:27], v2, s[8:11], s26 offen
    s_add_u32 s26, s26, 0x500
    buffer_load_dwordx2 v[28:29], v2, s[8:11], s26 offen
    s_add_u32 s26, s26, 0x500
    buffer_load_dwordx2 v[30:31], v2, s[8:11], s26 offen
    s_add_u32 s26, s26, 0xffffdd80
    s_waitcnt vmcnt(48)
    v_perm_b32 v4, v34, v32, s24
    v_accvgpr_write_b32 a128, v4
    v_perm_b32 v5, v38, v36, s24
    v_accvgpr_write_b32 a129, v5
    v_perm_b32 v4, v42, v40, s24
    v_accvgpr_write_b32 a130, v4
    v_perm_b32 v5, v46, v44, s24
    v_accvgpr_write_b32 a131, v5
    v_perm_b32 v4, v34, v32, s25
    v_accvgpr_write_b32 a132, v4
    v_perm_b32 v5, v38, v36, s25
    v_accvgpr_write_b32 a133, v5
    v_perm_b32 v4, v42, v40, s25
    v_accvgpr_write_b32 a134, v4
    v_perm_b32 v5, v46, v44, s25
    v_accvgpr_write_b32 a135, v5
    v_perm_b32 v4, v35, v33, s24
    v_accvgpr_write_b32 a136, v4
    v_perm_b32 v5, v39, v37, s24
    v_accvgpr_write_b32 a137, v5
    v_perm_b32 v4, v43, v41, s24
    v_accvgpr_write_b32 a138, v4
    v_perm_b32 v5, v47, v45, s24
    v_accvgpr_write_b32 a139, v5
    v_perm_b32 v4, v35, v33, s25
    v_accvgpr_write_b32 a140, v4
    v_perm_b32 v5, v39, v37, s25
    v_accvgpr_write_b32 a141, v5
    v_perm_b32 v4, v43, v41, s25
    v_accvgpr_write_b32 a142, v4
    v_perm_b32 v5, v47, v45, s25
    v_accvgpr_write_b32 a143, v5
    buffer_load_dwordx2 v[32:33], v2, s[8:11], s26 offen
    s_add_u32 s26, s26, 0x500
    buffer_load_dwordx2 v[34:35], v2, s[8:11], s26 offen
    s_add_u32 s26, s26, 0x500
    buffer_load_dwordx2 v[36:37], v2, s[8:11], s26 offen
    s_add_u32 s26, s26, 0x500
    buffer_load_dwordx2 v[38:39], v2, s[8:11], s26 offen
    s_add_u32 s26, s26, 0x500
    buffer_load_dwordx2 v[40:41], v2, s[8:11], s26 offen
    s_add_u32 s26, s26, 0x500
    buffer_load_dwordx2 v[42:43], v2, s[8:11], s26 offen
    s_add_u32 s26, s26, 0x500
    buffer_load_dwordx2 v[44:45], v2, s[8:11], s26 offen
    s_add_u32 s26, s26, 0x500
    buffer_load_dwordx2 v[46:47], v2, s[8:11], s26 offen
    s_add_u32 s26, s26, 0xf480
    s_waitcnt vmcnt(48)
    v_perm_b32 v4, v50, v48, s24
    v_accvgpr_write_b32 a144, v4
    v_perm_b32 v5, v54, v52, s24
    v_accvgpr_write_b32 a145, v5
    v_perm_b32 v4, v58, v56, s24
    v_accvgpr_write_b32 a146, v4
    v_perm_b32 v5, v62, v60, s24
    v_accvgpr_write_b32 a147, v5
    v_perm_b32 v4, v50, v48, s25
    v_accvgpr_write_b32 a148, v4
    v_perm_b32 v5, v54, v52, s25
    v_accvgpr_write_b32 a149, v5
    v_perm_b32 v4, v58, v56, s25
    v_accvgpr_write_b32 a150, v4
    v_perm_b32 v5, v62, v60, s25
    v_accvgpr_write_b32 a151, v5
    v_perm_b32 v4, v51, v49, s24
    v_accvgpr_write_b32 a152, v4
    v_perm_b32 v5, v55, v53, s24
    v_accvgpr_write_b32 a153, v5
    v_perm_b32 v4, v59, v57, s24
    v_accvgpr_write_b32 a154, v4
    v_perm_b32 v5, v63, v61, s24
    v_accvgpr_write_b32 a155, v5
    v_perm_b32 v4, v51, v49, s25
    v_accvgpr_write_b32 a156, v4
    v_perm_b32 v5, v55, v53, s25
    v_accvgpr_write_b32 a157, v5
    v_perm_b32 v4, v59, v57, s25
    v_accvgpr_write_b32 a158, v4
    v_perm_b32 v5, v63, v61, s25
    v_accvgpr_write_b32 a159, v5
    s_waitcnt vmcnt(40)
    v_perm_b32 v4, v66, v64, s24
    v_accvgpr_write_b32 a160, v4
    v_perm_b32 v5, v70, v68, s24
    v_accvgpr_write_b32 a161, v5
    v_perm_b32 v4, v74, v72, s24
    v_accvgpr_write_b32 a162, v4
    v_perm_b32 v5, v78, v76, s24
    v_accvgpr_write_b32 a163, v5
    v_perm_b32 v4, v66, v64, s25
    v_accvgpr_write_b32 a164, v4
    v_perm_b32 v5, v70, v68, s25
    v_accvgpr_write_b32 a165, v5
    v_perm_b32 v4, v74, v72, s25
    v_accvgpr_write_b32 a166, v4
    v_perm_b32 v5, v78, v76, s25
    v_accvgpr_write_b32 a167, v5
    v_perm_b32 v4, v67, v65, s24
    v_accvgpr_write_b32 a168, v4
    v_perm_b32 v5, v71, v69, s24
    v_accvgpr_write_b32 a169, v5
    v_perm_b32 v4, v75, v73, s24
    v_accvgpr_write_b32 a170, v4
    v_perm_b32 v5, v79, v77, s24
    v_accvgpr_write_b32 a171, v5
    v_perm_b32 v4, v67, v65, s25
    v_accvgpr_write_b32 a172, v4
    v_perm_b32 v5, v71, v69, s25
    v_accvgpr_write_b32 a173, v5
    v_perm_b32 v4, v75, v73, s25
    v_accvgpr_write_b32 a174, v4
    v_perm_b32 v5, v79, v77, s25
    v_accvgpr_write_b32 a175, v5
    s_waitcnt vmcnt(32)
    v_perm_b32 v4, v82, v80, s24
    v_accvgpr_write_b32 a176, v4
    v_perm_b32 v5, v86, v84, s24
    v_accvgpr_write_b32 a177, v5
    v_perm_b32 v4, v90, v88, s24
    v_accvgpr_write_b32 a178, v4
    v_perm_b32 v5, v94, v92, s24
    v_accvgpr_write_b32 a179, v5
    v_perm_b32 v4, v82, v80, s25
    v_accvgpr_write_b32 a180, v4
    v_perm_b32 v5, v86, v84, s25
    v_accvgpr_write_b32 a181, v5
    v_perm_b32 v4, v90, v88, s25
    v_accvgpr_write_b32 a182, v4
    v_perm_b32 v5, v94, v92, s25
    v_accvgpr_write_b32 a183, v5
    v_perm_b32 v4, v83, v81, s24
    v_accvgpr_write_b32 a184, v4
    v_perm_b32 v5, v87, v85, s24
    v_accvgpr_write_b32 a185, v5
    v_perm_b32 v4, v91, v89, s24
    v_accvgpr_write_b32 a186, v4
    v_perm_b32 v5, v95, v93, s24
    v_accvgpr_write_b32 a187, v5
    v_perm_b32 v4, v83, v81, s25
    v_accvgpr_write_b32 a188, v4
    v_perm_b32 v5, v87, v85, s25
    v_accvgpr_write_b32 a189, v5
    v_perm_b32 v4, v91, v89, s25
    v_accvgpr_write_b32 a190, v4
    v_perm_b32 v5, v95, v93, s25
    v_accvgpr_write_b32 a191, v5
    s_waitcnt vmcnt(24)
    v_perm_b32 v4, v98, v96, s24
    v_accvgpr_write_b32 a192, v4
    v_perm_b32 v5, v102, v100, s24
    v_accvgpr_write_b32 a193, v5
    v_perm_b32 v4, v106, v104, s24
    v_accvgpr_write_b32 a194, v4
    v_perm_b32 v5, v110, v108, s24
    v_accvgpr_write_b32 a195, v5
    v_perm_b32 v4, v98, v96, s25
    v_accvgpr_write_b32 a196, v4
    v_perm_b32 v5, v102, v100, s25
    v_accvgpr_write_b32 a197, v5
    v_perm_b32 v4, v106, v104, s25
    v_accvgpr_write_b32 a198, v4
    v_perm_b32 v5, v110, v108, s25
    v_accvgpr_write_b32 a199, v5
    v_perm_b32 v4, v99, v97, s24
    v_accvgpr_write_b32 a200, v4
    v_perm_b32 v5, v103, v101, s24
    v_accvgpr_write_b32 a201, v5
    v_perm_b32 v4, v107, v105, s24
    v_accvgpr_write_b32 a202, v4
    v_perm_b32 v5, v111, v109, s24
    v_accvgpr_write_b32 a203, v5
    v_perm_b32 v4, v99, v97, s25
    v_accvgpr_write_b32 a204, v4
    v_perm_b32 v5, v103, v101, s25
    v_accvgpr_write_b32 a205, v5
    v_perm_b32 v4, v107, v105, s25
    v_accvgpr_write_b32 a206, v4
    v_perm_b32 v5, v111, v109, s25
    v_accvgpr_write_b32 a207, v5
    s_waitcnt vmcnt(16)
    v_perm_b32 v4, v114, v112, s24
    v_accvgpr_write_b32 a208, v4
    v_perm_b32 v5, v118, v116, s24
    v_accvgpr_write_b32 a209, v5
    v_perm_b32 v4, v122, v120, s24
    v_accvgpr_write_b32 a210, v4
    v_perm_b32 v5, v126, v124, s24
    v_accvgpr_write_b32 a211, v5
    v_perm_b32 v4, v114, v112, s25
    v_accvgpr_write_b32 a212, v4
    v_perm_b32 v5, v118, v116, s25
    v_accvgpr_write_b32 a213, v5
    v_perm_b32 v4, v122, v120, s25
    v_accvgpr_write_b32 a214, v4
    v_perm_b32 v5, v126, v124, s25
    v_accvgpr_write_b32 a215, v5
    v_perm_b32 v4, v115, v113, s24
    v_accvgpr_write_b32 a216, v4
    v_perm_b32 v5, v119, v117, s24
    v_accvgpr_write_b32 a217, v5
    v_perm_b32 v4, v123, v121, s24
    v_accvgpr_write_b32 a218, v4
    v_perm_b32 v5, v127, v125, s24
    v_accvgpr_write_b32 a219, v5
    v_perm_b32 v4, v115, v113, s25
    v_accvgpr_write_b32 a220, v4
    v_perm_b32 v5, v119, v117, s25
    v_accvgpr_write_b32 a221, v5
    v_perm_b32 v4, v123, v121, s25
    v_accvgpr_write_b32 a222, v4
    v_perm_b32 v5, v127, v125, s25
    v_accvgpr_write_b32 a223, v5
    s_waitcnt vmcnt(8)
    v_perm_b32 v4, v18, v16, s24
    v_accvgpr_write_b32 a224, v4
    v_perm_b32 v5, v22, v20, s24
    v_accvgpr_write_b32 a225, v5
    v_perm_b32 v4, v26, v24, s24
    v_accvgpr_write_b32 a226, v4
    v_perm_b32 v5, v30, v28, s24
    v_accvgpr_write_b32 a227, v5
    v_perm_b32 v4, v18, v16, s25
    v_accvgpr_write_b32 a228, v4
    v_perm_b32 v5, v22, v20, s25
    v_accvgpr_write_b32 a229, v5
    v_perm_b32 v4, v26, v24, s25
    v_accvgpr_write_b32 a230, v4
    v_perm_b32 v5, v30, v28, s25
    v_accvgpr_write_b32 a231, v5
    v_perm_b32 v4, v19, v17, s24
    v_accvgpr_write_b32 a232, v4
    v_perm_b32 v5, v23, v21, s24
    v_accvgpr_write_b32 a233, v5
    v_perm_b32 v4, v27, v25, s24
    v_accvgpr_write_b32 a234, v4
    v_perm_b32 v5, v31, v29, s24
    v_accvgpr_write_b32 a235, v5
    v_perm_b32 v4, v19, v17, s25
    v_accvgpr_write_b32 a236, v4
    v_perm_b32 v5, v23, v21, s25
    v_accvgpr_write_b32 a237, v5
    v_perm_b32 v4, v27, v25, s25
    v_accvgpr_write_b32 a238, v4
    v_perm_b32 v5, v31, v29, s25
    v_accvgpr_write_b32 a239, v5
    s_waitcnt vmcnt(0)
    v_perm_b32 v4, v34, v32, s24
    v_accvgpr_write_b32 a240, v4
    v_perm_b32 v5, v38, v36, s24
    v_accvgpr_write_b32 a241, v5
    v_perm_b32 v4, v42, v40, s24
    v_accvgpr_write_b32 a242, v4
    v_perm_b32 v5, v46, v44, s24
    v_accvgpr_write_b32 a243, v5
    v_perm_b32 v4, v34, v32, s25
    v_accvgpr_write_b32 a244, v4
    v_perm_b32 v5, v38, v36, s25
    v_accvgpr_write_b32 a245, v5
    v_perm_b32 v4, v42, v40, s25
    v_accvgpr_write_b32 a246, v4
    v_perm_b32 v5, v46, v44, s25
    v_accvgpr_write_b32 a247, v5
    v_perm_b32 v4, v35, v33, s24
    v_accvgpr_write_b32 a248, v4
    v_perm_b32 v5, v39, v37, s24
    v_accvgpr_write_b32 a249, v5
    v_perm_b32 v4, v43, v41, s24
    v_accvgpr_write_b32 a250, v4
    v_perm_b32 v5, v47, v45, s24
    v_accvgpr_write_b32 a251, v5
    v_perm_b32 v4, v35, v33, s25
    v_accvgpr_write_b32 a252, v4
    v_perm_b32 v5, v39, v37, s25
    v_accvgpr_write_b32 a253, v5
    v_perm_b32 v4, v43, v41, s25
    v_accvgpr_write_b32 a254, v4
    v_perm_b32 v5, v47, v45, s25
    v_accvgpr_write_b32 a255, v5
    s_mov_b32 s30, s21
    s_cmp_eq_u32 s23, 3
    s_cselect_b32 s31, 0x40000000, 0
    s_lshl_b32 s25, s23, 13
    v_add_u32 v3, s25, v1
    s_lshr_b32 s25, s23, 1
    s_lshl_b32 s25, s25, 12
    s_and_b32 s26, s23, 1
    s_lshl_b32 s26, s26, 3
    s_add_u32 s25, s25, s26
    v_add_u32 v4, s25, v1
    s_mov_b32 s33, 0
KS_95:
    s_cmp_lg_u32 s23, 0
    s_cbranch_scc1 FW_97
    s_mov_b32 s53, 0
FW_98:
    buffer_load_dword v255, off, s[48:51], s57 sc1
    s_add_u32 s53, s53, 1
    s_cmp_gt_u32 s53, 0x20000
    s_cbranch_scc1 FW_99
    s_waitcnt vmcnt(0)
    v_readfirstlane_b32 s54, v255
    s_cmp_lg_u32 s54, 2
    s_cbranch_scc1 FW_98
FW_99:
FW_97:
    s_barrier
    s_add_u32 s27, s30, 0
    buffer_load_dwordx4 v[16:19], v1, s[12:15], s27 offen offset:0 sc1
    s_add_u32 s27, s30, 0
    buffer_load_dwordx4 v[20:23], v1, s[12:15], s27 offen offset:1024 sc1
    s_add_u32 s27, s30, 0
    buffer_load_dwordx4 v[24:27], v1, s[12:15], s27 offen offset:2048 sc1
    s_add_u32 s27, s30, 0
    buffer_load_dwordx4 v[28:31], v1, s[12:15], s27 offen offset:3072 sc1
    s_add_u32 s27, s30, 4096
    buffer_load_dwordx4 v[32:35], v1, s[12:15], s27 offen offset:0 sc1
    s_add_u32 s27, s30, 4096
    buffer_load_dwordx4 v[36:39], v1, s[12:15], s27 offen offset:1024 sc1
    s_add_u32 s27, s30, 4096
    buffer_load_dwordx4 v[40:43], v1, s[12:15], s27 offen offset:2048 sc1
    s_add_u32 s27, s30, 4096
    buffer_load_dwordx4 v[44:47], v1, s[12:15], s27 offen offset:3072 sc1
    s_add_u32 s30, s30, 131072
    s_add_u32 s27, s30, 0
    buffer_load_dwordx4 v[48:51], v1, s[12:15], s27 offen offset:0 sc1
    s_add_u32 s27, s30, 0
    buffer_load_dwordx4 v[52:55], v1, s[12:15], s27 offen offset:1024 sc1
    s_add_u32 s27, s30, 0
    buffer_load_dwordx4 v[56:59], v1, s[12:15], s27 offen offset:2048 sc1
    s_add_u32 s27, s30, 0
    buffer_load_dwordx4 v[60:63], v1, s[12:15], s27 offen offset:3072 sc1
    s_add_u32 s27, s30, 4096
    buffer_load_dwordx4 v[64:67], v1, s[12:15], s27 offen offset:0 sc1
    s_add_u32 s27, s30, 4096
    buffer_load_dwordx4 v[68:71], v1, s[12:15], s27 offen offset:1024 sc1
    s_add_u32 s27, s30, 4096
    buffer_load_dwordx4 v[72:75], v1, s[12:15], s27 offen offset:2048 sc1
    s_add_u32 s27, s30, 4096
    buffer_load_dwordx4 v[76:79], v1, s[12:15], s27 offen offset:3072 sc1
    s_add_u32 s30, s30, 917504
    s_waitcnt vmcnt(15)
    v_mfma_f32_16x16x32_bf16 v[144:147], a[0:3], v[16:19], 0
    v_mfma_f32_16x16x32_bf16 v[148:151], a[4:7], v[16:19], 0
    v_mfma_f32_16x16x32_bf16 v[152:155], a[8:11], v[16:19], 0
    v_mfma_f32_16x16x32_bf16 v[156:159], a[12:15], v[16:19], 0
    v_mfma_f32_16x16x32_bf16 v[160:163], a[16:19], v[16:19], 0
    v_mfma_f32_16x16x32_bf16 v[164:167], a[20:23], v[16:19], 0
    v_mfma_f32_16x16x32_bf16 v[168:171], a[24:27], v[16:19], 0
    v_mfma_f32_16x16x32_bf16 v[172:175], a[28:31], v[16:19], 0
    s_waitcnt vmcnt(14)
    v_mfma_f32_16x16x32_bf16 v[144:147], a[32:35], v[20:23], v[144:147]
    v_mfma_f32_16x16x32_bf16 v[148:151], a[36:39], v[20:23], v[148:151]
    v_mfma_f32_16x16x32_bf16 v[152:155], a[40:43], v[20:23], v[152:155]
    v_mfma_f32_16x16x32_bf16 v[156:159], a[44:47], v[20:23], v[156:159]
    v_mfma_f32_16x16x32_bf16 v[160:163], a[48:51], v[20:23], v[160:163]
    v_mfma_f32_16x16x32_bf16 v[164:167], a[52:55], v[20:23], v[164:167]
    v_mfma_f32_16x16x32_bf16 v[168:171], a[56:59], v[20:23], v[168:171]
    v_mfma_f32_16x16x32_bf16 v[172:175], a[60:63], v[20:23], v[172:175]
    s_waitcnt vmcnt(13)
    v_mfma_f32_16x16x32_bf16 v[144:147], a[64:67], v[24:27], v[144:147]
    v_mfma_f32_16x16x32_bf16 v[148:151], a[68:71], v[24:27], v[148:151]
    v_mfma_f32_16x16x32_bf16 v[152:155], a[72:75], v[24:27], v[152:155]
    v_mfma_f32_16x16x32_bf16 v[156:159], a[76:79], v[24:27], v[156:159]
    v_mfma_f32_16x16x32_bf16 v[160:163], a[80:83], v[24:27], v[160:163]
    v_mfma_f32_16x16x32_bf16 v[164:167], a[84:87], v[24:27], v[164:167]
    v_mfma_f32_16x16x32_bf16 v[168:171], a[88:91], v[24:27], v[168:171]
    v_mfma_f32_16x16x32_bf16 v[172:175], a[92:95], v[24:27], v[172:175]
    s_waitcnt vmcnt(12)
    v_mfma_f32_16x16x32_bf16 v[144:147], a[96:99], v[28:31], v[144:147]
    v_mfma_f32_16x16x32_bf16 v[148:151], a[100:103], v[28:31], v[148:151]
    v_mfma_f32_16x16x32_bf16 v[152:155], a[104:107], v[28:31], v[152:155]
    v_mfma_f32_16x16x32_bf16 v[156:159], a[108:111], v[28:31], v[156:159]
    v_mfma_f32_16x16x32_bf16 v[160:163], a[112:115], v[28:31], v[160:163]
    v_mfma_f32_16x16x32_bf16 v[164:167], a[116:119], v[28:31], v[164:167]
    v_mfma_f32_16x16x32_bf16 v[168:171], a[120:123], v[28:31], v[168:171]
    v_mfma_f32_16x16x32_bf16 v[172:175], a[124:127], v[28:31], v[172:175]
    s_waitcnt vmcnt(11)
    v_mfma_f32_16x16x32_bf16 v[144:147], a[128:131], v[32:35], v[144:147]
    v_mfma_f32_16x16x32_bf16 v[148:151], a[132:135], v[32:35], v[148:151]
    v_mfma_f32_16x16x32_bf16 v[152:155], a[136:139], v[32:35], v[152:155]
    v_mfma_f32_16x16x32_bf16 v[156:159], a[140:143], v[32:35], v[156:159]
    v_mfma_f32_16x16x32_bf16 v[160:163], a[144:147], v[32:35], v[160:163]
    v_mfma_f32_16x16x32_bf16 v[164:167], a[148:151], v[32:35], v[164:167]
    v_mfma_f32_16x16x32_bf16 v[168:171], a[152:155], v[32:35], v[168:171]
    v_mfma_f32_16x16x32_bf16 v[172:175], a[156:159], v[32:35], v[172:175]
    s_waitcnt vmcnt(10)
    v_mfma_f32_16x16x32_bf16 v[144:147], a[160:163], v[36:39], v[144:147]
    v_mfma_f32_16x16x32_bf16 v[148:151], a[164:167], v[36:39], v[148:151]
    v_mfma_f32_16x16x32_bf16 v[152:155], a[168:171], v[36:39], v[152:155]
    v_mfma_f32_16x16x32_bf16 v[156:159], a[172:175], v[36:39], v[156:159]
    v_mfma_f32_16x16x32_bf16 v[160:163], a[176:179], v[36:39], v[160:163]
    v_mfma_f32_16x16x32_bf16 v[164:167], a[180:183], v[36:39], v[164:167]
    v_mfma_f32_16x16x32_bf16 v[168:171], a[184:187], v[36:39], v[168:171]
    v_mfma_f32_16x16x32_bf16 v[172:175], a[188:191], v[36:39], v[172:175]
    s_waitcnt vmcnt(9)
    v_mfma_f32_16x16x32_bf16 v[144:147], a[192:195], v[40:43], v[144:147]
    v_mfma_f32_16x16x32_bf16 v[148:151], a[196:199], v[40:43], v[148:151]
    v_mfma_f32_16x16x32_bf16 v[152:155], a[200:203], v[40:43], v[152:155]
    v_mfma_f32_16x16x32_bf16 v[156:159], a[204:207], v[40:43], v[156:159]
    v_mfma_f32_16x16x32_bf16 v[160:163], a[208:211], v[40:43], v[160:163]
    v_mfma_f32_16x16x32_bf16 v[164:167], a[212:215], v[40:43], v[164:167]
    v_mfma_f32_16x16x32_bf16 v[168:171], a[216:219], v[40:43], v[168:171]
    v_mfma_f32_16x16x32_bf16 v[172:175], a[220:223], v[40:43], v[172:175]
    s_waitcnt vmcnt(8)
    v_mfma_f32_16x16x32_bf16 v[144:147], a[224:227], v[44:47], v[144:147]
    v_mfma_f32_16x16x32_bf16 v[148:151], a[228:231], v[44:47], v[148:151]
    v_mfma_f32_16x16x32_bf16 v[152:155], a[232:235], v[44:47], v[152:155]
    v_mfma_f32_16x16x32_bf16 v[156:159], a[236:239], v[44:47], v[156:159]
    v_mfma_f32_16x16x32_bf16 v[160:163], a[240:243], v[44:47], v[160:163]
    v_mfma_f32_16x16x32_bf16 v[164:167], a[244:247], v[44:47], v[164:167]
    v_mfma_f32_16x16x32_bf16 v[168:171], a[248:251], v[44:47], v[168:171]
    v_mfma_f32_16x16x32_bf16 v[172:175], a[252:255], v[44:47], v[172:175]
    s_waitcnt vmcnt(7)
    v_mfma_f32_16x16x32_bf16 v[176:179], a[0:3], v[48:51], 0
    v_mfma_f32_16x16x32_bf16 v[180:183], a[4:7], v[48:51], 0
    v_mfma_f32_16x16x32_bf16 v[184:187], a[8:11], v[48:51], 0
    v_mfma_f32_16x16x32_bf16 v[188:191], a[12:15], v[48:51], 0
    v_mfma_f32_16x16x32_bf16 v[192:195], a[16:19], v[48:51], 0
    v_mfma_f32_16x16x32_bf16 v[196:199], a[20:23], v[48:51], 0
    v_mfma_f32_16x16x32_bf16 v[200:203], a[24:27], v[48:51], 0
    v_mfma_f32_16x16x32_bf16 v[204:207], a[28:31], v[48:51], 0
    s_waitcnt vmcnt(6)
    v_mfma_f32_16x16x32_bf16 v[176:179], a[32:35], v[52:55], v[176:179]
    ds_write_b128 v3, v[144:147] offset:0
    v_mfma_f32_16x16x32_bf16 v[180:183], a[36:39], v[52:55], v[180:183]
    ds_write_b128 v3, v[148:151] offset:1024
    v_mfma_f32_16x16x32_bf16 v[184:187], a[40:43], v[52:55], v[184:187]
    ds_write_b128 v3, v[152:155] offset:2048
    v_mfma_f32_16x16x32_bf16 v[188:191], a[44:47], v[52:55], v[188:191]
    ds_write_b128 v3, v[156:159] offset:3072
    v_mfma_f32_16x16x32_bf16 v[192:195], a[48:51], v[52:55], v[192:195]
    ds_write_b128 v3, v[160:163] offset:4096
    v_mfma_f32_16x16x32_bf16 v[196:199], a[52:55], v[52:55], v[196:199]
    ds_write_b128 v3, v[164:167] offset:5120
    v_mfma_f32_16x16x32_bf16 v[200:203], a[56:59], v[52:55], v[200:203]
    ds_write_b128 v3, v[168:171] offset:6144
    v_mfma_f32_16x16x32_bf16 v[204:207], a[60:63], v[52:55], v[204:207]
    ds_write_b128 v3, v[172:175] offset:7168
    s_waitcnt vmcnt(5)
    v_mfma_f32_16x16x32_bf16 v[176:179], a[64:67], v[56:59], v[176:179]
    v_mfma_f32_16x16x32_bf16 v[180:183], a[68:71], v[56:59], v[180:183]
    v_mfma_f32_16x16x32_bf16 v[184:187], a[72:75], v[56:59], v[184:187]
    v_mfma_f32_16x16x32_bf16 v[188:191], a[76:79], v[56:59], v[188:191]
    v_mfma_f32_16x16x32_bf16 v[192:195], a[80:83], v[56:59], v[192:195]
    v_mfma_f32_16x16x32_bf16 v[196:199], a[84:87], v[56:59], v[196:199]
    v_mfma_f32_16x16x32_bf16 v[200:203], a[88:91], v[56:59], v[200:203]
    v_mfma_f32_16x16x32_bf16 v[204:207], a[92:95], v[56:59], v[204:207]
    s_waitcnt vmcnt(4)
    v_mfma_f32_16x16x32_bf16 v[176:179], a[96:99], v[60:63], v[176:179]
    v_mfma_f32_16x16x32_bf16 v[180:183], a[100:103], v[60:63], v[180:183]
    v_mfma_f32_16x16x32_bf16 v[184:187], a[104:107], v[60:63], v[184:187]
    v_mfma_f32_16x16x32_bf16 v[188:191], a[108:111], v[60:63], v[188:191]
    v_mfma_f32_16x16x32_bf16 v[192:195], a[112:115], v[60:63], v[192:195]
    v_mfma_f32_16x16x32_bf16 v[196:199], a[116:119], v[60:63], v[196:199]
    v_mfma_f32_16x16x32_bf16 v[200:203], a[120:123], v[60:63], v[200:203]
    v_mfma_f32_16x16x32_bf16 v[204:207], a[124:127], v[60:63], v[204:207]
    s_waitcnt vmcnt(3)
    v_mfma_f32_16x16x32_bf16 v[176:179], a[128:131], v[64:67], v[176:179]
    v_mfma_f32_16x16x32_bf16 v[180:183], a[132:135], v[64:67], v[180:183]
    v_mfma_f32_16x16x32_bf16 v[184:187], a[136:139], v[64:67], v[184:187]
    v_mfma_f32_16x16x32_bf16 v[188:191], a[140:143], v[64:67], v[188:191]
    v_mfma_f32_16x16x32_bf16 v[192:195], a[144:147], v[64:67], v[192:195]
    v_mfma_f32_16x16x32_bf16 v[196:199], a[148:151], v[64:67], v[196:199]
    v_mfma_f32_16x16x32_bf16 v[200:203], a[152:155], v[64:67], v[200:203]
    v_mfma_f32_16x16x32_bf16 v[204:207], a[156:159], v[64:67], v[204:207]
    s_waitcnt vmcnt(2)
    v_mfma_f32_16x16x32_bf16 v[176:179], a[160:163], v[68:71], v[176:179]
    v_mfma_f32_16x16x32_bf16 v[180:183], a[164:167], v[68:71], v[180:183]
    v_mfma_f32_16x16x32_bf16 v[184:187], a[168:171], v[68:71], v[184:187]
    v_mfma_f32_16x16x32_bf16 v[188:191], a[172:175], v[68:71], v[188:191]
    v_mfma_f32_16x16x32_bf16 v[192:195], a[176:179], v[68:71], v[192:195]
    v_mfma_f32_16x16x32_bf16 v[196:199], a[180:183], v[68:71], v[196:199]
    v_mfma_f32_16x16x32_bf16 v[200:203], a[184:187], v[68:71], v[200:203]
    v_mfma_f32_16x16x32_bf16 v[204:207], a[188:191], v[68:71], v[204:207]
    s_waitcnt vmcnt(1)
    v_mfma_f32_16x16x32_bf16 v[176:179], a[192:195], v[72:75], v[176:179]
    v_mfma_f32_16x16x32_bf16 v[180:183], a[196:199], v[72:75], v[180:183]
    v_mfma_f32_16x16x32_bf16 v[184:187], a[200:203], v[72:75], v[184:187]
    v_mfma_f32_16x16x32_bf16 v[188:191], a[204:207], v[72:75], v[188:191]
    v_mfma_f32_16x16x32_bf16 v[192:195], a[208:211], v[72:75], v[192:195]
    v_mfma_f32_16x16x32_bf16 v[196:199], a[212:215], v[72:75], v[196:199]
    v_mfma_f32_16x16x32_bf16 v[200:203], a[216:219], v[72:75], v[200:203]
    v_mfma_f32_16x16x32_bf16 v[204:207], a[220:223], v[72:75], v[204:207]
    s_waitcnt vmcnt(0)
    v_mfma_f32_16x16x32_bf16 v[176:179], a[224:227], v[76:79], v[176:179]
    v_mfma_f32_16x16x32_bf16 v[180:183], a[228:231], v[76:79], v[180:183]
    v_mfma_f32_16x16x32_bf16 v[184:187], a[232:235], v[76:79], v[184:187]
    v_mfma_f32_16x16x32_bf16 v[188:191], a[236:239], v[76:79], v[188:191]
    v_mfma_f32_16x16x32_bf16 v[192:195], a[240:243], v[76:79], v[192:195]
    v_mfma_f32_16x16x32_bf16 v[196:199], a[244:247], v[76:79], v[196:199]
    v_mfma_f32_16x16x32_bf16 v[200:203], a[248:251], v[76:79], v[200:203]
    v_mfma_f32_16x16x32_bf16 v[204:207], a[252:255], v[76:79], v[204:207]
    s_nop 7
    ds_write_b128 v3, v[176:179] offset:32768
    ds_write_b128 v3, v[180:183] offset:33792
    ds_write_b128 v3, v[184:187] offset:34816
    ds_write_b128 v3, v[188:191] offset:35840
    ds_write_b128 v3, v[192:195] offset:36864
    ds_write_b128 v3, v[196:199] offset:37888
    ds_write_b128 v3, v[200:203] offset:38912
    ds_write_b128 v3, v[204:207] offset:39936
    s_waitcnt vmcnt(0) lgkmcnt(0)
    s_barrier
    ds_read_b64 v[208:209], v4 offset:0
    ds_read_b64 v[210:211], v4 offset:1024
    ds_read_b64 v[212:213], v4 offset:2048
    ds_read_b64 v[214:215], v4 offset:3072
    ds_read_b64 v[216:217], v4 offset:8192
    ds_read_b64 v[218:219], v4 offset:9216
    ds_read_b64 v[220:221], v4 offset:10240
    ds_read_b64 v[222:223], v4 offset:11264
    ds_read_b64 v[224:225], v4 offset:16384
    ds_read_b64 v[226:227], v4 offset:17408
    ds_read_b64 v[228:229], v4 offset:18432
    ds_read_b64 v[230:231], v4 offset:19456
    ds_read_b64 v[232:233], v4 offset:24576
    ds_read_b64 v[234:235], v4 offset:25600
    ds_read_b64 v[236:237], v4 offset:26624
    ds_read_b64 v[238:239], v4 offset:27648
    s_waitcnt lgkmcnt(0)
    v_add_f32 v208, v208, v216
    v_add_f32 v209, v209, v217
    v_add_f32 v210, v210, v218
    v_add_f32 v211, v211, v219
    v_add_f32 v212, v212, v220
    v_add_f32 v213, v213, v221
    v_add_f32 v214, v214, v222
    v_add_f32 v215, v215, v223
    v_add_f32 v224, v224, v232
    v_add_f32 v225, v225, v233
    v_add_f32 v226, v226, v234
    v_add_f32 v227, v227, v235
    v_add_f32 v228, v228, v236
    v_add_f32 v229, v229, v237
    v_add_f32 v230, v230, v238
    v_add_f32 v231, v231, v239
    v_add_f32 v216, v208, v224
    v_add_f32 v220, v209, v225
    v_add_f32 v217, v210, v226
    v_add_f32 v221, v211, v227
    v_add_f32 v218, v212, v228
    v_add_f32 v222, v213, v229
    v_add_f32 v219, v214, v230
    v_add_f32 v223, v215, v231
    buffer_store_dwordx4 v[216:219], v1, s[16:19], s22 offen sc1
    buffer_store_dwordx4 v[220:223], v1, s[16:19], s22 offen offset:1024 sc1
    s_add_u32 s22, s22, 40960
    ds_read_b64 v[208:209], v4 offset:32768
    ds_read_b64 v[210:211], v4 offset:33792
    ds_read_b64 v[212:213], v4 offset:34816
    ds_read_b64 v[214:215], v4 offset:35840
    ds_read_b64 v[216:217], v4 offset:40960
    ds_read_b64 v[218:219], v4 offset:41984
    ds_read_b64 v[220:221], v4 offset:43008
    ds_read_b64 v[222:223], v4 offset:44032
    ds_read_b64 v[224:225], v4 offset:49152
    ds_read_b64 v[226:227], v4 offset:50176
    ds_read_b64 v[228:229], v4 offset:51200
    ds_read_b64 v[230:231], v4 offset:52224
    ds_read_b64 v[232:233], v4 offset:57344
    ds_read_b64 v[234:235], v4 offset:58368
    ds_read_b64 v[236:237], v4 offset:59392
    ds_read_b64 v[238:239], v4 offset:60416
    s_waitcnt lgkmcnt(0)
    v_add_f32 v208, v208, v216
    v_add_f32 v209, v209, v217
    v_add_f32 v210, v210, v218
    v_add_f32 v211, v211, v219
    v_add_f32 v212, v212, v220
    v_add_f32 v213, v213, v221
    v_add_f32 v214, v214, v222
    v_add_f32 v215, v215, v223
    v_add_f32 v224, v224, v232
    v_add_f32 v225, v225, v233
    v_add_f32 v226, v226, v234
    v_add_f32 v227, v227, v235
    v_add_f32 v228, v228, v236
    v_add_f32 v229, v229, v237
    v_add_f32 v230, v230, v238
    v_add_f32 v231, v231, v239
    v_add_f32 v216, v208, v224
    v_add_f32 v220, v209, v225
    v_add_f32 v217, v210, v226
    v_add_f32 v221, v211, v227
    v_add_f32 v218, v212, v228
    v_add_f32 v222, v213, v229
    v_add_f32 v219, v214, v230
    v_add_f32 v223, v215, v231
    buffer_store_dwordx4 v[216:219], v1, s[16:19], s22 offen sc1
    buffer_store_dwordx4 v[220:223], v1, s[16:19], s22 offen offset:1024 sc1
    s_add_u32 s22, s22, 40960
    s_add_u32 s22, s22, 245760
    s_waitcnt vmcnt(0) lgkmcnt(0)
    s_barrier
    s_cmp_lg_u32 s23, 0
    s_cbranch_scc1 FS_100
    s_mov_b64 exec, 1
    v_mov_b32 v255, 1
    buffer_atomic_add v255, off, s[48:51], s58 sc1
    s_mov_b64 exec, -1
FS_100:
    s_add_u32 s58, s58, 512
    s_add_u32 s57, s57, 1024
    s_add_u32 s52, s52, 4
    s_cmp_lt_u32 s52, 64
    s_cbranch_scc1 KS_95
    s_waitcnt vmcnt(0)
    s_branch RW_13
RW_94:
    s_sub_u32 s2, s2, 80
    s_cmp_ge_u32 s2, 12
    s_cbranch_scc1 RW_101
    s_load_dwordx2 s[4:5], s[0:1], 0
    s_mov_b32 s20, s2
    s_waitcnt lgkmcnt(0)
    s_add_u32 s8, s4, 0x0
    s_addc_u32 s9, s5, 0
    s_and_b32 s9, s9, 0xffff
    s_mov_b32 s10, 0x280000
    s_mov_b32 s11, 0x20000
    s_add_u32 s12, s6, 0x5400000
    s_addc_u32 s13, s7, 0
    s_and_b32 s13, s13, 0xffff
    s_mov_b32 s14, 0x1400000
    s_mov_b32 s15, 0x20000
    s_add_u32 s16, s6, 0x6a00000
    s_addc_u32 s17, s7, 0
    s_and_b32 s17, s17, 0xffff
    s_mov_b32 s18, 0x680000
    s_mov_b32 s19, 0x20000
LL_102:
    s_lshr_b32 s55, s20, 1
    s_lshl_b32 s55, s55, 7
    s_add_u32 s56, s55, 32768
    s_add_u32 s55, s55, 24576
    v_and_b32 v1, 63, v0
    v_and_b32 v2, 15, v1
    v_mul_u32_u24 v2, 1280, v2
    v_lshrrev_b32 v3, 4, v1
    v_lshl_add_u32 v2, v3, 5, v2
    v_lshlrev_b32 v1, 4, v1
    s_mul_i32 s24, s20, 40960
    s_mul_i32 s25, s20, 20480
    s_cmp_ge_u32 s23, 2
    s_cselect_b32 s29, 0x40000000, 0
    s_lshl_b32 s27, s23, 7
    s_add_u32 s27, s27, s25
    s_add_u32 s27, s27, 0
    buffer_load_dwordx4 v[160:163], v2, s[8:11], s27 offen
    buffer_load_dwordx4 v[164:167], v2, s[8:11], s27 offen offset:16
    s_lshl_b32 s27, s23, 7
    s_add_u32 s27, s27, s25
    s_add_u32 s27, s27, 512
    buffer_load_dwordx4 v[168:171], v2, s[8:11], s27 offen
    buffer_load_dwordx4 v[172:175], v2, s[8:11], s27 offen offset:16
    s_lshl_b32 s27, s23, 7
    s_add_u32 s27, s27, s25
    s_add_u32 s27, s27, 1024
    s_add_u32 s27, s27, s29
    buffer_load_dwordx4 v[176:179], v2, s[8:11], s27 offen
    buffer_load_dwordx4 v[180:183], v2, s[8:11], s27 offen offset:16
    s_cmp_lg_u32 s23, 0
    s_cbranch_scc1 FW_104
    s_mov_b32 s53, 0
FW_105:
    buffer_load_dword v255, off, s[48:51], s55 sc1
    s_add_u32 s53, s53, 1
    s_cmp_gt_u32 s53, 0x20000
    s_cbranch_scc1 FW_106
    s_waitcnt vmcnt(0)
    v_readfirstlane_b32 s54, v255
    s_cmp_lg_u32 s54, 20
    s_cbranch_scc1 FW_105
FW_106:
FW_104:
    s_barrier
    s_lshl_b32 s26, s23, 12
    s_add_u32 s26, s26, s24
    s_add_u32 s26, s26, 0
    buffer_load_dwordx4 v[16:19], v1, s[12:15], s26 offen offset:0 sc1
    buffer_load_dwordx4 v[20:23], v1, s[12:15], s26 offen offset:1024 sc1
    buffer_load_dwordx4 v[24:27], v1, s[12:15], s26 offen offset:2048 sc1
    buffer_load_dwordx4 v[28:31], v1, s[12:15], s26 offen offset:3072 sc1
    s_add_u32 s26, s26, 5242880
    buffer_load_dwordx4 v[64:67], v1, s[12:15], s26 offen offset:0 sc1
    buffer_load_dwordx4 v[68:71], v1, s[12:15], s26 offen offset:1024 sc1
    buffer_load_dwordx4 v[72:75], v1, s[12:15], s26 offen offset:2048 sc1
    buffer_load_dwordx4 v[76:79], v1, s[12:15], s26 offen offset:3072 sc1
    s_add_u32 s26, s26, 5242880
    buffer_load_dwordx4 v[80:83], v1, s[12:15], s26 offen offset:0 sc1
    buffer_load_dwordx4 v[84:87], v1, s[12:15], s26 offen offset:1024 sc1
    buffer_load_dwordx4 v[88:91], v1, s[12:15], s26 offen offset:2048 sc1
    buffer_load_dwordx4 v[92:95], v1, s[12:15], s26 offen offset:3072 sc1
    s_add_u32 s26, s26, 5242880
    buffer_load_dwordx4 v[96:99], v1, s[12:15], s26 offen offset:0 sc1
    buffer_load_dwordx4 v[100:103], v1, s[12:15], s26 offen offset:1024 sc1
    buffer_load_dwordx4 v[104:107], v1, s[12:15], s26 offen offset:2048 sc1
    buffer_load_dwordx4 v[108:111], v1, s[12:15], s26 offen offset:3072 sc1
    s_add_u32 s26, s26, 5242880
    s_lshl_b32 s26, s23, 12
    s_add_u32 s26, s26, s24
    s_add_u32 s26, s26, 16384
    buffer_load_dwordx4 v[32:35], v1, s[12:15], s26 offen offset:0 sc1
    buffer_load_dwordx4 v[36:39], v1, s[12:15], s26 offen offset:1024 sc1
    buffer_load_dwordx4 v[40:43], v1, s[12:15], s26 offen offset:2048 sc1
    buffer_load_dwordx4 v[44:47], v1, s[12:15], s26 offen offset:3072 sc1
    s_add_u32 s26, s26, 5242880
    buffer_load_dwordx4 v[112:115], v1, s[12:15], s26 offen offset:0 sc1
    buffer_load_dwordx4 v[116:119], v1, s[12:15], s26 offen offset:1024 sc1
    buffer_load_dwordx4 v[120:123], v1, s[12:15], s26 offen offset:2048 sc1
    buffer_load_dwordx4 v[124:127], v1, s[12:15], s26 offen offset:3072 sc1
    s_add_u32 s26, s26, 5242880
    buffer_load_dwordx4 v[128:131], v1, s[12:15], s26 offen offset:0 sc1
    buffer_load_dwordx4 v[132:135], v1, s[12:15], s26 offen offset:1024 sc1
    buffer_load_dwordx4 v[136:139], v1, s[12:15], s26 offen offset:2048 sc1
    buffer_load_dwordx4 v[140:143], v1, s[12:15], s26 offen offset:3072 sc1
    s_add_u32 s26, s26, 5242880
    buffer_load_dwordx4 v[144:147], v1, s[12:15], s26 offen offset:0 sc1
    buffer_load_dwordx4 v[148:151], v1, s[12:15], s26 offen offset:1024 sc1
    buffer_load_dwordx4 v[152:155], v1, s[12:15], s26 offen offset:2048 sc1
    buffer_load_dwordx4 v[156:159], v1, s[12:15], s26 offen offset:3072 sc1
    s_add_u32 s26, s26, 5242880
    s_waitcnt vmcnt(16)
    v_add_f32 v16, v16, v64
    v_add_f32 v17, v17, v65
    v_add_f32 v18, v18, v66
    v_add_f32 v19, v19, v67
    v_add_f32 v20, v20, v68
    v_add_f32 v21, v21, v69
    v_add_f32 v22, v22, v70
    v_add_f32 v23, v23, v71
    v_add_f32 v24, v24, v72
    v_add_f32 v25, v25, v73
    v_add_f32 v26, v26, v74
    v_add_f32 v27, v27, v75
    v_add_f32 v28, v28, v76
    v_add_f32 v29, v29, v77
    v_add_f32 v30, v30, v78
    v_add_f32 v31, v31, v79
    v_add_f32 v16, v16, v80
    v_add_f32 v17, v17, v81
    v_add_f32 v18, v18, v82
    v_add_f32 v19, v19, v83
    v_add_f32 v20, v20, v84
    v_add_f32 v21, v21, v85
    v_add_f32 v22, v22, v86
    v_add_f32 v23, v23, v87
    v_add_f32 v24, v24, v88
    v_add_f32 v25, v25, v89
    v_add_f32 v26, v26, v90
    v_add_f32 v27, v27, v91
    v_add_f32 v28, v28, v92
    v_add_f32 v29, v29, v93
    v_add_f32 v30, v30, v94
    v_add_f32 v31, v31, v95
    v_add_f32 v16, v16, v96
    v_add_f32 v17, v17, v97
    v_add_f32 v18, v18, v98
    v_add_f32 v19, v19, v99
    v_add_f32 v20, v20, v100
    v_add_f32 v21, v21, v101
    v_add_f32 v22, v22, v102
    v_add_f32 v23, v23, v103
    v_add_f32 v24, v24, v104
    v_add_f32 v25, v25, v105
    v_add_f32 v26, v26, v106
    v_add_f32 v27, v27, v107
    v_add_f32 v28, v28, v108
    v_add_f32 v29, v29, v109
    v_add_f32 v30, v30, v110
    v_add_f32 v31, v31, v111
    s_lshl_b32 s26, s23, 12
    s_add_u32 s26, s26, s24
    s_add_u32 s26, s26, 32768
    s_add_u32 s26, s26, s29
    buffer_load_dwordx4 v[48:51], v1, s[12:15], s26 offen offset:0 sc1
    buffer_load_dwordx4 v[52:55], v1, s[12:15], s26 offen offset:1024 sc1
    buffer_load_dwordx4 v[56:59], v1, s[12:15], s26 offen offset:2048 sc1
    buffer_load_dwordx4 v[60:63], v1, s[12:15], s26 offen offset:3072 sc1
    s_add_u32 s26, s26, 5242880
    buffer_load_dwordx4 v[64:67], v1, s[12:15], s26 offen offset:0 sc1
    buffer_load_dwordx4 v[68:71], v1, s[12:15], s26 offen offset:1024 sc1
    buffer_load_dwordx4 v[72:75], v1, s[12:15], s26 offen offset:2048 sc1
    buffer_load_dwordx4 v[76:79], v1, s[12:15], s26 offen offset:3072 sc1
    s_add_u32 s26, s26, 5242880
    buffer_load_dwordx4 v[80:83], v1, s[12:15], s26 offen offset:0 sc1
    buffer_load_dwordx4 v[84:87], v1, s[12:15], s26 offen offset:1024 sc1
    buffer_load_dwordx4 v[88:91], v1, s[12:15], s26 offen offset:2048 sc1
    buffer_load_dwordx4 v[92:95], v1, s[12:15], s26 offen offset:3072 sc1
    s_add_u32 s26, s26, 5242880
    buffer_load_dwordx4 v[96:99], v1, s[12:15], s26 offen offset:0 sc1
    buffer_load_dwordx4 v[100:103], v1, s[12:15], s26 offen offset:1024 sc1
    buffer_load_dwordx4 v[104:107], v1, s[12:15], s26 offen offset:2048 sc1
    buffer_load_dwordx4 v[108:111], v1, s[12:15], s26 offen offset:3072 sc1
    s_add_u32 s26, s26, 5242880
    s_waitcnt vmcnt(16)
    v_add_f32 v32, v32, v112
    v_add_f32 v33, v33, v113
    v_add_f32 v34, v34, v114
    v_add_f32 v35, v35, v115
    v_add_f32 v36, v36, v116
    v_add_f32 v37, v37, v117
    v_add_f32 v38, v38, v118
    v_add_f32 v39, v39, v119
    v_add_f32 v40, v40, v120
    v_add_f32 v41, v41, v121
    v_add_f32 v42, v42, v122
    v_add_f32 v43, v43, v123
    v_add_f32 v44, v44, v124
    v_add_f32 v45, v45, v125
    v_add_f32 v46, v46, v126
    v_add_f32 v47, v47, v127
    v_add_f32 v32, v32, v128
    v_add_f32 v33, v33, v129
    v_add_f32 v34, v34, v130
    v_add_f32 v35, v35, v131
    v_add_f32 v36, v36, v132
    v_add_f32 v37, v37, v133
    v_add_f32 v38, v38, v134
    v_add_f32 v39, v39, v135
    v_add_f32 v40, v40, v136
    v_add_f32 v41, v41, v137
    v_add_f32 v42, v42, v138
    v_add_f32 v43, v43, v139
    v_add_f32 v44, v44, v140
    v_add_f32 v45, v45, v141
    v_add_f32 v46, v46, v142
    v_add_f32 v47, v47, v143
    v_add_f32 v32, v32, v144
    v_add_f32 v33, v33, v145
    v_add_f32 v34, v34, v146
    v_add_f32 v35, v35, v147
    v_add_f32 v36, v36, v148
    v_add_f32 v37, v37, v149
    v_add_f32 v38, v38, v150
    v_add_f32 v39, v39, v151
    v_add_f32 v40, v40, v152
    v_add_f32 v41, v41, v153
    v_add_f32 v42, v42, v154
    v_add_f32 v43, v43, v155
    v_add_f32 v44, v44, v156
    v_add_f32 v45, v45, v157
    v_add_f32 v46, v46, v158
    v_add_f32 v47, v47, v159
    s_waitcnt vmcnt(0)
    v_add_f32 v48, v48, v64
    v_add_f32 v49, v49, v65
    v_add_f32 v50, v50, v66
    v_add_f32 v51, v51, v67
    v_add_f32 v52, v52, v68
    v_add_f32 v53, v53, v69
    v_add_f32 v54, v54, v70
    v_add_f32 v55, v55, v71
    v_add_f32 v56, v56, v72
    v_add_f32 v57, v57, v73
    v_add_f32 v58, v58, v74
    v_add_f32 v59, v59, v75
    v_add_f32 v60, v60, v76
    v_add_f32 v61, v61, v77
    v_add_f32 v62, v62, v78
    v_add_f32 v63, v63, v79
    v_add_f32 v48, v48, v80
    v_add_f32 v49, v49, v81
    v_add_f32 v50, v50, v82
    v_add_f32 v51, v51, v83
    v_add_f32 v52, v52, v84
    v_add_f32 v53, v53, v85
    v_add_f32 v54, v54, v86
    v_add_f32 v55, v55, v87
    v_add_f32 v56, v56, v88
    v_add_f32 v57, v57, v89
    v_add_f32 v58, v58, v90
    v_add_f32 v59, v59, v91
    v_add_f32 v60, v60, v92
    v_add_f32 v61, v61, v93
    v_add_f32 v62, v62, v94
    v_add_f32 v63, v63, v95
    v_add_f32 v48, v48, v96
    v_add_f32 v49, v49, v97
    v_add_f32 v50, v50, v98
    v_add_f32 v51, v51, v99
    v_add_f32 v52, v52, v100
    v_add_f32 v53, v53, v101
    v_add_f32 v54, v54, v102
    v_add_f32 v55, v55, v103
    v_add_f32 v56, v56, v104
    v_add_f32 v57, v57, v105
    v_add_f32 v58, v58, v106
    v_add_f32 v59, v59, v107
    v_add_f32 v60, v60, v108
    v_add_f32 v61, v61, v109
    v_add_f32 v62, v62, v110
    v_add_f32 v63, v63, v111
    v_mov_b32 v4, 0
    v_mov_b32 v5, 0
    v_cvt_pk_bf16_f32 v16, v16, v17
    v_and_b32 v17, 0xffff0000, v16
    v_lshlrev_b32 v16, 16, v16
    v_lshlrev_b32 v6, 16, v160
    v_and_b32 v7, 0xffff0000, v160
    v_add_f32 v16, v16, v6
    v_add_f32 v17, v17, v7
    v_cvt_pk_bf16_f32 v160, v16, v17
    v_lshlrev_b32 v16, 16, v160
    v_and_b32 v17, 0xffff0000, v160
    v_add_f32 v4, v4, v16
    v_add_f32 v5, v5, v17
    v_cvt_pk_bf16_f32 v18, v18, v19
    v_and_b32 v19, 0xffff0000, v18
    v_lshlrev_b32 v18, 16, v18
    v_lshlrev_b32 v6, 16, v161
    v_and_b32 v7, 0xffff0000, v161
    v_add_f32 v18, v18, v6
    v_add_f32 v19, v19, v7
    v_cvt_pk_bf16_f32 v161, v18, v19
    v_lshlrev_b32 v18, 16, v161
    v_and_b32 v19, 0xffff0000, v161
    v_add_f32 v4, v4, v18
    v_add_f32 v5, v5, v19
    v_cvt_pk_bf16_f32 v20, v20, v21
    v_and_b32 v21, 0xffff0000, v20
    v_lshlrev_b32 v20, 16, v20
    v_lshlrev_b32 v6, 16, v162
    v_and_b32 v7, 0xffff0000, v162
    v_add_f32 v20, v20, v6
    v_add_f32 v21, v21, v7
    v_cvt_pk_bf16_f32 v162, v20, v21
    v_lshlrev_b32 v20, 16, v162
    v_and_b32 v21, 0xffff0000, v162
    v_add_f32 v4, v4, v20
    v_add_f32 v5, v5, v21
    v_cvt_pk_bf16_f32 v22, v22, v23
    v_and_b32 v23, 0xffff0000, v22
    v_lshlrev_b32 v22, 16, v22
    v_lshlrev_b32 v6, 16, v163
    v_and_b32 v7, 0xffff0000, v163
    v_add_f32 v22, v22, v6
    v_add_f32 v23, v23, v7
    v_cvt_pk_bf16_f32 v163, v22, v23
    v_lshlrev_b32 v22, 16, v163
    v_and_b32 v23, 0xffff0000, v163
    v_add_f32 v4, v4, v22
    v_add_f32 v5, v5, v23
    v_cvt_pk_bf16_f32 v24, v24, v25
    v_and_b32 v25, 0xffff0000, v24
    v_lshlrev_b32 v24, 16, v24
    v_lshlrev_b32 v6, 16, v164
    v_and_b32 v7, 0xffff0000, v164
    v_add_f32 v24, v24, v6
    v_add_f32 v25, v25, v7
    v_cvt_pk_bf16_f32 v164, v24, v25
    v_lshlrev_b32 v24, 16, v164
    v_and_b32 v25, 0xffff0000, v164
    v_add_f32 v4, v4, v24
    v_add_f32 v5, v5, v25
    v_cvt_pk_bf16_f32 v26, v26, v27
    v_and_b32 v27, 0xffff0000, v26
    v_lshlrev_b32 v26, 16, v26
    v_lshlrev_b32 v6, 16, v165
    v_and_b32 v7, 0xffff0000, v165
    v_add_f32 v26, v26, v6
    v_add_f32 v27, v27, v7
    v_cvt_pk_bf16_f32 v165, v26, v27
    v_lshlrev_b32 v26, 16, v165
    v_and_b32 v27, 0xffff0000, v165
    v_add_f32 v4, v4, v26
    v_add_f32 v5, v5, v27
    v_cvt_pk_bf16_f32 v28, v28, v29
    v_and_b32 v29, 0xffff0000, v28
    v_lshlrev_b32 v28, 16, v28
    v_lshlrev_b32 v6, 16, v166
    v_and_b32 v7, 0xffff0000, v166
    v_add_f32 v28, v28, v6
    v_add_f32 v29, v29, v7
    v_cvt_pk_bf16_f32 v166, v28, v29
    v_lshlrev_b32 v28, 16, v166
    v_and_b32 v29, 0xffff0000, v166
    v_add_f32 v4, v4, v28
    v_add_f32 v5, v5, v29
    v_cvt_pk_bf16_f32 v30, v30, v31
    v_and_b32 v31, 0xffff0000, v30
    v_lshlrev_b32 v30, 16, v30
    v_lshlrev_b32 v6, 16, v167
    v_and_b32 v7, 0xffff0000, v167
    v_add_f32 v30, v30, v6
    v_add_f32 v31, v31, v7
    v_cvt_pk_bf16_f32 v167, v30, v31
    v_lshlrev_b32 v30, 16, v167
    v_and_b32 v31, 0xffff0000, v167
    v_add_f32 v4, v4, v30
    v_add_f32 v5, v5, v31
    v_cvt_pk_bf16_f32 v32, v32, v33
    v_and_b32 v33, 0xffff0000, v32
    v_lshlrev_b32 v32, 16, v32
    v_lshlrev_b32 v6, 16, v168
    v_and_b32 v7, 0xffff0000, v168
    v_add_f32 v32, v32, v6
    v_add_f32 v33, v33, v7
    v_cvt_pk_bf16_f32 v168, v32, v33
    v_lshlrev_b32 v32, 16, v168
    v_and_b32 v33, 0xffff0000, v168
    v_add_f32 v4, v4, v32
    v_add_f32 v5, v5, v33
    v_cvt_pk_bf16_f32 v34, v34, v35
    v_and_b32 v35, 0xffff0000, v34
    v_lshlrev_b32 v34, 16, v34
    v_lshlrev_b32 v6, 16, v169
    v_and_b32 v7, 0xffff0000, v169
    v_add_f32 v34, v34, v6
    v_add_f32 v35, v35, v7
    v_cvt_pk_bf16_f32 v169, v34, v35
    v_lshlrev_b32 v34, 16, v169
    v_and_b32 v35, 0xffff0000, v169
    v_add_f32 v4, v4, v34
    v_add_f32 v5, v5, v35
    v_cvt_pk_bf16_f32 v36, v36, v37
    v_and_b32 v37, 0xffff0000, v36
    v_lshlrev_b32 v36, 16, v36
    v_lshlrev_b32 v6, 16, v170
    v_and_b32 v7, 0xffff0000, v170
    v_add_f32 v36, v36, v6
    v_add_f32 v37, v37, v7
    v_cvt_pk_bf16_f32 v170, v36, v37
    v_lshlrev_b32 v36, 16, v170
    v_and_b32 v37, 0xffff0000, v170
    v_add_f32 v4, v4, v36
    v_add_f32 v5, v5, v37
    v_cvt_pk_bf16_f32 v38, v38, v39
    v_and_b32 v39, 0xffff0000, v38
    v_lshlrev_b32 v38, 16, v38
    v_lshlrev_b32 v6, 16, v171
    v_and_b32 v7, 0xffff0000, v171
    v_add_f32 v38, v38, v6
    v_add_f32 v39, v39, v7
    v_cvt_pk_bf16_f32 v171, v38, v39
    v_lshlrev_b32 v38, 16, v171
    v_and_b32 v39, 0xffff0000, v171
    v_add_f32 v4, v4, v38
    v_add_f32 v5, v5, v39
    v_cvt_pk_bf16_f32 v40, v40, v41
    v_and_b32 v41, 0xffff0000, v40
    v_lshlrev_b32 v40, 16, v40
    v_lshlrev_b32 v6, 16, v172
    v_and_b32 v7, 0xffff0000, v172
    v_add_f32 v40, v40, v6
    v_add_f32 v41, v41, v7
    v_cvt_pk_bf16_f32 v172, v40, v41
    v_lshlrev_b32 v40, 16, v172
    v_and_b32 v41, 0xffff0000, v172
    v_add_f32 v4, v4, v40
    v_add_f32 v5, v5, v41
    v_cvt_pk_bf16_f32 v42, v42, v43
    v_and_b32 v43, 0xffff0000, v42
    v_lshlrev_b32 v42, 16, v42
    v_lshlrev_b32 v6, 16, v173
    v_and_b32 v7, 0xffff0000, v173
    v_add_f32 v42, v42, v6
    v_add_f32 v43, v43, v7
    v_cvt_pk_bf16_f32 v173, v42, v43
    v_lshlrev_b32 v42, 16, v173
    v_and_b32 v43, 0xffff0000, v173
    v_add_f32 v4, v4, v42
    v_add_f32 v5, v5, v43
    v_cvt_pk_bf16_f32 v44, v44, v45
    v_and_b32 v45, 0xffff0000, v44
    v_lshlrev_b32 v44, 16, v44
    v_lshlrev_b32 v6, 16, v174
    v_and_b32 v7, 0xffff0000, v174
    v_add_f32 v44, v44, v6
    v_add_f32 v45, v45, v7
    v_cvt_pk_bf16_f32 v174, v44, v45
    v_lshlrev_b32 v44, 16, v174
    v_and_b32 v45, 0xffff0000, v174
    v_add_f32 v4, v4, v44
    v_add_f32 v5, v5, v45
    v_cvt_pk_bf16_f32 v46, v46, v47
    v_and_b32 v47, 0xffff0000, v46
    v_lshlrev_b32 v46, 16, v46
    v_lshlrev_b32 v6, 16, v175
    v_and_b32 v7, 0xffff0000, v175
    v_add_f32 v46, v46, v6
    v_add_f32 v47, v47, v7
    v_cvt_pk_bf16_f32 v175, v46, v47
    v_lshlrev_b32 v46, 16, v175
    v_and_b32 v47, 0xffff0000, v175
    v_add_f32 v4, v4, v46
    v_add_f32 v5, v5, v47
    v_cvt_pk_bf16_f32 v48, v48, v49
    v_and_b32 v49, 0xffff0000, v48
    v_lshlrev_b32 v48, 16, v48
    v_lshlrev_b32 v6, 16, v176
    v_and_b32 v7, 0xffff0000, v176
    v_add_f32 v48, v48, v6
    v_add_f32 v49, v49, v7
    v_cvt_pk_bf16_f32 v176, v48, v49
    v_lshlrev_b32 v48, 16, v176
    v_and_b32 v49, 0xffff0000, v176
    v_add_f32 v4, v4, v48
    v_add_f32 v5, v5, v49
    v_cvt_pk_bf16_f32 v50, v50, v51
    v_and_b32 v51, 0xffff0000, v50
    v_lshlrev_b32 v50, 16, v50
    v_lshlrev_b32 v6, 16, v177
    v_and_b32 v7, 0xffff0000, v177
    v_add_f32 v50, v50, v6
    v_add_f32 v51, v51, v7
    v_cvt_pk_bf16_f32 v177, v50, v51
    v_lshlrev_b32 v50, 16, v177
    v_and_b32 v51, 0xffff0000, v177
    v_add_f32 v4, v4, v50
    v_add_f32 v5, v5, v51
    v_cvt_pk_bf16_f32 v52, v52, v53
    v_and_b32 v53, 0xffff0000, v52
    v_lshlrev_b32 v52, 16, v52
    v_lshlrev_b32 v6, 16, v178
    v_and_b32 v7, 0xffff0000, v178
    v_add_f32 v52, v52, v6
    v_add_f32 v53, v53, v7
    v_cvt_pk_bf16_f32 v178, v52, v53
    v_lshlrev_b32 v52, 16, v178
    v_and_b32 v53, 0xffff0000, v178
    v_add_f32 v4, v4, v52
    v_add_f32 v5, v5, v53
    v_cvt_pk_bf16_f32 v54, v54, v55
    v_and_b32 v55, 0xffff0000, v54
    v_lshlrev_b32 v54, 16, v54
    v_lshlrev_b32 v6, 16, v179
    v_and_b32 v7, 0xffff0000, v179
    v_add_f32 v54, v54, v6
    v_add_f32 v55, v55, v7
    v_cvt_pk_bf16_f32 v179, v54, v55
    v_lshlrev_b32 v54, 16, v179
    v_and_b32 v55, 0xffff0000, v179
    v_add_f32 v4, v4, v54
    v_add_f32 v5, v5, v55
    v_cvt_pk_bf16_f32 v56, v56, v57
    v_and_b32 v57, 0xffff0000, v56
    v_lshlrev_b32 v56, 16, v56
    v_lshlrev_b32 v6, 16, v180
    v_and_b32 v7, 0xffff0000, v180
    v_add_f32 v56, v56, v6
    v_add_f32 v57, v57, v7
    v_cvt_pk_bf16_f32 v180, v56, v57
    v_lshlrev_b32 v56, 16, v180
    v_and_b32 v57, 0xffff0000, v180
    v_add_f32 v4, v4, v56
    v_add_f32 v5, v5, v57
    v_cvt_pk_bf16_f32 v58, v58, v59
    v_and_b32 v59, 0xffff0000, v58
    v_lshlrev_b32 v58, 16, v58
    v_lshlrev_b32 v6, 16, v181
    v_and_b32 v7, 0xffff0000, v181
    v_add_f32 v58, v58, v6
    v_add_f32 v59, v59, v7
    v_cvt_pk_bf16_f32 v181, v58, v59
    v_lshlrev_b32 v58, 16, v181
    v_and_b32 v59, 0xffff0000, v181
    v_add_f32 v4, v4, v58
    v_add_f32 v5, v5, v59
    v_cvt_pk_bf16_f32 v60, v60, v61
    v_and_b32 v61, 0xffff0000, v60
    v_lshlrev_b32 v60, 16, v60
    v_lshlrev_b32 v6, 16, v182
    v_and_b32 v7, 0xffff0000, v182
    v_add_f32 v60, v60, v6
    v_add_f32 v61, v61, v7
    v_cvt_pk_bf16_f32 v182, v60, v61
    v_lshlrev_b32 v60, 16, v182
    v_and_b32 v61, 0xffff0000, v182
    v_add_f32 v4, v4, v60
    v_add_f32 v5, v5, v61
    v_cvt_pk_bf16_f32 v62, v62, v63
    v_and_b32 v63, 0xffff0000, v62
    v_lshlrev_b32 v62, 16, v62
    v_lshlrev_b32 v6, 16, v183
    v_and_b32 v7, 0xffff0000, v183
    v_add_f32 v62, v62, v6
    v_add_f32 v63, v63, v7
    v_cvt_pk_bf16_f32 v183, v62, v63
    v_lshlrev_b32 v62, 16, v183
    v_and_b32 v63, 0xffff0000, v183
    v_add_f32 v4, v4, v62
    v_add_f32 v5, v5, v63
    s_lshl_b32 s26, s23, 11
    s_add_u32 s26, s26, s25
    s_add_u32 s34, s26, 0
    s_lshl_b32 s26, s23, 11
    s_add_u32 s26, s26, s25
    s_add_u32 s35, s26, 8192
    s_lshl_b32 s26, s23, 11
    s_add_u32 s26, s26, s25
    s_add_u32 s36, s26, 16384
    s_add_u32 s36, s36, s29
    buffer_store_dwordx4 v[160:163], v1, s[16:19], s34 offen offset:0 sc1
    buffer_store_dwordx4 v[164:167], v1, s[16:19], s34 offen offset:1024 sc1
    buffer_store_dwordx4 v[168:171], v1, s[16:19], s35 offen offset:0 sc1
    buffer_store_dwordx4 v[172:175], v1, s[16:19], s35 offen offset:1024 sc1
    buffer_store_dwordx4 v[176:179], v1, s[16:19], s36 offen offset:0 sc1
    buffer_store_dwordx4 v[180:183], v1, s[16:19], s36 offen offset:1024 sc1
    v_and_b32 v9, 0xf0, v1
    s_lshl_b32 s26, s23, 2
    v_add_u32 v8, s26, v9
    v_add_f32 v4, v4, v5
    v_mov_b32 v6, v4
    s_nop 1
    v_permlane32_swap_b32 v4, v6
    v_add_f32 v4, v4, v6
    v_mov_b32 v6, v4
    s_nop 1
    v_permlane16_swap_b32 v4, v6
    v_add_f32 v4, v4, v6
    ds_write_b32 v8, v4 offset:0
    s_waitcnt lgkmcnt(0)
    s_barrier
    ds_read_b128 v[12:15], v9 offset:0
    s_waitcnt lgkmcnt(0)
    v_add_f32 v12, v12, v13
    v_add_f32 v14, v14, v15
    v_add_f32 v4, v12, v14
    v_mul_f32 v4, 0x3acccccd, v4
    v_mov_b32 v5, 0
    v_mov_b32 v10, 0
    v_sub_f32 v6, v16, v4
    v_sub_f32 v7, v17, v4
    v_fmac_f32 v5, v6, v6
    v_fmac_f32 v10, v7, v7
    v_sub_f32 v6, v18, v4
    v_sub_f32 v7, v19, v4
    v_fmac_f32 v5, v6, v6
    v_fmac_f32 v10, v7, v7
    v_sub_f32 v6, v20, v4
    v_sub_f32 v7, v21, v4
    v_fmac_f32 v5, v6, v6
    v_fmac_f32 v10, v7, v7
    v_sub_f32 v6, v22, v4
    v_sub_f32 v7, v23, v4
    v_fmac_f32 v5, v6, v6
    v_fmac_f32 v10, v7, v7
    v_sub_f32 v6, v24, v4
    v_sub_f32 v7, v25, v4
    v_fmac_f32 v5, v6, v6
    v_fmac_f32 v10, v7, v7
    v_sub_f32 v6, v26, v4
    v_sub_f32 v7, v27, v4
    v_fmac_f32 v5, v6, v6
    v_fmac_f32 v10, v7, v7
    v_sub_f32 v6, v28, v4
    v_sub_f32 v7, v29, v4
    v_fmac_f32 v5, v6, v6
    v_fmac_f32 v10, v7, v7
    v_sub_f32 v6, v30, v4
    v_sub_f32 v7, v31, v4
    v_fmac_f32 v5, v6, v6
    v_fmac_f32 v10, v7, v7
    v_sub_f32 v6, v32, v4
    v_sub_f32 v7, v33, v4
    v_fmac_f32 v5, v6, v6
    v_fmac_f32 v10, v7, v7
    v_sub_f32 v6, v34, v4
    v_sub_f32 v7, v35, v4
    v_fmac_f32 v5, v6, v6
    v_fmac_f32 v10, v7, v7
    v_sub_f32 v6, v36, v4
    v_sub_f32 v7, v37, v4
    v_fmac_f32 v5, v6, v6
    v_fmac_f32 v10, v7, v7
    v_sub_f32 v6, v38, v4
    v_sub_f32 v7, v39, v4
    v_fmac_f32 v5, v6, v6
    v_fmac_f32 v10, v7, v7
    v_sub_f32 v6, v40, v4
    v_sub_f32 v7, v41, v4
    v_fmac_f32 v5, v6, v6
    v_fmac_f32 v10, v7, v7
    v_sub_f32 v6, v42, v4
    v_sub_f32 v7, v43, v4
    v_fmac_f32 v5, v6, v6
    v_fmac_f32 v10, v7, v7
    v_sub_f32 v6, v44, v4
    v_sub_f32 v7, v45, v4
    v_fmac_f32 v5, v6, v6
    v_fmac_f32 v10, v7, v7
    v_sub_f32 v6, v46, v4
    v_sub_f32 v7, v47, v4
    v_fmac_f32 v5, v6, v6
    v_fmac_f32 v10, v7, v7
    s_cmp_ge_u32 s23, 2
    s_cbranch_scc1 LN_107
    v_sub_f32 v6, v48, v4
    v_sub_f32 v7, v49, v4
    v_fmac_f32 v5, v6, v6
    v_fmac_f32 v10, v7, v7
    v_sub_f32 v6, v50, v4
    v_sub_f32 v7, v51, v4
    v_fmac_f32 v5, v6, v6
    v_fmac_f32 v10, v7, v7
    v_sub_f32 v6, v52, v4
    v_sub_f32 v7, v53, v4
    v_fmac_f32 v5, v6, v6
    v_fmac_f32 v10, v7, v7
    v_sub_f32 v6, v54, v4
    v_sub_f32 v7, v55, v4
    v_fmac_f32 v5, v6, v6
    v_fmac_f32 v10, v7, v7
    v_sub_f32 v6, v56, v4
    v_sub_f32 v7, v57, v4
    v_fmac_f32 v5, v6, v6
    v_fmac_f32 v10, v7, v7
    v_sub_f32 v6, v58, v4
    v_sub_f32 v7, v59, v4
    v_fmac_f32 v5, v6, v6
    v_fmac_f32 v10, v7, v7
    v_sub_f32 v6, v60, v4
    v_sub_f32 v7, v61, v4
    v_fmac_f32 v5, v6, v6
    v_fmac_f32 v10, v7, v7
    v_sub_f32 v6, v62, v4
    v_sub_f32 v7, v63, v4
    v_fmac_f32 v5, v6, v6
    v_fmac_f32 v10, v7, v7
LN_107:
    v_add_f32 v5, v5, v10
    v_mov_b32 v6, v5
    s_nop 1
    v_permlane32_swap_b32 v5, v6
    v_add_f32 v5, v5, v6
    v_mov_b32 v6, v5
    s_nop 1
    v_permlane16_swap_b32 v5, v6
    v_add_f32 v5, v5, v6
    ds_write_b32 v8, v5 offset:256
    s_waitcnt lgkmcnt(0)
    s_barrier
    ds_read_b128 v[12:15], v9 offset:256
    s_waitcnt lgkmcnt(0)
    v_add_f32 v12, v12, v13
    v_add_f32 v14, v14, v15
    v_add_f32 v5, v12, v14
    v_mul_f32 v5, 0x3acccccd, v5
    v_cvt_pk_bf16_f32 v5, v5, v5
    v_and_b32 v5, 0xffff0000, v5
    v_add_f32 v5, 0x3727c5ac, v5
    v_cvt_pk_bf16_f32 v5, v5, v5
    v_and_b32 v5, 0xffff0000, v5
    v_sqrt_f32 v5, v5
    s_nop 0
    v_cvt_pk_bf16_f32 v5, v5, v5
    v_and_b32 v5, 0xffff0000, v5
    v_rcp_f32 v5, v5
    v_cvt_pk_bf16_f32 v4, v4, v4
    v_and_b32 v4, 0xffff0000, v4
    s_add_u32 s34, s34, 4194304
    s_add_u32 s35, s35, 4194304
    s_add_u32 s36, s36, 4194304
    v_sub_f32 v16, v16, v4
    v_sub_f32 v17, v17, v4
    v_cvt_pk_bf16_f32 v64, v16, v17
    v_lshlrev_b32 v16, 16, v64
    v_and_b32 v17, 0xffff0000, v64
    v_mul_f32 v16, v16, v5
    v_mul_f32 v17, v17, v5
    v_cvt_pk_bf16_f32 v64, v16, v17
    v_sub_f32 v18, v18, v4
    v_sub_f32 v19, v19, v4
    v_cvt_pk_bf16_f32 v65, v18, v19
    v_lshlrev_b32 v18, 16, v65
    v_and_b32 v19, 0xffff0000, v65
    v_mul_f32 v18, v18, v5
    v_mul_f32 v19, v19, v5
    v_cvt_pk_bf16_f32 v65, v18, v19
    v_sub_f32 v20, v20, v4
    v_sub_f32 v21, v21, v4
    v_cvt_pk_bf16_f32 v66, v20, v21
    v_lshlrev_b32 v20, 16, v66
    v_and_b32 v21, 0xffff0000, v66
    v_mul_f32 v20, v20, v5
    v_mul_f32 v21, v21, v5
    v_cvt_pk_bf16_f32 v66, v20, v21
    v_sub_f32 v22, v22, v4
    v_sub_f32 v23, v23, v4
    v_cvt_pk_bf16_f32 v67, v22, v23
    v_lshlrev_b32 v22, 16, v67
    v_and_b32 v23, 0xffff0000, v67
    v_mul_f32 v22, v22, v5
    v_mul_f32 v23, v23, v5
    v_cvt_pk_bf16_f32 v67, v22, v23
    buffer_store_dwordx4 v[64:67], v1, s[16:19], s34 offen offset:0 sc1
    v_sub_f32 v24, v24, v4
    v_sub_f32 v25, v25, v4
    v_cvt_pk_bf16_f32 v68, v24, v25
    v_lshlrev_b32 v24, 16, v68
    v_and_b32 v25, 0xffff0000, v68
    v_mul_f32 v24, v24, v5
    v_mul_f32 v25, v25, v5
    v_cvt_pk_bf16_f32 v68, v24, v25
    v_sub_f32 v26, v26, v4
    v_sub_f32 v27, v27, v4
    v_cvt_pk_bf16_f32 v69, v26, v27
    v_lshlrev_b32 v26, 16, v69
    v_and_b32 v27, 0xffff0000, v69
    v_mul_f32 v26, v26, v5
    v_mul_f32 v27, v27, v5
    v_cvt_pk_bf16_f32 v69, v26, v27
    v_sub_f32 v28, v28, v4
    v_sub_f32 v29, v29, v4
    v_cvt_pk_bf16_f32 v70, v28, v29
    v_lshlrev_b32 v28, 16, v70
    v_and_b32 v29, 0xffff0000, v70
    v_mul_f32 v28, v28, v5
    v_mul_f32 v29, v29, v5
    v_cvt_pk_bf16_f32 v70, v28, v29
    v_sub_f32 v30, v30, v4
    v_sub_f32 v31, v31, v4
    v_cvt_pk_bf16_f32 v71, v30, v31
    v_lshlrev_b32 v30, 16, v71
    v_and_b32 v31, 0xffff0000, v71
    v_mul_f32 v30, v30, v5
    v_mul_f32 v31, v31, v5
    v_cvt_pk_bf16_f32 v71, v30, v31
    buffer_store_dwordx4 v[68:71], v1, s[16:19], s34 offen offset:1024 sc1
    v_sub_f32 v32, v32, v4
    v_sub_f32 v33, v33, v4
    v_cvt_pk_bf16_f32 v72, v32, v33
    v_lshlrev_b32 v32, 16, v72
    v_and_b32 v33, 0xffff0000, v72
    v_mul_f32 v32, v32, v5
    v_mul_f32 v33, v33, v5
    v_cvt_pk_bf16_f32 v72, v32, v33
    v_sub_f32 v34, v34, v4
    v_sub_f32 v35, v35, v4
    v_cvt_pk_bf16_f32 v73, v34, v35
    v_lshlrev_b32 v34, 16, v73
    v_and_b32 v35, 0xffff0000, v73
    v_mul_f32 v34, v34, v5
    v_mul_f32 v35, v35, v5
    v_cvt_pk_bf16_f32 v73, v34, v35
    v_sub_f32 v36, v36, v4
    v_sub_f32 v37, v37, v4
    v_cvt_pk_bf16_f32 v74, v36, v37
    v_lshlrev_b32 v36, 16, v74
    v_and_b32 v37, 0xffff0000, v74
    v_mul_f32 v36, v36, v5
    v_mul_f32 v37, v37, v5
    v_cvt_pk_bf16_f32 v74, v36, v37
    v_sub_f32 v38, v38, v4
    v_sub_f32 v39, v39, v4
    v_cvt_pk_bf16_f32 v75, v38, v39
    v_lshlrev_b32 v38, 16, v75
    v_and_b32 v39, 0xffff0000, v75
    v_mul_f32 v38, v38, v5
    v_mul_f32 v39, v39, v5
    v_cvt_pk_bf16_f32 v75, v38, v39
    buffer_store_dwordx4 v[72:75], v1, s[16:19], s35 offen offset:0 sc1
    v_sub_f32 v40, v40, v4
    v_sub_f32 v41, v41, v4
    v_cvt_pk_bf16_f32 v76, v40, v41
    v_lshlrev_b32 v40, 16, v76
    v_and_b32 v41, 0xffff0000, v76
    v_mul_f32 v40, v40, v5
    v_mul_f32 v41, v41, v5
    v_cvt_pk_bf16_f32 v76, v40, v41
    v_sub_f32 v42, v42, v4
    v_sub_f32 v43, v43, v4
    v_cvt_pk_bf16_f32 v77, v42, v43
    v_lshlrev_b32 v42, 16, v77
    v_and_b32 v43, 0xffff0000, v77
    v_mul_f32 v42, v42, v5
    v_mul_f32 v43, v43, v5
    v_cvt_pk_bf16_f32 v77, v42, v43
    v_sub_f32 v44, v44, v4
    v_sub_f32 v45, v45, v4
    v_cvt_pk_bf16_f32 v78, v44, v45
    v_lshlrev_b32 v44, 16, v78
    v_and_b32 v45, 0xffff0000, v78
    v_mul_f32 v44, v44, v5
    v_mul_f32 v45, v45, v5
    v_cvt_pk_bf16_f32 v78, v44, v45
    v_sub_f32 v46, v46, v4
    v_sub_f32 v47, v47, v4
    v_cvt_pk_bf16_f32 v79, v46, v47
    v_lshlrev_b32 v46, 16, v79
    v_and_b32 v47, 0xffff0000, v79
    v_mul_f32 v46, v46, v5
    v_mul_f32 v47, v47, v5
    v_cvt_pk_bf16_f32 v79, v46, v47
    buffer_store_dwordx4 v[76:79], v1, s[16:19], s35 offen offset:1024 sc1
    v_sub_f32 v48, v48, v4
    v_sub_f32 v49, v49, v4
    v_cvt_pk_bf16_f32 v80, v48, v49
    v_lshlrev_b32 v48, 16, v80
    v_and_b32 v49, 0xffff0000, v80
    v_mul_f32 v48, v48, v5
    v_mul_f32 v49, v49, v5
    v_cvt_pk_bf16_f32 v80, v48, v49
    v_sub_f32 v50, v50, v4
    v_sub_f32 v51, v51, v4
    v_cvt_pk_bf16_f32 v81, v50, v51
    v_lshlrev_b32 v50, 16, v81
    v_and_b32 v51, 0xffff0000, v81
    v_mul_f32 v50, v50, v5
    v_mul_f32 v51, v51, v5
    v_cvt_pk_bf16_f32 v81, v50, v51
    v_sub_f32 v52, v52, v4
    v_sub_f32 v53, v53, v4
    v_cvt_pk_bf16_f32 v82, v52, v53
    v_lshlrev_b32 v52, 16, v82
    v_and_b32 v53, 0xffff0000, v82
    v_mul_f32 v52, v52, v5
    v_mul_f32 v53, v53, v5
    v_cvt_pk_bf16_f32 v82, v52, v53
    v_sub_f32 v54, v54, v4
    v_sub_f32 v55, v55, v4
    v_cvt_pk_bf16_f32 v83, v54, v55
    v_lshlrev_b32 v54, 16, v83
    v_and_b32 v55, 0xffff0000, v83
    v_mul_f32 v54, v54, v5
    v_mul_f32 v55, v55, v5
    v_cvt_pk_bf16_f32 v83, v54, v55
    buffer_store_dwordx4 v[80:83], v1, s[16:19], s36 offen offset:0 sc1
    v_sub_f32 v56, v56, v4
    v_sub_f32 v57, v57, v4
    v_cvt_pk_bf16_f32 v84, v56, v57
    v_lshlrev_b32 v56, 16, v84
    v_and_b32 v57, 0xffff0000, v84
    v_mul_f32 v56, v56, v5
    v_mul_f32 v57, v57, v5
    v_cvt_pk_bf16_f32 v84, v56, v57
    v_sub_f32 v58, v58, v4
    v_sub_f32 v59, v59, v4
    v_cvt_pk_bf16_f32 v85, v58, v59
    v_lshlrev_b32 v58, 16, v85
    v_and_b32 v59, 0xffff0000, v85
    v_mul_f32 v58, v58, v5
    v_mul_f32 v59, v59, v5
    v_cvt_pk_bf16_f32 v85, v58, v59
    v_sub_f32 v60, v60, v4
    v_sub_f32 v61, v61, v4
    v_cvt_pk_bf16_f32 v86, v60, v61
    v_lshlrev_b32 v60, 16, v86
    v_and_b32 v61, 0xffff0000, v86
    v_mul_f32 v60, v60, v5
    v_mul_f32 v61, v61, v5
    v_cvt_pk_bf16_f32 v86, v60, v61
    v_sub_f32 v62, v62, v4
    v_sub_f32 v63, v63, v4
    v_cvt_pk_bf16_f32 v87, v62, v63
    v_lshlrev_b32 v62, 16, v87
    v_and_b32 v63, 0xffff0000, v87
    v_mul_f32 v62, v62, v5
    v_mul_f32 v63, v63, v5
    v_cvt_pk_bf16_f32 v87, v62, v63
    buffer_store_dwordx4 v[84:87], v1, s[16:19], s36 offen offset:1024 sc1
    s_waitcnt vmcnt(0) lgkmcnt(0)
    s_barrier
    s_cmp_lg_u32 s23, 0
    s_cbranch_scc1 FS_108
    s_mov_b64 exec, 1
    v_mov_b32 v255, 1
    buffer_atomic_add v255, off, s[48:51], s56 sc1
    s_mov_b64 exec, -1
FS_108:
    s_add_u32 s20, s20, 12
    s_cmp_lt_u32 s20, 128
    s_cbranch_scc1 LL_102
    s_branch RW_13
RW_101:
    s_sub_u32 s2, s2, 12
    s_cmp_ge_u32 s2, 28
    s_cbranch_scc1 RW_109
    s_load_dwordx2 s[4:5], s[0:1], 64
    s_and_b32 s21, s2, 3
    s_and_b32 s24, s2, 0xfc
    s_add_u32 s24, s24, s23
    s_lshl_b32 s20, s24, 7
    s_lshl_b32 s22, s24, 11
    s_cmp_eq_u32 s24, 27
    s_cselect_b32 s22, 0x40000000, s22
    s_waitcnt lgkmcnt(0)
    s_add_u32 s8, s4, 0x0
    s_addc_u32 s9, s5, 0
    s_and_b32 s9, s9, 0xffff
    s_mov_b32 s10, 0x21c000
    s_mov_b32 s11, 0x20000
    s_add_u32 s12, s6, 0x6e00000
    s_addc_u32 s13, s7, 0
    s_and_b32 s13, s13, 0xffff
    s_mov_b32 s14, 0x280000
    s_mov_b32 s15, 0x20000
    s_add_u32 s16, s6, 0x7200000
    s_addc_u32 s17, s7, 0
    s_and_b32 s17, s17, 0xffff
    s_mov_b32 s18, 0x6c0000
    s_mov_b32 s19, 0x20000
    v_and_b32 v1, 63, v0
    v_lshrrev_b32 v3, 4, v1
    v_mul_u32_u24 v2, 55296, v3
    v_and_b32 v3, 15, v1
    v_lshl_add_u32 v2, v3, 3, v2
    v_lshlrev_b32 v1, 4, v1
    s_mul_i32 s28, s23, 10240
    s_mov_b32 s30, 0
    s_mov_b32 s31, s21
    s_mov_b32 s24, 0x05040100
    s_mov_b32 s25, 0x07060302
    s_mov_b32 s26, s20
    buffer_load_dwordx2 v[64:65], v2, s[8:11], s26 offen
    s_add_u32 s26, s26, 0xd80
    buffer_load_dwordx2 v[66:67], v2, s[8:11], s26 offen
    s_add_u32 s26, s26, 0xd80
    buffer_load_dwordx2 v[68:69], v2, s[8:11], s26 offen
    s_add_u32 s26, s26, 0xd80
    buffer_load_dwordx2 v[70:71], v2, s[8:11], s26 offen
    s_add_u32 s26, s26, 0xd80
    buffer_load_dwordx2 v[72:73], v2, s[8:11], s26 offen
    s_add_u32 s26, s26, 0xd80
    buffer_load_dwordx2 v[74:75], v2, s[8:11], s26 offen
    s_add_u32 s26, s26, 0xd80
    buffer_load_dwordx2 v[76:77], v2, s[8:11], s26 offen
    s_add_u32 s26, s26, 0xd80
    buffer_load_dwordx2 v[78:79], v2, s[8:11], s26 offen
    s_add_u32 s26, s26, 0xd80
    buffer_load_dwordx2 v[80:81], v2, s[8:11], s26 offen
    s_add_u32 s26, s26, 0xd80
    buffer_load_dwordx2 v[82:83], v2, s[8:11], s26 offen
    s_add_u32 s26, s26, 0xd80
    buffer_load_dwordx2 v[84:85], v2, s[8:11], s26 offen
    s_add_u32 s26, s26, 0xd80
    buffer_load_dwordx2 v[86:87], v2, s[8:11], s26 offen
    s_add_u32 s26, s26, 0xd80
    buffer_load_dwordx2 v[88:89], v2, s[8:11], s26 offen
    s_add_u32 s26, s26, 0xd80
    buffer_load_dwordx2 v[90:91], v2, s[8:11], s26 offen
    s_add_u32 s26, s26, 0xd80
    buffer_load_dwordx2 v[92:93], v2, s[8:11], s26 offen
    s_add_u32 s26, s26, 0xd80
    buffer_load_dwordx2 v[94:95], v2, s[8:11], s26 offen
    s_add_u32 s26, s26, 0x29580
    buffer_load_dwordx2 v[96:97], v2, s[8:11], s26 offen
    s_add_u32 s26, s26, 0xd80
    buffer_load_dwordx2 v[98:99], v2, s[8:11], s26 offen
    s_add_u32 s26, s26, 0xd80
    buffer_load_dwordx2 v[100:101], v2, s[8:11], s26 offen
    s_add_u32 s26, s26, 0xd80
    buffer_load_dwordx2 v[102:103], v2, s[8:11], s26 offen
    s_add_u32 s26, s26, 0xd80
    buffer_load_dwordx2 v[104:105], v2, s[8:11], s26 offen
    s_add_u32 s26, s26, 0xd80
    buffer_load_dwordx2 v[106:107], v2, s[8:11], s26 offen
    s_add_u32 s26, s26, 0xd80
    buffer_load_dwordx2 v[108:109], v2, s[8:11], s26 offen
    s_add_u32 s26, s26, 0xd80
    buffer_load_dwordx2 v[110:111], v2, s[8:11], s26 offen
    s_add_u32 s26, s26, 0xd80
    buffer_load_dwordx2 v[112:113], v2, s[8:11], s26 offen
    s_add_u32 s26, s26, 0xd80
    buffer_load_dwordx2 v[114:115], v2, s[8:11], s26 offen
    s_add_u32 s26, s26, 0xd80
    buffer_load_dwordx2 v[116:117], v2, s[8:11], s26 offen
    s_add_u32 s26, s26, 0xd80
    buffer_load_dwordx2 v[118:119], v2, s[8:11], s26 offen
    s_add_u32 s26, s26, 0xd80
    buffer_load_dwordx2 v[120:121], v2, s[8:11], s26 offen
    s_add_u32 s26, s26, 0xd80
    buffer_load_dwordx2 v[122:123], v2, s[8:11], s26 offen
    s_add_u32 s26, s26, 0xd80
    buffer_load_dwordx2 v[124:125], v2, s[8:11], s26 offen
    s_add_u32 s26, s26, 0xd80
    buffer_load_dwordx2 v[126:127], v2, s[8:11], s26 offen
    s_add_u32 s26, s26, 0x29580
    buffer_load_dwordx2 v[128:129], v2, s[8:11], s26 offen
    s_add_u32 s26, s26, 0xd80
    buffer_load_dwordx2 v[130:131], v2, s[8:11], s26 offen
    s_add_u32 s26, s26, 0xd80
    buffer_load_dwordx2 v[132:133], v2, s[8:11], s26 offen
    s_add_u32 s26, s26, 0xd80
    buffer_load_dwordx2 v[134:135], v2, s[8:11], s26 offen
    s_add_u32 s26, s26, 0xd80
    buffer_load_dwordx2 v[136:137], v2, s[8:11], s26 offen
    s_add_u32 s26, s26, 0xd80
    buffer_load_dwordx2 v[138:139], v2, s[8:11], s26 offen
    s_add_u32 s26, s26, 0xd80
    buffer_load_dwordx2 v[140:141], v2, s[8:11], s26 offen
    s_add_u32 s26, s26, 0xd80
    buffer_load_dwordx2 v[142:143], v2, s[8:11], s26 offen
    s_add_u32 s26, s26, 0xd80
    buffer_load_dwordx2 v[144:145], v2, s[8:11], s26 offen
    s_add_u32 s26, s26, 0xd80
    buffer_load_dwordx2 v[146:147], v2, s[8:11], s26 offen
    s_add_u32 s26, s26, 0xd80
    buffer_load_dwordx2 v[148:149], v2, s[8:11], s26 offen
    s_add_u32 s26, s26, 0xd80
    buffer_load_dwordx2 v[150:151], v2, s[8:11], s26 offen
    s_add_u32 s26, s26, 0xd80
    buffer_load_dwordx2 v[152:153], v2, s[8:11], s26 offen
    s_add_u32 s26, s26, 0xd80
    buffer_load_dwordx2 v[154:155], v2, s[8:11], s26 offen
    s_add_u32 s26, s26, 0xd80
    buffer_load_dwordx2 v[156:157], v2, s[8:11], s26 offen
    s_add_u32 s26, s26, 0xd80
    buffer_load_dwordx2 v[158:159], v2, s[8:11], s26 offen
    s_add_u32 s26, s26, 0x29580
    buffer_load_dwordx2 v[160:161], v2, s[8:11], s26 offen
    s_add_u32 s26, s26, 0xd80
    buffer_load_dwordx2 v[162:163], v2, s[8:11], s26 offen
    s_add_u32 s26, s26, 0xd80
    buffer_load_dwordx2 v[164:165], v2, s[8:11], s26 offen
    s_add_u32 s26, s26, 0xd80
    buffer_load_dwordx2 v[166:167], v2, s[8:11], s26 offen
    s_add_u32 s26, s26, 0xd80
    buffer_load_dwordx2 v[168:169], v2, s[8:11], s26 offen
    s_add_u32 s26, s26, 0xd80
    buffer_load_dwordx2 v[170:171], v2, s[8:11], s26 offen
    s_add_u32 s26, s26, 0xd80
    buffer_load_dwordx2 v[172:173], v2, s[8:11], s26 offen
    s_add_u32 s26, s26, 0xd80
    buffer_load_dwordx2 v[174:175], v2, s[8:11], s26 offen
    s_add_u32 s26, s26, 0xd80
    buffer_load_dwordx2 v[176:177], v2, s[8:11], s26 offen
    s_add_u32 s26, s26, 0xd80
    buffer_load_dwordx2 v[178:179], v2, s[8:11], s26 offen
    s_add_u32 s26, s26, 0xd80
    buffer_load_dwordx2 v[180:181], v2, s[8:11], s26 offen
    s_add_u32 s26, s26, 0xd80
    buffer_load_dwordx2 v[182:183], v2, s[8:11], s26 offen
    s_add_u32 s26, s26, 0xd80
    buffer_load_dwordx2 v[184:185], v2, s[8:11], s26 offen
    s_add_u32 s26, s26, 0xd80
    buffer_load_dwordx2 v[186:187], v2, s[8:11], s26 offen
    s_add_u32 s26, s26, 0xd80
    buffer_load_dwordx2 v[188:189], v2, s[8:11], s26 offen
    s_add_u32 s26, s26, 0xd80
    buffer_load_dwordx2 v[190:191], v2, s[8:11], s26 offen
    s_add_u32 s26, s26, 0x29580
    s_waitcnt vmcnt(56)
    v_perm_b32 v4, v66, v64, s24
    v_accvgpr_write_b32 a0, v4
    v_perm_b32 v5, v70, v68, s24
    v_accvgpr_write_b32 a1, v5
    v_perm_b32 v4, v74, v72, s24
    v_accvgpr_write_b32 a2, v4
    v_perm_b32 v5, v78, v76, s24
    v_accvgpr_write_b32 a3, v5
    v_perm_b32 v4, v66, v64, s25
    v_accvgpr_write_b32 a4, v4
    v_perm_b32 v5, v70, v68, s25
    v_accvgpr_write_b32 a5, v5
    v_perm_b32 v4, v74, v72, s25
    v_accvgpr_write_b32 a6, v4
    v_perm_b32 v5, v78, v76, s25
    v_accvgpr_write_b32 a7, v5
    v_perm_b32 v4, v67, v65, s24
    v_accvgpr_write_b32 a8, v4
    v_perm_b32 v5, v71, v69, s24
    v_accvgpr_write_b32 a9, v5
    v_perm_b32 v4, v75, v73, s24
    v_accvgpr_write_b32 a10, v4
    v_perm_b32 v5, v79, v77, s24
    v_accvgpr_write_b32 a11, v5
    v_perm_b32 v4, v67, v65, s25
    v_accvgpr_write_b32 a12, v4
    v_perm_b32 v5, v71, v69, s25
    v_accvgpr_write_b32 a13, v5
    v_perm_b32 v4, v75, v73, s25
    v_accvgpr_write_b32 a14, v4
    v_perm_b32 v5, v79, v77, s25
    v_accvgpr_write_b32 a15, v5
    buffer_load_dwordx2 v[64:65], v2, s[8:11], s26 offen
    s_add_u32 s26, s26, 0xd80
    buffer_load_dwordx2 v[66:67], v2, s[8:11], s26 offen
    s_add_u32 s26, s26, 0xd80
    buffer_load_dwordx2 v[68:69], v2, s[8:11], s26 offen
    s_add_u32 s26, s26, 0xd80
    buffer_load_dwordx2 v[70:71], v2, s[8:11], s26 offen
    s_add_u32 s26, s26, 0xd80
    buffer_load_dwordx2 v[72:73], v2, s[8:11], s26 offen
    s_add_u32 s26, s26, 0xd80
    buffer_load_dwordx2 v[74:75], v2, s[8:11], s26 offen
    s_add_u32 s26, s26, 0xd80
    buffer_load_dwordx2 v[76:77], v2, s[8:11], s26 offen
    s_add_u32 s26, s26, 0xd80
    buffer_load_dwordx2 v[78:79], v2, s[8:11], s26 offen
    s_add_u32 s26, s26, 0xd80
    s_waitcnt vmcnt(56)
    v_perm_b32 v4, v82, v80, s24
    v_accvgpr_write_b32 a16, v4
    v_perm_b32 v5, v86, v84, s24
    v_accvgpr_write_b32 a17, v5
    v_perm_b32 v4, v90, v88, s24
    v_accvgpr_write_b32 a18, v4
    v_perm_b32 v5, v94, v92, s24
    v_accvgpr_write_b32 a19, v5
    v_perm_b32 v4, v82, v80, s25
    v_accvgpr_write_b32 a20, v4
    v_perm_b32 v5, v86, v84, s25
    v_accvgpr_write_b32 a21, v5
    v_perm_b32 v4, v90, v88, s25
    v_accvgpr_write_b32 a22, v4
    v_perm_b32 v5, v94, v92, s25
    v_accvgpr_write_b32 a23, v5
    v_perm_b32 v4, v83, v81, s24
    v_accvgpr_write_b32 a24, v4
    v_perm_b32 v5, v87, v85, s24
    v_accvgpr_write_b32 a25, v5
    v_perm_b32 v4, v91, v89, s24
    v_accvgpr_write_b32 a26, v4
    v_perm_b32 v5, v95, v93, s24
    v_accvgpr_write_b32 a27, v5
    v_perm_b32 v4, v83, v81, s25
    v_accvgpr_write_b32 a28, v4
    v_perm_b32 v5, v87, v85, s25
    v_accvgpr_write_b32 a29, v5
    v_perm_b32 v4, v91, v89, s25
    v_accvgpr_write_b32 a30, v4
    v_perm_b32 v5, v95, v93, s25
    v_accvgpr_write_b32 a31, v5
    buffer_load_dwordx2 v[80:81], v2, s[8:11], s26 offen
    s_add_u32 s26, s26, 0xd80
    buffer_load_dwordx2 v[82:83], v2, s[8:11], s26 offen
    s_add_u32 s26, s26, 0xd80
    buffer_load_dwordx2 v[84:85], v2, s[8:11], s26 offen
    s_add_u32 s26, s26, 0xd80
    buffer_load_dwordx2 v[86:87], v2, s[8:11], s26 offen
    s_add_u32 s26, s26, 0xd80
    buffer_load_dwordx2 v[88:89], v2, s[8:11], s26 offen
    s_add_u32 s26, s26, 0xd80
    buffer_load_dwordx2 v[90:91], v2, s[8:11], s26 offen
    s_add_u32 s26, s26, 0xd80
    buffer_load_dwordx2 v[92:93], v2, s[8:11], s26 offen
    s_add_u32 s26, s26, 0xd80
    buffer_load_dwordx2 v[94:95], v2, s[8:11], s26 offen
    s_add_u32 s26, s26, 0x29580
    s_waitcnt vmcnt(56)
    v_perm_b32 v4, v98, v96, s24
    v_accvgpr_write_b32 a32, v4
    v_perm_b32 v5, v102, v100, s24
    v_accvgpr_write_b32 a33, v5
    v_perm_b32 v4, v106, v104, s24
    v_accvgpr_write_b32 a34, v4
    v_perm_b32 v5, v110, v108, s24
    v_accvgpr_write_b32 a35, v5
    v_perm_b32 v4, v98, v96, s25
    v_accvgpr_write_b32 a36, v4
    v_perm_b32 v5, v102, v100, s25
    v_accvgpr_write_b32 a37, v5
    v_perm_b32 v4, v106, v104, s25
    v_accvgpr_write_b32 a38, v4
    v_perm_b32 v5, v110, v108, s25
    v_accvgpr_write_b32 a39, v5
    v_perm_b32 v4, v99, v97, s24
    v_accvgpr_write_b32 a40, v4
    v_perm_b32 v5, v103, v101, s24
    v_accvgpr_write_b32 a41, v5
    v_perm_b32 v4, v107, v105, s24
    v_accvgpr_write_b32 a42, v4
    v_perm_b32 v5, v111, v109, s24
    v_accvgpr_write_b32 a43, v5
    v_perm_b32 v4, v99, v97, s25
    v_accvgpr_write_b32 a44, v4
    v_perm_b32 v5, v103, v101, s25
    v_accvgpr_write_b32 a45, v5
    v_perm_b32 v4, v107, v105, s25
    v_accvgpr_write_b32 a46, v4
    v_perm_b32 v5, v111, v109, s25
    v_accvgpr_write_b32 a47, v5
    buffer_load_dwordx2 v[96:97], v2, s[8:11], s26 offen
    s_add_u32 s26, s26, 0xd80
    buffer_load_dwordx2 v[98:99], v2, s[8:11], s26 offen
    s_add_u32 s26, s26, 0xd80
    buffer_load_dwordx2 v[100:101], v2, s[8:11], s26 offen
    s_add_u32 s26, s26, 0xd80
    buffer_load_dwordx2 v[102:103], v2, s[8:11], s26 offen
    s_add_u32 s26, s26, 0xd80
    buffer_load_dwordx2 v[104:105], v2, s[8:11], s26 offen
    s_add_u32 s26, s26, 0xd80
    buffer_load_dwordx2 v[106:107], v2, s[8:11], s26 offen
    s_add_u32 s26, s26, 0xd80
    buffer_load_dwordx2 v[108:109], v2, s[8:11], s26 offen
    s_add_u32 s26, s26, 0xd80
    buffer_load_dwordx2 v[110:111], v2, s[8:11], s26 offen
    s_add_u32 s26, s26, 0xd80
    s_waitcnt vmcnt(56)
    v_perm_b32 v4, v114, v112, s24
    v_accvgpr_write_b32 a48, v4
    v_perm_b32 v5, v118, v116, s24
    v_accvgpr_write_b32 a49, v5
    v_perm_b32 v4, v122, v120, s24
    v_accvgpr_write_b32 a50, v4
    v_perm_b32 v5, v126, v124, s24
    v_accvgpr_write_b32 a51, v5
    v_perm_b32 v4, v114, v112, s25
    v_accvgpr_write_b32 a52, v4
    v_perm_b32 v5, v118, v116, s25
    v_accvgpr_write_b32 a53, v5
    v_perm_b32 v4, v122, v120, s25
    v_accvgpr_write_b32 a54, v4
    v_perm_b32 v5, v126, v124, s25
    v_accvgpr_write_b32 a55, v5
    v_perm_b32 v4, v115, v113, s24
    v_accvgpr_write_b32 a56, v4
    v_perm_b32 v5, v119, v117, s24
    v_accvgpr_write_b32 a57, v5
    v_perm_b32 v4, v123, v121, s24
    v_accvgpr_write_b32 a58, v4
    v_perm_b32 v5, v127, v125, s24
    v_accvgpr_write_b32 a59, v5
    v_perm_b32 v4, v115, v113, s25
    v_accvgpr_write_b32 a60, v4
    v_perm_b32 v5, v119, v117, s25
    v_accvgpr_write_b32 a61, v5
    v_perm_b32 v4, v123, v121, s25
    v_accvgpr_write_b32 a62, v4
    v_perm_b32 v5, v127, v125, s25
    v_accvgpr_write_b32 a63, v5
    buffer_load_dwordx2 v[112:113], v2, s[8:11], s26 offen
    s_add_u32 s26, s26, 0xd80
    buffer_load_dwordx2 v[114:115], v2, s[8:11], s26 offen
    s_add_u32 s26, s26, 0xd80
    buffer_load_dwordx2 v[116:117], v2, s[8:11], s26 offen
    s_add_u32 s26, s26, 0xd80
    buffer_load_dwordx2 v[118:119], v2, s[8:11], s26 offen
    s_add_u32 s26, s26, 0xd80
    buffer_load_dwordx2 v[120:121], v2, s[8:11], s26 offen
    s_add_u32 s26, s26, 0xd80
    buffer_load_dwordx2 v[122:123], v2, s[8:11], s26 offen
    s_add_u32 s26, s26, 0xd80
    buffer_load_dwordx2 v[124:125], v2, s[8:11], s26 offen
    s_add_u32 s26, s26, 0xd80
    buffer_load_dwordx2 v[126:127], v2, s[8:11], s26 offen
    s_add_u32 s26, s26, 0x29580
    s_waitcnt vmcnt(56)
    v_perm_b32 v4, v130, v128, s24
    v_accvgpr_write_b32 a64, v4
    v_perm_b32 v5, v134, v132, s24
    v_accvgpr_write_b32 a65, v5
    v_perm_b32 v4, v138, v136, s24
    v_accvgpr_write_b32 a66, v4
    v_perm_b32 v5, v142, v140, s24
    v_accvgpr_write_b32 a67, v5
    v_perm_b32 v4, v130, v128, s25
    v_accvgpr_write_b32 a68, v4
    v_perm_b32 v5, v134, v132, s25
    v_accvgpr_write_b32 a69, v5
    v_perm_b32 v4, v138, v136, s25
    v_accvgpr_write_b32 a70, v4
    v_perm_b32 v5, v142, v140, s25
    v_accvgpr_write_b32 a71, v5
    v_perm_b32 v4, v131, v129, s24
    v_accvgpr_write_b32 a72, v4
    v_perm_b32 v5, v135, v133, s24
    v_accvgpr_write_b32 a73, v5
    v_perm_b32 v4, v139, v137, s24
    v_accvgpr_write_b32 a74, v4
    v_perm_b32 v5, v143, v141, s24
    v_accvgpr_write_b32 a75, v5
    v_perm_b32 v4, v131, v129, s25
    v_accvgpr_write_b32 a76, v4
    v_perm_b32 v5, v135, v133, s25
    v_accvgpr_write_b32 a77, v5
    v_perm_b32 v4, v139, v137, s25
    v_accvgpr_write_b32 a78, v4
    v_perm_b32 v5, v143, v141, s25
    v_accvgpr_write_b32 a79, v5
    buffer_load_dwordx2 v[128:129], v2, s[8:11], s26 offen
    s_add_u32 s26, s26, 0xd80
    buffer_load_dwordx2 v[130:131], v2, s[8:11], s26 offen
    s_add_u32 s26, s26, 0xd80
    buffer_load_dwordx2 v[132:133], v2, s[8:11], s26 offen
    s_add_u32 s26, s26, 0xd80
    buffer_load_dwordx2 v[134:135], v2, s[8:11], s26 offen
    s_add_u32 s26, s26, 0xd80
    buffer_load_dwordx2 v[136:137], v2, s[8:11], s26 offen
    s_add_u32 s26, s26, 0xd80
    buffer_load_dwordx2 v[138:139], v2, s[8:11], s26 offen
    s_add_u32 s26, s26, 0xd80
    buffer_load_dwordx2 v[140:141], v2, s[8:11], s26 offen
    s_add_u32 s26, s26, 0xd80
    buffer_load_dwordx2 v[142:143], v2, s[8:11], s26 offen
    s_add_u32 s26, s26, 0xd80
    s_waitcnt vmcnt(56)
    v_perm_b32 v4, v146, v144, s24
    v_accvgpr_write_b32 a80, v4
    v_perm_b32 v5, v150, v148, s24
    v_accvgpr_write_b32 a81, v5
    v_perm_b32 v4, v154, v152, s24
    v_accvgpr_write_b32 a82, v4
    v_perm_b32 v5, v158, v156, s24
    v_accvgpr_write_b32 a83, v5
    v_perm_b32 v4, v146, v144, s25
    v_accvgpr_write_b32 a84, v4
    v_perm_b32 v5, v150, v148, s25
    v_accvgpr_write_b32 a85, v5
    v_perm_b32 v4, v154, v152, s25
    v_accvgpr_write_b32 a86, v4
    v_perm_b32 v5, v158, v156, s25
    v_accvgpr_write_b32 a87, v5
    v_perm_b32 v4, v147, v145, s24
    v_accvgpr_write_b32 a88, v4
    v_perm_b32 v5, v151, v149, s24
    v_accvgpr_write_b32 a89, v5
    v_perm_b32 v4, v155, v153, s24
    v_accvgpr_write_b32 a90, v4
    v_perm_b32 v5, v159, v157, s24
    v_accvgpr_write_b32 a91, v5
    v_perm_b32 v4, v147, v145, s25
    v_accvgpr_write_b32 a92, v4
    v_perm_b32 v5, v151, v149, s25
    v_accvgpr_write_b32 a93, v5
    v_perm_b32 v4, v155, v153, s25
    v_accvgpr_write_b32 a94, v4
    v_perm_b32 v5, v159, v157, s25
    v_accvgpr_write_b32 a95, v5
    buffer_load_dwordx2 v[144:145], v2, s[8:11], s26 offen
    s_add_u32 s26, s26, 0xd80
    buffer_load_dwordx2 v[146:147], v2, s[8:11], s26 offen
    s_add_u32 s26, s26, 0xd80
    buffer_load_dwordx2 v[148:149], v2, s[8:11], s26 offen
    s_add_u32 s26, s26, 0xd80
    buffer_load_dwordx2 v[150:151], v2, s[8:11], s26 offen
    s_add_u32 s26, s26, 0xd80
    buffer_load_dwordx2 v[152:153], v2, s[8:11], s26 offen
    s_add_u32 s26, s26, 0xd80
    buffer_load_dwordx2 v[154:155], v2, s[8:11], s26 offen
    s_add_u32 s26, s26, 0xd80
    buffer_load_dwordx2 v[156:157], v2, s[8:11], s26 offen
    s_add_u32 s26, s26, 0xd80
    buffer_load_dwordx2 v[158:159], v2, s[8:11], s26 offen
    s_add_u32 s26, s26, 0x29580
    s_waitcnt vmcnt(56)
    v_perm_b32 v4, v162, v160, s24
    v_accvgpr_write_b32 a96, v4
    v_perm_b32 v5, v166, v164, s24
    v_accvgpr_write_b32 a97, v5
    v_perm_b32 v4, v170, v168, s24
    v_accvgpr_write_b32 a98, v4
    v_perm_b32 v5, v174, v172, s24
    v_accvgpr_write_b32 a99, v5
    v_perm_b32 v4, v162, v160, s25
    v_accvgpr_write_b32 a100, v4
    v_perm_b32 v5, v166, v164, s25
    v_accvgpr_write_b32 a101, v5
    v_perm_b32 v4, v170, v168, s25
    v_accvgpr_write_b32 a102, v4
    v_perm_b32 v5, v174, v172, s25
    v_accvgpr_write_b32 a103, v5
    v_perm_b32 v4, v163, v161, s24
    v_accvgpr_write_b32 a104, v4
    v_perm_b32 v5, v167, v165, s24
    v_accvgpr_write_b32 a105, v5
    v_perm_b32 v4, v171, v169, s24
    v_accvgpr_write_b32 a106, v4
    v_perm_b32 v5, v175, v173, s24
    v_accvgpr_write_b32 a107, v5
    v_perm_b32 v4, v163, v161, s25
    v_accvgpr_write_b32 a108, v4
    v_perm_b32 v5, v167, v165, s25
    v_accvgpr_write_b32 a109, v5
    v_perm_b32 v4, v171, v169, s25
    v_accvgpr_write_b32 a110, v4
    v_perm_b32 v5, v175, v173, s25
    v_accvgpr_write_b32 a111, v5
    buffer_load_dwordx2 v[160:161], v2, s[8:11], s26 offen
    s_add_u32 s26, s26, 0xd80
    buffer_load_dwordx2 v[162:163], v2, s[8:11], s26 offen
    s_add_u32 s26, s26, 0xd80
    buffer_load_dwordx2 v[164:165], v2, s[8:11], s26 offen
    s_add_u32 s26, s26, 0xd80
    buffer_load_dwordx2 v[166:167], v2, s[8:11], s26 offen
    s_add_u32 s26, s26, 0xd80
    buffer_load_dwordx2 v[168:169], v2, s[8:11], s26 offen
    s_add_u32 s26, s26, 0xd80
    buffer_load_dwordx2 v[170:171], v2, s[8:11], s26 offen
    s_add_u32 s26, s26, 0xd80
    buffer_load_dwordx2 v[172:173], v2, s[8:11], s26 offen
    s_add_u32 s26, s26, 0xd80
    buffer_load_dwordx2 v[174:175], v2, s[8:11], s26 offen
    s_add_u32 s26, s26, 0xd80
    s_waitcnt vmcnt(56)
    v_perm_b32 v4, v178, v176, s24
    v_accvgpr_write_b32 a112, v4
    v_perm_b32 v5, v182, v180, s24
    v_accvgpr_write_b32 a113, v5
    v_perm_b32 v4, v186, v184, s24
    v_accvgpr_write_b32 a114, v4
    v_perm_b32 v5, v190, v188, s24
    v_accvgpr_write_b32 a115, v5
    v_perm_b32 v4, v178, v176, s25
    v_accvgpr_write_b32 a116, v4
    v_perm_b32 v5, v182, v180, s25
    v_accvgpr_write_b32 a117, v5
    v_perm_b32 v4, v186, v184, s25
    v_accvgpr_write_b32 a118, v4
    v_perm_b32 v5, v190, v188, s25
    v_accvgpr_write_b32 a119, v5
    v_perm_b32 v4, v179, v177, s24
    v_accvgpr_write_b32 a120, v4
    v_perm_b32 v5, v183, v181, s24
    v_accvgpr_write_b32 a121, v5
    v_perm_b32 v4, v187, v185, s24
    v_accvgpr_write_b32 a122, v4
    v_perm_b32 v5, v191, v189, s24
    v_accvgpr_write_b32 a123, v5
    v_perm_b32 v4, v179, v177, s25
    v_accvgpr_write_b32 a124, v4
    v_perm_b32 v5, v183, v181, s25
    v_accvgpr_write_b32 a125, v5
    v_perm_b32 v4, v187, v185, s25
    v_accvgpr_write_b32 a126, v4
    v_perm_b32 v5, v191, v189, s25
    v_accvgpr_write_b32 a127, v5
    buffer_load_dwordx2 v[176:177], v2, s[8:11], s26 offen
    s_add_u32 s26, s26, 0xd80
    buffer_load_dwordx2 v[178:179], v2, s[8:11], s26 offen
    s_add_u32 s26, s26, 0xd80
    buffer_load_dwordx2 v[180:181], v2, s[8:11], s26 offen
    s_add_u32 s26, s26, 0xd80
    buffer_load_dwordx2 v[182:183], v2, s[8:11], s26 offen
    s_add_u32 s26, s26, 0xd80
    buffer_load_dwordx2 v[184:185], v2, s[8:11], s26 offen
    s_add_u32 s26, s26, 0xd80
    buffer_load_dwordx2 v[186:187], v2, s[8:11], s26 offen
    s_add_u32 s26, s26, 0xd80
    buffer_load_dwordx2 v[188:189], v2, s[8:11], s26 offen
    s_add_u32 s26, s26, 0xd80
    buffer_load_dwordx2 v[190:191], v2, s[8:11], s26 offen
    s_add_u32 s26, s26, 0x29580
    s_waitcnt vmcnt(56)
    v_perm_b32 v4, v66, v64, s24
    v_accvgpr_write_b32 a128, v4
    v_perm_b32 v5, v70, v68, s24
    v_accvgpr_write_b32 a129, v5
    v_perm_b32 v4, v74, v72, s24
    v_accvgpr_write_b32 a130, v4
    v_perm_b32 v5, v78, v76, s24
    v_accvgpr_write_b32 a131, v5
    v_perm_b32 v4, v66, v64, s25
    v_accvgpr_write_b32 a132, v4
    v_perm_b32 v5, v70, v68, s25
    v_accvgpr_write_b32 a133, v5
    v_perm_b32 v4, v74, v72, s25
    v_accvgpr_write_b32 a134, v4
    v_perm_b32 v5, v78, v76, s25
    v_accvgpr_write_b32 a135, v5
    v_perm_b32 v4, v67, v65, s24
    v_accvgpr_write_b32 a136, v4
    v_perm_b32 v5, v71, v69, s24
    v_accvgpr_write_b32 a137, v5
    v_perm_b32 v4, v75, v73, s24
    v_accvgpr_write_b32 a138, v4
    v_perm_b32 v5, v79, v77, s24
    v_accvgpr_write_b32 a139, v5
    v_perm_b32 v4, v67, v65, s25
    v_accvgpr_write_b32 a140, v4
    v_perm_b32 v5, v71, v69, s25
    v_accvgpr_write_b32 a141, v5
    v_perm_b32 v4, v75, v73, s25
    v_accvgpr_write_b32 a142, v4
    v_perm_b32 v5, v79, v77, s25
    v_accvgpr_write_b32 a143, v5
    buffer_load_dwordx2 v[64:65], v2, s[8:11], s26 offen
    s_add_u32 s26, s26, 0xd80
    buffer_load_dwordx2 v[66:67], v2, s[8:11], s26 offen
    s_add_u32 s26, s26, 0xd80
    buffer_load_dwordx2 v[68:69], v2, s[8:11], s26 offen
    s_add_u32 s26, s26, 0xd80
    buffer_load_dwordx2 v[70:71], v2, s[8:11], s26 offen
    s_add_u32 s26, s26, 0xd80
    buffer_load_dwordx2 v[72:73], v2, s[8:11], s26 offen
    s_add_u32 s26, s26, 0xd80
    buffer_load_dwordx2 v[74:75], v2, s[8:11], s26 offen
    s_add_u32 s26, s26, 0xd80
    buffer_load_dwordx2 v[76:77], v2, s[8:11], s26 offen
    s_add_u32 s26, s26, 0xd80
    buffer_load_dwordx2 v[78:79], v2, s[8:11], s26 offen
    s_add_u32 s26, s26, 0xd80
    s_waitcnt vmcnt(56)
    v_perm_b32 v4, v82, v80, s24
    v_accvgpr_write_b32 a144, v4
    v_perm_b32 v5, v86, v84, s24
    v_accvgpr_write_b32 a145, v5
    v_perm_b32 v4, v90, v88, s24
    v_accvgpr_write_b32 a146, v4
    v_perm_b32 v5, v94, v92, s24
    v_accvgpr_write_b32 a147, v5
    v_perm_b32 v4, v82, v80, s25
    v_accvgpr_write_b32 a148, v4
    v_perm_b32 v5, v86, v84, s25
    v_accvgpr_write_b32 a149, v5
    v_perm_b32 v4, v90, v88, s25
    v_accvgpr_write_b32 a150, v4
    v_perm_b32 v5, v94, v92, s25
    v_accvgpr_write_b32 a151, v5
    v_perm_b32 v4, v83, v81, s24
    v_accvgpr_write_b32 a152, v4
    v_perm_b32 v5, v87, v85, s24
    v_accvgpr_write_b32 a153, v5
    v_perm_b32 v4, v91, v89, s24
    v_accvgpr_write_b32 a154, v4
    v_perm_b32 v5, v95, v93, s24
    v_accvgpr_write_b32 a155, v5
    v_perm_b32 v4, v83, v81, s25
    v_accvgpr_write_b32 a156, v4
    v_perm_b32 v5, v87, v85, s25
    v_accvgpr_write_b32 a157, v5
    v_perm_b32 v4, v91, v89, s25
    v_accvgpr_write_b32 a158, v4
    v_perm_b32 v5, v95, v93, s25
    v_accvgpr_write_b32 a159, v5
    buffer_load_dwordx2 v[80:81], v2, s[8:11], s26 offen
    s_add_u32 s26, s26, 0xd80
    buffer_load_dwordx2 v[82:83], v2, s[8:11], s26 offen
    s_add_u32 s26, s26, 0xd80
    buffer_load_dwordx2 v[84:85], v2, s[8:11], s26 offen
    s_add_u32 s26, s26, 0xd80
    buffer_load_dwordx2 v[86:87], v2, s[8:11], s26 offen
    s_add_u32 s26, s26, 0xd80
    buffer_load_dwordx2 v[88:89], v2, s[8:11], s26 offen
    s_add_u32 s26, s26, 0xd80
    buffer_load_dwordx2 v[90:91], v2, s[8:11], s26 offen
    s_add_u32 s26, s26, 0xd80
    buffer_load_dwordx2 v[92:93], v2, s[8:11], s26 offen
    s_add_u32 s26, s26, 0xd80
    buffer_load_dwordx2 v[94:95], v2, s[8:11], s26 offen
    s_add_u32 s26, s26, 0x29580
    s_waitcnt vmcnt(56)
    v_perm_b32 v4, v98, v96, s24
    v_accvgpr_write_b32 a160, v4
    v_perm_b32 v5, v102, v100, s24
    v_accvgpr_write_b32 a161, v5
    v_perm_b32 v4, v106, v104, s24
    v_accvgpr_write_b32 a162, v4
    v_perm_b32 v5, v110, v108, s24
    v_accvgpr_write_b32 a163, v5
    v_perm_b32 v4, v98, v96, s25
    v_accvgpr_write_b32 a164, v4
    v_perm_b32 v5, v102, v100, s25
    v_accvgpr_write_b32 a165, v5
    v_perm_b32 v4, v106, v104, s25
    v_accvgpr_write_b32 a166, v4
    v_perm_b32 v5, v110, v108, s25
    v_accvgpr_write_b32 a167, v5
    v_perm_b32 v4, v99, v97, s24
    v_accvgpr_write_b32 a168, v4
    v_perm_b32 v5, v103, v101, s24
    v_accvgpr_write_b32 a169, v5
    v_perm_b32 v4, v107, v105, s24
    v_accvgpr_write_b32 a170, v4
    v_perm_b32 v5, v111, v109, s24
    v_accvgpr_write_b32 a171, v5
    v_perm_b32 v4, v99, v97, s25
    v_accvgpr_write_b32 a172, v4
    v_perm_b32 v5, v103, v101, s25
    v_accvgpr_write_b32 a173, v5
    v_perm_b32 v4, v107, v105, s25
    v_accvgpr_write_b32 a174, v4
    v_perm_b32 v5, v111, v109, s25
    v_accvgpr_write_b32 a175, v5
    buffer_load_dwordx2 v[96:97], v2, s[8:11], s26 offen
    s_add_u32 s26, s26, 0xd80
    buffer_load_dwordx2 v[98:99], v2, s[8:11], s26 offen
    s_add_u32 s26, s26, 0xd80
    buffer_load_dwordx2 v[100:101], v2, s[8:11], s26 offen
    s_add_u32 s26, s26, 0xd80
    buffer_load_dwordx2 v[102:103], v2, s[8:11], s26 offen
    s_add_u32 s26, s26, 0xd80
    buffer_load_dwordx2 v[104:105], v2, s[8:11], s26 offen
    s_add_u32 s26, s26, 0xd80
    buffer_load_dwordx2 v[106:107], v2, s[8:11], s26 offen
    s_add_u32 s26, s26, 0xd80
    buffer_load_dwordx2 v[108:109], v2, s[8:11], s26 offen
    s_add_u32 s26, s26, 0xd80
    buffer_load_dwordx2 v[110:111], v2, s[8:11], s26 offen
    s_add_u32 s26, s26, 0xd80
    s_waitcnt vmcnt(56)
    v_perm_b32 v4, v114, v112, s24
    v_accvgpr_write_b32 a176, v4
    v_perm_b32 v5, v118, v116, s24
    v_accvgpr_write_b32 a177, v5
    v_perm_b32 v4, v122, v120, s24
    v_accvgpr_write_b32 a178, v4
    v_perm_b32 v5, v126, v124, s24
    v_accvgpr_write_b32 a179, v5
    v_perm_b32 v4, v114, v112, s25
    v_accvgpr_write_b32 a180, v4
    v_perm_b32 v5, v118, v116, s25
    v_accvgpr_write_b32 a181, v5
    v_perm_b32 v4, v122, v120, s25
    v_accvgpr_write_b32 a182, v4
    v_perm_b32 v5, v126, v124, s25
    v_accvgpr_write_b32 a183, v5
    v_perm_b32 v4, v115, v113, s24
    v_accvgpr_write_b32 a184, v4
    v_perm_b32 v5, v119, v117, s24
    v_accvgpr_write_b32 a185, v5
    v_perm_b32 v4, v123, v121, s24
    v_accvgpr_write_b32 a186, v4
    v_perm_b32 v5, v127, v125, s24
    v_accvgpr_write_b32 a187, v5
    v_perm_b32 v4, v115, v113, s25
    v_accvgpr_write_b32 a188, v4
    v_perm_b32 v5, v119, v117, s25
    v_accvgpr_write_b32 a189, v5
    v_perm_b32 v4, v123, v121, s25
    v_accvgpr_write_b32 a190, v4
    v_perm_b32 v5, v127, v125, s25
    v_accvgpr_write_b32 a191, v5
    buffer_load_dwordx2 v[112:113], v2, s[8:11], s26 offen
    s_add_u32 s26, s26, 0xd80
    buffer_load_dwordx2 v[114:115], v2, s[8:11], s26 offen
    s_add_u32 s26, s26, 0xd80
    buffer_load_dwordx2 v[116:117], v2, s[8:11], s26 offen
    s_add_u32 s26, s26, 0xd80
    buffer_load_dwordx2 v[118:119], v2, s[8:11], s26 offen
    s_add_u32 s26, s26, 0xd80
    buffer_load_dwordx2 v[120:121], v2, s[8:11], s26 offen
    s_add_u32 s26, s26, 0xd80
    buffer_load_dwordx2 v[122:123], v2, s[8:11], s26 offen
    s_add_u32 s26, s26, 0xd80
    buffer_load_dwordx2 v[124:125], v2, s[8:11], s26 offen
    s_add_u32 s26, s26, 0xd80
    buffer_load_dwordx2 v[126:127], v2, s[8:11], s26 offen
    s_add_u32 s26, s26, 0x29580
    s_waitcnt vmcnt(56)
    v_perm_b32 v4, v130, v128, s24
    v_accvgpr_write_b32 a192, v4
    v_perm_b32 v5, v134, v132, s24
    v_accvgpr_write_b32 a193, v5
    v_perm_b32 v4, v138, v136, s24
    v_accvgpr_write_b32 a194, v4
    v_perm_b32 v5, v142, v140, s24
    v_accvgpr_write_b32 a195, v5
    v_perm_b32 v4, v130, v128, s25
    v_accvgpr_write_b32 a196, v4
    v_perm_b32 v5, v134, v132, s25
    v_accvgpr_write_b32 a197, v5
    v_perm_b32 v4, v138, v136, s25
    v_accvgpr_write_b32 a198, v4
    v_perm_b32 v5, v142, v140, s25
    v_accvgpr_write_b32 a199, v5
    v_perm_b32 v4, v131, v129, s24
    v_accvgpr_write_b32 a200, v4
    v_perm_b32 v5, v135, v133, s24
    v_accvgpr_write_b32 a201, v5
    v_perm_b32 v4, v139, v137, s24
    v_accvgpr_write_b32 a202, v4
    v_perm_b32 v5, v143, v141, s24
    v_accvgpr_write_b32 a203, v5
    v_perm_b32 v4, v131, v129, s25
    v_accvgpr_write_b32 a204, v4
    v_perm_b32 v5, v135, v133, s25
    v_accvgpr_write_b32 a205, v5
    v_perm_b32 v4, v139, v137, s25
    v_accvgpr_write_b32 a206, v4
    v_perm_b32 v5, v143, v141, s25
    v_accvgpr_write_b32 a207, v5
    s_waitcnt vmcnt(48)
    v_perm_b32 v4, v146, v144, s24
    v_accvgpr_write_b32 a208, v4
    v_perm_b32 v5, v150, v148, s24
    v_accvgpr_write_b32 a209, v5
    v_perm_b32 v4, v154, v152, s24
    v_accvgpr_write_b32 a210, v4
    v_perm_b32 v5, v158, v156, s24
    v_accvgpr_write_b32 a211, v5
    v_perm_b32 v4, v146, v144, s25
    v_accvgpr_write_b32 a212, v4
    v_perm_b32 v5, v150, v148, s25
    v_accvgpr_write_b32 a213, v5
    v_perm_b32 v4, v154, v152, s25
    v_accvgpr_write_b32 a214, v4
    v_perm_b32 v5, v158, v156, s25
    v_accvgpr_write_b32 a215, v5
    v_perm_b32 v4, v147, v145, s24
    v_accvgpr_write_b32 a216, v4
    v_perm_b32 v5, v151, v149, s24
    v_accvgpr_write_b32 a217, v5
    v_perm_b32 v4, v155, v153, s24
    v_accvgpr_write_b32 a218, v4
    v_perm_b32 v5, v159, v157, s24
    v_accvgpr_write_b32 a219, v5
    v_perm_b32 v4, v147, v145, s25
    v_accvgpr_write_b32 a220, v4
    v_perm_b32 v5, v151, v149, s25
    v_accvgpr_write_b32 a221, v5
    v_perm_b32 v4, v155, v153, s25
    v_accvgpr_write_b32 a222, v4
    v_perm_b32 v5, v159, v157, s25
    v_accvgpr_write_b32 a223, v5
    s_waitcnt vmcnt(40)
    v_perm_b32 v4, v162, v160, s24
    v_accvgpr_write_b32 a224, v4
    v_perm_b32 v5, v166, v164, s24
    v_accvgpr_write_b32 a225, v5
    v_perm_b32 v4, v170, v168, s24
    v_accvgpr_write_b32 a226, v4
    v_perm_b32 v5, v174, v172, s24
    v_accvgpr_write_b32 a227, v5
    v_perm_b32 v4, v162, v160, s25
    v_accvgpr_write_b32 a228, v4
    v_perm_b32 v5, v166, v164, s25
    v_accvgpr_write_b32 a229, v5
    v_perm_b32 v4, v170, v168, s25
    v_accvgpr_write_b32 a230, v4
    v_perm_b32 v5, v174, v172, s25
    v_accvgpr_write_b32 a231, v5
    v_perm_b32 v4, v163, v161, s24
    v_accvgpr_write_b32 a232, v4
    v_perm_b32 v5, v167, v165, s24
    v_accvgpr_write_b32 a233, v5
    v_perm_b32 v4, v171, v169, s24
    v_accvgpr_write_b32 a234, v4
    v_perm_b32 v5, v175, v173, s24
    v_accvgpr_write_b32 a235, v5
    v_perm_b32 v4, v163, v161, s25
    v_accvgpr_write_b32 a236, v4
    v_perm_b32 v5, v167, v165, s25
    v_accvgpr_write_b32 a237, v5
    v_perm_b32 v4, v171, v169, s25
    v_accvgpr_write_b32 a238, v4
    v_perm_b32 v5, v175, v173, s25
    v_accvgpr_write_b32 a239, v5
    s_waitcnt vmcnt(32)
    v_perm_b32 v4, v178, v176, s24
    v_accvgpr_write_b32 a240, v4
    v_perm_b32 v5, v182, v180, s24
    v_accvgpr_write_b32 a241, v5
    v_perm_b32 v4, v186, v184, s24
    v_accvgpr_write_b32 a242, v4
    v_perm_b32 v5, v190, v188, s24
    v_accvgpr_write_b32 a243, v5
    v_perm_b32 v4, v178, v176, s25
    v_accvgpr_write_b32 a244, v4
    v_perm_b32 v5, v182, v180, s25
    v_accvgpr_write_b32 a245, v5
    v_perm_b32 v4, v186, v184, s25
    v_accvgpr_write_b32 a246, v4
    v_perm_b32 v5, v190, v188, s25
    v_accvgpr_write_b32 a247, v5
    v_perm_b32 v4, v179, v177, s24
    v_accvgpr_write_b32 a248, v4
    v_perm_b32 v5, v183, v181, s24
    v_accvgpr_write_b32 a249, v5
    v_perm_b32 v4, v187, v185, s24
    v_accvgpr_write_b32 a250, v4
    v_perm_b32 v5, v191, v189, s24
    v_accvgpr_write_b32 a251, v5
    v_perm_b32 v4, v179, v177, s25
    v_accvgpr_write_b32 a252, v4
    v_perm_b32 v5, v183, v181, s25
    v_accvgpr_write_b32 a253, v5
    v_perm_b32 v4, v187, v185, s25
    v_accvgpr_write_b32 a254, v4
    v_perm_b32 v5, v191, v189, s25
    v_accvgpr_write_b32 a255, v5
    s_waitcnt vmcnt(24)
    v_perm_b32 v192, v66, v64, s24
    v_perm_b32 v193, v70, v68, s24
    v_perm_b32 v194, v74, v72, s24
    v_perm_b32 v195, v78, v76, s24
    v_perm_b32 v196, v66, v64, s25
    v_perm_b32 v197, v70, v68, s25
    v_perm_b32 v198, v74, v72, s25
    v_perm_b32 v199, v78, v76, s25
    v_perm_b32 v200, v67, v65, s24
    v_perm_b32 v201, v71, v69, s24
    v_perm_b32 v202, v75, v73, s24
    v_perm_b32 v203, v79, v77, s24
    v_perm_b32 v204, v67, v65, s25
    v_perm_b32 v205, v71, v69, s25
    v_perm_b32 v206, v75, v73, s25
    v_perm_b32 v207, v79, v77, s25
    s_waitcnt vmcnt(16)
    v_perm_b32 v208, v82, v80, s24
    v_perm_b32 v209, v86, v84, s24
    v_perm_b32 v210, v90, v88, s24
    v_perm_b32 v211, v94, v92, s24
    v_perm_b32 v212, v82, v80, s25
    v_perm_b32 v213, v86, v84, s25
    v_perm_b32 v214, v90, v88, s25
    v_perm_b32 v215, v94, v92, s25
    v_perm_b32 v216, v83, v81, s24
    v_perm_b32 v217, v87, v85, s24
    v_perm_b32 v218, v91, v89, s24
    v_perm_b32 v219, v95, v93, s24
    v_perm_b32 v220, v83, v81, s25
    v_perm_b32 v221, v87, v85, s25
    v_perm_b32 v222, v91, v89, s25
    v_perm_b32 v223, v95, v93, s25
    s_waitcnt vmcnt(8)
    v_perm_b32 v224, v98, v96, s24
    v_perm_b32 v225, v102, v100, s24
    v_perm_b32 v226, v106, v104, s24
    v_perm_b32 v227, v110, v108, s24
    v_perm_b32 v228, v98, v96, s25
    v_perm_b32 v229, v102, v100, s25
    v_perm_b32 v230, v106, v104, s25
    v_perm_b32 v231, v110, v108, s25
    v_perm_b32 v232, v99, v97, s24
    v_perm_b32 v233, v103, v101, s24
    v_perm_b32 v234, v107, v105, s24
    v_perm_b32 v235, v111, v109, s24
    v_perm_b32 v236, v99, v97, s25
    v_perm_b32 v237, v103, v101, s25
    v_perm_b32 v238, v107, v105, s25
    v_perm_b32 v239, v111, v109, s25
    s_waitcnt vmcnt(0)
    v_perm_b32 v240, v114, v112, s24
    v_perm_b32 v241, v118, v116, s24
    v_perm_b32 v242, v122, v120, s24
    v_perm_b32 v243, v126, v124, s24
    v_perm_b32 v244, v114, v112, s25
    v_perm_b32 v245, v118, v116, s25
    v_perm_b32 v246, v122, v120, s25
    v_perm_b32 v247, v126, v124, s25
    v_perm_b32 v248, v115, v113, s24
    v_perm_b32 v249, v119, v117, s24
    v_perm_b32 v250, v123, v121, s24
    v_perm_b32 v251, v127, v125, s24
    v_perm_b32 v252, v115, v113, s25
    v_perm_b32 v253, v119, v117, s25
    v_perm_b32 v254, v123, v121, s25
    v_perm_b32 v255, v127, v125, s25
    s_sub_u32 s27, s27, 8192
    s_sub_u32 s29, s29, 8192
    s_add_u32 m0, s29, 4096
    s_add_u32 s38, s27, 4096
    s_mov_b32 s30, 81920
    s_mov_b32 s32, 0
    s_mov_b32 s33, 0
    s_mov_b32 s34, s21
    s_mov_b32 s37, 64
    v_mov_b32 v3, v1
    s_waitcnt vmcnt(0)
    s_barrier
    s_mov_b32 s30, 0
    s_mov_b32 s37, s21
    v_mov_b32 v6, v255
WS_110:
    s_lshl_b32 s55, s37, 7
    s_add_u32 s56, s55, 40960
    s_add_u32 s55, s55, 32768
    s_cmp_lg_u32 s23, 0
    s_cbranch_scc1 FW_112
    s_mov_b32 s53, 0
FW_113:
    buffer_load_dword v255, off, s[48:51], s55 sc1
    s_add_u32 s53, s53, 1
    s_cmp_gt_u32 s53, 0x20000
    s_cbranch_scc1 FW_114
    s_waitcnt vmcnt(0)
    v_readfirstlane_b32 s54, v255
    s_cmp_lg_u32 s54, 2
    s_cbranch_scc1 FW_113
FW_114:
FW_112:
    s_barrier
    v_mov_b32 v255, v6
    s_mul_i32 s27, s37, 40960
    s_add_u32 s27, s27, s28
    s_add_u32 s29, s30, s28
    s_mov_b32 m0, s29
    s_nop 0
    buffer_load_dwordx4 v1, s[12:15], s27 offen offset:0 sc1 lds
    buffer_load_dwordx4 v1, s[12:15], s27 offen offset:1024 sc1 lds
    buffer_load_dwordx4 v1, s[12:15], s27 offen offset:2048 sc1 lds
    buffer_load_dwordx4 v1, s[12:15], s27 offen offset:3072 sc1 lds
    s_add_u32 s27, s27, 4096
    s_add_u32 s29, s29, 4096
    s_mov_b32 m0, s29
    s_nop 0
    buffer_load_dwordx4 v1, s[12:15], s27 offen offset:0 sc1 lds
    buffer_load_dwordx4 v1, s[12:15], s27 offen offset:1024 sc1 lds
    buffer_load_dwordx4 v1, s[12:15], s27 offen offset:2048 sc1 lds
    buffer_load_dwordx4 v1, s[12:15], s27 offen offset:3072 sc1 lds
    s_add_u32 s27, s27, 4096
    s_add_u32 s29, s29, 4096
    s_mov_b32 m0, s29
    s_nop 0
    buffer_load_dwordx4 v1, s[12:15], s27 offen offset:0 sc1 lds
    buffer_load_dwordx4 v1, s[12:15], s27 offen offset:1024 sc1 lds
    s_mul_i32 s35, s37, 110592
    s_add_u32 s35, s35, s22
    s_add_u32 s36, s35, 55296
    s_waitcnt vmcnt(0)
    s_barrier
    ds_read_b128 v[128:131], v3 offset:0
    ds_read_b128 v[132:135], v3 offset:20480
    ds_read_b128 v[136:139], v3 offset:1024
    ds_read_b128 v[140:143], v3 offset:21504
    ds_read_b128 v[144:147], v3 offset:2048
    ds_read_b128 v[148:151], v3 offset:22528
    ds_read_b128 v[152:155], v3 offset:3072
    ds_read_b128 v[156:159], v3 offset:23552
    s_waitcnt lgkmcnt(6)
    v_mfma_f32_16x16x32_bf16 v[64:67], a[0:3], v[128:131], 0
    v_mfma_f32_16x16x32_bf16 v[68:71], a[4:7], v[128:131], 0
    v_mfma_f32_16x16x32_bf16 v[72:75], a[8:11], v[128:131], 0
    v_mfma_f32_16x16x32_bf16 v[76:79], a[12:15], v[128:131], 0
    v_mfma_f32_16x16x32_bf16 v[80:83], a[0:3], v[132:135], 0
    v_mfma_f32_16x16x32_bf16 v[84:87], a[4:7], v[132:135], 0
    v_mfma_f32_16x16x32_bf16 v[88:91], a[8:11], v[132:135], 0
    v_mfma_f32_16x16x32_bf16 v[92:95], a[12:15], v[132:135], 0
    ds_read_b128 v[128:131], v3 offset:4096
    ds_read_b128 v[132:135], v3 offset:24576
    s_waitcnt lgkmcnt(6)
    v_mfma_f32_16x16x32_bf16 v[64:67], a[16:19], v[136:139], v[64:67]
    v_mfma_f32_16x16x32_bf16 v[68:71], a[20:23], v[136:139], v[68:71]
    v_mfma_f32_16x16x32_bf16 v[72:75], a[24:27], v[136:139], v[72:75]
    v_mfma_f32_16x16x32_bf16 v[76:79], a[28:31], v[136:139], v[76:79]
    v_mfma_f32_16x16x32_bf16 v[80:83], a[16:19], v[140:143], v[80:83]
    v_mfma_f32_16x16x32_bf16 v[84:87], a[20:23], v[140:143], v[84:87]
    v_mfma_f32_16x16x32_bf16 v[88:91], a[24:27], v[140:143], v[88:91]
    v_mfma_f32_16x16x32_bf16 v[92:95], a[28:31], v[140:143], v[92:95]
    ds_read_b128 v[136:139], v3 offset:5120
    ds_read_b128 v[140:143], v3 offset:25600
    s_waitcnt lgkmcnt(6)
    v_mfma_f32_16x16x32_bf16 v[64:67], a[32:35], v[144:147], v[64:67]
    v_mfma_f32_16x16x32_bf16 v[68:71], a[36:39], v[144:147], v[68:71]
    v_mfma_f32_16x16x32_bf16 v[72:75], a[40:43], v[144:147], v[72:75]
    v_mfma_f32_16x16x32_bf16 v[76:79], a[44:47], v[144:147], v[76:79]
    v_mfma_f32_16x16x32_bf16 v[80:83], a[32:35], v[148:151], v[80:83]
    v_mfma_f32_16x16x32_bf16 v[84:87], a[36:39], v[148:151], v[84:87]
    v_mfma_f32_16x16x32_bf16 v[88:91], a[40:43], v[148:151], v[88:91]
    v_mfma_f32_16x16x32_bf16 v[92:95], a[44:47], v[148:151], v[92:95]
    ds_read_b128 v[144:147], v3 offset:6144
    ds_read_b128 v[148:151], v3 offset:26624
    s_waitcnt lgkmcnt(6)
    v_mfma_f32_16x16x32_bf16 v[64:67], a[48:51], v[152:155], v[64:67]
    v_mfma_f32_16x16x32_bf16 v[68:71], a[52:55], v[152:155], v[68:71]
    v_mfma_f32_16x16x32_bf16 v[72:75], a[56:59], v[152:155], v[72:75]
    v_mfma_f32_16x16x32_bf16 v[76:79], a[60:63], v[152:155], v[76:79]
    v_mfma_f32_16x16x32_bf16 v[80:83], a[48:51], v[156:159], v[80:83]
    v_mfma_f32_16x16x32_bf16 v[84:87], a[52:55], v[156:159], v[84:87]
    v_mfma_f32_16x16x32_bf16 v[88:91], a[56:59], v[156:159], v[88:91]
    v_mfma_f32_16x16x32_bf16 v[92:95], a[60:63], v[156:159], v[92:95]
    ds_read_b128 v[152:155], v3 offset:7168
    ds_read_b128 v[156:159], v3 offset:27648
    s_waitcnt lgkmcnt(6)
    v_mfma_f32_16x16x32_bf16 v[64:67], a[64:67], v[128:131], v[64:67]
    v_mfma_f32_16x16x32_bf16 v[68:71], a[68:71], v[128:131], v[68:71]
    v_mfma_f32_16x16x32_bf16 v[72:75], a[72:75], v[128:131], v[72:75]
    v_mfma_f32_16x16x32_bf16 v[76:79], a[76:79], v[128:131], v[76:79]
    v_mfma_f32_16x16x32_bf16 v[80:83], a[64:67], v[132:135], v[80:83]
    v_mfma_f32_16x16x32_bf16 v[84:87], a[68:71], v[132:135], v[84:87]
    v_mfma_f32_16x16x32_bf16 v[88:91], a[72:75], v[132:135], v[88:91]
    v_mfma_f32_16x16x32_bf16 v[92:95], a[76:79], v[132:135], v[92:95]
    ds_read_b128 v[128:131], v3 offset:8192
    ds_read_b128 v[132:135], v3 offset:28672
    s_waitcnt lgkmcnt(6)
    v_mfma_f32_16x16x32_bf16 v[64:67], a[80:83], v[136:139], v[64:67]
    v_mfma_f32_16x16x32_bf16 v[68:71], a[84:87], v[136:139], v[68:71]
    v_mfma_f32_16x16x32_bf16 v[72:75], a[88:91], v[136:139], v[72:75]
    v_mfma_f32_16x16x32_bf16 v[76:79], a[92:95], v[136:139], v[76:79]
    v_mfma_f32_16x16x32_bf16 v[80:83], a[80:83], v[140:143], v[80:83]
    v_mfma_f32_16x16x32_bf16 v[84:87], a[84:87], v[140:143], v[84:87]
    v_mfma_f32_16x16x32_bf16 v[88:91], a[88:91], v[140:143], v[88:91]
    v_mfma_f32_16x16x32_bf16 v[92:95], a[92:95], v[140:143], v[92:95]
    ds_read_b128 v[136:139], v3 offset:9216
    ds_read_b128 v[140:143], v3 offset:29696
    s_waitcnt lgkmcnt(6)
    v_mfma_f32_16x16x32_bf16 v[64:67], a[96:99], v[144:147], v[64:67]
    v_mfma_f32_16x16x32_bf16 v[68:71], a[100:103], v[144:147], v[68:71]
    v_mfma_f32_16x16x32_bf16 v[72:75], a[104:107], v[144:147], v[72:75]
    v_mfma_f32_16x16x32_bf16 v[76:79], a[108:111], v[144:147], v[76:79]
    v_mfma_f32_16x16x32_bf16 v[80:83], a[96:99], v[148:151], v[80:83]
    v_mfma_f32_16x16x32_bf16 v[84:87], a[100:103], v[148:151], v[84:87]
    v_mfma_f32_16x16x32_bf16 v[88:91], a[104:107], v[148:151], v[88:91]
    v_mfma_f32_16x16x32_bf16 v[92:95], a[108:111], v[148:151], v[92:95]
    ds_read_b128 v[144:147], v3 offset:10240
    ds_read_b128 v[148:151], v3 offset:30720
    s_waitcnt lgkmcnt(6)
    v_mfma_f32_16x16x32_bf16 v[64:67], a[112:115], v[152:155], v[64:67]
    v_mfma_f32_16x16x32_bf16 v[68:71], a[116:119], v[152:155], v[68:71]
    v_mfma_f32_16x16x32_bf16 v[72:75], a[120:123], v[152:155], v[72:75]
    v_mfma_f32_16x16x32_bf16 v[76:79], a[124:127], v[152:155], v[76:79]
    v_mfma_f32_16x16x32_bf16 v[80:83], a[112:115], v[156:159], v[80:83]
    v_mfma_f32_16x16x32_bf16 v[84:87], a[116:119], v[156:159], v[84:87]
    v_mfma_f32_16x16x32_bf16 v[88:91], a[120:123], v[156:159], v[88:91]
    v_mfma_f32_16x16x32_bf16 v[92:95], a[124:127], v[156:159], v[92:95]
    ds_read_b128 v[152:155], v3 offset:11264
    ds_read_b128 v[156:159], v3 offset:31744
    s_waitcnt lgkmcnt(6)
    v_mfma_f32_16x16x32_bf16 v[64:67], a[128:131], v[128:131], v[64:67]
    v_mfma_f32_16x16x32_bf16 v[68:71], a[132:135], v[128:131], v[68:71]
    v_mfma_f32_16x16x32_bf16 v[72:75], a[136:139], v[128:131], v[72:75]
    v_mfma_f32_16x16x32_bf16 v[76:79], a[140:143], v[128:131], v[76:79]
    v_mfma_f32_16x16x32_bf16 v[80:83], a[128:131], v[132:135], v[80:83]
    v_mfma_f32_16x16x32_bf16 v[84:87], a[132:135], v[132:135], v[84:87]
    v_mfma_f32_16x16x32_bf16 v[88:91], a[136:139], v[132:135], v[88:91]
    v_mfma_f32_16x16x32_bf16 v[92:95], a[140:143], v[132:135], v[92:95]
    ds_read_b128 v[128:131], v3 offset:12288
    ds_read_b128 v[132:135], v3 offset:32768
    s_waitcnt lgkmcnt(6)
    v_mfma_f32_16x16x32_bf16 v[64:67], a[144:147], v[136:139], v[64:67]
    v_mfma_f32_16x16x32_bf16 v[68:71], a[148:151], v[136:139], v[68:71]
    v_mfma_f32_16x16x32_bf16 v[72:75], a[152:155], v[136:139], v[72:75]
    v_mfma_f32_16x16x32_bf16 v[76:79], a[156:159], v[136:139], v[76:79]
    v_mfma_f32_16x16x32_bf16 v[80:83], a[144:147], v[140:143], v[80:83]
    v_mfma_f32_16x16x32_bf16 v[84:87], a[148:151], v[140:143], v[84:87]
    v_mfma_f32_16x16x32_bf16 v[88:91], a[152:155], v[140:143], v[88:91]
    v_mfma_f32_16x16x32_bf16 v[92:95], a[156:159], v[140:143], v[92:95]
    ds_read_b128 v[136:139], v3 offset:13312
    ds_read_b128 v[140:143], v3 offset:33792
    s_waitcnt lgkmcnt(6)
    v_mfma_f32_16x16x32_bf16 v[64:67], a[160:163], v[144:147], v[64:67]
    v_mfma_f32_16x16x32_bf16 v[68:71], a[164:167], v[144:147], v[68:71]
    v_mfma_f32_16x16x32_bf16 v[72:75], a[168:171], v[144:147], v[72:75]
    v_mfma_f32_16x16x32_bf16 v[76:79], a[172:175], v[144:147], v[76:79]
    v_mfma_f32_16x16x32_bf16 v[80:83], a[160:163], v[148:151], v[80:83]
    v_mfma_f32_16x16x32_bf16 v[84:87], a[164:167], v[148:151], v[84:87]
    v_mfma_f32_16x16x32_bf16 v[88:91], a[168:171], v[148:151], v[88:91]
    v_mfma_f32_16x16x32_bf16 v[92:95], a[172:175], v[148:151], v[92:95]
    ds_read_b128 v[144:147], v3 offset:14336
    ds_read_b128 v[148:151], v3 offset:34816
    s_waitcnt lgkmcnt(6)
    v_mfma_f32_16x16x32_bf16 v[64:67], a[176:179], v[152:155], v[64:67]
    v_mfma_f32_16x16x32_bf16 v[68:71], a[180:183], v[152:155], v[68:71]
    v_mfma_f32_16x16x32_bf16 v[72:75], a[184:187], v[152:155], v[72:75]
    v_mfma_f32_16x16x32_bf16 v[76:79], a[188:191], v[152:155], v[76:79]
    v_mfma_f32_16x16x32_bf16 v[80:83], a[176:179], v[156:159], v[80:83]
    v_mfma_f32_16x16x32_bf16 v[84:87], a[180:183], v[156:159], v[84:87]
    v_mfma_f32_16x16x32_bf16 v[88:91], a[184:187], v[156:159], v[88:91]
    v_mfma_f32_16x16x32_bf16 v[92:95], a[188:191], v[156:159], v[92:95]
    ds_read_b128 v[152:155], v3 offset:15360
    ds_read_b128 v[156:159], v3 offset:35840
    s_waitcnt lgkmcnt(6)
    v_mfma_f32_16x16x32_bf16 v[64:67], a[192:195], v[128:131], v[64:67]
    v_mfma_f32_16x16x32_bf16 v[68:71], a[196:199], v[128:131], v[68:71]
    v_mfma_f32_16x16x32_bf16 v[72:75], a[200:203], v[128:131], v[72:75]
    v_mfma_f32_16x16x32_bf16 v[76:79], a[204:207], v[128:131], v[76:79]
    v_mfma_f32_16x16x32_bf16 v[80:83], a[192:195], v[132:135], v[80:83]
    v_mfma_f32_16x16x32_bf16 v[84:87], a[196:199], v[132:135], v[84:87]
    v_mfma_f32_16x16x32_bf16 v[88:91], a[200:203], v[132:135], v[88:91]
    v_mfma_f32_16x16x32_bf16 v[92:95], a[204:207], v[132:135], v[92:95]
    ds_read_b128 v[128:131], v3 offset:16384
    ds_read_b128 v[132:135], v3 offset:36864
    s_waitcnt lgkmcnt(6)
    v_mfma_f32_16x16x32_bf16 v[64:67], a[208:211], v[136:139], v[64:67]
    v_mfma_f32_16x16x32_bf16 v[68:71], a[212:215], v[136:139], v[68:71]
    v_mfma_f32_16x16x32_bf16 v[72:75], a[216:219], v[136:139], v[72:75]
    v_mfma_f32_16x16x32_bf16 v[76:79], a[220:223], v[136:139], v[76:79]
    v_mfma_f32_16x16x32_bf16 v[80:83], a[208:211], v[140:143], v[80:83]
    v_mfma_f32_16x16x32_bf16 v[84:87], a[212:215], v[140:143], v[84:87]
    v_mfma_f32_16x16x32_bf16 v[88:91], a[216:219], v[140:143], v[88:91]
    v_mfma_f32_16x16x32_bf16 v[92:95], a[220:223], v[140:143], v[92:95]
    ds_read_b128 v[136:139], v3 offset:17408
    ds_read_b128 v[140:143], v3 offset:37888
    s_waitcnt lgkmcnt(6)
    v_mfma_f32_16x16x32_bf16 v[64:67], a[224:227], v[144:147], v[64:67]
    v_mfma_f32_16x16x32_bf16 v[68:71], a[228:231], v[144:147], v[68:71]
    v_mfma_f32_16x16x32_bf16 v[72:75], a[232:235], v[144:147], v[72:75]
    v_mfma_f32_16x16x32_bf16 v[76:79], a[236:239], v[144:147], v[76:79]
    v_mfma_f32_16x16x32_bf16 v[80:83], a[224:227], v[148:151], v[80:83]
    v_mfma_f32_16x16x32_bf16 v[84:87], a[228:231], v[148:151], v[84:87]
    v_mfma_f32_16x16x32_bf16 v[88:91], a[232:235], v[148:151], v[88:91]
    v_mfma_f32_16x16x32_bf16 v[92:95], a[236:239], v[148:151], v[92:95]
    ds_read_b128 v[144:147], v3 offset:18432
    ds_read_b128 v[148:151], v3 offset:38912
    s_waitcnt lgkmcnt(6)
    v_mfma_f32_16x16x32_bf16 v[64:67], a[240:243], v[152:155], v[64:67]
    v_mfma_f32_16x16x32_bf16 v[68:71], a[244:247], v[152:155], v[68:71]
    v_mfma_f32_16x16x32_bf16 v[72:75], a[248:251], v[152:155], v[72:75]
    v_mfma_f32_16x16x32_bf16 v[76:79], a[252:255], v[152:155], v[76:79]
    v_mfma_f32_16x16x32_bf16 v[80:83], a[240:243], v[156:159], v[80:83]
    v_mfma_f32_16x16x32_bf16 v[84:87], a[244:247], v[156:159], v[84:87]
    v_mfma_f32_16x16x32_bf16 v[88:91], a[248:251], v[156:159], v[88:91]
    v_mfma_f32_16x16x32_bf16 v[92:95], a[252:255], v[156:159], v[92:95]
    ds_read_b128 v[152:155], v3 offset:19456
    ds_read_b128 v[156:159], v3 offset:39936
    s_waitcnt lgkmcnt(6)
    v_mfma_f32_16x16x32_bf16 v[64:67], v[192:195], v[128:131], v[64:67]
    v_mfma_f32_16x16x32_bf16 v[68:71], v[196:199], v[128:131], v[68:71]
    v_mfma_f32_16x16x32_bf16 v[72:75], v[200:203], v[128:131], v[72:75]
    v_mfma_f32_16x16x32_bf16 v[76:79], v[204:207], v[128:131], v[76:79]
    v_mfma_f32_16x16x32_bf16 v[80:83], v[192:195], v[132:135], v[80:83]
    v_mfma_f32_16x16x32_bf16 v[84:87], v[196:199], v[132:135], v[84:87]
    v_mfma_f32_16x16x32_bf16 v[88:91], v[200:203], v[132:135], v[88:91]
    v_mfma_f32_16x16x32_bf16 v[92:95], v[204:207], v[132:135], v[92:95]
    s_waitcnt lgkmcnt(4)
    v_mfma_f32_16x16x32_bf16 v[64:67], v[208:211], v[136:139], v[64:67]
    v_mfma_f32_16x16x32_bf16 v[68:71], v[212:215], v[136:139], v[68:71]
    v_mfma_f32_16x16x32_bf16 v[72:75], v[216:219], v[136:139], v[72:75]
    v_mfma_f32_16x16x32_bf16 v[76:79], v[220:223], v[136:139], v[76:79]
    v_mfma_f32_16x16x32_bf16 v[80:83], v[208:211], v[140:143], v[80:83]
    v_mfma_f32_16x16x32_bf16 v[84:87], v[212:215], v[140:143], v[84:87]
    v_mfma_f32_16x16x32_bf16 v[88:91], v[216:219], v[140:143], v[88:91]
    v_mfma_f32_16x16x32_bf16 v[92:95], v[220:223], v[140:143], v[92:95]
    s_waitcnt lgkmcnt(2)
    v_mfma_f32_16x16x32_bf16 v[64:67], v[224:227], v[144:147], v[64:67]
    v_mfma_f32_16x16x32_bf16 v[68:71], v[228:231], v[144:147], v[68:71]
    v_mfma_f32_16x16x32_bf16 v[72:75], v[232:235], v[144:147], v[72:75]
    v_mfma_f32_16x16x32_bf16 v[76:79], v[236:239], v[144:147], v[76:79]
    v_mfma_f32_16x16x32_bf16 v[80:83], v[224:227], v[148:151], v[80:83]
    v_mfma_f32_16x16x32_bf16 v[84:87], v[228:231], v[148:151], v[84:87]
    v_mfma_f32_16x16x32_bf16 v[88:91], v[232:235], v[148:151], v[88:91]
    v_mfma_f32_16x16x32_bf16 v[92:95], v[236:239], v[148:151], v[92:95]
    s_waitcnt lgkmcnt(0)
    v_mfma_f32_16x16x32_bf16 v[64:67], v[240:243], v[152:155], v[64:67]
    v_mfma_f32_16x16x32_bf16 v[68:71], v[244:247], v[152:155], v[68:71]
    v_mfma_f32_16x16x32_bf16 v[72:75], v[248:251], v[152:155], v[72:75]
    v_mfma_f32_16x16x32_bf16 v[76:79], v[252:255], v[152:155], v[76:79]
    v_mfma_f32_16x16x32_bf16 v[80:83], v[240:243], v[156:159], v[80:83]
    v_mfma_f32_16x16x32_bf16 v[84:87], v[244:247], v[156:159], v[84:87]
    v_mfma_f32_16x16x32_bf16 v[88:91], v[248:251], v[156:159], v[88:91]
    v_mfma_f32_16x16x32_bf16 v[92:95], v[252:255], v[156:159], v[92:95]
    s_nop 7
    v_max_f32 v64, 0, v64
    v_max_f32 v68, 0, v68
    v_cvt_pk_bf16_f32 v160, v64, v68
    v_max_f32 v72, 0, v72
    v_max_f32 v76, 0, v76
    v_cvt_pk_bf16_f32 v161, v72, v76
    v_max_f32 v65, 0, v65
    v_max_f32 v69, 0, v69
    v_cvt_pk_bf16_f32 v162, v65, v69
    v_max_f32 v73, 0, v73
    v_max_f32 v77, 0, v77
    v_cvt_pk_bf16_f32 v163, v73, v77
    buffer_store_dwordx4 v[160:163], v1, s[16:19], s35 offen offset:0 sc1
    v_max_f32 v66, 0, v66
    v_max_f32 v70, 0, v70
    v_cvt_pk_bf16_f32 v164, v66, v70
    v_max_f32 v74, 0, v74
    v_max_f32 v78, 0, v78
    v_cvt_pk_bf16_f32 v165, v74, v78
    v_max_f32 v67, 0, v67
    v_max_f32 v71, 0, v71
    v_cvt_pk_bf16_f32 v166, v67, v71
    v_max_f32 v75, 0, v75
    v_max_f32 v79, 0, v79
    v_cvt_pk_bf16_f32 v167, v75, v79
    buffer_store_dwordx4 v[164:167], v1, s[16:19], s35 offen offset:1024 sc1
    v_max_f32 v80, 0, v80
    v_max_f32 v84, 0, v84
    v_cvt_pk_bf16_f32 v168, v80, v84
    v_max_f32 v88, 0, v88
    v_max_f32 v92, 0, v92
    v_cvt_pk_bf16_f32 v169, v88, v92
    v_max_f32 v81, 0, v81
    v_max_f32 v85, 0, v85
    v_cvt_pk_bf16_f32 v170, v81, v85
    v_max_f32 v89, 0, v89
    v_max_f32 v93, 0, v93
    v_cvt_pk_bf16_f32 v171, v89, v93
    buffer_store_dwordx4 v[168:171], v1, s[16:19], s36 offen offset:0 sc1
    v_max_f32 v82, 0, v82
    v_max_f32 v86, 0, v86
    v_cvt_pk_bf16_f32 v172, v82, v86
    v_max_f32 v90, 0, v90
    v_max_f32 v94, 0, v94
    v_cvt_pk_bf16_f32 v173, v90, v94
    v_max_f32 v83, 0, v83
    v_max_f32 v87, 0, v87
    v_cvt_pk_bf16_f32 v174, v83, v87
    v_max_f32 v91, 0, v91
    v_max_f32 v95, 0, v95
    v_cvt_pk_bf16_f32 v175, v91, v95
    buffer_store_dwordx4 v[172:175], v1, s[16:19], s36 offen offset:1024 sc1
    s_waitcnt vmcnt(0) lgkmcnt(0)
    s_barrier
    s_cmp_lg_u32 s23, 0
    s_cbranch_scc1 FS_115
    s_mov_b64 exec, 1
    v_mov_b32 v255, 1
    buffer_atomic_add v255, off, s[48:51], s56 sc1
    s_mov_b64 exec, -1
FS_115:
    s_add_u32 s37, s37, 4
    s_cmp_lt_u32 s37, 64
    s_cbranch_scc1 WS_110
    s_branch RW_13
RW_109:
    s_sub_u32 s2, s2, 28
    s_cmp_ge_u32 s2, 40
    s_cbranch_scc1 RW_116
    s_load_dwordx2 s[4:5], s[0:1], 72
    s_load_dwordx2 s[46:47], s[0:1], 80
    s_and_b32 s36, s2, 3
    s_lshr_b32 s34, s2, 2
    s_mov_b32 s52, s36
    s_lshl_b32 s57, s52, 7
    s_add_u32 s57, s57, 40960
    s_mul_i32 s20, s23, 573440
    s_lshl_b32 s38, s34, 7
    s_add_u32 s20, s20, s38
    s_mul_i32 s21, s36, 110592
    s_mul_i32 s39, s23, 14336
    s_add_u32 s21, s21, s39
    s_lshl_b32 s39, s36, 1
    s_lshr_b32 s45, s23, 1
    s_add_u32 s39, s39, s45
    s_mul_i32 s39, s39, 20480
    s_and_b32 s45, s23, 1
    s_lshl_b32 s22, s45, 4
    s_add_u32 s22, s22, s38
    s_add_u32 s22, s22, s39
    s_lshl_b32 s24, s34, 1
    s_add_u32 s24, s24, s45
    s_lshl_b32 s24, s24, 10
    s_add_u32 s24, s24, s39
    s_waitcnt lgkmcnt(0)
    s_add_u32 s8, s4, 0x0
    s_addc_u32 s9, s5, 0
    s_and_b32 s9, s9, 0xffff
    s_mov_b32 s10, 0x21c000
    s_mov_b32 s11, 0x20000
    s_add_u32 s12, s6, 0x7200000
    s_addc_u32 s13, s7, 0
    s_and_b32 s13, s13, 0xffff
    s_mov_b32 s14, 0x6c0000
    s_mov_b32 s15, 0x20000
    s_add_u32 s16, s46, 0x0
    s_addc_u32 s17, s47, 0
    s_and_b32 s17, s17, 0xffff
    s_mov_b32 s18, 0x280000
    s_mov_b32 s19, 0x20000
    s_add_u32 s40, s6, 0x6a00000
    s_addc_u32 s41, s7, 0
    s_and_b32 s41, s41, 0xffff
    s_mov_b32 s42, 0x280000
    s_mov_b32 s43, 0x20000
    v_and_b32 v1, 63, v0
    v_lshrrev_b32 v3, 4, v1
    v_mul_u32_u24 v2, 20480, v3
    v_and_b32 v3, 15, v1
    v_lshl_add_u32 v2, v3, 3, v2
    s_mov_b32 s44, s24
    v_lshlrev_b32 v1, 4, v1
    s_mov_b32 s24, 0x05040100
    s_mov_b32 s25, 0x07060302
    s_mov_b32 s26, s20
    buffer_load_dwordx2 v[16:17], v2, s[8:11], s26 offen
    s_add_u32 s26, s26, 0x500
    buffer_load_dwordx2 v[18:19], v2, s[8:11], s26 offen
    s_add_u32 s26, s26, 0x500
    buffer_load_dwordx2 v[20:21], v2, s[8:11], s26 offen
    s_add_u32 s26, s26, 0x500
    buffer_load_dwordx2 v[22:23], v2, s[8:11], s26 offen
    s_add_u32 s26, s26, 0x500
    buffer_load_dwordx2 v[24:25], v2, s[8:11], s26 offen
    s_add_u32 s26, s26, 0x500
    buffer_load_dwordx2 v[26:27], v2, s[8:11], s26 offen
    s_add_u32 s26, s26, 0x500
    buffer_load_dwordx2 v[28:29], v2, s[8:11], s26 offen
    s_add_u32 s26, s26, 0x500
    buffer_load_dwordx2 v[30:31], v2, s[8:11], s26 offen
    s_add_u32 s26, s26, 0x500
    buffer_load_dwordx2 v[32:33], v2, s[8:11], s26 offen
    s_add_u32 s26, s26, 0x500
    buffer_load_dwordx2 v[34:35], v2, s[8:11], s26 offen
    s_add_u32 s26, s26, 0x500
    buffer_load_dwordx2 v[36:37], v2, s[8:11], s26 offen
    s_add_u32 s26, s26, 0x500
    buffer_load_dwordx2 v[38:39], v2, s[8:11], s26 offen
    s_add_u32 s26, s26, 0x500
    buffer_load_dwordx2 v[40:41], v2, s[8:11], s26 offen
    s_add_u32 s26, s26, 0x500
    buffer_load_dwordx2 v[42:43], v2, s[8:11], s26 offen
    s_add_u32 s26, s26, 0x500
    buffer_load_dwordx2 v[44:45], v2, s[8:11], s26 offen
    s_add_u32 s26, s26, 0x500
    buffer_load_dwordx2 v[46:47], v2, s[8:11], s26 offen
    s_add_u32 s26, s26, 0xf500
    buffer_load_dwordx2 v[48:49], v2, s[8:11], s26 offen
    s_add_u32 s26, s26, 0x500
    buffer_load_dwordx2 v[50:51], v2, s[8:11], s26 offen
    s_add_u32 s26, s26, 0x500
    buffer_load_dwordx2 v[52:53], v2, s[8:11], s26 offen
    s_add_u32 s26, s26, 0x500
    buffer_load_dwordx2 v[54:55], v2, s[8:11], s26 offen
    s_add_u32 s26, s26, 0x500
    buffer_load_dwordx2 v[56:57], v2, s[8:11], s26 offen
    s_add_u32 s26, s26, 0x500
    buffer_load_dwordx2 v[58:59], v2, s[8:11], s26 offen
    s_add_u32 s26, s26, 0x500
    buffer_load_dwordx2 v[60:61], v2, s[8:11], s26 offen
    s_add_u32 s26, s26, 0x500
    buffer_load_dwordx2 v[62:63], v2, s[8:11], s26 offen
    s_add_u32 s26, s26, 0x500
    buffer_load_dwordx2 v[64:65], v2, s[8:11], s26 offen
    s_add_u32 s26, s26, 0x500
    buffer_load_dwordx2 v[66:67], v2, s[8:11], s26 offen
    s_add_u32 s26, s26, 0x500
    buffer_load_dwordx2 v[68:69], v2, s[8:11], s26 offen
    s_add_u32 s26, s26, 0x500
    buffer_load_dwordx2 v[70:71], v2, s[8:11], s26 offen
    s_add_u32 s26, s26, 0x500
    buffer_load_dwordx2 v[72:73], v2, s[8:11], s26 offen
    s_add_u32 s26, s26, 0x500
    buffer_load_dwordx2 v[74:75], v2, s[8:11], s26 offen
    s_add_u32 s26, s26, 0x500
    buffer_load_dwordx2 v[76:77], v2, s[8:11], s26 offen
    s_add_u32 s26, s26, 0x500
    buffer_load_dwordx2 v[78:79], v2, s[8:11], s26 offen
    s_add_u32 s26, s26, 0xf500
    buffer_load_dwordx2 v[80:81], v2, s[8:11], s26 offen
    s_add_u32 s26, s26, 0x500
    buffer_load_dwordx2 v[82:83], v2, s[8:11], s26 offen
    s_add_u32 s26, s26, 0x500
    buffer_load_dwordx2 v[84:85], v2, s[8:11], s26 offen
    s_add_u32 s26, s26, 0x500
    buffer_load_dwordx2 v[86:87], v2, s[8:11], s26 offen
    s_add_u32 s26, s26, 0x500
    buffer_load_dwordx2 v[88:89], v2, s[8:11], s26 offen
    s_add_u32 s26, s26, 0x500
    buffer_load_dwordx2 v[90:91], v2, s[8:11], s26 offen
    s_add_u32 s26, s26, 0x500
    buffer_load_dwordx2 v[92:93], v2, s[8:11], s26 offen
    s_add_u32 s26, s26, 0x500
    buffer_load_dwordx2 v[94:95], v2, s[8:11], s26 offen
    s_add_u32 s26, s26, 0x500
    buffer_load_dwordx2 v[96:97], v2, s[8:11], s26 offen
    s_add_u32 s26, s26, 0x500
    buffer_load_dwordx2 v[98:99], v2, s[8:11], s26 offen
    s_add_u32 s26, s26, 0x500
    buffer_load_dwordx2 v[100:101], v2, s[8:11], s26 offen
    s_add_u32 s26, s26, 0x500
    buffer_load_dwordx2 v[102:103], v2, s[8:11], s26 offen
    s_add_u32 s26, s26, 0x500
    buffer_load_dwordx2 v[104:105], v2, s[8:11], s26 offen
    s_add_u32 s26, s26, 0x500
    buffer_load_dwordx2 v[106:107], v2, s[8:11], s26 offen
    s_add_u32 s26, s26, 0x500
    buffer_load_dwordx2 v[108:109], v2, s[8:11], s26 offen
    s_add_u32 s26, s26, 0x500
    buffer_load_dwordx2 v[110:111], v2, s[8:11], s26 offen
    s_add_u32 s26, s26, 0xf500
    buffer_load_dwordx2 v[112:113], v2, s[8:11], s26 offen
    s_add_u32 s26, s26, 0x500
    buffer_load_dwordx2 v[114:115], v2, s[8:11], s26 offen
    s_add_u32 s26, s26, 0x500
    buffer_load_dwordx2 v[116:117], v2, s[8:11], s26 offen
    s_add_u32 s26, s26, 0x500
    buffer_load_dwordx2 v[118:119], v2, s[8:11], s26 offen
    s_add_u32 s26, s26, 0x500
    buffer_load_dwordx2 v[120:121], v2, s[8:11], s26 offen
    s_add_u32 s26, s26, 0x500
    buffer_load_dwordx2 v[122:123], v2, s[8:11], s26 offen
    s_add_u32 s26, s26, 0x500
    buffer_load_dwordx2 v[124:125], v2, s[8:11], s26 offen
    s_add_u32 s26, s26, 0x500
    buffer_load_dwordx2 v[126:127], v2, s[8:11], s26 offen
    s_add_u32 s26, s26, 0x500
    s_waitcnt vmcnt(48)
    v_perm_b32 v4, v18, v16, s24
    v_accvgpr_write_b32 a0, v4
    v_perm_b32 v5, v22, v20, s24
    v_accvgpr_write_b32 a1, v5
    v_perm_b32 v4, v26, v24, s24
    v_accvgpr_write_b32 a2, v4
    v_perm_b32 v5, v30, v28, s24
    v_accvgpr_write_b32 a3, v5
    v_perm_b32 v4, v18, v16, s25
    v_accvgpr_write_b32 a4, v4
    v_perm_b32 v5, v22, v20, s25
    v_accvgpr_write_b32 a5, v5
    v_perm_b32 v4, v26, v24, s25
    v_accvgpr_write_b32 a6, v4
    v_perm_b32 v5, v30, v28, s25
    v_accvgpr_write_b32 a7, v5
    v_perm_b32 v4, v19, v17, s24
    v_accvgpr_write_b32 a8, v4
    v_perm_b32 v5, v23, v21, s24
    v_accvgpr_write_b32 a9, v5
    v_perm_b32 v4, v27, v25, s24
    v_accvgpr_write_b32 a10, v4
    v_perm_b32 v5, v31, v29, s24
    v_accvgpr_write_b32 a11, v5
    v_perm_b32 v4, v19, v17, s25
    v_accvgpr_write_b32 a12, v4
    v_perm_b32 v5, v23, v21, s25
    v_accvgpr_write_b32 a13, v5
    v_perm_b32 v4, v27, v25, s25
    v_accvgpr_write_b32 a14, v4
    v_perm_b32 v5, v31, v29, s25
    v_accvgpr_write_b32 a15, v5
    buffer_load_dwordx2 v[16:17], v2, s[8:11], s26 offen
    s_add_u32 s26, s26, 0x500
    buffer_load_dwordx2 v[18:19], v2, s[8:11], s26 offen
    s_add_u32 s26, s26, 0x500
    buffer_load_dwordx2 v[20:21], v2, s[8:11], s26 offen
    s_add_u32 s26, s26, 0x500
    buffer_load_dwordx2 v[22:23], v2, s[8:11], s26 offen
    s_add_u32 s26, s26, 0x500
    buffer_load_dwordx2 v[24:25], v2, s[8:11], s26 offen
    s_add_u32 s26, s26, 0x500
    buffer_load_dwordx2 v[26:27], v2, s[8:11], s26 offen
    s_add_u32 s26, s26, 0x500
    buffer_load_dwordx2 v[28:29], v2, s[8:11], s26 offen
    s_add_u32 s26, s26, 0x500
    buffer_load_dwordx2 v[30:31], v2, s[8:11], s26 offen
    s_add_u32 s26, s26, 0xf500
    s_waitcnt vmcnt(48)
    v_perm_b32 v4, v34, v32, s24
    v_accvgpr_write_b32 a16, v4
    v_perm_b32 v5, v38, v36, s24
    v_accvgpr_write_b32 a17, v5
    v_perm_b32 v4, v42, v40, s24
    v_accvgpr_write_b32 a18, v4
    v_perm_b32 v5, v46, v44, s24
    v_accvgpr_write_b32 a19, v5
    v_perm_b32 v4, v34, v32, s25
    v_accvgpr_write_b32 a20, v4
    v_perm_b32 v5, v38, v36, s25
    v_accvgpr_write_b32 a21, v5
    v_perm_b32 v4, v42, v40, s25
    v_accvgpr_write_b32 a22, v4
    v_perm_b32 v5, v46, v44, s25
    v_accvgpr_write_b32 a23, v5
    v_perm_b32 v4, v35, v33, s24
    v_accvgpr_write_b32 a24, v4
    v_perm_b32 v5, v39, v37, s24
    v_accvgpr_write_b32 a25, v5
    v_perm_b32 v4, v43, v41, s24
    v_accvgpr_write_b32 a26, v4
    v_perm_b32 v5, v47, v45, s24
    v_accvgpr_write_b32 a27, v5
    v_perm_b32 v4, v35, v33, s25
    v_accvgpr_write_b32 a28, v4
    v_perm_b32 v5, v39, v37, s25
    v_accvgpr_write_b32 a29, v5
    v_perm_b32 v4, v43, v41, s25
    v_accvgpr_write_b32 a30, v4
    v_perm_b32 v5, v47, v45, s25
    v_accvgpr_write_b32 a31, v5
    buffer_load_dwordx2 v[32:33], v2, s[8:11], s26 offen
    s_add_u32 s26, s26, 0x500
    buffer_load_dwordx2 v[34:35], v2, s[8:11], s26 offen
    s_add_u32 s26, s26, 0x500
    buffer_load_dwordx2 v[36:37], v2, s[8:11], s26 offen
    s_add_u32 s26, s26, 0x500
    buffer_load_dwordx2 v[38:39], v2, s[8:11], s26 offen
    s_add_u32 s26, s26, 0x500
    buffer_load_dwordx2 v[40:41], v2, s[8:11], s26 offen
    s_add_u32 s26, s26, 0x500
    buffer_load_dwordx2 v[42:43], v2, s[8:11], s26 offen
    s_add_u32 s26, s26, 0x500
    buffer_load_dwordx2 v[44:45], v2, s[8:11], s26 offen
    s_add_u32 s26, s26, 0x500
    buffer_load_dwordx2 v[46:47], v2, s[8:11], s26 offen
    s_add_u32 s26, s26, 0x500
    s_waitcnt vmcnt(48)
    v_perm_b32 v4, v50, v48, s24
    v_accvgpr_write_b32 a32, v4
    v_perm_b32 v5, v54, v52, s24
    v_accvgpr_write_b32 a33, v5
    v_perm_b32 v4, v58, v56, s24
    v_accvgpr_write_b32 a34, v4
    v_perm_b32 v5, v62, v60, s24
    v_accvgpr_write_b32 a35, v5
    v_perm_b32 v4, v50, v48, s25
    v_accvgpr_write_b32 a36, v4
    v_perm_b32 v5, v54, v52, s25
    v_accvgpr_write_b32 a37, v5
    v_perm_b32 v4, v58, v56, s25
    v_accvgpr_write_b32 a38, v4
    v_perm_b32 v5, v62, v60, s25
    v_accvgpr_write_b32 a39, v5
    v_perm_b32 v4, v51, v49, s24
    v_accvgpr_write_b32 a40, v4
    v_perm_b32 v5, v55, v53, s24
    v_accvgpr_write_b32 a41, v5
    v_perm_b32 v4, v59, v57, s24
    v_accvgpr_write_b32 a42, v4
    v_perm_b32 v5, v63, v61, s24
    v_accvgpr_write_b32 a43, v5
    v_perm_b32 v4, v51, v49, s25
    v_accvgpr_write_b32 a44, v4
    v_perm_b32 v5, v55, v53, s25
    v_accvgpr_write_b32 a45, v5
    v_perm_b32 v4, v59, v57, s25
    v_accvgpr_write_b32 a46, v4
    v_perm_b32 v5, v63, v61, s25
    v_accvgpr_write_b32 a47, v5
    buffer_load_dwordx2 v[48:49], v2, s[8:11], s26 offen
    s_add_u32 s26, s26, 0x500
    buffer_load_dwordx2 v[50:51], v2, s[8:11], s26 offen
    s_add_u32 s26, s26, 0x500
    buffer_load_dwordx2 v[52:53], v2, s[8:11], s26 offen
    s_add_u32 s26, s26, 0x500
    buffer_load_dwordx2 v[54:55], v2, s[8:11], s26 offen
    s_add_u32 s26, s26, 0x500
    buffer_load_dwordx2 v[56:57], v2, s[8:11], s26 offen
    s_add_u32 s26, s26, 0x500
    buffer_load_dwordx2 v[58:59], v2, s[8:11], s26 offen
    s_add_u32 s26, s26, 0x500
    buffer_load_dwordx2 v[60:61], v2, s[8:11], s26 offen
    s_add_u32 s26, s26, 0x500
    buffer_load_dwordx2 v[62:63], v2, s[8:11], s26 offen
    s_add_u32 s26, s26, 0xf500
    s_waitcnt vmcnt(48)
    v_perm_b32 v4, v66, v64, s24
    v_accvgpr_write_b32 a48, v4
    v_perm_b32 v5, v70, v68, s24
    v_accvgpr_write_b32 a49, v5
    v_perm_b32 v4, v74, v72, s24
    v_accvgpr_write_b32 a50, v4
    v_perm_b32 v5, v78, v76, s24
    v_accvgpr_write_b32 a51, v5
    v_perm_b32 v4, v66, v64, s25
    v_accvgpr_write_b32 a52, v4
    v_perm_b32 v5, v70, v68, s25
    v_accvgpr_write_b32 a53, v5
    v_perm_b32 v4, v74, v72, s25
    v_accvgpr_write_b32 a54, v4
    v_perm_b32 v5, v78, v76, s25
    v_accvgpr_write_b32 a55, v5
    v_perm_b32 v4, v67, v65, s24
    v_accvgpr_write_b32 a56, v4
    v_perm_b32 v5, v71, v69, s24
    v_accvgpr_write_b32 a57, v5
    v_perm_b32 v4, v75, v73, s24
    v_accvgpr_write_b32 a58, v4
    v_perm_b32 v5, v79, v77, s24
    v_accvgpr_write_b32 a59, v5
    v_perm_b32 v4, v67, v65, s25
    v_accvgpr_write_b32 a60, v4
    v_perm_b32 v5, v71, v69, s25
    v_accvgpr_write_b32 a61, v5
    v_perm_b32 v4, v75, v73, s25
    v_accvgpr_write_b32 a62, v4
    v_perm_b32 v5, v79, v77, s25
    v_accvgpr_write_b32 a63, v5
    buffer_load_dwordx2 v[64:65], v2, s[8:11], s26 offen
    s_add_u32 s26, s26, 0x500
    buffer_load_dwordx2 v[66:67], v2, s[8:11], s26 offen
    s_add_u32 s26, s26, 0x500
    buffer_load_dwordx2 v[68:69], v2, s[8:11], s26 offen
    s_add_u32 s26, s26, 0x500
    buffer_load_dwordx2 v[70:71], v2, s[8:11], s26 offen
    s_add_u32 s26, s26, 0x500
    buffer_load_dwordx2 v[72:73], v2, s[8:11], s26 offen
    s_add_u32 s26, s26, 0x500
    buffer_load_dwordx2 v[74:75], v2, s[8:11], s26 offen
    s_add_u32 s26, s26, 0x500
    buffer_load_dwordx2 v[76:77], v2, s[8:11], s26 offen
    s_add_u32 s26, s26, 0x500
    buffer_load_dwordx2 v[78:79], v2, s[8:11], s26 offen
    s_add_u32 s26, s26, 0x500
    s_waitcnt vmcnt(48)
    v_perm_b32 v4, v82, v80, s24
    v_accvgpr_write_b32 a64, v4
    v_perm_b32 v5, v86, v84, s24
    v_accvgpr_write_b32 a65, v5
    v_perm_b32 v4, v90, v88, s24
    v_accvgpr_write_b32 a66, v4
    v_perm_b32 v5, v94, v92, s24
    v_accvgpr_write_b32 a67, v5
    v_perm_b32 v4, v82, v80, s25
    v_accvgpr_write_b32 a68, v4
    v_perm_b32 v5, v86, v84, s25
    v_accvgpr_write_b32 a69, v5
    v_perm_b32 v4, v90, v88, s25
    v_accvgpr_write_b32 a70, v4
    v_perm_b32 v5, v94, v92, s25
    v_accvgpr_write_b32 a71, v5
    v_perm_b32 v4, v83, v81, s24
    v_accvgpr_write_b32 a72, v4
    v_perm_b32 v5, v87, v85, s24
    v_accvgpr_write_b32 a73, v5
    v_perm_b32 v4, v91, v89, s24
    v_accvgpr_write_b32 a74, v4
    v_perm_b32 v5, v95, v93, s24
    v_accvgpr_write_b32 a75, v5
    v_perm_b32 v4, v83, v81, s25
    v_accvgpr_write_b32 a76, v4
    v_perm_b32 v5, v87, v85, s25
    v_accvgpr_write_b32 a77, v5
    v_perm_b32 v4, v91, v89, s25
    v_accvgpr_write_b32 a78, v4
    v_perm_b32 v5, v95, v93, s25
    v_accvgpr_write_b32 a79, v5
    buffer_load_dwordx2 v[80:81], v2, s[8:11], s26 offen
    s_add_u32 s26, s26, 0x500
    buffer_load_dwordx2 v[82:83], v2, s[8:11], s26 offen
    s_add_u32 s26, s26, 0x500
    buffer_load_dwordx2 v[84:85], v2, s[8:11], s26 offen
    s_add_u32 s26, s26, 0x500
    buffer_load_dwordx2 v[86:87], v2, s[8:11], s26 offen
    s_add_u32 s26, s26, 0x500
    buffer_load_dwordx2 v[88:89], v2, s[8:11], s26 offen
    s_add_u32 s26, s26, 0x500
    buffer_load_dwordx2 v[90:91], v2, s[8:11], s26 offen
    s_add_u32 s26, s26, 0x500
    buffer_load_dwordx2 v[92:93], v2, s[8:11], s26 offen
    s_add_u32 s26, s26, 0x500
    buffer_load_dwordx2 v[94:95], v2, s[8:11], s26 offen
    s_add_u32 s26, s26, 0xf500
    s_waitcnt vmcnt(48)
    v_perm_b32 v4, v98, v96, s24
    v_accvgpr_write_b32 a80, v4
    v_perm_b32 v5, v102, v100, s24
    v_accvgpr_write_b32 a81, v5
    v_perm_b32 v4, v106, v104, s24
    v_accvgpr_write_b32 a82, v4
    v_perm_b32 v5, v110, v108, s24
    v_accvgpr_write_b32 a83, v5
    v_perm_b32 v4, v98, v96, s25
    v_accvgpr_write_b32 a84, v4
    v_perm_b32 v5, v102, v100, s25
    v_accvgpr_write_b32 a85, v5
    v_perm_b32 v4, v106, v104, s25
    v_accvgpr_write_b32 a86, v4
    v_perm_b32 v5, v110, v108, s25
    v_accvgpr_write_b32 a87, v5
    v_perm_b32 v4, v99, v97, s24
    v_accvgpr_write_b32 a88, v4
    v_perm_b32 v5, v103, v101, s24
    v_accvgpr_write_b32 a89, v5
    v_perm_b32 v4, v107, v105, s24
    v_accvgpr_write_b32 a90, v4
    v_perm_b32 v5, v111, v109, s24
    v_accvgpr_write_b32 a91, v5
    v_perm_b32 v4, v99, v97, s25
    v_accvgpr_write_b32 a92, v4
    v_perm_b32 v5, v103, v101, s25
    v_accvgpr_write_b32 a93, v5
    v_perm_b32 v4, v107, v105, s25
    v_accvgpr_write_b32 a94, v4
    v_perm_b32 v5, v111, v109, s25
    v_accvgpr_write_b32 a95, v5
    buffer_load_dwordx2 v[96:97], v2, s[8:11], s26 offen
    s_add_u32 s26, s26, 0x500
    buffer_load_dwordx2 v[98:99], v2, s[8:11], s26 offen
    s_add_u32 s26, s26, 0x500
    buffer_load_dwordx2 v[100:101], v2, s[8:11], s26 offen
    s_add_u32 s26, s26, 0x500
    buffer_load_dwordx2 v[102:103], v2, s[8:11], s26 offen
    s_add_u32 s26, s26, 0x500
    buffer_load_dwordx2 v[104:105], v2, s[8:11], s26 offen
    s_add_u32 s26, s26, 0x500
    buffer_load_dwordx2 v[106:107], v2, s[8:11], s26 offen
    s_add_u32 s26, s26, 0x500
    buffer_load_dwordx2 v[108:109], v2, s[8:11], s26 offen
    s_add_u32 s26, s26, 0x500
    buffer_load_dwordx2 v[110:111], v2, s[8:11], s26 offen
    s_add_u32 s26, s26, 0x500
    s_waitcnt vmcnt(48)
    v_perm_b32 v4, v114, v112, s24
    v_accvgpr_write_b32 a96, v4
    v_perm_b32 v5, v118, v116, s24
    v_accvgpr_write_b32 a97, v5
    v_perm_b32 v4, v122, v120, s24
    v_accvgpr_write_b32 a98, v4
    v_perm_b32 v5, v126, v124, s24
    v_accvgpr_write_b32 a99, v5
    v_perm_b32 v4, v114, v112, s25
    v_accvgpr_write_b32 a100, v4
    v_perm_b32 v5, v118, v116, s25
    v_accvgpr_write_b32 a101, v5
    v_perm_b32 v4, v122, v120, s25
    v_accvgpr_write_b32 a102, v4
    v_perm_b32 v5, v126, v124, s25
    v_accvgpr_write_b32 a103, v5
    v_perm_b32 v4, v115, v113, s24
    v_accvgpr_write_b32 a104, v4
    v_perm_b32 v5, v119, v117, s24
    v_accvgpr_write_b32 a105, v5
    v_perm_b32 v4, v123, v121, s24
    v_accvgpr_write_b32 a106, v4
    v_perm_b32 v5, v127, v125, s24
    v_accvgpr_write_b32 a107, v5
    v_perm_b32 v4, v115, v113, s25
    v_accvgpr_write_b32 a108, v4
    v_perm_b32 v5, v119, v117, s25
    v_accvgpr_write_b32 a109, v5
    v_perm_b32 v4, v123, v121, s25
    v_accvgpr_write_b32 a110, v4
    v_perm_b32 v5, v127, v125, s25
    v_accvgpr_write_b32 a111, v5
    buffer_load_dwordx2 v[112:113], v2, s[8:11], s26 offen
    s_add_u32 s26, s26, 0x500
    buffer_load_dwordx2 v[114:115], v2, s[8:11], s26 offen
    s_add_u32 s26, s26, 0x500
    buffer_load_dwordx2 v[116:117], v2, s[8:11], s26 offen
    s_add_u32 s26, s26, 0x500
    buffer_load_dwordx2 v[118:119], v2, s[8:11], s26 offen
    s_add_u32 s26, s26, 0x500
    buffer_load_dwordx2 v[120:121], v2, s[8:11], s26 offen
    s_add_u32 s26, s26, 0x500
    buffer_load_dwordx2 v[122:123], v2, s[8:11], s26 offen
    s_add_u32 s26, s26, 0x500
    buffer_load_dwordx2 v[124:125], v2, s[8:11], s26 offen
    s_add_u32 s26, s26, 0x500
    buffer_load_dwordx2 v[126:127], v2, s[8:11], s26 offen
    s_add_u32 s26, s26, 0xf500
    s_waitcnt vmcnt(48)
    v_perm_b32 v4, v18, v16, s24
    v_accvgpr_write_b32 a112, v4
    v_perm_b32 v5, v22, v20, s24
    v_accvgpr_write_b32 a113, v5
    v_perm_b32 v4, v26, v24, s24
    v_accvgpr_write_b32 a114, v4
    v_perm_b32 v5, v30, v28, s24
    v_accvgpr_write_b32 a115, v5
    v_perm_b32 v4, v18, v16, s25
    v_accvgpr_write_b32 a116, v4
    v_perm_b32 v5, v22, v20, s25
    v_accvgpr_write_b32 a117, v5
    v_perm_b32 v4, v26, v24, s25
    v_accvgpr_write_b32 a118, v4
    v_perm_b32 v5, v30, v28, s25
    v_accvgpr_write_b32 a119, v5
    v_perm_b32 v4, v19, v17, s24
    v_accvgpr_write_b32 a120, v4
    v_perm_b32 v5, v23, v21, s24
    v_accvgpr_write_b32 a121, v5
    v_perm_b32 v4, v27, v25, s24
    v_accvgpr_write_b32 a122, v4
    v_perm_b32 v5, v31, v29, s24
    v_accvgpr_write_b32 a123, v5
    v_perm_b32 v4, v19, v17, s25
    v_accvgpr_write_b32 a124, v4
    v_perm_b32 v5, v23, v21, s25
    v_accvgpr_write_b32 a125, v5
    v_perm_b32 v4, v27, v25, s25
    v_accvgpr_write_b32 a126, v4
    v_perm_b32 v5, v31, v29, s25
    v_accvgpr_write_b32 a127, v5
    s_waitcnt vmcnt(40)
    v_perm_b32 v4, v34, v32, s24
    v_accvgpr_write_b32 a128, v4
    v_perm_b32 v5, v38, v36, s24
    v_accvgpr_write_b32 a129, v5
    v_perm_b32 v4, v42, v40, s24
    v_accvgpr_write_b32 a130, v4
    v_perm_b32 v5, v46, v44, s24
    v_accvgpr_write_b32 a131, v5
    v_perm_b32 v4, v34, v32, s25
    v_accvgpr_write_b32 a132, v4
    v_perm_b32 v5, v38, v36, s25
    v_accvgpr_write_b32 a133, v5
    v_perm_b32 v4, v42, v40, s25
    v_accvgpr_write_b32 a134, v4
    v_perm_b32 v5, v46, v44, s25
    v_accvgpr_write_b32 a135, v5
    v_perm_b32 v4, v35, v33, s24
    v_accvgpr_write_b32 a136, v4
    v_perm_b32 v5, v39, v37, s24
    v_accvgpr_write_b32 a137, v5
    v_perm_b32 v4, v43, v41, s24
    v_accvgpr_write_b32 a138, v4
    v_perm_b32 v5, v47, v45, s24
    v_accvgpr_write_b32 a139, v5
    v_perm_b32 v4, v35, v33, s25
    v_accvgpr_write_b32 a140, v4
    v_perm_b32 v5, v39, v37, s25
    v_accvgpr_write_b32 a141, v5
    v_perm_b32 v4, v43, v41, s25
    v_accvgpr_write_b32 a142, v4
    v_perm_b32 v5, v47, v45, s25
    v_accvgpr_write_b32 a143, v5
    s_waitcnt vmcnt(32)
    v_perm_b32 v4, v50, v48, s24
    v_accvgpr_write_b32 a144, v4
    v_perm_b32 v5, v54, v52, s24
    v_accvgpr_write_b32 a145, v5
    v_perm_b32 v4, v58, v56, s24
    v_accvgpr_write_b32 a146, v4
    v_perm_b32 v5, v62, v60, s24
    v_accvgpr_write_b32 a147, v5
    v_perm_b32 v4, v50, v48, s25
    v_accvgpr_write_b32 a148, v4
    v_perm_b32 v5, v54, v52, s25
    v_accvgpr_write_b32 a149, v5
    v_perm_b32 v4, v58, v56, s25
    v_accvgpr_write_b32 a150, v4
    v_perm_b32 v5, v62, v60, s25
    v_accvgpr_write_b32 a151, v5
    v_perm_b32 v4, v51, v49, s24
    v_accvgpr_write_b32 a152, v4
    v_perm_b32 v5, v55, v53, s24
    v_accvgpr_write_b32 a153, v5
    v_perm_b32 v4, v59, v57, s24
    v_accvgpr_write_b32 a154, v4
    v_perm_b32 v5, v63, v61, s24
    v_accvgpr_write_b32 a155, v5
    v_perm_b32 v4, v51, v49, s25
    v_accvgpr_write_b32 a156, v4
    v_perm_b32 v5, v55, v53, s25
    v_accvgpr_write_b32 a157, v5
    v_perm_b32 v4, v59, v57, s25
    v_accvgpr_write_b32 a158, v4
    v_perm_b32 v5, v63, v61, s25
    v_accvgpr_write_b32 a159, v5
    s_waitcnt vmcnt(24)
    v_perm_b32 v4, v66, v64, s24
    v_accvgpr_write_b32 a160, v4
    v_perm_b32 v5, v70, v68, s24
    v_accvgpr_write_b32 a161, v5
    v_perm_b32 v4, v74, v72, s24
    v_accvgpr_write_b32 a162, v4
    v_perm_b32 v5, v78, v76, s24
    v_accvgpr_write_b32 a163, v5
    v_perm_b32 v4, v66, v64, s25
    v_accvgpr_write_b32 a164, v4
    v_perm_b32 v5, v70, v68, s25
    v_accvgpr_write_b32 a165, v5
    v_perm_b32 v4, v74, v72, s25
    v_accvgpr_write_b32 a166, v4
    v_perm_b32 v5, v78, v76, s25
    v_accvgpr_write_b32 a167, v5
    v_perm_b32 v4, v67, v65, s24
    v_accvgpr_write_b32 a168, v4
    v_perm_b32 v5, v71, v69, s24
    v_accvgpr_write_b32 a169, v5
    v_perm_b32 v4, v75, v73, s24
    v_accvgpr_write_b32 a170, v4
    v_perm_b32 v5, v79, v77, s24
    v_accvgpr_write_b32 a171, v5
    v_perm_b32 v4, v67, v65, s25
    v_accvgpr_write_b32 a172, v4
    v_perm_b32 v5, v71, v69, s25
    v_accvgpr_write_b32 a173, v5
    v_perm_b32 v4, v75, v73, s25
    v_accvgpr_write_b32 a174, v4
    v_perm_b32 v5, v79, v77, s25
    v_accvgpr_write_b32 a175, v5
    s_waitcnt vmcnt(16)
    v_perm_b32 v4, v82, v80, s24
    v_accvgpr_write_b32 a176, v4
    v_perm_b32 v5, v86, v84, s24
    v_accvgpr_write_b32 a177, v5
    v_perm_b32 v4, v90, v88, s24
    v_accvgpr_write_b32 a178, v4
    v_perm_b32 v5, v94, v92, s24
    v_accvgpr_write_b32 a179, v5
    v_perm_b32 v4, v82, v80, s25
    v_accvgpr_write_b32 a180, v4
    v_perm_b32 v5, v86, v84, s25
    v_accvgpr_write_b32 a181, v5
    v_perm_b32 v4, v90, v88, s25
    v_accvgpr_write_b32 a182, v4
    v_perm_b32 v5, v94, v92, s25
    v_accvgpr_write_b32 a183, v5
    v_perm_b32 v4, v83, v81, s24
    v_accvgpr_write_b32 a184, v4
    v_perm_b32 v5, v87, v85, s24
    v_accvgpr_write_b32 a185, v5
    v_perm_b32 v4, v91, v89, s24
    v_accvgpr_write_b32 a186, v4
    v_perm_b32 v5, v95, v93, s24
    v_accvgpr_write_b32 a187, v5
    v_perm_b32 v4, v83, v81, s25
    v_accvgpr_write_b32 a188, v4
    v_perm_b32 v5, v87, v85, s25
    v_accvgpr_write_b32 a189, v5
    v_perm_b32 v4, v91, v89, s25
    v_accvgpr_write_b32 a190, v4
    v_perm_b32 v5, v95, v93, s25
    v_accvgpr_write_b32 a191, v5
    s_waitcnt vmcnt(8)
    v_perm_b32 v4, v98, v96, s24
    v_accvgpr_write_b32 a192, v4
    v_perm_b32 v5, v102, v100, s24
    v_accvgpr_write_b32 a193, v5
    v_perm_b32 v4, v106, v104, s24
    v_accvgpr_write_b32 a194, v4
    v_perm_b32 v5, v110, v108, s24
    v_accvgpr_write_b32 a195, v5
    v_perm_b32 v4, v98, v96, s25
    v_accvgpr_write_b32 a196, v4
    v_perm_b32 v5, v102, v100, s25
    v_accvgpr_write_b32 a197, v5
    v_perm_b32 v4, v106, v104, s25
    v_accvgpr_write_b32 a198, v4
    v_perm_b32 v5, v110, v108, s25
    v_accvgpr_write_b32 a199, v5
    v_perm_b32 v4, v99, v97, s24
    v_accvgpr_write_b32 a200, v4
    v_perm_b32 v5, v103, v101, s24
    v_accvgpr_write_b32 a201, v5
    v_perm_b32 v4, v107, v105, s24
    v_accvgpr_write_b32 a202, v4
    v_perm_b32 v5, v111, v109, s24
    v_accvgpr_write_b32 a203, v5
    v_perm_b32 v4, v99, v97, s25
    v_accvgpr_write_b32 a204, v4
    v_perm_b32 v5, v103, v101, s25
    v_accvgpr_write_b32 a205, v5
    v_perm_b32 v4, v107, v105, s25
    v_accvgpr_write_b32 a206, v4
    v_perm_b32 v5, v111, v109, s25
    v_accvgpr_write_b32 a207, v5
    s_waitcnt vmcnt(0)
    v_perm_b32 v4, v114, v112, s24
    v_accvgpr_write_b32 a208, v4
    v_perm_b32 v5, v118, v116, s24
    v_accvgpr_write_b32 a209, v5
    v_perm_b32 v4, v122, v120, s24
    v_accvgpr_write_b32 a210, v4
    v_perm_b32 v5, v126, v124, s24
    v_accvgpr_write_b32 a211, v5
    v_perm_b32 v4, v114, v112, s25
    v_accvgpr_write_b32 a212, v4
    v_perm_b32 v5, v118, v116, s25
    v_accvgpr_write_b32 a213, v5
    v_perm_b32 v4, v122, v120, s25
    v_accvgpr_write_b32 a214, v4
    v_perm_b32 v5, v126, v124, s25
    v_accvgpr_write_b32 a215, v5
    v_perm_b32 v4, v115, v113, s24
    v_accvgpr_write_b32 a216, v4
    v_perm_b32 v5, v119, v117, s24
    v_accvgpr_write_b32 a217, v5
    v_perm_b32 v4, v123, v121, s24
    v_accvgpr_write_b32 a218, v4
    v_perm_b32 v5, v127, v125, s24
    v_accvgpr_write_b32 a219, v5
    v_perm_b32 v4, v115, v113, s25
    v_accvgpr_write_b32 a220, v4
    v_perm_b32 v5, v119, v117, s25
    v_accvgpr_write_b32 a221, v5
    v_perm_b32 v4, v123, v121, s25
    v_accvgpr_write_b32 a222, v4
    v_perm_b32 v5, v127, v125, s25
    v_accvgpr_write_b32 a223, v5
    s_mov_b32 s30, s21
    s_cmp_eq_u32 s23, 3
    s_cselect_b32 s31, 0x40000000, 0
    s_lshl_b32 s25, s23, 13
    v_add_u32 v3, s25, v1
    s_lshr_b32 s25, s23, 1
    s_lshl_b32 s25, s25, 12
    s_and_b32 s26, s23, 1
    s_lshl_b32 s26, s26, 3
    s_add_u32 s25, s25, s26
    v_add_u32 v4, s25, v1
    v_bfe_u32 v5, v0, 0, 4
    v_mul_u32_u24 v5, 1280, v5
    v_bfe_u32 v6, v0, 4, 2
    v_lshl_add_u32 v5, v6, 5, v5
    s_mov_b32 s33, 0
KS_117:
    s_cmp_lg_u32 s23, 0
    s_cbranch_scc1 FW_119
    s_mov_b32 s53, 0
FW_120:
    buffer_load_dword v255, off, s[48:51], s57 sc1
    s_add_u32 s53, s53, 1
    s_cmp_gt_u32 s53, 0x20000
    s_cbranch_scc1 FW_121
    s_waitcnt vmcnt(0)
    v_readfirstlane_b32 s54, v255
    s_cmp_lg_u32 s54, 7
    s_cbranch_scc1 FW_120
FW_121:
FW_119:
    s_barrier
    s_add_u32 s27, s30, 0
    buffer_load_dwordx4 v[16:19], v1, s[12:15], s27 offen offset:0 sc1
    s_add_u32 s27, s30, 0
    buffer_load_dwordx4 v[20:23], v1, s[12:15], s27 offen offset:1024 sc1
    s_add_u32 s27, s30, 0
    buffer_load_dwordx4 v[24:27], v1, s[12:15], s27 offen offset:2048 sc1
    s_add_u32 s27, s30, 0
    buffer_load_dwordx4 v[28:31], v1, s[12:15], s27 offen offset:3072 sc1
    s_add_u32 s27, s30, 4096
    buffer_load_dwordx4 v[32:35], v1, s[12:15], s27 offen offset:0 sc1
    s_add_u32 s27, s30, 4096
    buffer_load_dwordx4 v[36:39], v1, s[12:15], s27 offen offset:1024 sc1
    s_add_u32 s27, s30, 4096
    buffer_load_dwordx4 v[40:43], v1, s[12:15], s27 offen offset:2048 sc1
    s_add_u32 s27, s30, 4096
    buffer_load_dwordx4 v[44:47], v1, s[12:15], s27 offen offset:3072 sc1
    s_add_u32 s27, s30, 8192
    buffer_load_dwordx4 v[48:51], v1, s[12:15], s27 offen offset:0 sc1
    s_add_u32 s27, s30, 8192
    buffer_load_dwordx4 v[52:55], v1, s[12:15], s27 offen offset:1024 sc1
    s_add_u32 s27, s30, 8192
    buffer_load_dwordx4 v[56:59], v1, s[12:15], s27 offen offset:2048 sc1
    s_add_u32 s27, s30, 8192
    buffer_load_dwordx4 v[60:63], v1, s[12:15], s27 offen offset:3072 sc1
    s_add_u32 s27, s30, 12288
    s_add_u32 s27, s27, s31
    buffer_load_dwordx4 v[64:67], v1, s[12:15], s27 offen offset:0 sc1
    s_add_u32 s27, s30, 12288
    s_add_u32 s27, s27, s31
    buffer_load_dwordx4 v[68:71], v1, s[12:15], s27 offen offset:1024 sc1
    s_add_u32 s27, s30, 53248
    buffer_load_dwordx4 v[72:75], v1, s[12:15], s27 offen offset:2048 sc1
    s_add_u32 s27, s30, 53248
    buffer_load_dwordx4 v[76:79], v1, s[12:15], s27 offen offset:3072 sc1
    s_add_u32 s27, s30, 57344
    buffer_load_dwordx4 v[80:83], v1, s[12:15], s27 offen offset:0 sc1
    s_add_u32 s27, s30, 57344
    buffer_load_dwordx4 v[84:87], v1, s[12:15], s27 offen offset:1024 sc1
    s_add_u32 s27, s30, 57344
    buffer_load_dwordx4 v[88:91], v1, s[12:15], s27 offen offset:2048 sc1
    s_add_u32 s27, s30, 57344
    buffer_load_dwordx4 v[92:95], v1, s[12:15], s27 offen offset:3072 sc1
    s_add_u32 s27, s30, 61440
    buffer_load_dwordx4 v[96:99], v1, s[12:15], s27 offen offset:0 sc1
    s_add_u32 s27, s30, 61440
    buffer_load_dwordx4 v[100:103], v1, s[12:15], s27 offen offset:1024 sc1
    s_add_u32 s27, s30, 61440
    buffer_load_dwordx4 v[104:107], v1, s[12:15], s27 offen offset:2048 sc1
    s_add_u32 s27, s30, 61440
    buffer_load_dwordx4 v[108:111], v1, s[12:15], s27 offen offset:3072 sc1
    s_add_u32 s27, s30, 65536
    buffer_load_dwordx4 v[112:115], v1, s[12:15], s27 offen offset:0 sc1
    s_add_u32 s27, s30, 65536
    buffer_load_dwordx4 v[116:119], v1, s[12:15], s27 offen offset:1024 sc1
    s_add_u32 s27, s30, 65536
    s_add_u32 s27, s27, s31
    buffer_load_dwordx4 v[120:123], v1, s[12:15], s27 offen offset:2048 sc1
    s_add_u32 s27, s30, 65536
    s_add_u32 s27, s27, s31
    buffer_load_dwordx4 v[124:127], v1, s[12:15], s27 offen offset:3072 sc1
    s_add_u32 s30, s30, 442368
    buffer_load_dwordx4 v[8:11], v1, s[40:43], s44 offen sc1
    s_waitcnt vmcnt(28)
    v_mfma_f32_16x16x32_bf16 v[144:147], a[0:3], v[16:19], 0
    v_mfma_f32_16x16x32_bf16 v[148:151], a[4:7], v[16:19], 0
    v_mfma_f32_16x16x32_bf16 v[152:155], a[8:11], v[16:19], 0
    v_mfma_f32_16x16x32_bf16 v[156:159], a[12:15], v[16:19], 0
    s_waitcnt vmcnt(27)
    v_mfma_f32_16x16x32_bf16 v[144:147], a[16:19], v[20:23], v[144:147]
    v_mfma_f32_16x16x32_bf16 v[148:151], a[20:23], v[20:23], v[148:151]
    v_mfma_f32_16x16x32_bf16 v[152:155], a[24:27], v[20:23], v[152:155]
    v_mfma_f32_16x16x32_bf16 v[156:159], a[28:31], v[20:23], v[156:159]
    s_waitcnt vmcnt(26)
    v_mfma_f32_16x16x32_bf16 v[144:147], a[32:35], v[24:27], v[144:147]
    v_mfma_f32_16x16x32_bf16 v[148:151], a[36:39], v[24:27], v[148:151]
    v_mfma_f32_16x16x32_bf16 v[152:155], a[40:43], v[24:27], v[152:155]
    v_mfma_f32_16x16x32_bf16 v[156:159], a[44:47], v[24:27], v[156:159]
    s_waitcnt vmcnt(25)
    v_mfma_f32_16x16x32_bf16 v[144:147], a[48:51], v[28:31], v[144:147]
    v_mfma_f32_16x16x32_bf16 v[148:151], a[52:55], v[28:31], v[148:151]
    v_mfma_f32_16x16x32_bf16 v[152:155], a[56:59], v[28:31], v[152:155]
    v_mfma_f32_16x16x32_bf16 v[156:159], a[60:63], v[28:31], v[156:159]
    s_waitcnt vmcnt(24)
    v_mfma_f32_16x16x32_bf16 v[144:147], a[64:67], v[32:35], v[144:147]
    v_mfma_f32_16x16x32_bf16 v[148:151], a[68:71], v[32:35], v[148:151]
    v_mfma_f32_16x16x32_bf16 v[152:155], a[72:75], v[32:35], v[152:155]
    v_mfma_f32_16x16x32_bf16 v[156:159], a[76:79], v[32:35], v[156:159]
    s_waitcnt vmcnt(23)
    v_mfma_f32_16x16x32_bf16 v[144:147], a[80:83], v[36:39], v[144:147]
    v_mfma_f32_16x16x32_bf16 v[148:151], a[84:87], v[36:39], v[148:151]
    v_mfma_f32_16x16x32_bf16 v[152:155], a[88:91], v[36:39], v[152:155]
    v_mfma_f32_16x16x32_bf16 v[156:159], a[92:95], v[36:39], v[156:159]
    s_waitcnt vmcnt(22)
    v_mfma_f32_16x16x32_bf16 v[144:147], a[96:99], v[40:43], v[144:147]
    v_mfma_f32_16x16x32_bf16 v[148:151], a[100:103], v[40:43], v[148:151]
    v_mfma_f32_16x16x32_bf16 v[152:155], a[104:107], v[40:43], v[152:155]
    v_mfma_f32_16x16x32_bf16 v[156:159], a[108:111], v[40:43], v[156:159]
    s_waitcnt vmcnt(21)
    v_mfma_f32_16x16x32_bf16 v[144:147], a[112:115], v[44:47], v[144:147]
    v_mfma_f32_16x16x32_bf16 v[148:151], a[116:119], v[44:47], v[148:151]
    v_mfma_f32_16x16x32_bf16 v[152:155], a[120:123], v[44:47], v[152:155]
    v_mfma_f32_16x16x32_bf16 v[156:159], a[124:127], v[44:47], v[156:159]
    s_waitcnt vmcnt(20)
    v_mfma_f32_16x16x32_bf16 v[144:147], a[128:131], v[48:51], v[144:147]
    v_mfma_f32_16x16x32_bf16 v[148:151], a[132:135], v[48:51], v[148:151]
    v_mfma_f32_16x16x32_bf16 v[152:155], a[136:139], v[48:51], v[152:155]
    v_mfma_f32_16x16x32_bf16 v[156:159], a[140:143], v[48:51], v[156:159]
    s_waitcnt vmcnt(19)
    v_mfma_f32_16x16x32_bf16 v[144:147], a[144:147], v[52:55], v[144:147]
    v_mfma_f32_16x16x32_bf16 v[148:151], a[148:151], v[52:55], v[148:151]
    v_mfma_f32_16x16x32_bf16 v[152:155], a[152:155], v[52:55], v[152:155]
    v_mfma_f32_16x16x32_bf16 v[156:159], a[156:159], v[52:55], v[156:159]
    s_waitcnt vmcnt(18)
    v_mfma_f32_16x16x32_bf16 v[144:147], a[160:163], v[56:59], v[144:147]
    v_mfma_f32_16x16x32_bf16 v[148:151], a[164:167], v[56:59], v[148:151]
    v_mfma_f32_16x16x32_bf16 v[152:155], a[168:171], v[56:59], v[152:155]
    v_mfma_f32_16x16x32_bf16 v[156:159], a[172:175], v[56:59], v[156:159]
    s_waitcnt vmcnt(17)
    v_mfma_f32_16x16x32_bf16 v[144:147], a[176:179], v[60:63], v[144:147]
    v_mfma_f32_16x16x32_bf16 v[148:151], a[180:183], v[60:63], v[148:151]
    v_mfma_f32_16x16x32_bf16 v[152:155], a[184:187], v[60:63], v[152:155]
    v_mfma_f32_16x16x32_bf16 v[156:159], a[188:191], v[60:63], v[156:159]
    s_waitcnt vmcnt(16)
    v_mfma_f32_16x16x32_bf16 v[144:147], a[192:195], v[64:67], v[144:147]
    v_mfma_f32_16x16x32_bf16 v[148:151], a[196:199], v[64:67], v[148:151]
    v_mfma_f32_16x16x32_bf16 v[152:155], a[200:203], v[64:67], v[152:155]
    v_mfma_f32_16x16x32_bf16 v[156:159], a[204:207], v[64:67], v[156:159]
    s_waitcnt vmcnt(15)
    v_mfma_f32_16x16x32_bf16 v[144:147], a[208:211], v[68:71], v[144:147]
    v_mfma_f32_16x16x32_bf16 v[148:151], a[212:215], v[68:71], v[148:151]
    v_mfma_f32_16x16x32_bf16 v[152:155], a[216:219], v[68:71], v[152:155]
    v_mfma_f32_16x16x32_bf16 v[156:159], a[220:223], v[68:71], v[156:159]
    s_waitcnt vmcnt(14)
    v_mfma_f32_16x16x32_bf16 v[160:163], a[0:3], v[72:75], 0
    v_mfma_f32_16x16x32_bf16 v[164:167], a[4:7], v[72:75], 0
    v_mfma_f32_16x16x32_bf16 v[168:171], a[8:11], v[72:75], 0
    v_mfma_f32_16x16x32_bf16 v[172:175], a[12:15], v[72:75], 0
    s_waitcnt vmcnt(13)
    v_mfma_f32_16x16x32_bf16 v[160:163], a[16:19], v[76:79], v[160:163]
    v_mfma_f32_16x16x32_bf16 v[164:167], a[20:23], v[76:79], v[164:167]
    v_mfma_f32_16x16x32_bf16 v[168:171], a[24:27], v[76:79], v[168:171]
    v_mfma_f32_16x16x32_bf16 v[172:175], a[28:31], v[76:79], v[172:175]
    s_waitcnt vmcnt(12)
    v_mfma_f32_16x16x32_bf16 v[160:163], a[32:35], v[80:83], v[160:163]
    v_mfma_f32_16x16x32_bf16 v[164:167], a[36:39], v[80:83], v[164:167]
    v_mfma_f32_16x16x32_bf16 v[168:171], a[40:43], v[80:83], v[168:171]
    v_mfma_f32_16x16x32_bf16 v[172:175], a[44:47], v[80:83], v[172:175]
    s_waitcnt vmcnt(11)
    v_mfma_f32_16x16x32_bf16 v[160:163], a[48:51], v[84:87], v[160:163]
    v_mfma_f32_16x16x32_bf16 v[164:167], a[52:55], v[84:87], v[164:167]
    v_mfma_f32_16x16x32_bf16 v[168:171], a[56:59], v[84:87], v[168:171]
    v_mfma_f32_16x16x32_bf16 v[172:175], a[60:63], v[84:87], v[172:175]
    s_waitcnt vmcnt(10)
    v_mfma_f32_16x16x32_bf16 v[160:163], a[64:67], v[88:91], v[160:163]
    v_mfma_f32_16x16x32_bf16 v[164:167], a[68:71], v[88:91], v[164:167]
    v_mfma_f32_16x16x32_bf16 v[168:171], a[72:75], v[88:91], v[168:171]
    v_mfma_f32_16x16x32_bf16 v[172:175], a[76:79], v[88:91], v[172:175]
    s_waitcnt vmcnt(9)
    v_mfma_f32_16x16x32_bf16 v[160:163], a[80:83], v[92:95], v[160:163]
    v_mfma_f32_16x16x32_bf16 v[164:167], a[84:87], v[92:95], v[164:167]
    v_mfma_f32_16x16x32_bf16 v[168:171], a[88:91], v[92:95], v[168:171]
    v_mfma_f32_16x16x32_bf16 v[172:175], a[92:95], v[92:95], v[172:175]
    s_waitcnt vmcnt(8)
    v_mfma_f32_16x16x32_bf16 v[160:163], a[96:99], v[96:99], v[160:163]
    v_mfma_f32_16x16x32_bf16 v[164:167], a[100:103], v[96:99], v[164:167]
    v_mfma_f32_16x16x32_bf16 v[168:171], a[104:107], v[96:99], v[168:171]
    v_mfma_f32_16x16x32_bf16 v[172:175], a[108:111], v[96:99], v[172:175]
    s_waitcnt vmcnt(7)
    v_mfma_f32_16x16x32_bf16 v[160:163], a[112:115], v[100:103], v[160:163]
    v_mfma_f32_16x16x32_bf16 v[164:167], a[116:119], v[100:103], v[164:167]
    v_mfma_f32_16x16x32_bf16 v[168:171], a[120:123], v[100:103], v[168:171]
    v_mfma_f32_16x16x32_bf16 v[172:175], a[124:127], v[100:103], v[172:175]
    s_waitcnt vmcnt(6)
    v_mfma_f32_16x16x32_bf16 v[160:163], a[128:131], v[104:107], v[160:163]
    v_mfma_f32_16x16x32_bf16 v[164:167], a[132:135], v[104:107], v[164:167]
    v_mfma_f32_16x16x32_bf16 v[168:171], a[136:139], v[104:107], v[168:171]
    v_mfma_f32_16x16x32_bf16 v[172:175], a[140:143], v[104:107], v[172:175]
    s_waitcnt vmcnt(5)
    v_mfma_f32_16x16x32_bf16 v[160:163], a[144:147], v[108:111], v[160:163]
    v_mfma_f32_16x16x32_bf16 v[164:167], a[148:151], v[108:111], v[164:167]
    v_mfma_f32_16x16x32_bf16 v[168:171], a[152:155], v[108:111], v[168:171]
    v_mfma_f32_16x16x32_bf16 v[172:175], a[156:159], v[108:111], v[172:175]
    s_waitcnt vmcnt(4)
    v_mfma_f32_16x16x32_bf16 v[160:163], a[160:163], v[112:115], v[160:163]
    v_mfma_f32_16x16x32_bf16 v[164:167], a[164:167], v[112:115], v[164:167]
    v_mfma_f32_16x16x32_bf16 v[168:171], a[168:171], v[112:115], v[168:171]
    v_mfma_f32_16x16x32_bf16 v[172:175], a[172:175], v[112:115], v[172:175]
    s_waitcnt vmcnt(3)
    v_mfma_f32_16x16x32_bf16 v[160:163], a[176:179], v[116:119], v[160:163]
    v_mfma_f32_16x16x32_bf16 v[164:167], a[180:183], v[116:119], v[164:167]
    v_mfma_f32_16x16x32_bf16 v[168:171], a[184:187], v[116:119], v[168:171]
    v_mfma_f32_16x16x32_bf16 v[172:175], a[188:191], v[116:119], v[172:175]
    s_waitcnt vmcnt(2)
    v_mfma_f32_16x16x32_bf16 v[160:163], a[192:195], v[120:123], v[160:163]
    v_mfma_f32_16x16x32_bf16 v[164:167], a[196:199], v[120:123], v[164:167]
    v_mfma_f32_16x16x32_bf16 v[168:171], a[200:203], v[120:123], v[168:171]
    v_mfma_f32_16x16x32_bf16 v[172:175], a[204:207], v[120:123], v[172:175]
    s_waitcnt vmcnt(1)
    v_mfma_f32_16x16x32_bf16 v[160:163], a[208:211], v[124:127], v[160:163]
    v_mfma_f32_16x16x32_bf16 v[164:167], a[212:215], v[124:127], v[164:167]
    v_mfma_f32_16x16x32_bf16 v[168:171], a[216:219], v[124:127], v[168:171]
    v_mfma_f32_16x16x32_bf16 v[172:175], a[220:223], v[124:127], v[172:175]
    s_nop 7
    ds_write_b128 v3, v[144:147] offset:0
    ds_write_b128 v3, v[148:151] offset:1024
    ds_write_b128 v3, v[152:155] offset:2048
    ds_write_b128 v3, v[156:159] offset:3072
    ds_write_b128 v3, v[160:163] offset:4096
    ds_write_b128 v3, v[164:167] offset:5120
    ds_write_b128 v3, v[168:171] offset:6144
    ds_write_b128 v3, v[172:175] offset:7168
    s_waitcnt vmcnt(0) lgkmcnt(0)
    s_barrier
    ds_read_b64 v[208:209], v4 offset:0
    ds_read_b64 v[210:211], v4 offset:1024
    ds_read_b64 v[212:213], v4 offset:2048
    ds_read_b64 v[214:215], v4 offset:3072
    ds_read_b64 v[216:217], v4 offset:8192
    ds_read_b64 v[218:219], v4 offset:9216
    ds_read_b64 v[220:221], v4 offset:10240
    ds_read_b64 v[222:223], v4 offset:11264
    ds_read_b64 v[224:225], v4 offset:16384
    ds_read_b64 v[226:227], v4 offset:17408
    ds_read_b64 v[228:229], v4 offset:18432
    ds_read_b64 v[230:231], v4 offset:19456
    ds_read_b64 v[232:233], v4 offset:24576
    ds_read_b64 v[234:235], v4 offset:25600
    ds_read_b64 v[236:237], v4 offset:26624
    ds_read_b64 v[238:239], v4 offset:27648
    s_waitcnt lgkmcnt(0)
    v_add_f32 v208, v208, v216
    v_add_f32 v209, v209, v217
    v_add_f32 v210, v210, v218
    v_add_f32 v211, v211, v219
    v_add_f32 v212, v212, v220
    v_add_f32 v213, v213, v221
    v_add_f32 v214, v214, v222
    v_add_f32 v215, v215, v223
    v_add_f32 v224, v224, v232
    v_add_f32 v225, v225, v233
    v_add_f32 v226, v226, v234
    v_add_f32 v227, v227, v235
    v_add_f32 v228, v228, v236
    v_add_f32 v229, v229, v237
    v_add_f32 v230, v230, v238
    v_add_f32 v231, v231, v239
    v_add_f32 v216, v208, v224
    v_add_f32 v220, v209, v225
    v_add_f32 v217, v210, v226
    v_add_f32 v221, v211, v227
    v_add_f32 v218, v212, v228
    v_add_f32 v222, v213, v229
    v_add_f32 v219, v214, v230
    v_add_f32 v223, v215, v231
    s_waitcnt vmcnt(8)
    v_cvt_pk_bf16_f32 v216, v216, v217
    v_lshlrev_b32 v208, 16, v8
    v_and_b32 v209, 0xffff0000, v8
    v_and_b32 v217, 0xffff0000, v216
    v_lshlrev_b32 v216, 16, v216
    v_add_f32 v216, v216, v208
    v_add_f32 v217, v217, v209
    v_cvt_pk_bf16_f32 v12, v216, v217
    v_cvt_pk_bf16_f32 v218, v218, v219
    v_lshlrev_b32 v208, 16, v9
    v_and_b32 v209, 0xffff0000, v9
    v_and_b32 v219, 0xffff0000, v218
    v_lshlrev_b32 v218, 16, v218
    v_add_f32 v218, v218, v208
    v_add_f32 v219, v219, v209
    v_cvt_pk_bf16_f32 v13, v218, v219
    v_cvt_pk_bf16_f32 v220, v220, v221
    v_lshlrev_b32 v208, 16, v10
    v_and_b32 v209, 0xffff0000, v10
    v_and_b32 v221, 0xffff0000, v220
    v_lshlrev_b32 v220, 16, v220
    v_add_f32 v220, v220, v208
    v_add_f32 v221, v221, v209
    v_cvt_pk_bf16_f32 v14, v220, v221
    v_cvt_pk_bf16_f32 v222, v222, v223
    v_lshlrev_b32 v208, 16, v11
    v_and_b32 v209, 0xffff0000, v11
    v_and_b32 v223, 0xffff0000, v222
    v_lshlrev_b32 v222, 16, v222
    v_add_f32 v222, v222, v208
    v_add_f32 v223, v223, v209
    v_cvt_pk_bf16_f32 v15, v222, v223
    buffer_store_dwordx4 v[12:15], v5, s[16:19], s22 offen
    s_add_u32 s22, s22, 163840
    s_add_u32 s44, s44, 163840
    s_add_u32 s57, s57, 512
    s_add_u32 s52, s52, 4
    s_cmp_lt_u32 s52, 64
    s_cbranch_scc1 KS_117
    s_waitcnt vmcnt(0)
    s_branch RW_13
RW_116:
    s_sub_u32 s2, s2, 40
    s_endpgm
.section .rodata,"a"
.p2align 6
.amdhsa_kernel prep_kernel
  .amdhsa_next_free_vgpr 72
  .amdhsa_next_free_sgpr 102
  .amdhsa_accum_offset 72
  .amdhsa_group_segment_fixed_size 0
  .amdhsa_kernarg_size 104
  .amdhsa_user_sgpr_count 2
  .amdhsa_user_sgpr_kernarg_segment_ptr 1
  .amdhsa_system_sgpr_workgroup_id_x 1
.end_amdhsa_kernel
.p2align 6
.amdhsa_kernel rec_kernel
  .amdhsa_next_free_vgpr 512
  .amdhsa_next_free_sgpr 102
  .amdhsa_accum_offset 256
  .amdhsa_group_segment_fixed_size 0
  .amdhsa_kernarg_size 104
  .amdhsa_user_sgpr_count 2
  .amdhsa_user_sgpr_kernarg_segment_ptr 1
  .amdhsa_system_sgpr_workgroup_id_x 1
.end_amdhsa_kernel
```
